```python
import torch

def _softmax(x, axis=-1):
    return torch.softmax(x, dim=axis)
def _gelu(x):
    return torch.nn.functional.gelu(x, approximate="tanh")
def _silu(x):
    return torch.nn.functional.silu(x)
def _sigmoid(x):
    return torch.sigmoid(x)
def _layernorm(x, axis=-1, eps=1e-5):
    m = x.mean(dim=axis, keepdim=True)
    v = x.var(dim=axis, keepdim=True, unbiased=False)
    return (x - m) / torch.sqrt(v + eps)
def _scatter_add(tgt, idx, src, axis=0):
    return tgt.clone().index_add_(axis, idx, src)
def _segment_sum(src, seg, n):
    out = torch.zeros((n,) + src.shape[1:], dtype=src.dtype)
    return out.index_add_(0, seg, src)
def _pad(x, pw):
    flat = tuple(v for pair in reversed(pw) for v in pair)
    return torch.nn.functional.pad(x, flat)

kernel_name = 'standalone__gqa_block_cached__near_ridge'

def setup_inputs():

    _w = (lambda a: (lambda t: t.to(torch.bfloat16) if t.is_floating_point() else t)(torch.as_tensor(a)))
    B, Sq, D = 8, 112, 448
    Hq, Hkv, Sk, Dh = 16, 8, 512, 256
    assert Hq % Hkv == 0, (Hq, Hkv)
    return {
        "x": _w((lambda *s: torch.randn(*s, dtype=torch.bfloat16) * 0.8)(B, Sq, D)),
        "k_cache": _w((lambda *s: torch.randn(*s, dtype=torch.bfloat16) * 0.8)(B, Hkv, Sk, Dh)),
        "v_cache": _w((lambda *s: torch.randn(*s, dtype=torch.bfloat16) * 0.05)(B, Hkv, Sk, Dh)),
        "wq": _w((lambda *s: torch.randn(*s, dtype=torch.bfloat16) * 0.8)(D, Hq * Dh) * (D ** -0.5)),
        "wo": _w((lambda *s: torch.randn(*s, dtype=torch.bfloat16) * 0.05)(Hq * Dh, D) * ((Hq * Dh) ** -0.5)),
    }

def reference(x, k_cache, v_cache, wq, wo):
    B, Sq, D = x.shape
    Hq, Dh = 16, 256
    Hkv = k_cache.shape[1]
    rep = Hq // Hkv
    q = (lambda x, *d: x.permute(*d))((x @ wq).reshape(B, Sq, Hq, Dh), 0, 2, 1, 3)
    k = (lambda x, n, axis: torch.repeat_interleave(x, n, dim=axis))(k_cache, rep, axis=1)
    v = (lambda x, n, axis: torch.repeat_interleave(x, n, dim=axis))(v_cache, rep, axis=1)
    scores = torch.einsum("bhqd,bhkd->bhqk", q, k) * (Dh ** -0.5)
    p = _softmax(scores, axis=-1)
    o = torch.einsum("bhqk,bhkd->bhqd", p, v)
    return (lambda x, *d: x.permute(*d))(o, 0, 2, 1, 3).reshape(B, Sq, Hq * Dh) @ wo
```

```asm
; @launch grid=(256,1,1) block=(256,1,1) lds=163840
.amdgcn_target "amdgcn-amd-amdhsa--gfx950"
.text
.globl standalone__gqa_block_cached__near_ridge_kernel
.p2align 8
.type standalone__gqa_block_cached__near_ridge_kernel,@function
standalone__gqa_block_cached__near_ridge_kernel:
s_movk_i32 s71, 0x1000
L_top:
s_load_dwordx16 s[4:19], s[0:1], 0
s_getpc_b64 s[74:75]
L_ref:
s_load_dwordx16 s[84:99], s[74:75], 80
s_load_dwordx16 s[84:99], s[74:75], 208
s_load_dwordx16 s[84:99], s[74:75], 336
s_load_dwordx16 s[84:99], s[74:75], 464
s_load_dwordx16 s[84:99], s[74:75], 592
s_cmpk_ge_u32 s2, 256
s_cbranch_scc1 L_end
v_lshrrev_b32 v2, 6, v0
v_and_b32 v1, 63, v0
s_and_b32 s65, s2, 7
v_readfirstlane_b32 s52, v2
s_lshr_b32 s64, s2, 5
s_bfe_u32 s59, s2, 0x10004
s_lshl1_add_u32 s67, s65, s59
v_lshrrev_b32 v3, 3, v1
v_and_b32 v4, 7, v1
v_lshrrev_b32 v5, 4, v1
v_xor_b32 v9, v4, v5
v_lshlrev_b32 v9, 4, v9
v_xor_b32 v10, 64, v9
v_lshl_add_u32 v6, v2, 4, v3
v_mul_u32_u24 v6, 896, v6
v_add_u32 v250, v6, v9
v_add_u32 v251, v6, v10
v_add_u32 v251, 6144, v251
s_lshl_b32 s61, s59, 2
s_mul_i32 s60, s64, 100352
s_add_u32 s62, s60, 57344
s_movk_i32 s23, 896
s_bitcmp1_b32 s2, 3
s_cselect_b32 s59, s59, s61
s_cselect_b32 s60, s62, s60
s_cselect_b32 s22, 48, 64
s_mul_i32 s22, s22, s23
s_add_u32 s59, s59, s64
s_add_u32 s76, s59, 0
s_sub_u32 s61, s76, 7
s_min_u32 s76, s76, s61
s_lshl_b32 s76, s76, 7
s_add_u32 s77, s59, 1
s_sub_u32 s61, s77, 7
s_min_u32 s77, s77, s61
s_lshl_b32 s77, s77, 7
s_add_u32 s78, s59, 2
s_sub_u32 s61, s78, 7
s_min_u32 s78, s78, s61
s_lshl_b32 s78, s78, 7
s_add_u32 s79, s64, 3
s_sub_u32 s61, s79, 7
s_min_u32 s79, s79, s61
s_lshl_b32 s79, s79, 7
s_mov_b32 s23, 0x20000
s_lshl_b32 s68, s52, 11
s_mul_i32 s53, s52, 24576
s_add_u32 s53, s53, 65536
v_and_b32 v6, 1, v5
v_lshlrev_b32 v6, 1, v6
v_xor_b32 v6, v4, v6
v_lshlrev_b32 v6, 4, v6
v_lshl_add_u32 v208, v3, 13, v6
v_xor_b32 v209, 64, v208
v_add_u32 v210, 129024, v208
v_add_u32 v211, 193536, v209
v_add_u32 v209, 64512, v209
s_lshl_b32 s62, s67, 9
s_lshl_b32 s61, s52, 7
s_add_u32 s62, s62, s61
s_sub_u32 s34, 3670016, s62
s_mov_b32 s35, s23
s_bfe_u32 s3, s2, 0x20003
s_mov_b32 s72, L_v0-L_ref
s_cmp_eq_u32 s3, 1
s_cselect_b32 s72, L_v1-L_ref, s72
s_cmp_eq_u32 s3, 2
s_cselect_b32 s72, L_v2-L_ref, s72
s_cmp_eq_u32 s3, 3
s_cselect_b32 s72, L_v3-L_ref, s72
s_lshl2_add_u32 s3, s64, s52
s_lshl_b32 s3, s3, 6
s_add_u32 s72, s72, s3
s_add_u32 s74, s74, s72
s_addc_u32 s75, s75, 0
s_waitcnt lgkmcnt(0)
s_add_u32 s20, s4, s60
s_addc_u32 s21, s5, 0
s_add_u32 s32, s10, s62
s_addc_u32 s33, s11, 0
s_load_dword s3, s[74:75], 0
s_bitcmp1_b32 s2, 3
s_cbranch_scc0 L_h4
s_add_u32 m0, s68, 8192
s_nop 0
buffer_load_dwordx4 v250, s[20:23], s76 offen lds
buffer_load_dwordx4 v251, s[20:23], s76 offen offset:1024 lds
s_add_u32 m0, s53, 0
s_lshl_b32 s58, s76, 12
buffer_load_dwordx4 v208, s[32:35], s58 offen lds
buffer_load_dwordx4 v209, s[32:35], s58 offen offset:1024 lds
buffer_load_dwordx4 v210, s[32:35], s58 offen offset:2048 lds
buffer_load_dwordx4 v211, s[32:35], s58 offen offset:3072 lds
s_add_u32 m0, s53, 4096
s_lshl_b32 s58, s76, 12
s_add_u32 s58, s58, 262144
buffer_load_dwordx4 v208, s[32:35], s58 offen lds
buffer_load_dwordx4 v209, s[32:35], s58 offen offset:1024 lds
buffer_load_dwordx4 v210, s[32:35], s58 offen offset:2048 lds
buffer_load_dwordx4 v211, s[32:35], s58 offen offset:3072 lds
s_load_dword s3, s[74:75], 2048
s_load_dword s3, s[74:75], 4096
s_load_dword s3, s[74:75], 6144
s_load_dword s3, s[74:75], 8192
s_load_dword s3, s[74:75], 10240
s_load_dword s3, s[74:75], 12288
s_load_dword s3, s[74:75], 14336
s_load_dword s3, s[74:75], 16384
s_load_dword s3, s[74:75], 18432
s_bitcmp1_b32 s2, 4
s_cbranch_scc1 L_v3
s_branch L_v1
L_h4:
s_add_u32 m0, s68, 8192
s_nop 0
buffer_load_dwordx4 v250, s[20:23], s76 offen lds
buffer_load_dwordx4 v251, s[20:23], s76 offen offset:1024 lds
s_add_u32 m0, s68, 24576
s_nop 0
buffer_load_dwordx4 v250, s[20:23], s77 offen lds
buffer_load_dwordx4 v251, s[20:23], s77 offen offset:1024 lds
s_add_u32 m0, s68, 40960
s_nop 0
buffer_load_dwordx4 v250, s[20:23], s78 offen lds
buffer_load_dwordx4 v251, s[20:23], s78 offen offset:1024 lds
s_add_u32 m0, s68, 0
s_nop 0
buffer_load_dwordx4 v250, s[20:23], s79 offen lds
buffer_load_dwordx4 v251, s[20:23], s79 offen offset:1024 lds
s_load_dword s3, s[74:75], 2048
s_load_dword s3, s[74:75], 4096
s_load_dword s3, s[74:75], 6144
s_load_dword s3, s[74:75], 8192
s_load_dword s3, s[74:75], 10240
s_load_dword s3, s[74:75], 12288
s_load_dword s3, s[74:75], 14336
s_load_dword s3, s[74:75], 16384
s_load_dword s3, s[74:75], 18432
s_load_dword s3, s[74:75], 20480
s_load_dword s3, s[74:75], 22528
s_bitcmp1_b32 s2, 4
s_cbranch_scc1 L_v2
L_v0:
v_accvgpr_write_b32 a248, v0
s_cmp_eq_u32 s71, 0
s_cbranch_scc1 L_ni0
v_mov_b32 v6, 0xff800000
v_accvgpr_write_b32 a244, v6
v_accvgpr_write_b32 a245, v6
v_accvgpr_write_b32 a246, v6
v_accvgpr_write_b32 a247, v6
L_ni0:
s_lshl_b32 s59, s64, 7
s_add_u32 s77, s59, 128
s_sub_u32 s69, s77, 896
s_min_u32 s77, s77, s69
s_add_u32 s78, s59, 256
s_sub_u32 s69, s78, 896
s_min_u32 s78, s78, s69
s_add_u32 s79, s59, 384
s_sub_u32 s69, s79, 896
s_min_u32 s79, s79, s69
s_add_u32 s80, s59, 512
s_sub_u32 s69, s80, 896
s_min_u32 s80, s80, s69
s_add_u32 s81, s59, 640
s_sub_u32 s69, s81, 896
s_min_u32 s81, s81, s69
s_add_u32 s82, s59, 768
s_sub_u32 s69, s82, 896
s_min_u32 s82, s82, s69
s_add_u32 s14, s14, s60
s_addc_u32 s15, s15, 0
s_lshl_b32 s66, s64, 1
s_lshl_b32 s60, s66, 12
s_add_u32 s60, s60, 33554432
s_add_u32 s72, s18, s60
s_addc_u32 s73, s19, 0
s_mov_b32 s74, 4096
s_mov_b32 s75, 0x20000
s_lshl_b32 s60, s67, 8
v_lshlrev_b32 v7, 2, v1
v_mov_b32 v8, 0
s_mov_b32 s74, s71
buffer_store_dword v8, v7, s[72:75], s60 offen sc1
s_mov_b32 s74, 4096
s_lshl_b32 s60, s64, 3
s_add_u32 s60, s60, s65
s_lshl_b32 s60, s60, 18
s_add_u32 s62, s60, s61
s_add_u32 s28, s8, s62
s_addc_u32 s29, s9, 0
s_sub_u32 s30, 262144, s61
s_mov_b32 s31, 0x20000
s_lshl_b32 s62, s52, 16
s_add_u32 s62, s62, s60
s_add_u32 s24, s6, s62
s_addc_u32 s25, s7, 0
s_mov_b32 s26, 65536
s_mov_b32 s27, 0x20000
s_add_u32 s54, s52, s64
s_and_b32 s54, s54, 7
s_lshl_b32 s62, s54, 7
s_mul_i32 s60, s67, 229376
s_add_u32 s60, s60, s62
s_add_u32 s36, s12, s60
s_addc_u32 s37, s13, 0
s_sub_u32 s38, 229376, s62
s_mov_b32 s39, 0x20000
s_mul_i32 s60, s66, 896
s_add_u32 s60, s60, s67
s_lshl_b32 s60, s60, 10
s_lshl_b32 s62, s54, 17
s_add_u32 s60, s60, s62
s_add_u32 s44, s18, s60
s_addc_u32 s45, s19, 0
s_mov_b32 s46, 131072
s_mov_b32 s47, 0x20000
s_cmp_lt_u32 s54, 7
s_cselect_b32 s38, s38, 0
s_cselect_b32 s46, s46, 0
s_add_u32 s54, s52, s64
s_add_u32 s54, s54, 4
s_and_b32 s54, s54, 7
s_lshl_b32 s62, s54, 7
s_mul_i32 s60, s67, 229376
s_add_u32 s60, s60, s62
s_add_u32 s40, s12, s60
s_addc_u32 s41, s13, 0
s_sub_u32 s42, 229376, s62
s_mov_b32 s43, 0x20000
s_mul_i32 s60, s66, 896
s_add_u32 s60, s60, s67
s_lshl_b32 s60, s60, 10
s_lshl_b32 s62, s54, 17
s_add_u32 s60, s60, s62
s_add_u32 s48, s18, s60
s_addc_u32 s49, s19, 0
s_mov_b32 s50, 131072
s_mov_b32 s51, 0x20000
s_cmp_lt_u32 s54, 7
s_cselect_b32 s42, s42, 0
s_cselect_b32 s50, s50, 0
s_add_u32 s60, s52, 0
s_and_b32 s60, s60, 3
s_lshl_b32 s54, s60, 7
s_mul_i32 s4, s60, 57344
s_lshl_b32 s60, s60, 14
v_lshl_add_u32 v235, v1, 4, s60
s_add_u32 s60, s52, 1
s_and_b32 s60, s60, 3
s_lshl_b32 s55, s60, 7
s_mul_i32 s5, s60, 57344
s_lshl_b32 s60, s60, 14
v_lshl_add_u32 v236, v1, 4, s60
s_add_u32 s60, s52, 2
s_and_b32 s60, s60, 3
s_lshl_b32 s56, s60, 7
s_mul_i32 s6, s60, 57344
s_lshl_b32 s60, s60, 14
v_lshl_add_u32 v237, v1, 4, s60
s_add_u32 s60, s52, 3
s_and_b32 s60, s60, 3
s_lshl_b32 s57, s60, 7
s_mul_i32 s7, s60, 57344
s_lshl_b32 s60, s60, 14
v_lshl_add_u32 v238, v1, 4, s60
s_mov_b32 s63, 0x3db8aa3b
v_and_b32 v11, 15, v1
v_lshrrev_b32 v6, 1, v11
v_xor_b32 v7, v6, v5
v_lshlrev_b32 v7, 4, v7
v_lshl_add_u32 v228, v11, 7, v7
v_xor_b32 v229, 64, v228
v_bfe_u32 v7, v1, 3, 2
v_lshlrev_b32 v7, 5, v7
v_and_b32 v8, 3, v1
v_lshl_add_u32 v7, v8, 3, v7
v_bfe_u32 v8, v1, 2, 2
v_lshl_add_u32 v7, v8, 7, v7
v_lshl_add_u32 v7, v5, 10, v7
v_add_u32 v230, s53, v7
v_xor_b32 v231, 32, v230
v_xor_b32 v232, 64, v230
v_xor_b32 v233, 96, v230
v_lshlrev_b32 v254, 9, v5
v_lshrrev_b32 v7, 1, v5
v_xor_b32 v7, v7, v6
v_lshlrev_b32 v7, 4, v7
v_lshl_add_u32 v7, v11, 7, v7
v_and_b32 v8, 1, v5
v_lshl_add_u32 v7, v8, 3, v7
v_add_u32 v224, s53, v7
v_xor_b32 v225, 32, v224
v_xor_b32 v226, 64, v224
v_xor_b32 v227, 96, v224
v_lshlrev_b32 v6, 9, v3
v_add_u32 v212, v6, v9
v_add_u32 v213, v6, v10
v_add_u32 v214, 6144, v212
v_add_u32 v215, 9216, v213
v_add_u32 v213, 3072, v213
v_lshlrev_b32 v12, 1, v5
v_xor_b32 v12, v4, v12
v_lshlrev_b32 v12, 4, v12
v_add_u32 v216, v6, v12
v_add_u32 v217, 3072, v216
v_add_u32 v218, 6144, v216
v_add_u32 v219, 9216, v216
v_mul_u32_u24 v6, 896, v3
v_add_u32 v220, v6, v12
v_add_u32 v221, 6144, v220
v_add_u32 v222, 12288, v220
v_add_u32 v223, 18432, v220
v_lshlrev_b32 v234, 4, v1
v_add_u32 v241, s53, v234
v_lshlrev_b32 v6, 7, v1
v_accvgpr_write_b32 a250, v6
v_and_b32 v6, 31, v1
v_lshlrev_b32 v6, 9, v6
v_lshrrev_b32 v7, 5, v1
v_lshl_add_u32 v6, v7, 16, v6
v_accvgpr_write_b32 a251, v6
v_mul_u32_u24 v6, 896, v1
v_accvgpr_write_b32 a252, v6
v_lshlrev_b32 v6, 4, v11
v_lshl_add_u32 v240, v2, 14, v6
v_lshl_add_u32 v6, v5, 2, v6
v_lshl_add_u32 v239, v2, 8, v6
s_add_u32 m0, s53, 0
s_lshl_b32 s58, s76, 12
buffer_load_dwordx4 v208, s[32:35], s58 offen lds
buffer_load_dwordx4 v209, s[32:35], s58 offen offset:1024 lds
buffer_load_dwordx4 v210, s[32:35], s58 offen offset:2048 lds
buffer_load_dwordx4 v211, s[32:35], s58 offen offset:3072 lds
s_add_u32 m0, s53, 4096
s_lshl_b32 s58, s76, 12
s_add_u32 s58, s58, 262144
buffer_load_dwordx4 v208, s[32:35], s58 offen lds
buffer_load_dwordx4 v209, s[32:35], s58 offen offset:1024 lds
buffer_load_dwordx4 v210, s[32:35], s58 offen offset:2048 lds
s_waitcnt vmcnt(8)
s_barrier
buffer_load_dwordx4 v211, s[32:35], s58 offen offset:3072 lds
s_add_u32 m0, s53, 8192
s_lshl_b32 s58, s77, 12
buffer_load_dwordx4 v208, s[32:35], s58 offen lds
buffer_load_dwordx4 v209, s[32:35], s58 offen offset:1024 lds
buffer_load_dwordx4 v210, s[32:35], s58 offen offset:2048 lds
buffer_load_dwordx4 v211, s[32:35], s58 offen offset:3072 lds
s_waitcnt vmcnt(8)
ds_read_b64_tr_b16 a[96:97], v230 offset:0
ds_read_b64_tr_b16 a[98:99], v230 offset:512
ds_read_b128 a[112:115], v228 offset:8192
ds_read_b128 a[116:119], v228 offset:10240
ds_read_b128 a[120:123], v228 offset:12288
ds_read_b128 a[124:127], v228 offset:14336
ds_read_b64_tr_b16 a[100:101], v231 offset:0
ds_read_b64_tr_b16 a[102:103], v231 offset:512
ds_read_b64_tr_b16 a[104:105], v232 offset:0
ds_read_b64_tr_b16 a[106:107], v232 offset:512
ds_read_b64_tr_b16 a[108:109], v233 offset:0
ds_read_b64_tr_b16 a[110:111], v233 offset:512
s_waitcnt lgkmcnt(9)
v_mfma_f32_16x16x32_bf16 v[128:131], a[96:99], a[112:115], 0
s_add_u32 m0, s68, 16384
s_nop 0
buffer_load_dwordx4 v250, s[20:23], s80 offen lds
buffer_load_dwordx4 v251, s[20:23], s80 offen offset:1024 lds
s_add_u32 m0, s53, 12288
s_lshl_b32 s58, s77, 12
s_add_u32 s58, s58, 262144
buffer_load_dwordx4 v208, s[32:35], s58 offen lds
buffer_load_dwordx4 v209, s[32:35], s58 offen offset:1024 lds
s_waitcnt vmcnt(8)
buffer_load_dwordx4 v210, s[32:35], s58 offen offset:2048 lds
s_waitcnt lgkmcnt(8)
v_mfma_f32_16x16x32_bf16 v[136:139], a[96:99], a[116:119], 0
ds_read_b64_tr_b16 a[128:129], v230 offset:4096
ds_read_b64_tr_b16 a[130:131], v230 offset:4608
s_waitcnt lgkmcnt(9)
v_mfma_f32_16x16x32_bf16 v[144:147], a[96:99], a[120:123], 0
ds_read_b128 a[144:147], v229 offset:8192
ds_read_b128 a[148:151], v229 offset:10240
s_waitcnt lgkmcnt(10)
v_mfma_f32_16x16x32_bf16 v[152:155], a[96:99], a[124:127], 0
ds_read_b128 a[152:155], v229 offset:12288
s_waitcnt lgkmcnt(9)
v_mfma_f32_16x16x32_bf16 v[156:159], a[100:103], a[124:127], 0
ds_read_b128 a[156:159], v229 offset:14336
ds_read_b64_tr_b16 a[132:133], v231 offset:4096
v_mfma_f32_16x16x32_bf16 v[148:151], a[100:103], a[120:123], 0
ds_read_b64_tr_b16 a[134:135], v231 offset:4608
ds_read_b64_tr_b16 a[136:137], v232 offset:4096
v_mfma_f32_16x16x32_bf16 v[140:143], a[100:103], a[116:119], 0
ds_read_b64_tr_b16 a[138:139], v232 offset:4608
buffer_load_dwordx4 v211, s[32:35], s58 offen offset:3072 lds
v_mfma_f32_16x16x32_bf16 v[132:135], a[100:103], a[112:115], 0
s_add_u32 m0, s53, 16384
s_lshl_b32 s58, s78, 12
s_waitcnt lgkmcnt(12)
v_mfma_f32_16x16x32_bf16 v[160:163], a[104:107], a[112:115], 0
ds_read_b64_tr_b16 a[140:141], v233 offset:4096
ds_read_b64_tr_b16 a[142:143], v233 offset:4608
v_mfma_f32_16x16x32_bf16 v[168:171], a[104:107], a[116:119], 0
buffer_load_dwordx4 v208, s[32:35], s58 offen lds
v_mfma_f32_16x16x32_bf16 v[176:179], a[104:107], a[120:123], 0
v_mfma_f32_16x16x32_bf16 v[184:187], a[104:107], a[124:127], 0
buffer_load_dwordx4 v209, s[32:35], s58 offen offset:1024 lds
s_waitcnt lgkmcnt(12)
v_mfma_f32_16x16x32_bf16 v[188:191], a[108:111], a[124:127], 0
buffer_load_dwordx4 v210, s[32:35], s58 offen offset:2048 lds
v_mfma_f32_16x16x32_bf16 v[180:183], a[108:111], a[120:123], 0
v_mfma_f32_16x16x32_bf16 v[172:175], a[108:111], a[116:119], 0
buffer_load_dwordx4 v211, s[32:35], s58 offen offset:3072 lds
v_mfma_f32_16x16x32_bf16 v[164:167], a[108:111], a[112:115], 0
s_add_u32 m0, s68, 32768
s_waitcnt lgkmcnt(0)
v_mfma_f32_16x16x32_bf16 v[128:131], a[128:131], a[144:147], v[128:131]
s_waitcnt vmcnt(10)
ds_read_b64_tr_b16 a[96:97], v230 offset:8192
v_mfma_f32_16x16x32_bf16 v[136:139], a[128:131], a[148:151], v[136:139]
ds_read_b64_tr_b16 a[98:99], v230 offset:8704
ds_read_b128 a[112:115], v228 offset:24576
v_mfma_f32_16x16x32_bf16 v[144:147], a[128:131], a[152:155], v[144:147]
ds_read_b128 a[116:119], v228 offset:26624
ds_read_b128 a[120:123], v228 offset:28672
v_mfma_f32_16x16x32_bf16 v[152:155], a[128:131], a[156:159], v[152:155]
buffer_load_dwordx4 v250, s[20:23], s81 offen lds
v_mfma_f32_16x16x32_bf16 v[156:159], a[132:135], a[156:159], v[156:159]
ds_read_b128 a[124:127], v228 offset:30720
ds_read_b64_tr_b16 a[100:101], v231 offset:8192
v_mfma_f32_16x16x32_bf16 v[148:151], a[132:135], a[152:155], v[148:151]
ds_read_b64_tr_b16 a[102:103], v231 offset:8704
ds_read_b64_tr_b16 a[104:105], v232 offset:8192
v_mfma_f32_16x16x32_bf16 v[140:143], a[132:135], a[148:151], v[140:143]
ds_read_b64_tr_b16 a[106:107], v232 offset:8704
v_mfma_f32_16x16x32_bf16 v[132:135], a[132:135], a[144:147], v[132:135]
buffer_load_dwordx4 v251, s[20:23], s81 offen offset:1024 lds
v_mfma_f32_16x16x32_bf16 v[160:163], a[136:139], a[144:147], v[160:163]
ds_read_b64_tr_b16 a[108:109], v233 offset:8192
ds_read_b64_tr_b16 a[110:111], v233 offset:8704
v_mfma_f32_16x16x32_bf16 v[168:171], a[136:139], a[148:151], v[168:171]
s_add_u32 m0, s53, 20480
s_lshl_b32 s58, s78, 12
v_mfma_f32_16x16x32_bf16 v[176:179], a[136:139], a[152:155], v[176:179]
s_add_u32 s58, s58, 262144
v_mfma_f32_16x16x32_bf16 v[184:187], a[136:139], a[156:159], v[184:187]
buffer_load_dwordx4 v208, s[32:35], s58 offen lds
v_mfma_f32_16x16x32_bf16 v[188:191], a[140:143], a[156:159], v[188:191]
v_mfma_f32_16x16x32_bf16 v[180:183], a[140:143], a[152:155], v[180:183]
buffer_load_dwordx4 v209, s[32:35], s58 offen offset:1024 lds
v_mfma_f32_16x16x32_bf16 v[172:175], a[140:143], a[148:151], v[172:175]
v_mfma_f32_16x16x32_bf16 v[164:167], a[140:143], a[144:147], v[164:167]
s_waitcnt lgkmcnt(0)
v_mfma_f32_16x16x32_bf16 v[128:131], a[96:99], a[112:115], v[128:131]
s_waitcnt vmcnt(8)
v_mfma_f32_16x16x32_bf16 v[136:139], a[96:99], a[116:119], v[136:139]
ds_read_b64_tr_b16 a[128:129], v230 offset:12288
ds_read_b64_tr_b16 a[130:131], v230 offset:12800
buffer_load_dwordx4 v210, s[32:35], s58 offen offset:2048 lds
v_mfma_f32_16x16x32_bf16 v[144:147], a[96:99], a[120:123], v[144:147]
ds_read_b128 a[144:147], v229 offset:24576
ds_read_b128 a[148:151], v229 offset:26624
v_mfma_f32_16x16x32_bf16 v[152:155], a[96:99], a[124:127], v[152:155]
buffer_load_dwordx4 v211, s[32:35], s58 offen offset:3072 lds
v_mfma_f32_16x16x32_bf16 v[156:159], a[100:103], a[124:127], v[156:159]
ds_read_b128 a[152:155], v229 offset:28672
ds_read_b128 a[156:159], v229 offset:30720
v_mfma_f32_16x16x32_bf16 v[148:151], a[100:103], a[120:123], v[148:151]
ds_read_b64_tr_b16 a[132:133], v231 offset:12288
ds_read_b64_tr_b16 a[134:135], v231 offset:12800
v_mfma_f32_16x16x32_bf16 v[140:143], a[100:103], a[116:119], v[140:143]
ds_read_b64_tr_b16 a[136:137], v232 offset:12288
ds_read_b64_tr_b16 a[138:139], v232 offset:12800
v_mfma_f32_16x16x32_bf16 v[132:135], a[100:103], a[112:115], v[132:135]
s_add_u32 m0, s53, 0
s_lshl_b32 s58, s79, 12
v_mfma_f32_16x16x32_bf16 v[160:163], a[104:107], a[112:115], v[160:163]
ds_read_b64_tr_b16 a[140:141], v233 offset:12288
ds_read_b64_tr_b16 a[142:143], v233 offset:12800
v_mfma_f32_16x16x32_bf16 v[168:171], a[104:107], a[116:119], v[168:171]
buffer_load_dwordx4 v208, s[32:35], s58 offen lds
v_mfma_f32_16x16x32_bf16 v[176:179], a[104:107], a[120:123], v[176:179]
v_mfma_f32_16x16x32_bf16 v[184:187], a[104:107], a[124:127], v[184:187]
buffer_load_dwordx4 v209, s[32:35], s58 offen offset:1024 lds
v_mfma_f32_16x16x32_bf16 v[188:191], a[108:111], a[124:127], v[188:191]
v_mfma_f32_16x16x32_bf16 v[180:183], a[108:111], a[120:123], v[180:183]
buffer_load_dwordx4 v210, s[32:35], s58 offen offset:2048 lds
v_mfma_f32_16x16x32_bf16 v[172:175], a[108:111], a[116:119], v[172:175]
v_mfma_f32_16x16x32_bf16 v[164:167], a[108:111], a[112:115], v[164:167]
s_waitcnt lgkmcnt(0)
v_mfma_f32_16x16x32_bf16 v[128:131], a[128:131], a[144:147], v[128:131]
s_waitcnt vmcnt(9)
ds_read_b64_tr_b16 a[96:97], v230 offset:16384
v_mfma_f32_16x16x32_bf16 v[136:139], a[128:131], a[148:151], v[136:139]
ds_read_b64_tr_b16 a[98:99], v230 offset:16896
ds_read_b128 a[112:115], v228 offset:40960
v_mfma_f32_16x16x32_bf16 v[144:147], a[128:131], a[152:155], v[144:147]
ds_read_b128 a[116:119], v228 offset:43008
ds_read_b128 a[120:123], v228 offset:45056
v_mfma_f32_16x16x32_bf16 v[152:155], a[128:131], a[156:159], v[152:155]
buffer_load_dwordx4 v211, s[32:35], s58 offen offset:3072 lds
v_mfma_f32_16x16x32_bf16 v[156:159], a[132:135], a[156:159], v[156:159]
ds_read_b128 a[124:127], v228 offset:47104
ds_read_b64_tr_b16 a[100:101], v231 offset:16384
v_mfma_f32_16x16x32_bf16 v[148:151], a[132:135], a[152:155], v[148:151]
ds_read_b64_tr_b16 a[102:103], v231 offset:16896
ds_read_b64_tr_b16 a[104:105], v232 offset:16384
v_mfma_f32_16x16x32_bf16 v[140:143], a[132:135], a[148:151], v[140:143]
ds_read_b64_tr_b16 a[106:107], v232 offset:16896
s_add_u32 m0, s68, 49152
v_mfma_f32_16x16x32_bf16 v[132:135], a[132:135], a[144:147], v[132:135]
buffer_load_dwordx4 v250, s[20:23], s82 offen lds
v_mfma_f32_16x16x32_bf16 v[160:163], a[136:139], a[144:147], v[160:163]
ds_read_b64_tr_b16 a[108:109], v233 offset:16384
ds_read_b64_tr_b16 a[110:111], v233 offset:16896
v_mfma_f32_16x16x32_bf16 v[168:171], a[136:139], a[148:151], v[168:171]
buffer_load_dwordx4 v251, s[20:23], s82 offen offset:1024 lds
v_mfma_f32_16x16x32_bf16 v[176:179], a[136:139], a[152:155], v[176:179]
s_add_u32 m0, s53, 4096
s_lshl_b32 s58, s79, 12
v_mfma_f32_16x16x32_bf16 v[184:187], a[136:139], a[156:159], v[184:187]
s_add_u32 s58, s58, 262144
v_mfma_f32_16x16x32_bf16 v[188:191], a[140:143], a[156:159], v[188:191]
buffer_load_dwordx4 v208, s[32:35], s58 offen lds
v_mfma_f32_16x16x32_bf16 v[180:183], a[140:143], a[152:155], v[180:183]
v_mfma_f32_16x16x32_bf16 v[172:175], a[140:143], a[148:151], v[172:175]
buffer_load_dwordx4 v209, s[32:35], s58 offen offset:1024 lds
v_mfma_f32_16x16x32_bf16 v[164:167], a[140:143], a[144:147], v[164:167]
s_waitcnt lgkmcnt(0)
v_mfma_f32_16x16x32_bf16 v[128:131], a[96:99], a[112:115], v[128:131]
s_waitcnt vmcnt(8)
v_mfma_f32_16x16x32_bf16 v[136:139], a[96:99], a[116:119], v[136:139]
ds_read_b64_tr_b16 a[128:129], v230 offset:20480
ds_read_b64_tr_b16 a[130:131], v230 offset:20992
v_mfma_f32_16x16x32_bf16 v[144:147], a[96:99], a[120:123], v[144:147]
ds_read_b128 a[144:147], v229 offset:40960
ds_read_b128 a[148:151], v229 offset:43008
v_mfma_f32_16x16x32_bf16 v[152:155], a[96:99], a[124:127], v[152:155]
buffer_load_dwordx4 v210, s[32:35], s58 offen offset:2048 lds
v_mfma_f32_16x16x32_bf16 v[156:159], a[100:103], a[124:127], v[156:159]
ds_read_b128 a[152:155], v229 offset:45056
ds_read_b128 a[156:159], v229 offset:47104
v_mfma_f32_16x16x32_bf16 v[148:151], a[100:103], a[120:123], v[148:151]
ds_read_b64_tr_b16 a[132:133], v231 offset:20480
ds_read_b64_tr_b16 a[134:135], v231 offset:20992
v_mfma_f32_16x16x32_bf16 v[140:143], a[100:103], a[116:119], v[140:143]
ds_read_b64_tr_b16 a[136:137], v232 offset:20480
ds_read_b64_tr_b16 a[138:139], v232 offset:20992
v_mfma_f32_16x16x32_bf16 v[132:135], a[100:103], a[112:115], v[132:135]
buffer_load_dwordx4 v211, s[32:35], s58 offen offset:3072 lds
v_mfma_f32_16x16x32_bf16 v[160:163], a[104:107], a[112:115], v[160:163]
ds_read_b64_tr_b16 a[140:141], v233 offset:20480
ds_read_b64_tr_b16 a[142:143], v233 offset:20992
v_mfma_f32_16x16x32_bf16 v[168:171], a[104:107], a[116:119], v[168:171]
s_add_u32 m0, s53, 8192
s_lshl_b32 s58, s80, 12
v_mfma_f32_16x16x32_bf16 v[176:179], a[104:107], a[120:123], v[176:179]
buffer_load_dwordx4 v208, s[32:35], s58 offen lds
v_mfma_f32_16x16x32_bf16 v[184:187], a[104:107], a[124:127], v[184:187]
v_mfma_f32_16x16x32_bf16 v[188:191], a[108:111], a[124:127], v[188:191]
buffer_load_dwordx4 v209, s[32:35], s58 offen offset:1024 lds
v_mfma_f32_16x16x32_bf16 v[180:183], a[108:111], a[120:123], v[180:183]
v_mfma_f32_16x16x32_bf16 v[172:175], a[108:111], a[116:119], v[172:175]
buffer_load_dwordx4 v210, s[32:35], s58 offen offset:2048 lds
v_mfma_f32_16x16x32_bf16 v[164:167], a[108:111], a[112:115], v[164:167]
s_waitcnt lgkmcnt(0)
v_mfma_f32_16x16x32_bf16 v[128:131], a[128:131], a[144:147], v[128:131]
s_waitcnt vmcnt(9)
ds_read_b64_tr_b16 a[96:97], v230 offset:0
v_mfma_f32_16x16x32_bf16 v[136:139], a[128:131], a[148:151], v[136:139]
ds_read_b64_tr_b16 a[98:99], v230 offset:512
ds_read_b128 a[112:115], v228 offset:0
v_mfma_f32_16x16x32_bf16 v[144:147], a[128:131], a[152:155], v[144:147]
ds_read_b128 a[116:119], v228 offset:2048
ds_read_b128 a[120:123], v228 offset:4096
v_mfma_f32_16x16x32_bf16 v[152:155], a[128:131], a[156:159], v[152:155]
buffer_load_dwordx4 v211, s[32:35], s58 offen offset:3072 lds
v_mfma_f32_16x16x32_bf16 v[156:159], a[132:135], a[156:159], v[156:159]
ds_read_b128 a[124:127], v228 offset:6144
ds_read_b64_tr_b16 a[100:101], v231 offset:0
v_mfma_f32_16x16x32_bf16 v[148:151], a[132:135], a[152:155], v[148:151]
ds_read_b64_tr_b16 a[102:103], v231 offset:512
ds_read_b64_tr_b16 a[104:105], v232 offset:0
v_mfma_f32_16x16x32_bf16 v[140:143], a[132:135], a[148:151], v[140:143]
ds_read_b64_tr_b16 a[106:107], v232 offset:512
s_add_u32 m0, s53, 12288
v_mfma_f32_16x16x32_bf16 v[132:135], a[132:135], a[144:147], v[132:135]
s_lshl_b32 s58, s80, 12
s_add_u32 s58, s58, 262144
v_mfma_f32_16x16x32_bf16 v[160:163], a[136:139], a[144:147], v[160:163]
ds_read_b64_tr_b16 a[108:109], v233 offset:0
ds_read_b64_tr_b16 a[110:111], v233 offset:512
v_mfma_f32_16x16x32_bf16 v[168:171], a[136:139], a[148:151], v[168:171]
buffer_load_dwordx4 v208, s[32:35], s58 offen lds
v_mfma_f32_16x16x32_bf16 v[176:179], a[136:139], a[152:155], v[176:179]
v_mfma_f32_16x16x32_bf16 v[184:187], a[136:139], a[156:159], v[184:187]
buffer_load_dwordx4 v209, s[32:35], s58 offen offset:1024 lds
v_mfma_f32_16x16x32_bf16 v[188:191], a[140:143], a[156:159], v[188:191]
v_mfma_f32_16x16x32_bf16 v[180:183], a[140:143], a[152:155], v[180:183]
buffer_load_dwordx4 v210, s[32:35], s58 offen offset:2048 lds
v_mfma_f32_16x16x32_bf16 v[172:175], a[140:143], a[148:151], v[172:175]
v_mfma_f32_16x16x32_bf16 v[164:167], a[140:143], a[144:147], v[164:167]
s_waitcnt lgkmcnt(0)
v_mfma_f32_16x16x32_bf16 v[128:131], a[96:99], a[112:115], v[128:131]
buffer_load_dwordx4 v211, s[32:35], s58 offen offset:3072 lds
s_waitcnt vmcnt(8)
v_mfma_f32_16x16x32_bf16 v[136:139], a[96:99], a[116:119], v[136:139]
ds_read_b64_tr_b16 a[128:129], v230 offset:4096
ds_read_b64_tr_b16 a[130:131], v230 offset:4608
v_mfma_f32_16x16x32_bf16 v[144:147], a[96:99], a[120:123], v[144:147]
ds_read_b128 a[144:147], v229 offset:0
ds_read_b128 a[148:151], v229 offset:2048
v_mfma_f32_16x16x32_bf16 v[152:155], a[96:99], a[124:127], v[152:155]
s_add_u32 m0, s53, 16384
s_add_u32 s58, s56, 0
buffer_load_dwordx4 v212, s[24:27], s58 offen lds
v_mfma_f32_16x16x32_bf16 v[156:159], a[100:103], a[124:127], v[156:159]
ds_read_b128 a[152:155], v229 offset:4096
ds_read_b128 a[156:159], v229 offset:6144
v_mfma_f32_16x16x32_bf16 v[148:151], a[100:103], a[120:123], v[148:151]
ds_read_b64_tr_b16 a[132:133], v231 offset:4096
ds_read_b64_tr_b16 a[134:135], v231 offset:4608
v_mfma_f32_16x16x32_bf16 v[140:143], a[100:103], a[116:119], v[140:143]
ds_read_b64_tr_b16 a[136:137], v232 offset:4096
ds_read_b64_tr_b16 a[138:139], v232 offset:4608
v_mfma_f32_16x16x32_bf16 v[132:135], a[100:103], a[112:115], v[132:135]
buffer_load_dwordx4 v213, s[24:27], s58 offen offset:1024 lds
v_mfma_f32_16x16x32_bf16 v[160:163], a[104:107], a[112:115], v[160:163]
ds_read_b64_tr_b16 a[140:141], v233 offset:4096
ds_read_b64_tr_b16 a[142:143], v233 offset:4608
v_mfma_f32_16x16x32_bf16 v[168:171], a[104:107], a[116:119], v[168:171]
buffer_load_dwordx4 v214, s[24:27], s58 offen offset:2048 lds
v_mfma_f32_16x16x32_bf16 v[176:179], a[104:107], a[120:123], v[176:179]
v_mfma_f32_16x16x32_bf16 v[184:187], a[104:107], a[124:127], v[184:187]
buffer_load_dwordx4 v215, s[24:27], s58 offen offset:3072 lds
v_mfma_f32_16x16x32_bf16 v[188:191], a[108:111], a[124:127], v[188:191]
s_add_u32 m0, s53, 20480
s_add_u32 s58, s57, 0
v_mfma_f32_16x16x32_bf16 v[180:183], a[108:111], a[120:123], v[180:183]
buffer_load_dwordx4 v212, s[24:27], s58 offen lds
v_mfma_f32_16x16x32_bf16 v[172:175], a[108:111], a[116:119], v[172:175]
v_mfma_f32_16x16x32_bf16 v[164:167], a[108:111], a[112:115], v[164:167]
s_waitcnt lgkmcnt(0)
v_mfma_f32_16x16x32_bf16 v[128:131], a[128:131], a[144:147], v[128:131]
s_barrier
buffer_load_dwordx4 v213, s[24:27], s58 offen offset:1024 lds
v_mfma_f32_16x16x32_bf16 v[136:139], a[128:131], a[148:151], v[136:139]
s_waitcnt vmcnt(10)
ds_read_b64_tr_b16 a[96:97], v230 offset:8192
v_mfma_f32_16x16x32_bf16 v[144:147], a[128:131], a[152:155], v[144:147]
ds_read_b64_tr_b16 a[98:99], v230 offset:8704
ds_read_b128 a[112:115], v228 offset:16384
v_mfma_f32_16x16x32_bf16 v[152:155], a[128:131], a[156:159], v[152:155]
buffer_load_dwordx4 v214, s[24:27], s58 offen offset:2048 lds
v_mfma_f32_16x16x32_bf16 v[156:159], a[132:135], a[156:159], v[156:159]
ds_read_b128 a[116:119], v228 offset:18432
ds_read_b128 a[120:123], v228 offset:20480
v_mfma_f32_16x16x32_bf16 v[148:151], a[132:135], a[152:155], v[148:151]
ds_read_b128 a[124:127], v228 offset:22528
ds_read_b64_tr_b16 a[100:101], v231 offset:8192
v_mfma_f32_16x16x32_bf16 v[140:143], a[132:135], a[148:151], v[140:143]
ds_read_b64_tr_b16 a[102:103], v231 offset:8704
ds_read_b64_tr_b16 a[104:105], v232 offset:8192
v_mfma_f32_16x16x32_bf16 v[132:135], a[132:135], a[144:147], v[132:135]
buffer_load_dwordx4 v215, s[24:27], s58 offen offset:3072 lds
v_mfma_f32_16x16x32_bf16 v[160:163], a[136:139], a[144:147], v[160:163]
ds_read_b64_tr_b16 a[106:107], v232 offset:8704
ds_read_b64_tr_b16 a[108:109], v233 offset:8192
v_mfma_f32_16x16x32_bf16 v[168:171], a[136:139], a[148:151], v[168:171]
ds_read_b64_tr_b16 a[110:111], v233 offset:8704
s_add_u32 m0, s53, 0
v_mfma_f32_16x16x32_bf16 v[176:179], a[136:139], a[152:155], v[176:179]
s_lshl_b32 s58, s81, 12
v_mfma_f32_16x16x32_bf16 v[184:187], a[136:139], a[156:159], v[184:187]
buffer_load_dwordx4 v208, s[32:35], s58 offen lds
v_mfma_f32_16x16x32_bf16 v[188:191], a[140:143], a[156:159], v[188:191]
v_mfma_f32_16x16x32_bf16 v[180:183], a[140:143], a[152:155], v[180:183]
buffer_load_dwordx4 v209, s[32:35], s58 offen offset:1024 lds
v_mfma_f32_16x16x32_bf16 v[172:175], a[140:143], a[148:151], v[172:175]
v_mfma_f32_16x16x32_bf16 v[164:167], a[140:143], a[144:147], v[164:167]
s_waitcnt lgkmcnt(0)
v_mfma_f32_16x16x32_bf16 v[128:131], a[96:99], a[112:115], v[128:131]
s_waitcnt vmcnt(10)
ds_read_b64_tr_b16 a[128:129], v230 offset:12288
v_mfma_f32_16x16x32_bf16 v[136:139], a[96:99], a[116:119], v[136:139]
ds_read_b64_tr_b16 a[130:131], v230 offset:12800
ds_read_b128 a[144:147], v229 offset:16384
v_mfma_f32_16x16x32_bf16 v[144:147], a[96:99], a[120:123], v[144:147]
ds_read_b128 a[148:151], v229 offset:18432
ds_read_b128 a[152:155], v229 offset:20480
v_mfma_f32_16x16x32_bf16 v[152:155], a[96:99], a[124:127], v[152:155]
buffer_load_dwordx4 v210, s[32:35], s58 offen offset:2048 lds
v_mfma_f32_16x16x32_bf16 v[156:159], a[100:103], a[124:127], v[156:159]
ds_read_b128 a[156:159], v229 offset:22528
ds_read_b64_tr_b16 a[132:133], v231 offset:12288
v_mfma_f32_16x16x32_bf16 v[148:151], a[100:103], a[120:123], v[148:151]
ds_read_b64_tr_b16 a[134:135], v231 offset:12800
ds_read_b64_tr_b16 a[136:137], v232 offset:12288
v_mfma_f32_16x16x32_bf16 v[140:143], a[100:103], a[116:119], v[140:143]
ds_read_b64_tr_b16 a[138:139], v232 offset:12800
v_mfma_f32_16x16x32_bf16 v[132:135], a[100:103], a[112:115], v[132:135]
ds_read_b64_tr_b16 a[140:141], v233 offset:12288
v_mfma_f32_16x16x32_bf16 v[160:163], a[104:107], a[112:115], v[160:163]
ds_read_b64_tr_b16 a[142:143], v233 offset:12800
v_mfma_f32_16x16x32_bf16 v[168:171], a[104:107], a[116:119], v[168:171]
v_mfma_f32_16x16x32_bf16 v[176:179], a[104:107], a[120:123], v[176:179]
v_mfma_f32_16x16x32_bf16 v[184:187], a[104:107], a[124:127], v[184:187]
v_mfma_f32_16x16x32_bf16 v[188:191], a[108:111], a[124:127], v[188:191]
v_mfma_f32_16x16x32_bf16 v[180:183], a[108:111], a[120:123], v[180:183]
v_mfma_f32_16x16x32_bf16 v[172:175], a[108:111], a[116:119], v[172:175]
v_mfma_f32_16x16x32_bf16 v[164:167], a[108:111], a[112:115], v[164:167]
s_waitcnt lgkmcnt(0)
v_mfma_f32_16x16x32_bf16 v[128:131], a[128:131], a[144:147], v[128:131]
buffer_load_dwordx4 v211, s[32:35], s58 offen offset:3072 lds
s_add_u32 m0, s53, 4096
s_lshl_b32 s58, s81, 12
s_add_u32 s58, s58, 262144
buffer_load_dwordx4 v208, s[32:35], s58 offen lds
buffer_load_dwordx4 v209, s[32:35], s58 offen offset:1024 lds
buffer_load_dwordx4 v210, s[32:35], s58 offen offset:2048 lds
buffer_load_dwordx4 v211, s[32:35], s58 offen offset:3072 lds
s_add_u32 m0, s53, 8192
s_lshl_b32 s58, s82, 12
buffer_load_dwordx4 v208, s[32:35], s58 offen lds
buffer_load_dwordx4 v209, s[32:35], s58 offen offset:1024 lds
buffer_load_dwordx4 v210, s[32:35], s58 offen offset:2048 lds
buffer_load_dwordx4 v211, s[32:35], s58 offen offset:3072 lds
s_waitcnt vmcnt(8)
v_mfma_f32_16x16x32_bf16 v[136:139], a[128:131], a[148:151], v[136:139]
ds_read_b64_tr_b16 a[96:97], v230 offset:0
ds_read_b64_tr_b16 a[98:99], v230 offset:512
v_mfma_f32_16x16x32_bf16 v[144:147], a[128:131], a[152:155], v[144:147]
ds_read_b128 a[112:115], v228 offset:32768
ds_read_b128 a[116:119], v228 offset:34816
v_mfma_f32_16x16x32_bf16 v[152:155], a[128:131], a[156:159], v[152:155]
s_add_u32 m0, s53, 12288
s_lshl_b32 s58, s82, 12
v_mfma_f32_16x16x32_bf16 v[156:159], a[132:135], a[156:159], v[156:159]
ds_read_b128 a[120:123], v228 offset:36864
ds_read_b128 a[124:127], v228 offset:38912
v_mfma_f32_16x16x32_bf16 v[148:151], a[132:135], a[152:155], v[148:151]
ds_read_b64_tr_b16 a[100:101], v231 offset:0
ds_read_b64_tr_b16 a[102:103], v231 offset:512
v_mfma_f32_16x16x32_bf16 v[140:143], a[132:135], a[148:151], v[140:143]
ds_read_b64_tr_b16 a[104:105], v232 offset:0
ds_read_b64_tr_b16 a[106:107], v232 offset:512
v_mfma_f32_16x16x32_bf16 v[132:135], a[132:135], a[144:147], v[132:135]
s_add_u32 s58, s58, 262144
buffer_load_dwordx4 v208, s[32:35], s58 offen lds
v_mfma_f32_16x16x32_bf16 v[160:163], a[136:139], a[144:147], v[160:163]
ds_read_b64_tr_b16 a[108:109], v233 offset:0
ds_read_b64_tr_b16 a[110:111], v233 offset:512
v_mfma_f32_16x16x32_bf16 v[168:171], a[136:139], a[148:151], v[168:171]
buffer_load_dwordx4 v209, s[32:35], s58 offen offset:1024 lds
v_mfma_f32_16x16x32_bf16 v[176:179], a[136:139], a[152:155], v[176:179]
v_mfma_f32_16x16x32_bf16 v[184:187], a[136:139], a[156:159], v[184:187]
buffer_load_dwordx4 v210, s[32:35], s58 offen offset:2048 lds
v_mfma_f32_16x16x32_bf16 v[188:191], a[140:143], a[156:159], v[188:191]
v_mfma_f32_16x16x32_bf16 v[180:183], a[140:143], a[152:155], v[180:183]
buffer_load_dwordx4 v211, s[32:35], s58 offen offset:3072 lds
v_mfma_f32_16x16x32_bf16 v[172:175], a[140:143], a[148:151], v[172:175]
v_mfma_f32_16x16x32_bf16 v[164:167], a[140:143], a[144:147], v[164:167]
s_waitcnt lgkmcnt(0)
v_mfma_f32_16x16x32_bf16 v[128:131], a[96:99], a[112:115], v[128:131]
s_waitcnt vmcnt(8)
ds_read_b64_tr_b16 a[128:129], v230 offset:4096
v_mfma_f32_16x16x32_bf16 v[136:139], a[96:99], a[116:119], v[136:139]
ds_read_b64_tr_b16 a[130:131], v230 offset:4608
ds_read_b128 a[144:147], v229 offset:32768
v_mfma_f32_16x16x32_bf16 v[144:147], a[96:99], a[120:123], v[144:147]
ds_read_b128 a[148:151], v229 offset:34816
ds_read_b128 a[152:155], v229 offset:36864
v_mfma_f32_16x16x32_bf16 v[152:155], a[96:99], a[124:127], v[152:155]
s_add_u32 m0, s53, 0
s_add_u32 s58, s54, 0
v_mfma_f32_16x16x32_bf16 v[156:159], a[100:103], a[124:127], v[156:159]
ds_read_b128 a[156:159], v229 offset:38912
ds_read_b64_tr_b16 a[132:133], v231 offset:4096
buffer_load_dwordx4 v212, s[24:27], s58 offen lds
v_mfma_f32_16x16x32_bf16 v[148:151], a[100:103], a[120:123], v[148:151]
ds_read_b64_tr_b16 a[134:135], v231 offset:4608
ds_read_b64_tr_b16 a[136:137], v232 offset:4096
v_mfma_f32_16x16x32_bf16 v[140:143], a[100:103], a[116:119], v[140:143]
ds_read_b64_tr_b16 a[138:139], v232 offset:4608
v_mfma_f32_16x16x32_bf16 v[132:135], a[100:103], a[112:115], v[132:135]
buffer_load_dwordx4 v213, s[24:27], s58 offen offset:1024 lds
v_mfma_f32_16x16x32_bf16 v[160:163], a[104:107], a[112:115], v[160:163]
ds_read_b64_tr_b16 a[140:141], v233 offset:4096
ds_read_b64_tr_b16 a[142:143], v233 offset:4608
v_mfma_f32_16x16x32_bf16 v[168:171], a[104:107], a[116:119], v[168:171]
buffer_load_dwordx4 v214, s[24:27], s58 offen offset:2048 lds
v_mfma_f32_16x16x32_bf16 v[176:179], a[104:107], a[120:123], v[176:179]
v_mfma_f32_16x16x32_bf16 v[184:187], a[104:107], a[124:127], v[184:187]
buffer_load_dwordx4 v215, s[24:27], s58 offen offset:3072 lds
v_mfma_f32_16x16x32_bf16 v[188:191], a[108:111], a[124:127], v[188:191]
v_mfma_f32_16x16x32_bf16 v[180:183], a[108:111], a[120:123], v[180:183]
v_mfma_f32_16x16x32_bf16 v[172:175], a[108:111], a[116:119], v[172:175]
v_mfma_f32_16x16x32_bf16 v[164:167], a[108:111], a[112:115], v[164:167]
s_waitcnt lgkmcnt(0)
v_mfma_f32_16x16x32_bf16 v[128:131], a[128:131], a[144:147], v[128:131]
s_add_u32 m0, s53, 4096
s_add_u32 s58, s54, 16384
buffer_load_dwordx4 v212, s[24:27], s58 offen lds
buffer_load_dwordx4 v213, s[24:27], s58 offen offset:1024 lds
buffer_load_dwordx4 v214, s[24:27], s58 offen offset:2048 lds
buffer_load_dwordx4 v215, s[24:27], s58 offen offset:3072 lds
s_waitcnt vmcnt(8)
v_mfma_f32_16x16x32_bf16 v[136:139], a[128:131], a[148:151], v[136:139]
ds_read_b64_tr_b16 a[96:97], v230 offset:8192
ds_read_b64_tr_b16 a[98:99], v230 offset:8704
v_mfma_f32_16x16x32_bf16 v[144:147], a[128:131], a[152:155], v[144:147]
ds_read_b128 a[160:163], v228 offset:49152
ds_read_b128 a[164:167], v228 offset:51200
v_mfma_f32_16x16x32_bf16 v[152:155], a[128:131], a[156:159], v[152:155]
ds_read_b128 a[168:171], v228 offset:53248
ds_read_b128 a[172:175], v228 offset:55296
v_mfma_f32_16x16x32_bf16 v[156:159], a[132:135], a[156:159], v[156:159]
ds_read_b64_tr_b16 a[100:101], v231 offset:8192
ds_read_b64_tr_b16 a[102:103], v231 offset:8704
v_mfma_f32_16x16x32_bf16 v[148:151], a[132:135], a[152:155], v[148:151]
ds_read_b64_tr_b16 a[104:105], v230 offset:12288
ds_read_b64_tr_b16 a[106:107], v230 offset:12800
v_mfma_f32_16x16x32_bf16 v[140:143], a[132:135], a[148:151], v[140:143]
ds_read_b128 a[176:179], v229 offset:49152
ds_read_b128 a[180:183], v229 offset:51200
v_mfma_f32_16x16x32_bf16 v[132:135], a[132:135], a[144:147], v[132:135]
ds_read_b128 a[184:187], v229 offset:53248
v_mfma_f32_16x16x32_bf16 v[160:163], a[136:139], a[144:147], v[160:163]
ds_read_b128 a[188:191], v229 offset:55296
ds_read_b64_tr_b16 a[108:109], v231 offset:12288
v_mfma_f32_16x16x32_bf16 v[168:171], a[136:139], a[148:151], v[168:171]
ds_read_b64_tr_b16 a[110:111], v231 offset:12800
v_mfma_f32_16x16x32_bf16 v[176:179], a[136:139], a[152:155], v[176:179]
v_mfma_f32_16x16x32_bf16 v[184:187], a[136:139], a[156:159], v[184:187]
v_mfma_f32_16x16x32_bf16 v[188:191], a[140:143], a[156:159], v[188:191]
v_mfma_f32_16x16x32_bf16 v[180:183], a[140:143], a[152:155], v[180:183]
v_mfma_f32_16x16x32_bf16 v[172:175], a[140:143], a[148:151], v[172:175]
v_mfma_f32_16x16x32_bf16 v[164:167], a[140:143], a[144:147], v[164:167]
s_waitcnt lgkmcnt(0)
v_mfma_f32_16x16x32_bf16 v[128:131], a[96:99], a[160:163], v[128:131]
ds_read_b64_tr_b16 a[128:129], v232 offset:8192
ds_read_b64_tr_b16 a[130:131], v232 offset:8704
v_mfma_f32_16x16x32_bf16 v[136:139], a[96:99], a[164:167], v[136:139]
ds_read_b64_tr_b16 a[132:133], v233 offset:8192
ds_read_b64_tr_b16 a[134:135], v233 offset:8704
v_mfma_f32_16x16x32_bf16 v[144:147], a[96:99], a[168:171], v[144:147]
ds_read_b64_tr_b16 a[136:137], v232 offset:12288
v_mfma_f32_16x16x32_bf16 v[152:155], a[96:99], a[172:175], v[152:155]
v_mfma_f32_16x16x32_bf16 v[156:159], a[100:103], a[172:175], v[156:159]
ds_read_b64_tr_b16 a[138:139], v232 offset:12800
v_mfma_f32_16x16x32_bf16 v[148:151], a[100:103], a[168:171], v[148:151]
ds_read_b64_tr_b16 a[140:141], v233 offset:12288
v_mfma_f32_16x16x32_bf16 v[140:143], a[100:103], a[164:167], v[140:143]
v_mfma_f32_16x16x32_bf16 v[132:135], a[100:103], a[160:163], v[132:135]
ds_read_b64_tr_b16 a[142:143], v233 offset:12800
v_mfma_f32_16x16x32_bf16 v[128:131], a[104:107], a[176:179], v[128:131]
v_mfma_f32_16x16x32_bf16 v[136:139], a[104:107], a[180:183], v[136:139]
v_mfma_f32_16x16x32_bf16 v[144:147], a[104:107], a[184:187], v[144:147]
v_mfma_f32_16x16x32_bf16 v[152:155], a[104:107], a[188:191], v[152:155]
v_mfma_f32_16x16x32_bf16 v[156:159], a[108:111], a[188:191], v[156:159]
v_mfma_f32_16x16x32_bf16 v[148:151], a[108:111], a[184:187], v[148:151]
v_mfma_f32_16x16x32_bf16 v[140:143], a[108:111], a[180:183], v[140:143]
v_mfma_f32_16x16x32_bf16 v[132:135], a[108:111], a[176:179], v[132:135]
s_waitcnt lgkmcnt(0)
v_mfma_f32_16x16x32_bf16 v[160:163], a[128:131], a[160:163], v[160:163]
s_add_u32 m0, s53, 8192
s_add_u32 s58, s54, 32768
buffer_load_dwordx4 v212, s[24:27], s58 offen lds
buffer_load_dwordx4 v213, s[24:27], s58 offen offset:1024 lds
buffer_load_dwordx4 v214, s[24:27], s58 offen offset:2048 lds
buffer_load_dwordx4 v215, s[24:27], s58 offen offset:3072 lds
s_waitcnt vmcnt(8)
v_mfma_f32_16x16x32_bf16 v[168:171], a[128:131], a[164:167], v[168:171]
ds_read_b64 a[96:97], v224 offset:0
ds_read_b64 a[98:99], v225 offset:0
v_mfma_f32_16x16x32_bf16 v[176:179], a[128:131], a[168:171], v[176:179]
ds_read_b64 a[100:101], v224 offset:2048
ds_read_b64 a[102:103], v225 offset:2048
v_cvt_pk_bf16_f32 v128, v128, v129
v_mfma_f32_16x16x32_bf16 v[184:187], a[128:131], a[172:175], v[184:187]
s_add_u32 m0, s53, 12288
s_add_u32 s58, s55, 0
v_cvt_pk_bf16_f32 v129, v130, v131
v_cvt_pk_bf16_f32 v130, v132, v133
v_mfma_f32_16x16x32_bf16 v[188:191], a[132:135], a[172:175], v[188:191]
ds_read_b64 a[104:105], v226 offset:2048
ds_read_b64 a[106:107], v227 offset:2048
v_cvt_pk_bf16_f32 v131, v134, v135
v_mfma_f32_16x16x32_bf16 v[180:183], a[132:135], a[168:171], v[180:183]
ds_read_b64 a[108:109], v226 offset:0
ds_write_b128 v235, v[128:131] offset:8192
v_cvt_pk_bf16_f32 v136, v136, v137
v_cvt_pk_bf16_f32 v137, v138, v139
v_mfma_f32_16x16x32_bf16 v[172:175], a[132:135], a[164:167], v[172:175]
buffer_load_dwordx4 v212, s[24:27], s58 offen lds
v_cvt_pk_bf16_f32 v138, v140, v141
v_mfma_f32_16x16x32_bf16 v[164:167], a[132:135], a[160:163], v[164:167]
buffer_load_dwordx4 v213, s[24:27], s58 offen offset:1024 lds
v_cvt_pk_bf16_f32 v139, v142, v143
v_mfma_f32_16x16x32_bf16 v[160:163], a[136:139], a[176:179], v[160:163]
ds_read_b64 a[110:111], v227 offset:0
ds_write_b128 v235, v[136:139] offset:9216
v_cvt_pk_bf16_f32 v144, v144, v145
v_cvt_pk_bf16_f32 v145, v146, v147
v_mfma_f32_16x16x32_bf16 v[168:171], a[136:139], a[180:183], v[168:171]
buffer_load_dwordx4 v214, s[24:27], s58 offen offset:2048 lds
v_cvt_pk_bf16_f32 v146, v148, v149
v_cvt_pk_bf16_f32 v147, v150, v151
v_mfma_f32_16x16x32_bf16 v[176:179], a[136:139], a[184:187], v[176:179]
buffer_load_dwordx4 v215, s[24:27], s58 offen offset:3072 lds
ds_write_b128 v235, v[144:147] offset:10240
v_mfma_f32_16x16x32_bf16 v[184:187], a[136:139], a[188:191], v[184:187]
v_cvt_pk_bf16_f32 v152, v152, v153
v_cvt_pk_bf16_f32 v153, v154, v155
v_cvt_pk_bf16_f32 v154, v156, v157
v_cvt_pk_bf16_f32 v155, v158, v159
v_mfma_f32_16x16x32_bf16 v[188:191], a[140:143], a[188:191], v[188:191]
ds_write_b128 v235, v[152:155] offset:11264
v_mfma_f32_16x16x32_bf16 v[180:183], a[140:143], a[184:187], v[180:183]
v_mfma_f32_16x16x32_bf16 v[172:175], a[140:143], a[180:183], v[172:175]
v_mfma_f32_16x16x32_bf16 v[164:167], a[140:143], a[176:179], v[164:167]
s_waitcnt lgkmcnt(3)
v_mfma_f32_16x16x32_bf16 v[0:3], a[96:99], v[128:131], 0
s_waitcnt vmcnt(8)
ds_read_b64 a[128:129], v224 offset:4096
v_mfma_f32_16x16x32_bf16 v[8:11], a[96:99], v[136:139], 0
ds_read_b64 a[130:131], v225 offset:4096
ds_read_b64 a[132:133], v224 offset:6144
v_mfma_f32_16x16x32_bf16 v[16:19], a[96:99], v[144:147], 0
ds_read_b64 a[134:135], v225 offset:6144
ds_read_b64 a[136:137], v226 offset:6144
v_cvt_pk_bf16_f32 v160, v160, v161
v_cvt_pk_bf16_f32 v161, v162, v163
v_cvt_pk_bf16_f32 v162, v164, v165
v_cvt_pk_bf16_f32 v163, v166, v167
v_mfma_f32_16x16x32_bf16 v[24:27], a[96:99], v[152:155], 0
s_add_u32 m0, s53, 0
s_add_u32 s58, s55, 16384
buffer_load_dwordx4 v212, s[24:27], s58 offen lds
ds_write_b128 v235, v[160:163] offset:12288
v_cvt_pk_bf16_f32 v168, v168, v169
v_cvt_pk_bf16_f32 v169, v170, v171
v_cvt_pk_bf16_f32 v170, v172, v173
v_cvt_pk_bf16_f32 v171, v174, v175
v_mfma_f32_16x16x32_bf16 v[28:31], a[100:103], v[152:155], 0
ds_read_b64 a[138:139], v227 offset:6144
ds_write_b128 v235, v[168:171] offset:13312
v_cvt_pk_bf16_f32 v176, v176, v177
v_cvt_pk_bf16_f32 v177, v178, v179
v_cvt_pk_bf16_f32 v178, v180, v181
v_cvt_pk_bf16_f32 v179, v182, v183
v_mfma_f32_16x16x32_bf16 v[20:23], a[100:103], v[144:147], 0
ds_read_b64 a[140:141], v226 offset:4096
ds_write_b128 v235, v[176:179] offset:14336
v_cvt_pk_bf16_f32 v184, v184, v185
v_cvt_pk_bf16_f32 v185, v186, v187
v_cvt_pk_bf16_f32 v186, v188, v189
v_cvt_pk_bf16_f32 v187, v190, v191
v_mfma_f32_16x16x32_bf16 v[12:15], a[100:103], v[136:139], 0
buffer_load_dwordx4 v213, s[24:27], s58 offen offset:1024 lds
v_mfma_f32_16x16x32_bf16 v[4:7], a[100:103], v[128:131], 0
ds_read_b64 a[142:143], v227 offset:4096
ds_write_b128 v235, v[184:187] offset:15360
v_mfma_f32_16x16x32_bf16 v[4:7], a[104:107], v[160:163], v[4:7]
buffer_load_dwordx4 v214, s[24:27], s58 offen offset:2048 lds
v_mfma_f32_16x16x32_bf16 v[12:15], a[104:107], v[168:171], v[12:15]
s_waitcnt lgkmcnt(0)
s_barrier
v_mfma_f32_16x16x32_bf16 v[20:23], a[104:107], v[176:179], v[20:23]
buffer_load_dwordx4 v215, s[24:27], s58 offen offset:3072 lds
v_mfma_f32_16x16x32_bf16 v[28:31], a[104:107], v[184:187], v[28:31]
v_sub_u32 v230, v230, v254
v_sub_u32 v231, v231, v254
v_sub_u32 v232, v232, v254
v_sub_u32 v233, v233, v254
v_mfma_f32_16x16x32_bf16 v[24:27], a[108:111], v[184:187], v[24:27]
v_mfma_f32_16x16x32_bf16 v[16:19], a[108:111], v[176:179], v[16:19]
v_mfma_f32_16x16x32_bf16 v[8:11], a[108:111], v[168:171], v[8:11]
v_mfma_f32_16x16x32_bf16 v[0:3], a[108:111], v[160:163], v[0:3]
v_mfma_f32_16x16x32_bf16 v[32:35], a[128:131], v[128:131], 0
s_waitcnt vmcnt(8)
ds_read_b64 a[96:97], v224 offset:8192
v_mfma_f32_16x16x32_bf16 v[40:43], a[128:131], v[136:139], 0
ds_read_b64 a[98:99], v225 offset:8192
ds_read_b64 a[100:101], v224 offset:10240
v_mfma_f32_16x16x32_bf16 v[48:51], a[128:131], v[144:147], 0
ds_read_b64 a[102:103], v225 offset:10240
ds_read_b64 a[104:105], v226 offset:10240
v_mfma_f32_16x16x32_bf16 v[56:59], a[128:131], v[152:155], 0
s_add_u32 m0, s53, 4096
s_add_u32 s58, s56, 16384
buffer_load_dwordx4 v212, s[24:27], s58 offen lds
v_mfma_f32_16x16x32_bf16 v[60:63], a[132:135], v[152:155], 0
ds_read_b64 a[106:107], v227 offset:10240
v_mfma_f32_16x16x32_bf16 v[52:55], a[132:135], v[144:147], 0
ds_read_b64 a[108:109], v226 offset:8192
v_mfma_f32_16x16x32_bf16 v[44:47], a[132:135], v[136:139], 0
buffer_load_dwordx4 v213, s[24:27], s58 offen offset:1024 lds
v_mfma_f32_16x16x32_bf16 v[36:39], a[132:135], v[128:131], 0
ds_read_b64 a[110:111], v227 offset:8192
v_mfma_f32_16x16x32_bf16 v[36:39], a[136:139], v[160:163], v[36:39]
buffer_load_dwordx4 v214, s[24:27], s58 offen offset:2048 lds
v_mfma_f32_16x16x32_bf16 v[44:47], a[136:139], v[168:171], v[44:47]
v_mfma_f32_16x16x32_bf16 v[52:55], a[136:139], v[176:179], v[52:55]
buffer_load_dwordx4 v215, s[24:27], s58 offen offset:3072 lds
v_mfma_f32_16x16x32_bf16 v[60:63], a[136:139], v[184:187], v[60:63]
v_mfma_f32_16x16x32_bf16 v[56:59], a[140:143], v[184:187], v[56:59]
v_mfma_f32_16x16x32_bf16 v[48:51], a[140:143], v[176:179], v[48:51]
v_mfma_f32_16x16x32_bf16 v[40:43], a[140:143], v[168:171], v[40:43]
v_mfma_f32_16x16x32_bf16 v[32:35], a[140:143], v[160:163], v[32:35]
s_waitcnt lgkmcnt(0)
v_mfma_f32_16x16x32_bf16 v[64:67], a[96:99], v[128:131], 0
s_waitcnt vmcnt(8)
ds_read_b64 a[128:129], v224 offset:12288
v_mfma_f32_16x16x32_bf16 v[72:75], a[96:99], v[136:139], 0
ds_read_b64 a[130:131], v225 offset:12288
ds_read_b128 a[0:3], v236 offset:8192
v_mfma_f32_16x16x32_bf16 v[80:83], a[96:99], v[144:147], 0
ds_read_b128 a[4:7], v236 offset:9216
ds_read_b128 a[8:11], v236 offset:10240
v_mfma_f32_16x16x32_bf16 v[88:91], a[96:99], v[152:155], 0
s_add_u32 m0, s53, 8192
s_add_u32 s58, s57, 16384
buffer_load_dwordx4 v212, s[24:27], s58 offen lds
v_mfma_f32_16x16x32_bf16 v[92:95], a[100:103], v[152:155], 0
ds_read_b128 a[12:15], v236 offset:11264
ds_read_b64 a[132:133], v224 offset:14336
v_mfma_f32_16x16x32_bf16 v[84:87], a[100:103], v[144:147], 0
ds_read_b64 a[134:135], v225 offset:14336
ds_read_b64 a[136:137], v226 offset:14336
v_mfma_f32_16x16x32_bf16 v[76:79], a[100:103], v[136:139], 0
ds_read_b64 a[138:139], v227 offset:14336
ds_read_b128 a[16:19], v236 offset:12288
v_mfma_f32_16x16x32_bf16 v[68:71], a[100:103], v[128:131], 0
buffer_load_dwordx4 v213, s[24:27], s58 offen offset:1024 lds
v_mfma_f32_16x16x32_bf16 v[68:71], a[104:107], v[160:163], v[68:71]
ds_read_b128 a[20:23], v236 offset:13312
ds_read_b128 a[24:27], v236 offset:14336
v_mfma_f32_16x16x32_bf16 v[76:79], a[104:107], v[168:171], v[76:79]
ds_read_b128 a[28:31], v236 offset:15360
ds_read_b64 a[140:141], v226 offset:12288
v_mfma_f32_16x16x32_bf16 v[84:87], a[104:107], v[176:179], v[84:87]
ds_read_b64 a[142:143], v227 offset:12288
v_mfma_f32_16x16x32_bf16 v[92:95], a[104:107], v[184:187], v[92:95]
buffer_load_dwordx4 v214, s[24:27], s58 offen offset:2048 lds
v_mfma_f32_16x16x32_bf16 v[88:91], a[108:111], v[184:187], v[88:91]
v_mfma_f32_16x16x32_bf16 v[80:83], a[108:111], v[176:179], v[80:83]
buffer_load_dwordx4 v215, s[24:27], s58 offen offset:3072 lds
v_mfma_f32_16x16x32_bf16 v[72:75], a[108:111], v[168:171], v[72:75]
v_mfma_f32_16x16x32_bf16 v[64:67], a[108:111], v[160:163], v[64:67]
s_waitcnt lgkmcnt(10)
v_mfma_f32_16x16x32_bf16 v[0:3], a[128:131], a[0:3], v[0:3]
ds_read_b64 a[96:97], v224 offset:16384
ds_read_b64 a[98:99], v225 offset:16384
v_mfma_f32_16x16x32_bf16 v[8:11], a[128:131], a[4:7], v[8:11]
ds_read_b128 a[32:35], v237 offset:8192
ds_read_b128 a[36:39], v237 offset:9216
v_mfma_f32_16x16x32_bf16 v[16:19], a[128:131], a[8:11], v[16:19]
ds_read_b128 a[40:43], v237 offset:10240
ds_read_b128 a[44:47], v237 offset:11264
v_mfma_f32_16x16x32_bf16 v[24:27], a[128:131], a[12:15], v[24:27]
ds_read_b64 a[100:101], v224 offset:18432
s_waitcnt lgkmcnt(7)
v_mfma_f32_16x16x32_bf16 v[28:31], a[132:135], a[12:15], v[28:31]
ds_read_b64 a[102:103], v225 offset:18432
ds_read_b64 a[104:105], v226 offset:18432
v_mfma_f32_16x16x32_bf16 v[20:23], a[132:135], a[8:11], v[20:23]
ds_read_b64 a[106:107], v227 offset:18432
ds_read_b128 a[48:51], v237 offset:12288
v_mfma_f32_16x16x32_bf16 v[12:15], a[132:135], a[4:7], v[12:15]
ds_read_b128 a[52:55], v237 offset:13312
s_add_u32 m0, s53, 12288
v_mfma_f32_16x16x32_bf16 v[4:7], a[132:135], a[0:3], v[4:7]
s_add_u32 s58, s55, 32768
buffer_load_dwordx4 v212, s[24:27], s58 offen lds
v_mfma_f32_16x16x32_bf16 v[4:7], a[136:139], a[16:19], v[4:7]
ds_read_b128 a[56:59], v237 offset:14336
ds_read_b128 a[60:63], v237 offset:15360
v_mfma_f32_16x16x32_bf16 v[12:15], a[136:139], a[20:23], v[12:15]
ds_read_b64 a[108:109], v226 offset:16384
ds_read_b64 a[110:111], v227 offset:16384
v_mfma_f32_16x16x32_bf16 v[20:23], a[136:139], a[24:27], v[20:23]
buffer_load_dwordx4 v213, s[24:27], s58 offen offset:1024 lds
v_mfma_f32_16x16x32_bf16 v[28:31], a[136:139], a[28:31], v[28:31]
v_mfma_f32_16x16x32_bf16 v[24:27], a[140:143], a[28:31], v[24:27]
buffer_load_dwordx4 v214, s[24:27], s58 offen offset:2048 lds
v_mfma_f32_16x16x32_bf16 v[16:19], a[140:143], a[24:27], v[16:19]
v_mfma_f32_16x16x32_bf16 v[8:11], a[140:143], a[20:23], v[8:11]
buffer_load_dwordx4 v215, s[24:27], s58 offen offset:3072 lds
v_mfma_f32_16x16x32_bf16 v[0:3], a[140:143], a[16:19], v[0:3]
s_waitcnt lgkmcnt(0)
v_mfma_f32_16x16x32_bf16 v[0:3], a[96:99], a[32:35], v[0:3]
ds_read_b64 a[128:129], v224 offset:20480
ds_read_b64 a[130:131], v225 offset:20480
v_mfma_f32_16x16x32_bf16 v[8:11], a[96:99], a[36:39], v[8:11]
ds_read_b128 a[64:67], v238 offset:8192
ds_read_b128 a[68:71], v238 offset:9216
v_mfma_f32_16x16x32_bf16 v[16:19], a[96:99], a[40:43], v[16:19]
ds_read_b128 a[72:75], v238 offset:10240
ds_read_b128 a[76:79], v238 offset:11264
v_mfma_f32_16x16x32_bf16 v[24:27], a[96:99], a[44:47], v[24:27]
s_add_u32 m0, s53, 16384
s_add_u32 s58, s56, 32768
v_mfma_f32_16x16x32_bf16 v[28:31], a[100:103], a[44:47], v[28:31]
ds_read_b64 a[132:133], v224 offset:22528
ds_read_b64 a[134:135], v225 offset:22528
v_mfma_f32_16x16x32_bf16 v[20:23], a[100:103], a[40:43], v[20:23]
ds_read_b64 a[136:137], v226 offset:22528
ds_read_b64 a[138:139], v227 offset:22528
buffer_load_dwordx4 v212, s[24:27], s58 offen lds
v_mfma_f32_16x16x32_bf16 v[12:15], a[100:103], a[36:39], v[12:15]
ds_read_b128 a[80:83], v238 offset:12288
ds_read_b128 a[84:87], v238 offset:13312
v_mfma_f32_16x16x32_bf16 v[4:7], a[100:103], a[32:35], v[4:7]
buffer_load_dwordx4 v213, s[24:27], s58 offen offset:1024 lds
v_mfma_f32_16x16x32_bf16 v[4:7], a[104:107], a[48:51], v[4:7]
ds_read_b128 a[88:91], v238 offset:14336
ds_read_b128 a[92:95], v238 offset:15360
v_mfma_f32_16x16x32_bf16 v[12:15], a[104:107], a[52:55], v[12:15]
ds_read_b64 a[140:141], v226 offset:20480
ds_read_b64 a[142:143], v227 offset:20480
v_mfma_f32_16x16x32_bf16 v[20:23], a[104:107], a[56:59], v[20:23]
buffer_load_dwordx4 v214, s[24:27], s58 offen offset:2048 lds
v_mfma_f32_16x16x32_bf16 v[28:31], a[104:107], a[60:63], v[28:31]
v_mfma_f32_16x16x32_bf16 v[24:27], a[108:111], a[60:63], v[24:27]
buffer_load_dwordx4 v215, s[24:27], s58 offen offset:3072 lds
v_mfma_f32_16x16x32_bf16 v[16:19], a[108:111], a[56:59], v[16:19]
v_mfma_f32_16x16x32_bf16 v[8:11], a[108:111], a[52:55], v[8:11]
v_mfma_f32_16x16x32_bf16 v[0:3], a[108:111], a[48:51], v[0:3]
s_waitcnt lgkmcnt(0)
v_mfma_f32_16x16x32_bf16 v[0:3], a[128:131], a[64:67], v[0:3]
s_waitcnt vmcnt(16)
ds_read_b64 a[96:97], v224 offset:0
v_mfma_f32_16x16x32_bf16 v[8:11], a[128:131], a[68:71], v[8:11]
ds_read_b64 a[98:99], v225 offset:0
ds_read_b64 a[100:101], v224 offset:2048
v_mfma_f32_16x16x32_bf16 v[16:19], a[128:131], a[72:75], v[16:19]
ds_read_b64 a[102:103], v225 offset:2048
ds_read_b64 a[104:105], v226 offset:2048
v_mfma_f32_16x16x32_bf16 v[24:27], a[128:131], a[76:79], v[24:27]
s_add_u32 m0, s53, 20480
s_add_u32 s58, s57, 32768
buffer_load_dwordx4 v212, s[24:27], s58 offen lds
v_mfma_f32_16x16x32_bf16 v[28:31], a[132:135], a[76:79], v[28:31]
ds_read_b64 a[106:107], v227 offset:2048
v_mfma_f32_16x16x32_bf16 v[20:23], a[132:135], a[72:75], v[20:23]
ds_read_b64 a[108:109], v226 offset:0
v_mfma_f32_16x16x32_bf16 v[12:15], a[132:135], a[68:71], v[12:15]
buffer_load_dwordx4 v213, s[24:27], s58 offen offset:1024 lds
v_mfma_f32_16x16x32_bf16 v[4:7], a[132:135], a[64:67], v[4:7]
ds_read_b64 a[110:111], v227 offset:0
v_mfma_f32_16x16x32_bf16 v[4:7], a[136:139], a[80:83], v[4:7]
buffer_load_dwordx4 v214, s[24:27], s58 offen offset:2048 lds
v_mfma_f32_16x16x32_bf16 v[12:15], a[136:139], a[84:87], v[12:15]
v_mfma_f32_16x16x32_bf16 v[20:23], a[136:139], a[88:91], v[20:23]
buffer_load_dwordx4 v215, s[24:27], s58 offen offset:3072 lds
v_mfma_f32_16x16x32_bf16 v[28:31], a[136:139], a[92:95], v[28:31]
v_mfma_f32_16x16x32_bf16 v[24:27], a[140:143], a[92:95], v[24:27]
v_mfma_f32_16x16x32_bf16 v[16:19], a[140:143], a[88:91], v[16:19]
v_mfma_f32_16x16x32_bf16 v[8:11], a[140:143], a[84:87], v[8:11]
v_mfma_f32_16x16x32_bf16 v[0:3], a[140:143], a[80:83], v[0:3]
s_waitcnt lgkmcnt(0)
v_mfma_f32_16x16x32_bf16 v[32:35], a[96:99], a[0:3], v[32:35]
s_waitcnt vmcnt(16)
ds_read_b64 a[128:129], v224 offset:4096
v_mfma_f32_16x16x32_bf16 v[40:43], a[96:99], a[4:7], v[40:43]
ds_read_b64 a[130:131], v225 offset:4096
ds_read_b64 a[132:133], v224 offset:6144
v_mfma_f32_16x16x32_bf16 v[48:51], a[96:99], a[8:11], v[48:51]
ds_read_b64 a[134:135], v225 offset:6144
ds_read_b64 a[136:137], v226 offset:6144
v_mfma_f32_16x16x32_bf16 v[56:59], a[96:99], a[12:15], v[56:59]
s_add_u32 m0, s53, 0
s_mov_b32 s58, 16384
buffer_load_dwordx4 v216, s[28:31], s58 offen lds
v_mfma_f32_16x16x32_bf16 v[60:63], a[100:103], a[12:15], v[60:63]
ds_read_b64 a[138:139], v227 offset:6144
v_max_f32 v242, v0, v1
v_max_f32 v243, v8, v9
v_mfma_f32_16x16x32_bf16 v[52:55], a[100:103], a[8:11], v[52:55]
ds_read_b64 a[140:141], v226 offset:4096
v_max_f32 v244, v16, v17
v_max_f32 v245, v24, v25
v_max3_f32 v242, v2, v3, v242
v_mfma_f32_16x16x32_bf16 v[44:47], a[100:103], a[4:7], v[44:47]
buffer_load_dwordx4 v217, s[28:31], s58 offen offset:1024 lds
v_max3_f32 v243, v10, v11, v243
v_mfma_f32_16x16x32_bf16 v[36:39], a[100:103], a[0:3], v[36:39]
buffer_load_dwordx4 v218, s[28:31], s58 offen offset:2048 lds
v_max3_f32 v244, v18, v19, v244
v_max3_f32 v245, v26, v27, v245
v_mfma_f32_16x16x32_bf16 v[36:39], a[104:107], a[16:19], v[36:39]
ds_read_b64 a[142:143], v227 offset:4096
v_max3_f32 v242, v4, v5, v242
v_max3_f32 v243, v12, v13, v243
v_mfma_f32_16x16x32_bf16 v[44:47], a[104:107], a[20:23], v[44:47]
buffer_load_dwordx4 v219, s[28:31], s58 offen offset:3072 lds
v_max3_f32 v244, v20, v21, v244
v_max3_f32 v245, v28, v29, v245
v_mfma_f32_16x16x32_bf16 v[52:55], a[104:107], a[24:27], v[52:55]
v_max3_f32 v242, v6, v7, v242
v_max3_f32 v243, v14, v15, v243
v_max3_f32 v244, v22, v23, v244
v_max3_f32 v245, v30, v31, v245
v_mfma_f32_16x16x32_bf16 v[60:63], a[104:107], a[28:31], v[60:63]
v_mov_b32 v200, v242
v_mov_b32 v201, v243
v_mov_b32 v202, v244
v_mfma_f32_16x16x32_bf16 v[56:59], a[108:111], a[28:31], v[56:59]
v_mov_b32 v203, v245
v_permlane32_swap_b32 v200, v202
v_mfma_f32_16x16x32_bf16 v[48:51], a[108:111], a[24:27], v[48:51]
v_permlane32_swap_b32 v201, v203
v_max_f32 v200, v200, v202
v_max_f32 v201, v201, v203
v_mfma_f32_16x16x32_bf16 v[40:43], a[108:111], a[20:23], v[40:43]
s_nop 0
v_permlane16_swap_b32 v200, v201
v_max_f32 v200, v200, v201
ds_write_b32 v239, v200 offset:0
v_mfma_f32_16x16x32_bf16 v[32:35], a[108:111], a[16:19], v[32:35]
ds_write_b32 v239, v200 offset:16384
ds_write_b32 v239, v200 offset:32768
ds_write_b32 v239, v200 offset:49152
s_waitcnt lgkmcnt(4)
v_mfma_f32_16x16x32_bf16 v[32:35], a[128:131], a[32:35], v[32:35]
s_waitcnt vmcnt(16)
ds_read_b64 a[96:97], v224 offset:8192
v_mov_b32 v246, 0x3f803f80
v_mfma_f32_16x16x32_bf16 v[40:43], a[128:131], a[36:39], v[40:43]
ds_read_b64 a[98:99], v225 offset:8192
ds_read_b64 a[100:101], v224 offset:10240
v_accvgpr_write_b32 a240, v246
v_mfma_f32_16x16x32_bf16 v[48:51], a[128:131], a[40:43], v[48:51]
ds_read_b64 a[102:103], v225 offset:10240
ds_read_b64 a[104:105], v226 offset:10240
v_accvgpr_write_b32 a241, v246
v_mfma_f32_16x16x32_bf16 v[56:59], a[128:131], a[44:47], v[56:59]
s_add_u32 m0, s53, 4096
s_mov_b32 s58, 81920
buffer_load_dwordx4 v216, s[28:31], s58 offen lds
v_accvgpr_write_b32 a242, v246
v_accvgpr_write_b32 a243, v246
v_mfma_f32_16x16x32_bf16 v[60:63], a[132:135], a[44:47], v[60:63]
ds_read_b64 a[106:107], v227 offset:10240
v_mfma_f32_16x16x32_bf16 v[52:55], a[132:135], a[40:43], v[52:55]
ds_read_b64 a[108:109], v226 offset:8192
v_mfma_f32_16x16x32_bf16 v[44:47], a[132:135], a[36:39], v[44:47]
buffer_load_dwordx4 v217, s[28:31], s58 offen offset:1024 lds
v_mfma_f32_16x16x32_bf16 v[36:39], a[132:135], a[32:35], v[36:39]
ds_read_b64 a[110:111], v227 offset:8192
s_waitcnt lgkmcnt(8)
s_barrier
v_mfma_f32_16x16x32_bf16 v[36:39], a[136:139], a[48:51], v[36:39]
buffer_load_dwordx4 v218, s[28:31], s58 offen offset:2048 lds
ds_read_b128 v[192:195], v240 offset:0
ds_read_b128 v[196:199], v240 offset:256
ds_read_b128 v[200:203], v240 offset:512
ds_read_b128 v[204:207], v240 offset:768
v_mfma_f32_16x16x32_bf16 v[44:47], a[136:139], a[52:55], v[44:47]
buffer_load_dwordx4 v219, s[28:31], s58 offen offset:3072 lds
v_mfma_f32_16x16x32_bf16 v[52:55], a[136:139], a[56:59], v[52:55]
v_mfma_f32_16x16x32_bf16 v[60:63], a[136:139], a[60:63], v[60:63]
v_mfma_f32_16x16x32_bf16 v[56:59], a[140:143], a[60:63], v[56:59]
v_mfma_f32_16x16x32_bf16 v[48:51], a[140:143], a[56:59], v[48:51]
v_mfma_f32_16x16x32_bf16 v[40:43], a[140:143], a[52:55], v[40:43]
v_mfma_f32_16x16x32_bf16 v[32:35], a[140:143], a[48:51], v[32:35]
s_waitcnt lgkmcnt(0)
v_max3_f32 v250, v192, v196, v200
v_max3_f32 v251, v193, v197, v201
v_max3_f32 v252, v194, v198, v202
v_max3_f32 v253, v195, v199, v203
v_accvgpr_read_b32 v192, a244
v_accvgpr_read_b32 v193, a245
v_accvgpr_read_b32 v194, a246
v_accvgpr_read_b32 v195, a247
v_max3_f32 v250, v250, v204, v192
v_max3_f32 v251, v251, v205, v193
v_max3_f32 v252, v252, v206, v194
v_max3_f32 v253, v253, v207, v195
v_mul_f32 v250, s63, v250
v_mul_f32 v251, s63, v251
v_mul_f32 v252, s63, v252
v_mfma_f32_16x16x32_bf16 v[32:35], a[96:99], a[64:67], v[32:35]
s_waitcnt vmcnt(16)
ds_read_b64 a[128:129], v224 offset:12288
v_mul_f32 v253, s63, v253
v_mfma_f32_16x16x32_bf16 v[40:43], a[96:99], a[68:71], v[40:43]
ds_read_b64 a[130:131], v225 offset:12288
ds_read_b64 a[132:133], v224 offset:14336
v_fma_f32 v0, v0, s63, -v250
v_mfma_f32_16x16x32_bf16 v[48:51], a[96:99], a[72:75], v[48:51]
ds_read_b64 a[134:135], v225 offset:14336
ds_read_b64 a[136:137], v226 offset:14336
v_fma_f32 v1, v1, s63, -v250
v_fma_f32 v2, v2, s63, -v250
v_mfma_f32_16x16x32_bf16 v[56:59], a[96:99], a[76:79], v[56:59]
s_add_u32 m0, s53, 8192
s_add_u32 s58, s54, 49152
buffer_load_dwordx4 v212, s[24:27], s58 offen lds
v_fma_f32 v3, v3, s63, -v250
v_mfma_f32_16x16x32_bf16 v[60:63], a[100:103], a[76:79], v[60:63]
ds_read_b64 a[138:139], v227 offset:14336
v_fma_f32 v4, v4, s63, -v250
v_fma_f32 v5, v5, s63, -v250
v_mfma_f32_16x16x32_bf16 v[52:55], a[100:103], a[72:75], v[52:55]
ds_read_b64 a[140:141], v226 offset:12288
v_fma_f32 v6, v6, s63, -v250
v_fma_f32 v7, v7, s63, -v250
v_mfma_f32_16x16x32_bf16 v[44:47], a[100:103], a[68:71], v[44:47]
buffer_load_dwordx4 v213, s[24:27], s58 offen offset:1024 lds
v_exp_f32 v0, v0
v_mfma_f32_16x16x32_bf16 v[36:39], a[100:103], a[64:67], v[36:39]
buffer_load_dwordx4 v214, s[24:27], s58 offen offset:2048 lds
v_mfma_f32_16x16x32_bf16 v[36:39], a[104:107], a[80:83], v[36:39]
ds_read_b64 a[142:143], v227 offset:12288
v_exp_f32 v1, v1
v_exp_f32 v2, v2
v_mfma_f32_16x16x32_bf16 v[44:47], a[104:107], a[84:87], v[44:47]
v_exp_f32 v3, v3
v_mfma_f32_16x16x32_bf16 v[52:55], a[104:107], a[88:91], v[52:55]
v_exp_f32 v4, v4
v_exp_f32 v5, v5
v_mfma_f32_16x16x32_bf16 v[60:63], a[104:107], a[92:95], v[60:63]
v_exp_f32 v6, v6
v_mfma_f32_16x16x32_bf16 v[56:59], a[108:111], a[92:95], v[56:59]
v_exp_f32 v7, v7
v_cvt_pk_bf16_f32 v196, v0, v1
v_cvt_pk_bf16_f32 v197, v2, v3
v_cvt_pk_bf16_f32 v198, v4, v5
v_mfma_f32_16x16x32_bf16 v[48:51], a[108:111], a[88:91], v[48:51]
v_cvt_pk_bf16_f32 v199, v6, v7
ds_write_b128 v235, v[196:199] offset:0
v_mfma_f32_16x16x32_bf16 v[40:43], a[108:111], a[84:87], v[40:43]
v_mfma_f32_16x16x32_bf16 a[224:227], a[240:243], v[196:199], 0
v_fma_f32 v8, v8, s63, -v251
v_fma_f32 v9, v9, s63, -v251
v_fma_f32 v10, v10, s63, -v251
v_mfma_f32_16x16x32_bf16 v[32:35], a[108:111], a[80:83], v[32:35]
v_fma_f32 v11, v11, s63, -v251
v_fma_f32 v12, v12, s63, -v251
s_waitcnt lgkmcnt(1)
v_mfma_f32_16x16x32_bf16 v[64:67], a[128:131], a[0:3], v[64:67]
s_waitcnt vmcnt(15)
ds_read_b64 a[96:97], v224 offset:16384
v_fma_f32 v13, v13, s63, -v251
v_fma_f32 v14, v14, s63, -v251
v_mfma_f32_16x16x32_bf16 v[72:75], a[128:131], a[4:7], v[72:75]
ds_read_b64 a[98:99], v225 offset:16384
ds_read_b64 a[100:101], v224 offset:18432
buffer_load_dwordx4 v215, s[24:27], s58 offen offset:3072 lds
v_fma_f32 v15, v15, s63, -v251
v_mfma_f32_16x16x32_bf16 v[80:83], a[128:131], a[8:11], v[80:83]
ds_read_b64 a[102:103], v225 offset:18432
ds_read_b64 a[104:105], v226 offset:18432
v_mfma_f32_16x16x32_bf16 v[88:91], a[128:131], a[12:15], v[88:91]
s_add_u32 m0, s53, 12288
s_add_u32 s58, s55, 49152
v_exp_f32 v8, v8
v_mfma_f32_16x16x32_bf16 v[92:95], a[132:135], a[12:15], v[92:95]
ds_read_b64 a[106:107], v227 offset:18432
v_exp_f32 v9, v9
v_mfma_f32_16x16x32_bf16 v[84:87], a[132:135], a[8:11], v[84:87]
ds_read_b64 a[108:109], v226 offset:16384
v_exp_f32 v10, v10
v_mfma_f32_16x16x32_bf16 v[76:79], a[132:135], a[4:7], v[76:79]
buffer_load_dwordx4 v212, s[24:27], s58 offen lds
v_exp_f32 v11, v11
v_mfma_f32_16x16x32_bf16 v[68:71], a[132:135], a[0:3], v[68:71]
buffer_load_dwordx4 v213, s[24:27], s58 offen offset:1024 lds
v_exp_f32 v12, v12
v_mfma_f32_16x16x32_bf16 v[68:71], a[136:139], a[16:19], v[68:71]
ds_read_b64 a[110:111], v227 offset:16384
v_exp_f32 v13, v13
v_mfma_f32_16x16x32_bf16 v[76:79], a[136:139], a[20:23], v[76:79]
buffer_load_dwordx4 v214, s[24:27], s58 offen offset:2048 lds
v_mfma_f32_16x16x32_bf16 v[84:87], a[136:139], a[24:27], v[84:87]
v_exp_f32 v14, v14
v_exp_f32 v15, v15
v_mfma_f32_16x16x32_bf16 v[92:95], a[136:139], a[28:31], v[92:95]
v_cvt_pk_bf16_f32 v192, v8, v9
v_cvt_pk_bf16_f32 v193, v10, v11
v_cvt_pk_bf16_f32 v194, v12, v13
v_cvt_pk_bf16_f32 v195, v14, v15
v_mfma_f32_16x16x32_bf16 v[88:91], a[140:143], a[28:31], v[88:91]
ds_write_b128 v235, v[192:195] offset:1024
v_mfma_f32_16x16x32_bf16 a[228:231], a[240:243], v[192:195], 0
v_fma_f32 v16, v16, s63, -v252
v_fma_f32 v17, v17, s63, -v252
v_fma_f32 v18, v18, s63, -v252
v_mfma_f32_16x16x32_bf16 v[80:83], a[140:143], a[24:27], v[80:83]
v_fma_f32 v19, v19, s63, -v252
v_fma_f32 v20, v20, s63, -v252
v_fma_f32 v21, v21, s63, -v252
v_mfma_f32_16x16x32_bf16 v[72:75], a[140:143], a[20:23], v[72:75]
v_fma_f32 v22, v22, s63, -v252
v_fma_f32 v23, v23, s63, -v252
v_mfma_f32_16x16x32_bf16 v[64:67], a[140:143], a[16:19], v[64:67]
v_exp_f32 v16, v16
v_exp_f32 v17, v17
s_waitcnt lgkmcnt(1)
v_mfma_f32_16x16x32_bf16 v[64:67], a[96:99], a[32:35], v[64:67]
s_waitcnt vmcnt(15)
ds_read_b64 a[128:129], v224 offset:20480
buffer_load_dwordx4 v215, s[24:27], s58 offen offset:3072 lds
v_mfma_f32_16x16x32_bf16 v[72:75], a[96:99], a[36:39], v[72:75]
ds_read_b64 a[130:131], v225 offset:20480
ds_read_b64 a[132:133], v224 offset:22528
v_exp_f32 v18, v18
v_mfma_f32_16x16x32_bf16 v[80:83], a[96:99], a[40:43], v[80:83]
ds_read_b64 a[134:135], v225 offset:22528
ds_read_b64 a[136:137], v226 offset:22528
v_mfma_f32_16x16x32_bf16 v[88:91], a[96:99], a[44:47], v[88:91]
s_add_u32 m0, s53, 16384
s_add_u32 s58, s56, 49152
v_exp_f32 v19, v19
v_mfma_f32_16x16x32_bf16 v[92:95], a[100:103], a[44:47], v[92:95]
ds_read_b64 a[138:139], v227 offset:22528
v_exp_f32 v20, v20
v_mfma_f32_16x16x32_bf16 v[84:87], a[100:103], a[40:43], v[84:87]
ds_read_b64 a[140:141], v226 offset:20480
v_exp_f32 v21, v21
v_mfma_f32_16x16x32_bf16 v[76:79], a[100:103], a[36:39], v[76:79]
buffer_load_dwordx4 v212, s[24:27], s58 offen lds
v_exp_f32 v22, v22
v_mfma_f32_16x16x32_bf16 v[68:71], a[100:103], a[32:35], v[68:71]
buffer_load_dwordx4 v213, s[24:27], s58 offen offset:1024 lds
v_exp_f32 v23, v23
v_mfma_f32_16x16x32_bf16 v[68:71], a[104:107], a[48:51], v[68:71]
ds_read_b64 a[142:143], v227 offset:20480
v_cvt_pk_bf16_f32 v196, v16, v17
v_cvt_pk_bf16_f32 v197, v18, v19
v_mfma_f32_16x16x32_bf16 v[76:79], a[104:107], a[52:55], v[76:79]
buffer_load_dwordx4 v214, s[24:27], s58 offen offset:2048 lds
v_cvt_pk_bf16_f32 v198, v20, v21
v_mfma_f32_16x16x32_bf16 v[84:87], a[104:107], a[56:59], v[84:87]
v_cvt_pk_bf16_f32 v199, v22, v23
ds_write_b128 v235, v[196:199] offset:2048
v_mfma_f32_16x16x32_bf16 v[92:95], a[104:107], a[60:63], v[92:95]
buffer_load_dwordx4 v215, s[24:27], s58 offen offset:3072 lds
v_mfma_f32_16x16x32_bf16 a[232:235], a[240:243], v[196:199], 0
v_fma_f32 v24, v24, s63, -v253
v_fma_f32 v25, v25, s63, -v253
v_fma_f32 v26, v26, s63, -v253
v_fma_f32 v27, v27, s63, -v253
v_mfma_f32_16x16x32_bf16 v[88:91], a[108:111], a[60:63], v[88:91]
v_fma_f32 v28, v28, s63, -v253
v_fma_f32 v29, v29, s63, -v253
v_fma_f32 v30, v30, s63, -v253
v_mfma_f32_16x16x32_bf16 v[80:83], a[108:111], a[56:59], v[80:83]
v_fma_f32 v31, v31, s63, -v253
v_exp_f32 v24, v24
v_mfma_f32_16x16x32_bf16 v[72:75], a[108:111], a[52:55], v[72:75]
v_exp_f32 v25, v25
v_mfma_f32_16x16x32_bf16 v[64:67], a[108:111], a[48:51], v[64:67]
v_exp_f32 v26, v26
v_exp_f32 v27, v27
s_waitcnt lgkmcnt(1)
v_mfma_f32_16x16x32_bf16 v[64:67], a[128:131], a[64:67], v[64:67]
s_waitcnt vmcnt(8)
v_mfma_f32_16x16x32_bf16 v[72:75], a[128:131], a[68:71], v[72:75]
ds_read_b64 a[96:97], v224 offset:8192
ds_read_b64 a[98:99], v225 offset:8192
v_exp_f32 v28, v28
v_mfma_f32_16x16x32_bf16 v[80:83], a[128:131], a[72:75], v[80:83]
ds_read_b64 a[100:101], v224 offset:10240
ds_read_b64 a[102:103], v225 offset:10240
v_mfma_f32_16x16x32_bf16 v[88:91], a[128:131], a[76:79], v[88:91]
s_add_u32 m0, s53, 20480
s_add_u32 s58, s57, 49152
buffer_load_dwordx4 v212, s[24:27], s58 offen lds
v_exp_f32 v29, v29
v_mfma_f32_16x16x32_bf16 v[92:95], a[132:135], a[76:79], v[92:95]
ds_read_b64 a[104:105], v226 offset:10240
ds_read_b64 a[106:107], v227 offset:10240
v_exp_f32 v30, v30
v_mfma_f32_16x16x32_bf16 v[84:87], a[132:135], a[72:75], v[84:87]
ds_read_b64 a[108:109], v226 offset:8192
v_exp_f32 v31, v31
v_mfma_f32_16x16x32_bf16 v[76:79], a[132:135], a[68:71], v[76:79]
buffer_load_dwordx4 v213, s[24:27], s58 offen offset:1024 lds
v_cvt_pk_bf16_f32 v192, v24, v25
v_mfma_f32_16x16x32_bf16 v[68:71], a[132:135], a[64:67], v[68:71]
buffer_load_dwordx4 v214, s[24:27], s58 offen offset:2048 lds
v_cvt_pk_bf16_f32 v193, v26, v27
v_mfma_f32_16x16x32_bf16 v[68:71], a[136:139], a[80:83], v[68:71]
ds_read_b64 a[110:111], v227 offset:8192
v_cvt_pk_bf16_f32 v194, v28, v29
v_cvt_pk_bf16_f32 v195, v30, v31
v_mfma_f32_16x16x32_bf16 v[76:79], a[136:139], a[84:87], v[76:79]
buffer_load_dwordx4 v215, s[24:27], s58 offen offset:3072 lds
ds_write_b128 v235, v[192:195] offset:3072
v_mfma_f32_16x16x32_bf16 v[84:87], a[136:139], a[88:91], v[84:87]
v_mfma_f32_16x16x32_bf16 a[236:239], a[240:243], v[192:195], 0
v_max3_f32 v242, v32, v33, v242
v_max3_f32 v243, v40, v41, v243
v_max3_f32 v244, v48, v49, v244
v_mfma_f32_16x16x32_bf16 v[92:95], a[136:139], a[92:95], v[92:95]
v_max3_f32 v245, v56, v57, v245
v_max3_f32 v242, v34, v35, v242
v_max3_f32 v243, v42, v43, v243
v_mfma_f32_16x16x32_bf16 v[88:91], a[140:143], a[92:95], v[88:91]
v_max3_f32 v244, v50, v51, v244
v_max3_f32 v245, v58, v59, v245
v_max3_f32 v242, v36, v37, v242
v_max3_f32 v243, v44, v45, v243
v_mfma_f32_16x16x32_bf16 v[80:83], a[140:143], a[88:91], v[80:83]
v_max3_f32 v244, v52, v53, v244
v_max3_f32 v245, v60, v61, v245
v_max3_f32 v242, v38, v39, v242
v_mfma_f32_16x16x32_bf16 v[72:75], a[140:143], a[84:87], v[72:75]
v_max3_f32 v243, v46, v47, v243
v_max3_f32 v244, v54, v55, v244
v_max3_f32 v245, v62, v63, v245
v_mfma_f32_16x16x32_bf16 v[64:67], a[140:143], a[80:83], v[64:67]
v_fma_f32 v32, v32, s63, -v250
v_fma_f32 v33, v33, s63, -v250
s_waitcnt lgkmcnt(1)
v_mfma_f32_16x16x32_bf16 v[96:99], a[96:99], v[128:131], 0
s_waitcnt vmcnt(8)
ds_read_b64 a[128:129], v224 offset:12288
v_fma_f32 v34, v34, s63, -v250
v_mfma_f32_16x16x32_bf16 v[104:107], a[96:99], v[136:139], 0
ds_read_b64 a[130:131], v225 offset:12288
ds_read_b64 a[132:133], v224 offset:14336
v_fma_f32 v35, v35, s63, -v250
v_fma_f32 v36, v36, s63, -v250
v_mfma_f32_16x16x32_bf16 v[112:115], a[96:99], v[144:147], 0
ds_read_b64 a[134:135], v225 offset:14336
ds_read_b64 a[136:137], v226 offset:14336
v_fma_f32 v37, v37, s63, -v250
v_mfma_f32_16x16x32_bf16 v[120:123], a[96:99], v[152:155], 0
s_add_u32 m0, s53, 8192
s_mov_b32 s58, 0
buffer_load_dwordx4 v216, s[28:31], s58 offen lds
v_fma_f32 v38, v38, s63, -v250
v_mfma_f32_16x16x32_bf16 v[124:127], a[100:103], v[152:155], 0
ds_read_b64 a[138:139], v227 offset:14336
v_fma_f32 v39, v39, s63, -v250
v_mfma_f32_16x16x32_bf16 v[116:119], a[100:103], v[144:147], 0
ds_read_b64 a[140:141], v226 offset:12288
v_exp_f32 v32, v32
v_mfma_f32_16x16x32_bf16 v[108:111], a[100:103], v[136:139], 0
buffer_load_dwordx4 v217, s[28:31], s58 offen offset:1024 lds
v_exp_f32 v33, v33
v_mfma_f32_16x16x32_bf16 v[100:103], a[100:103], v[128:131], 0
buffer_load_dwordx4 v218, s[28:31], s58 offen offset:2048 lds
v_exp_f32 v34, v34
v_mfma_f32_16x16x32_bf16 v[100:103], a[104:107], v[160:163], v[100:103]
ds_read_b64 a[142:143], v227 offset:12288
v_exp_f32 v35, v35
v_mfma_f32_16x16x32_bf16 v[108:111], a[104:107], v[168:171], v[108:111]
buffer_load_dwordx4 v219, s[28:31], s58 offen offset:3072 lds
v_mfma_f32_16x16x32_bf16 v[116:119], a[104:107], v[176:179], v[116:119]
v_exp_f32 v36, v36
v_exp_f32 v37, v37
v_mfma_f32_16x16x32_bf16 v[124:127], a[104:107], v[184:187], v[124:127]
v_exp_f32 v38, v38
v_exp_f32 v39, v39
v_mfma_f32_16x16x32_bf16 v[120:123], a[108:111], v[184:187], v[120:123]
v_cvt_pk_bf16_f32 v196, v32, v33
v_cvt_pk_bf16_f32 v197, v34, v35
v_cvt_pk_bf16_f32 v198, v36, v37
v_mfma_f32_16x16x32_bf16 v[112:115], a[108:111], v[176:179], v[112:115]
v_cvt_pk_bf16_f32 v199, v38, v39
ds_write_b128 v235, v[196:199] offset:4096
v_mfma_f32_16x16x32_bf16 v[104:107], a[108:111], v[168:171], v[104:107]
v_mfma_f32_16x16x32_bf16 a[224:227], a[240:243], v[196:199], a[224:227]
v_fma_f32 v40, v40, s63, -v251
v_fma_f32 v41, v41, s63, -v251
v_fma_f32 v42, v42, s63, -v251
v_mfma_f32_16x16x32_bf16 v[96:99], a[108:111], v[160:163], v[96:99]
v_fma_f32 v43, v43, s63, -v251
v_fma_f32 v44, v44, s63, -v251
s_waitcnt lgkmcnt(1)
v_mfma_f32_16x16x32_bf16 v[96:99], a[128:131], a[0:3], v[96:99]
s_waitcnt vmcnt(8)
ds_read_b64 a[96:97], v224 offset:16384
v_fma_f32 v45, v45, s63, -v251
v_fma_f32 v46, v46, s63, -v251
v_mfma_f32_16x16x32_bf16 v[104:107], a[128:131], a[4:7], v[104:107]
ds_read_b64 a[98:99], v225 offset:16384
ds_read_b64 a[100:101], v224 offset:18432
v_fma_f32 v47, v47, s63, -v251
v_mfma_f32_16x16x32_bf16 v[112:115], a[128:131], a[8:11], v[112:115]
ds_read_b64 a[102:103], v225 offset:18432
ds_read_b64 a[104:105], v226 offset:18432
v_mfma_f32_16x16x32_bf16 v[120:123], a[128:131], a[12:15], v[120:123]
s_add_u32 m0, s53, 12288
s_mov_b32 s58, 65536
buffer_load_dwordx4 v216, s[28:31], s58 offen lds
v_exp_f32 v40, v40
v_mfma_f32_16x16x32_bf16 v[124:127], a[132:135], a[12:15], v[124:127]
ds_read_b64 a[106:107], v227 offset:18432
v_exp_f32 v41, v41
v_mfma_f32_16x16x32_bf16 v[116:119], a[132:135], a[8:11], v[116:119]
ds_read_b64 a[108:109], v226 offset:16384
v_exp_f32 v42, v42
v_mfma_f32_16x16x32_bf16 v[108:111], a[132:135], a[4:7], v[108:111]
buffer_load_dwordx4 v217, s[28:31], s58 offen offset:1024 lds
v_exp_f32 v43, v43
v_mfma_f32_16x16x32_bf16 v[100:103], a[132:135], a[0:3], v[100:103]
buffer_load_dwordx4 v218, s[28:31], s58 offen offset:2048 lds
v_mfma_f32_16x16x32_bf16 v[100:103], a[136:139], a[16:19], v[100:103]
ds_read_b64 a[110:111], v227 offset:16384
v_exp_f32 v44, v44
v_mfma_f32_16x16x32_bf16 v[108:111], a[136:139], a[20:23], v[108:111]
buffer_load_dwordx4 v219, s[28:31], s58 offen offset:3072 lds
v_exp_f32 v45, v45
v_mfma_f32_16x16x32_bf16 v[116:119], a[136:139], a[24:27], v[116:119]
v_exp_f32 v46, v46
v_mfma_f32_16x16x32_bf16 v[124:127], a[136:139], a[28:31], v[124:127]
v_exp_f32 v47, v47
v_cvt_pk_bf16_f32 v192, v40, v41
v_cvt_pk_bf16_f32 v193, v42, v43
v_cvt_pk_bf16_f32 v194, v44, v45
v_mfma_f32_16x16x32_bf16 v[120:123], a[140:143], a[28:31], v[120:123]
v_cvt_pk_bf16_f32 v195, v46, v47
ds_write_b128 v235, v[192:195] offset:5120
v_mfma_f32_16x16x32_bf16 v[112:115], a[140:143], a[24:27], v[112:115]
v_mfma_f32_16x16x32_bf16 a[228:231], a[240:243], v[192:195], a[228:231]
v_fma_f32 v48, v48, s63, -v252
v_fma_f32 v49, v49, s63, -v252
v_fma_f32 v50, v50, s63, -v252
v_mfma_f32_16x16x32_bf16 v[104:107], a[140:143], a[20:23], v[104:107]
v_fma_f32 v51, v51, s63, -v252
v_fma_f32 v52, v52, s63, -v252
v_fma_f32 v53, v53, s63, -v252
v_mfma_f32_16x16x32_bf16 v[96:99], a[140:143], a[16:19], v[96:99]
v_fma_f32 v54, v54, s63, -v252
v_fma_f32 v55, v55, s63, -v252
s_waitcnt lgkmcnt(1)
v_mfma_f32_16x16x32_bf16 v[96:99], a[96:99], a[32:35], v[96:99]
s_waitcnt vmcnt(8)
ds_read_b64 a[128:129], v224 offset:20480
v_mfma_f32_16x16x32_bf16 v[104:107], a[96:99], a[36:39], v[104:107]
ds_read_b64 a[130:131], v225 offset:20480
ds_read_b64 a[132:133], v224 offset:22528
v_exp_f32 v48, v48
v_mfma_f32_16x16x32_bf16 v[112:115], a[96:99], a[40:43], v[112:115]
ds_read_b64 a[134:135], v225 offset:22528
ds_read_b64 a[136:137], v226 offset:22528
v_exp_f32 v49, v49
v_mfma_f32_16x16x32_bf16 v[120:123], a[96:99], a[44:47], v[120:123]
s_add_u32 m0, s53, 16384
s_mov_b32 s58, 131072
buffer_load_dwordx4 v216, s[28:31], s58 offen lds
v_mfma_f32_16x16x32_bf16 v[124:127], a[100:103], a[44:47], v[124:127]
ds_read_b64 a[138:139], v227 offset:22528
v_exp_f32 v50, v50
v_mfma_f32_16x16x32_bf16 v[116:119], a[100:103], a[40:43], v[116:119]
ds_read_b64 a[140:141], v226 offset:20480
v_exp_f32 v51, v51
v_mfma_f32_16x16x32_bf16 v[108:111], a[100:103], a[36:39], v[108:111]
buffer_load_dwordx4 v217, s[28:31], s58 offen offset:1024 lds
v_exp_f32 v52, v52
v_mfma_f32_16x16x32_bf16 v[100:103], a[100:103], a[32:35], v[100:103]
buffer_load_dwordx4 v218, s[28:31], s58 offen offset:2048 lds
v_exp_f32 v53, v53
v_mfma_f32_16x16x32_bf16 v[100:103], a[104:107], a[48:51], v[100:103]
ds_read_b64 a[142:143], v227 offset:20480
v_exp_f32 v54, v54
v_mfma_f32_16x16x32_bf16 v[108:111], a[104:107], a[52:55], v[108:111]
buffer_load_dwordx4 v219, s[28:31], s58 offen offset:3072 lds
v_mfma_f32_16x16x32_bf16 v[116:119], a[104:107], a[56:59], v[116:119]
v_exp_f32 v55, v55
v_cvt_pk_bf16_f32 v196, v48, v49
v_cvt_pk_bf16_f32 v197, v50, v51
v_mfma_f32_16x16x32_bf16 v[124:127], a[104:107], a[60:63], v[124:127]
v_cvt_pk_bf16_f32 v198, v52, v53
v_cvt_pk_bf16_f32 v199, v54, v55
v_mfma_f32_16x16x32_bf16 v[120:123], a[108:111], a[60:63], v[120:123]
ds_write_b128 v235, v[196:199] offset:6144
v_mfma_f32_16x16x32_bf16 a[232:235], a[240:243], v[196:199], a[232:235]
v_fma_f32 v56, v56, s63, -v253
v_fma_f32 v57, v57, s63, -v253
v_fma_f32 v58, v58, s63, -v253
v_fma_f32 v59, v59, s63, -v253
v_mfma_f32_16x16x32_bf16 v[112:115], a[108:111], a[56:59], v[112:115]
v_fma_f32 v60, v60, s63, -v253
v_fma_f32 v61, v61, s63, -v253
v_fma_f32 v62, v62, s63, -v253
v_fma_f32 v63, v63, s63, -v253
v_mfma_f32_16x16x32_bf16 v[104:107], a[108:111], a[52:55], v[104:107]
v_exp_f32 v56, v56
v_mfma_f32_16x16x32_bf16 v[96:99], a[108:111], a[48:51], v[96:99]
v_exp_f32 v57, v57
s_waitcnt lgkmcnt(1)
v_mfma_f32_16x16x32_bf16 v[96:99], a[128:131], a[64:67], v[96:99]
s_waitcnt lgkmcnt(0)
s_barrier
v_exp_f32 v58, v58
v_mfma_f32_16x16x32_bf16 v[104:107], a[128:131], a[68:71], v[104:107]
s_waitcnt vmcnt(8)
ds_read_b64_tr_b16 a[96:97], v230 offset:8192
v_mfma_f32_16x16x32_bf16 v[112:115], a[128:131], a[72:75], v[112:115]
ds_read_b64_tr_b16 a[98:99], v230 offset:10240
ds_read_b128 a[112:115], v234 offset:0
v_exp_f32 v59, v59
v_mfma_f32_16x16x32_bf16 v[120:123], a[128:131], a[76:79], v[120:123]
s_add_u32 m0, s53, 20480
s_mov_b32 s58, 196608
buffer_load_dwordx4 v216, s[28:31], s58 offen lds
v_mfma_f32_16x16x32_bf16 v[124:127], a[132:135], a[76:79], v[124:127]
ds_read_b128 a[116:119], v234 offset:1024
ds_read_b128 a[120:123], v234 offset:2048
v_exp_f32 v60, v60
v_mfma_f32_16x16x32_bf16 v[116:119], a[132:135], a[72:75], v[116:119]
ds_read_b128 a[124:127], v234 offset:3072
ds_read_b64_tr_b16 a[100:101], v231 offset:8192
v_exp_f32 v61, v61
v_mfma_f32_16x16x32_bf16 v[108:111], a[132:135], a[68:71], v[108:111]
ds_read_b64_tr_b16 a[102:103], v231 offset:10240
ds_read_b64_tr_b16 a[104:105], v232 offset:8192
v_mfma_f32_16x16x32_bf16 v[100:103], a[132:135], a[64:67], v[100:103]
buffer_load_dwordx4 v217, s[28:31], s58 offen offset:1024 lds
v_exp_f32 v62, v62
v_mfma_f32_16x16x32_bf16 v[100:103], a[136:139], a[80:83], v[100:103]
ds_read_b64_tr_b16 a[106:107], v232 offset:10240
ds_read_b64_tr_b16 a[108:109], v233 offset:8192
v_mfma_f32_16x16x32_bf16 v[108:111], a[136:139], a[84:87], v[108:111]
ds_read_b64_tr_b16 a[110:111], v233 offset:10240
v_exp_f32 v63, v63
v_cvt_pk_bf16_f32 v192, v56, v57
v_mfma_f32_16x16x32_bf16 v[116:119], a[136:139], a[88:91], v[116:119]
buffer_load_dwordx4 v218, s[28:31], s58 offen offset:2048 lds
v_cvt_pk_bf16_f32 v193, v58, v59
v_mfma_f32_16x16x32_bf16 v[124:127], a[136:139], a[92:95], v[124:127]
buffer_load_dwordx4 v219, s[28:31], s58 offen offset:3072 lds
v_cvt_pk_bf16_f32 v194, v60, v61
v_mfma_f32_16x16x32_bf16 v[120:123], a[140:143], a[92:95], v[120:123]
v_cvt_pk_bf16_f32 v195, v62, v63
ds_write_b128 v235, v[192:195] offset:7168
s_nop 0
v_mfma_f32_16x16x32_bf16 a[236:239], a[240:243], v[192:195], a[236:239]
v_max3_f32 v242, v64, v65, v242
v_max3_f32 v243, v72, v73, v243
v_max3_f32 v244, v80, v81, v244
v_mfma_f32_16x16x32_bf16 v[112:115], a[140:143], a[88:91], v[112:115]
v_max3_f32 v245, v88, v89, v245
v_max3_f32 v242, v66, v67, v242
v_max3_f32 v243, v74, v75, v243
v_mfma_f32_16x16x32_bf16 v[104:107], a[140:143], a[84:87], v[104:107]
v_max3_f32 v244, v82, v83, v244
v_max3_f32 v245, v90, v91, v245
v_max3_f32 v242, v68, v69, v242
v_mfma_f32_16x16x32_bf16 v[96:99], a[140:143], a[80:83], v[96:99]
v_max3_f32 v243, v76, v77, v243
v_max3_f32 v244, v84, v85, v244
s_waitcnt lgkmcnt(1)
v_mfma_f32_16x16x32_bf16 v[128:131], a[96:99], a[112:115], 0
s_waitcnt vmcnt(8)
ds_read_b64_tr_b16 a[128:129], v230 offset:12288
v_max3_f32 v245, v92, v93, v245
v_mfma_f32_16x16x32_bf16 v[136:139], a[96:99], a[116:119], 0
ds_read_b64_tr_b16 a[130:131], v230 offset:14336
ds_read_b128 a[144:147], v234 offset:16384
v_max3_f32 v242, v70, v71, v242
v_mfma_f32_16x16x32_bf16 v[144:147], a[96:99], a[120:123], 0
ds_read_b128 a[148:151], v234 offset:17408
ds_read_b128 a[152:155], v234 offset:18432
v_max3_f32 v243, v78, v79, v243
v_mfma_f32_16x16x32_bf16 v[152:155], a[96:99], a[124:127], 0
s_add_u32 m0, s53, 8192
s_mov_b32 s58, 147456
buffer_load_dwordx4 v216, s[28:31], s58 offen lds
v_max3_f32 v244, v86, v87, v244
v_mfma_f32_16x16x32_bf16 v[156:159], a[100:103], a[124:127], 0
ds_read_b128 a[156:159], v234 offset:19456
ds_read_b64_tr_b16 a[132:133], v231 offset:12288
v_max3_f32 v245, v94, v95, v245
v_mfma_f32_16x16x32_bf16 v[148:151], a[100:103], a[120:123], 0
ds_read_b64_tr_b16 a[134:135], v231 offset:14336
ds_read_b64_tr_b16 a[136:137], v232 offset:12288
v_fma_f32 v64, v64, s63, -v250
v_fma_f32 v65, v65, s63, -v250
v_mfma_f32_16x16x32_bf16 v[140:143], a[100:103], a[116:119], 0
ds_read_b64_tr_b16 a[138:139], v232 offset:14336
v_fma_f32 v66, v66, s63, -v250
v_fma_f32 v67, v67, s63, -v250
v_mfma_f32_16x16x32_bf16 v[132:135], a[100:103], a[112:115], 0
buffer_load_dwordx4 v217, s[28:31], s58 offen offset:1024 lds
v_fma_f32 v68, v68, s63, -v250
v_mfma_f32_16x16x32_bf16 v[160:163], a[104:107], a[112:115], 0
ds_read_b64_tr_b16 a[140:141], v233 offset:12288
ds_read_b64_tr_b16 a[142:143], v233 offset:14336
v_fma_f32 v69, v69, s63, -v250
v_mfma_f32_16x16x32_bf16 v[168:171], a[104:107], a[116:119], 0
buffer_load_dwordx4 v218, s[28:31], s58 offen offset:2048 lds
v_fma_f32 v70, v70, s63, -v250
v_mfma_f32_16x16x32_bf16 v[176:179], a[104:107], a[120:123], 0
buffer_load_dwordx4 v219, s[28:31], s58 offen offset:3072 lds
v_fma_f32 v71, v71, s63, -v250
v_mfma_f32_16x16x32_bf16 v[184:187], a[104:107], a[124:127], 0
v_exp_f32 v64, v64
v_mfma_f32_16x16x32_bf16 v[188:191], a[108:111], a[124:127], 0
v_exp_f32 v65, v65
v_exp_f32 v66, v66
v_mfma_f32_16x16x32_bf16 v[180:183], a[108:111], a[120:123], 0
v_exp_f32 v67, v67
v_exp_f32 v68, v68
v_mfma_f32_16x16x32_bf16 v[172:175], a[108:111], a[116:119], 0
v_exp_f32 v69, v69
v_mfma_f32_16x16x32_bf16 v[164:167], a[108:111], a[112:115], 0
v_exp_f32 v70, v70
s_waitcnt lgkmcnt(0)
v_mfma_f32_16x16x32_bf16 v[128:131], a[128:131], a[144:147], v[128:131]
s_waitcnt vmcnt(8)
ds_read_b64_tr_b16 a[96:97], v230 offset:16384
v_exp_f32 v71, v71
v_mfma_f32_16x16x32_bf16 v[136:139], a[128:131], a[148:151], v[136:139]
ds_read_b64_tr_b16 a[98:99], v230 offset:18432
ds_read_b128 a[112:115], v234 offset:32768
v_cvt_pk_bf16_f32 v196, v64, v65
v_mfma_f32_16x16x32_bf16 v[144:147], a[128:131], a[152:155], v[144:147]
ds_read_b128 a[116:119], v234 offset:33792
ds_read_b128 a[120:123], v234 offset:34816
v_cvt_pk_bf16_f32 v197, v66, v67
v_mfma_f32_16x16x32_bf16 v[152:155], a[128:131], a[156:159], v[152:155]
s_add_u32 m0, s53, 12288
s_mov_b32 s58, 212992
buffer_load_dwordx4 v216, s[28:31], s58 offen lds
v_cvt_pk_bf16_f32 v198, v68, v69
v_mfma_f32_16x16x32_bf16 v[156:159], a[132:135], a[156:159], v[156:159]
ds_read_b128 a[124:127], v234 offset:35840
ds_read_b64_tr_b16 a[100:101], v231 offset:16384
v_cvt_pk_bf16_f32 v199, v70, v71
v_mfma_f32_16x16x32_bf16 v[148:151], a[132:135], a[152:155], v[148:151]
ds_read_b64_tr_b16 a[102:103], v231 offset:18432
ds_read_b64_tr_b16 a[104:105], v232 offset:16384
ds_write_b128 v235, v[196:199] offset:8192
v_mfma_f32_16x16x32_bf16 v[140:143], a[132:135], a[148:151], v[140:143]
ds_read_b64_tr_b16 a[106:107], v232 offset:18432
v_mfma_f32_16x16x32_bf16 a[224:227], a[240:243], v[196:199], a[224:227]
v_fma_f32 v72, v72, s63, -v251
v_fma_f32 v73, v73, s63, -v251
v_fma_f32 v74, v74, s63, -v251
v_mfma_f32_16x16x32_bf16 v[132:135], a[132:135], a[144:147], v[132:135]
buffer_load_dwordx4 v217, s[28:31], s58 offen offset:1024 lds
v_fma_f32 v75, v75, s63, -v251
v_mfma_f32_16x16x32_bf16 v[160:163], a[136:139], a[144:147], v[160:163]
ds_read_b64_tr_b16 a[108:109], v233 offset:16384
ds_read_b64_tr_b16 a[110:111], v233 offset:18432
v_fma_f32 v76, v76, s63, -v251
v_mfma_f32_16x16x32_bf16 v[168:171], a[136:139], a[148:151], v[168:171]
buffer_load_dwordx4 v218, s[28:31], s58 offen offset:2048 lds
v_fma_f32 v77, v77, s63, -v251
v_mfma_f32_16x16x32_bf16 v[176:179], a[136:139], a[152:155], v[176:179]
buffer_load_dwordx4 v219, s[28:31], s58 offen offset:3072 lds
v_fma_f32 v78, v78, s63, -v251
v_mfma_f32_16x16x32_bf16 v[184:187], a[136:139], a[156:159], v[184:187]
v_fma_f32 v79, v79, s63, -v251
v_exp_f32 v72, v72
v_mfma_f32_16x16x32_bf16 v[188:191], a[140:143], a[156:159], v[188:191]
v_exp_f32 v73, v73
v_mfma_f32_16x16x32_bf16 v[180:183], a[140:143], a[152:155], v[180:183]
v_exp_f32 v74, v74
v_exp_f32 v75, v75
v_mfma_f32_16x16x32_bf16 v[172:175], a[140:143], a[148:151], v[172:175]
v_exp_f32 v76, v76
v_exp_f32 v77, v77
v_mfma_f32_16x16x32_bf16 v[164:167], a[140:143], a[144:147], v[164:167]
v_exp_f32 v78, v78
s_waitcnt lgkmcnt(0)
v_mfma_f32_16x16x32_bf16 v[128:131], a[96:99], a[112:115], v[128:131]
s_waitcnt vmcnt(8)
ds_read_b64_tr_b16 a[128:129], v230 offset:20480
v_mfma_f32_16x16x32_bf16 v[136:139], a[96:99], a[116:119], v[136:139]
ds_read_b64_tr_b16 a[130:131], v230 offset:22528
ds_read_b128 a[144:147], v234 offset:49152
v_exp_f32 v79, v79
v_mfma_f32_16x16x32_bf16 v[144:147], a[96:99], a[120:123], v[144:147]
ds_read_b128 a[148:151], v234 offset:50176
ds_read_b128 a[152:155], v234 offset:51200
v_cvt_pk_bf16_f32 v192, v72, v73
v_mfma_f32_16x16x32_bf16 v[152:155], a[96:99], a[124:127], v[152:155]
s_add_u32 m0, s53, 16384
s_mov_b32 s58, 32768
buffer_load_dwordx4 v216, s[28:31], s58 offen lds
v_cvt_pk_bf16_f32 v193, v74, v75
v_mfma_f32_16x16x32_bf16 v[156:159], a[100:103], a[124:127], v[156:159]
ds_read_b128 a[156:159], v234 offset:52224
ds_read_b64_tr_b16 a[132:133], v231 offset:20480
v_cvt_pk_bf16_f32 v194, v76, v77
v_mfma_f32_16x16x32_bf16 v[148:151], a[100:103], a[120:123], v[148:151]
ds_read_b64_tr_b16 a[134:135], v231 offset:22528
ds_read_b64_tr_b16 a[136:137], v232 offset:20480
v_cvt_pk_bf16_f32 v195, v78, v79
v_mfma_f32_16x16x32_bf16 v[140:143], a[100:103], a[116:119], v[140:143]
ds_read_b64_tr_b16 a[138:139], v232 offset:22528
ds_write_b128 v235, v[192:195] offset:9216
v_mfma_f32_16x16x32_bf16 v[132:135], a[100:103], a[112:115], v[132:135]
buffer_load_dwordx4 v217, s[28:31], s58 offen offset:1024 lds
v_mfma_f32_16x16x32_bf16 a[228:231], a[240:243], v[192:195], a[228:231]
v_fma_f32 v80, v80, s63, -v252
v_fma_f32 v81, v81, s63, -v252
v_fma_f32 v82, v82, s63, -v252
v_fma_f32 v83, v83, s63, -v252
v_mfma_f32_16x16x32_bf16 v[160:163], a[104:107], a[112:115], v[160:163]
ds_read_b64_tr_b16 a[140:141], v233 offset:20480
ds_read_b64_tr_b16 a[142:143], v233 offset:22528
v_fma_f32 v84, v84, s63, -v252
v_mfma_f32_16x16x32_bf16 v[168:171], a[104:107], a[116:119], v[168:171]
buffer_load_dwordx4 v218, s[28:31], s58 offen offset:2048 lds
v_fma_f32 v85, v85, s63, -v252
v_mfma_f32_16x16x32_bf16 v[176:179], a[104:107], a[120:123], v[176:179]
buffer_load_dwordx4 v219, s[28:31], s58 offen offset:3072 lds
v_fma_f32 v86, v86, s63, -v252
v_mfma_f32_16x16x32_bf16 v[184:187], a[104:107], a[124:127], v[184:187]
v_fma_f32 v87, v87, s63, -v252
v_exp_f32 v80, v80
v_mfma_f32_16x16x32_bf16 v[188:191], a[108:111], a[124:127], v[188:191]
v_exp_f32 v81, v81
v_mfma_f32_16x16x32_bf16 v[180:183], a[108:111], a[120:123], v[180:183]
v_exp_f32 v82, v82
v_exp_f32 v83, v83
v_mfma_f32_16x16x32_bf16 v[172:175], a[108:111], a[116:119], v[172:175]
v_exp_f32 v84, v84
v_mfma_f32_16x16x32_bf16 v[164:167], a[108:111], a[112:115], v[164:167]
v_exp_f32 v85, v85
s_waitcnt lgkmcnt(0)
v_mfma_f32_16x16x32_bf16 v[128:131], a[128:131], a[144:147], v[128:131]
s_barrier
v_exp_f32 v86, v86
v_mfma_f32_16x16x32_bf16 v[136:139], a[128:131], a[148:151], v[136:139]
ds_read_b64_tr_b16 a[96:97], v230 offset:0
ds_read_b64_tr_b16 a[98:99], v230 offset:2048
v_mfma_f32_16x16x32_bf16 v[144:147], a[128:131], a[152:155], v[144:147]
ds_read_b128 a[112:115], v234 offset:4096
ds_read_b128 a[116:119], v234 offset:5120
v_exp_f32 v87, v87
v_cvt_pk_bf16_f32 v196, v80, v81
v_mfma_f32_16x16x32_bf16 v[152:155], a[128:131], a[156:159], v[152:155]
s_add_u32 m0, s53, 20480
s_mov_b32 s58, 98304
buffer_load_dwordx4 v216, s[28:31], s58 offen lds
v_cvt_pk_bf16_f32 v197, v82, v83
v_mfma_f32_16x16x32_bf16 v[156:159], a[132:135], a[156:159], v[156:159]
ds_read_b128 a[120:123], v234 offset:6144
ds_read_b128 a[124:127], v234 offset:7168
v_cvt_pk_bf16_f32 v198, v84, v85
v_mfma_f32_16x16x32_bf16 v[148:151], a[132:135], a[152:155], v[148:151]
ds_read_b64_tr_b16 a[100:101], v231 offset:0
ds_read_b64_tr_b16 a[102:103], v231 offset:2048
v_cvt_pk_bf16_f32 v199, v86, v87
v_mfma_f32_16x16x32_bf16 v[140:143], a[132:135], a[148:151], v[140:143]
ds_read_b64_tr_b16 a[104:105], v232 offset:0
ds_read_b64_tr_b16 a[106:107], v232 offset:2048
v_mfma_f32_16x16x32_bf16 v[132:135], a[132:135], a[144:147], v[132:135]
buffer_load_dwordx4 v217, s[28:31], s58 offen offset:1024 lds
ds_write_b128 v235, v[196:199] offset:10240
v_mfma_f32_16x16x32_bf16 v[160:163], a[136:139], a[144:147], v[160:163]
ds_read_b64_tr_b16 a[108:109], v233 offset:0
ds_read_b64_tr_b16 a[110:111], v233 offset:2048
v_mfma_f32_16x16x32_bf16 a[232:235], a[240:243], v[196:199], a[232:235]
v_fma_f32 v88, v88, s63, -v253
v_fma_f32 v89, v89, s63, -v253
v_fma_f32 v90, v90, s63, -v253
v_mfma_f32_16x16x32_bf16 v[168:171], a[136:139], a[148:151], v[168:171]
buffer_load_dwordx4 v218, s[28:31], s58 offen offset:2048 lds
v_fma_f32 v91, v91, s63, -v253
v_mfma_f32_16x16x32_bf16 v[176:179], a[136:139], a[152:155], v[176:179]
buffer_load_dwordx4 v219, s[28:31], s58 offen offset:3072 lds
v_fma_f32 v92, v92, s63, -v253
v_mfma_f32_16x16x32_bf16 v[184:187], a[136:139], a[156:159], v[184:187]
v_fma_f32 v93, v93, s63, -v253
v_fma_f32 v94, v94, s63, -v253
v_fma_f32 v95, v95, s63, -v253
v_mfma_f32_16x16x32_bf16 v[188:191], a[140:143], a[156:159], v[188:191]
v_exp_f32 v88, v88
v_exp_f32 v89, v89
v_mfma_f32_16x16x32_bf16 v[180:183], a[140:143], a[152:155], v[180:183]
v_exp_f32 v90, v90
v_mfma_f32_16x16x32_bf16 v[172:175], a[140:143], a[148:151], v[172:175]
v_exp_f32 v91, v91
v_exp_f32 v92, v92
v_mfma_f32_16x16x32_bf16 v[164:167], a[140:143], a[144:147], v[164:167]
v_exp_f32 v93, v93
s_waitcnt lgkmcnt(0)
v_mfma_f32_16x16x32_bf16 v[128:131], a[96:99], a[112:115], v[128:131]
ds_read_b64_tr_b16 a[128:129], v230 offset:4096
ds_read_b64_tr_b16 a[130:131], v230 offset:6144
v_mfma_f32_16x16x32_bf16 v[136:139], a[96:99], a[116:119], v[136:139]
ds_read_b128 a[144:147], v234 offset:20480
ds_read_b128 a[148:151], v234 offset:21504
v_exp_f32 v94, v94
v_mfma_f32_16x16x32_bf16 v[144:147], a[96:99], a[120:123], v[144:147]
ds_read_b128 a[152:155], v234 offset:22528
ds_read_b128 a[156:159], v234 offset:23552
v_mfma_f32_16x16x32_bf16 v[152:155], a[96:99], a[124:127], v[152:155]
s_add_u32 m0, s53, 0
s_mov_b32 s58, 163840
buffer_load_dwordx4 v216, s[28:31], s58 offen lds
v_exp_f32 v95, v95
v_mfma_f32_16x16x32_bf16 v[156:159], a[100:103], a[124:127], v[156:159]
ds_read_b64_tr_b16 a[132:133], v231 offset:4096
ds_read_b64_tr_b16 a[134:135], v231 offset:6144
v_cvt_pk_bf16_f32 v192, v88, v89
v_mfma_f32_16x16x32_bf16 v[148:151], a[100:103], a[120:123], v[148:151]
ds_read_b64_tr_b16 a[136:137], v232 offset:4096
v_cvt_pk_bf16_f32 v193, v90, v91
v_cvt_pk_bf16_f32 v194, v92, v93
v_mfma_f32_16x16x32_bf16 v[140:143], a[100:103], a[116:119], v[140:143]
ds_read_b64_tr_b16 a[138:139], v232 offset:6144
v_cvt_pk_bf16_f32 v195, v94, v95
v_mfma_f32_16x16x32_bf16 v[132:135], a[100:103], a[112:115], v[132:135]
buffer_load_dwordx4 v217, s[28:31], s58 offen offset:1024 lds
ds_write_b128 v235, v[192:195] offset:11264
v_mfma_f32_16x16x32_bf16 v[160:163], a[104:107], a[112:115], v[160:163]
ds_read_b64_tr_b16 a[140:141], v233 offset:4096
ds_read_b64_tr_b16 a[142:143], v233 offset:6144
v_mfma_f32_16x16x32_bf16 a[236:239], a[240:243], v[192:195], a[236:239]
v_max3_f32 v242, v96, v97, v242
v_max3_f32 v243, v104, v105, v243
v_max3_f32 v244, v112, v113, v244
v_mfma_f32_16x16x32_bf16 v[168:171], a[104:107], a[116:119], v[168:171]
buffer_load_dwordx4 v218, s[28:31], s58 offen offset:2048 lds
v_max3_f32 v245, v120, v121, v245
v_mfma_f32_16x16x32_bf16 v[176:179], a[104:107], a[120:123], v[176:179]
buffer_load_dwordx4 v219, s[28:31], s58 offen offset:3072 lds
v_max3_f32 v242, v98, v99, v242
v_mfma_f32_16x16x32_bf16 v[184:187], a[104:107], a[124:127], v[184:187]
v_max3_f32 v243, v106, v107, v243
v_max3_f32 v244, v114, v115, v244
v_max3_f32 v245, v122, v123, v245
v_mfma_f32_16x16x32_bf16 v[188:191], a[108:111], a[124:127], v[188:191]
v_max3_f32 v242, v100, v101, v242
v_max3_f32 v243, v108, v109, v243
v_max3_f32 v244, v116, v117, v244
v_mfma_f32_16x16x32_bf16 v[180:183], a[108:111], a[120:123], v[180:183]
v_max3_f32 v245, v124, v125, v245
v_max3_f32 v242, v102, v103, v242
v_max3_f32 v243, v110, v111, v243
v_mfma_f32_16x16x32_bf16 v[172:175], a[108:111], a[116:119], v[172:175]
v_max3_f32 v244, v118, v119, v244
v_max3_f32 v245, v126, v127, v245
v_fma_f32 v96, v96, s63, -v250
v_mfma_f32_16x16x32_bf16 v[164:167], a[108:111], a[112:115], v[164:167]
v_fma_f32 v97, v97, s63, -v250
v_fma_f32 v98, v98, s63, -v250
s_waitcnt lgkmcnt(0)
v_mfma_f32_16x16x32_bf16 v[128:131], a[128:131], a[144:147], v[128:131]
s_waitcnt vmcnt(16)
ds_read_b64_tr_b16 a[96:97], v230 offset:8192
v_fma_f32 v99, v99, s63, -v250
v_mfma_f32_16x16x32_bf16 v[136:139], a[128:131], a[148:151], v[136:139]
ds_read_b64_tr_b16 a[98:99], v230 offset:10240
ds_read_b128 a[112:115], v234 offset:36864
v_fma_f32 v100, v100, s63, -v250
v_fma_f32 v101, v101, s63, -v250
v_mfma_f32_16x16x32_bf16 v[144:147], a[128:131], a[152:155], v[144:147]
ds_read_b128 a[116:119], v234 offset:37888
ds_read_b128 a[120:123], v234 offset:38912
v_fma_f32 v102, v102, s63, -v250
v_mfma_f32_16x16x32_bf16 v[152:155], a[128:131], a[156:159], v[152:155]
s_add_u32 m0, s53, 4096
s_mov_b32 s58, 229376
buffer_load_dwordx4 v216, s[28:31], s58 offen lds
v_fma_f32 v103, v103, s63, -v250
v_mfma_f32_16x16x32_bf16 v[156:159], a[132:135], a[156:159], v[156:159]
ds_read_b128 a[124:127], v234 offset:39936
ds_read_b64_tr_b16 a[100:101], v231 offset:8192
v_mfma_f32_16x16x32_bf16 v[148:151], a[132:135], a[152:155], v[148:151]
ds_read_b64_tr_b16 a[102:103], v231 offset:10240
ds_read_b64_tr_b16 a[104:105], v232 offset:8192
v_exp_f32 v96, v96
v_mfma_f32_16x16x32_bf16 v[140:143], a[132:135], a[148:151], v[140:143]
ds_read_b64_tr_b16 a[106:107], v232 offset:10240
v_exp_f32 v97, v97
v_mfma_f32_16x16x32_bf16 v[132:135], a[132:135], a[144:147], v[132:135]
buffer_load_dwordx4 v217, s[28:31], s58 offen offset:1024 lds
v_mfma_f32_16x16x32_bf16 v[160:163], a[136:139], a[144:147], v[160:163]
ds_read_b64_tr_b16 a[108:109], v233 offset:8192
ds_read_b64_tr_b16 a[110:111], v233 offset:10240
v_exp_f32 v98, v98
v_mfma_f32_16x16x32_bf16 v[168:171], a[136:139], a[148:151], v[168:171]
buffer_load_dwordx4 v218, s[28:31], s58 offen offset:2048 lds
v_mfma_f32_16x16x32_bf16 v[176:179], a[136:139], a[152:155], v[176:179]
v_exp_f32 v99, v99
v_exp_f32 v100, v100
v_mfma_f32_16x16x32_bf16 v[184:187], a[136:139], a[156:159], v[184:187]
buffer_load_dwordx4 v219, s[28:31], s58 offen offset:3072 lds
v_mfma_f32_16x16x32_bf16 v[188:191], a[140:143], a[156:159], v[188:191]
v_exp_f32 v101, v101
v_exp_f32 v102, v102
v_mfma_f32_16x16x32_bf16 v[180:183], a[140:143], a[152:155], v[180:183]
v_exp_f32 v103, v103
v_cvt_pk_bf16_f32 v196, v96, v97
v_mfma_f32_16x16x32_bf16 v[172:175], a[140:143], a[148:151], v[172:175]
v_cvt_pk_bf16_f32 v197, v98, v99
v_cvt_pk_bf16_f32 v198, v100, v101
v_cvt_pk_bf16_f32 v199, v102, v103
v_mfma_f32_16x16x32_bf16 v[164:167], a[140:143], a[144:147], v[164:167]
ds_write_b128 v235, v[196:199] offset:12288
s_waitcnt lgkmcnt(1)
v_mfma_f32_16x16x32_bf16 v[128:131], a[96:99], a[112:115], v[128:131]
s_waitcnt vmcnt(16)
ds_read_b64_tr_b16 a[128:129], v230 offset:12288
v_mfma_f32_16x16x32_bf16 a[224:227], a[240:243], v[196:199], a[224:227]
v_fma_f32 v104, v104, s63, -v251
v_fma_f32 v105, v105, s63, -v251
v_fma_f32 v106, v106, s63, -v251
v_mfma_f32_16x16x32_bf16 v[136:139], a[96:99], a[116:119], v[136:139]
ds_read_b64_tr_b16 a[130:131], v230 offset:14336
ds_read_b128 a[144:147], v234 offset:53248
v_fma_f32 v107, v107, s63, -v251
v_mfma_f32_16x16x32_bf16 v[144:147], a[96:99], a[120:123], v[144:147]
ds_read_b128 a[148:151], v234 offset:54272
ds_read_b128 a[152:155], v234 offset:55296
v_fma_f32 v108, v108, s63, -v251
v_mfma_f32_16x16x32_bf16 v[152:155], a[96:99], a[124:127], v[152:155]
s_add_u32 m0, s53, 8192
s_mov_b32 s58, 49152
buffer_load_dwordx4 v216, s[28:31], s58 offen lds
v_fma_f32 v109, v109, s63, -v251
v_mfma_f32_16x16x32_bf16 v[156:159], a[100:103], a[124:127], v[156:159]
ds_read_b128 a[156:159], v234 offset:56320
ds_read_b64_tr_b16 a[132:133], v231 offset:12288
v_fma_f32 v110, v110, s63, -v251
v_mfma_f32_16x16x32_bf16 v[148:151], a[100:103], a[120:123], v[148:151]
ds_read_b64_tr_b16 a[134:135], v231 offset:14336
ds_read_b64_tr_b16 a[136:137], v232 offset:12288
v_fma_f32 v111, v111, s63, -v251
v_mfma_f32_16x16x32_bf16 v[140:143], a[100:103], a[116:119], v[140:143]
ds_read_b64_tr_b16 a[138:139], v232 offset:14336
v_exp_f32 v104, v104
v_mfma_f32_16x16x32_bf16 v[132:135], a[100:103], a[112:115], v[132:135]
buffer_load_dwordx4 v217, s[28:31], s58 offen offset:1024 lds
v_mfma_f32_16x16x32_bf16 v[160:163], a[104:107], a[112:115], v[160:163]
ds_read_b64_tr_b16 a[140:141], v233 offset:12288
ds_read_b64_tr_b16 a[142:143], v233 offset:14336
v_exp_f32 v105, v105
v_mfma_f32_16x16x32_bf16 v[168:171], a[104:107], a[116:119], v[168:171]
buffer_load_dwordx4 v218, s[28:31], s58 offen offset:2048 lds
v_mfma_f32_16x16x32_bf16 v[176:179], a[104:107], a[120:123], v[176:179]
v_exp_f32 v106, v106
v_exp_f32 v107, v107
v_mfma_f32_16x16x32_bf16 v[184:187], a[104:107], a[124:127], v[184:187]
buffer_load_dwordx4 v219, s[28:31], s58 offen offset:3072 lds
v_mfma_f32_16x16x32_bf16 v[188:191], a[108:111], a[124:127], v[188:191]
v_exp_f32 v108, v108
v_exp_f32 v109, v109
v_mfma_f32_16x16x32_bf16 v[180:183], a[108:111], a[120:123], v[180:183]
v_exp_f32 v110, v110
v_mfma_f32_16x16x32_bf16 v[172:175], a[108:111], a[116:119], v[172:175]
v_exp_f32 v111, v111
v_cvt_pk_bf16_f32 v192, v104, v105
v_cvt_pk_bf16_f32 v193, v106, v107
v_mfma_f32_16x16x32_bf16 v[164:167], a[108:111], a[112:115], v[164:167]
v_cvt_pk_bf16_f32 v194, v108, v109
v_cvt_pk_bf16_f32 v195, v110, v111
s_waitcnt lgkmcnt(0)
v_mfma_f32_16x16x32_bf16 v[128:131], a[128:131], a[144:147], v[128:131]
s_barrier
v_mfma_f32_16x16x32_bf16 v[136:139], a[128:131], a[148:151], v[136:139]
s_waitcnt vmcnt(16)
ds_read_b64_tr_b16 a[96:97], v230 offset:16384
ds_write_b128 v235, v[192:195] offset:13312
v_mfma_f32_16x16x32_bf16 v[144:147], a[128:131], a[152:155], v[144:147]
ds_read_b64_tr_b16 a[98:99], v230 offset:18432
ds_read_b128 a[112:115], v234 offset:8192
v_mfma_f32_16x16x32_bf16 a[228:231], a[240:243], v[192:195], a[228:231]
v_fma_f32 v112, v112, s63, -v252
v_fma_f32 v113, v113, s63, -v252
v_fma_f32 v114, v114, s63, -v252
v_mfma_f32_16x16x32_bf16 v[152:155], a[128:131], a[156:159], v[152:155]
s_add_u32 m0, s53, 12288
s_mov_b32 s58, 114688
buffer_load_dwordx4 v216, s[28:31], s58 offen lds
v_fma_f32 v115, v115, s63, -v252
v_mfma_f32_16x16x32_bf16 v[156:159], a[132:135], a[156:159], v[156:159]
ds_read_b128 a[116:119], v234 offset:9216
ds_read_b128 a[120:123], v234 offset:10240
v_fma_f32 v116, v116, s63, -v252
v_mfma_f32_16x16x32_bf16 v[148:151], a[132:135], a[152:155], v[148:151]
ds_read_b128 a[124:127], v234 offset:11264
ds_read_b64_tr_b16 a[100:101], v231 offset:16384
v_fma_f32 v117, v117, s63, -v252
v_mfma_f32_16x16x32_bf16 v[140:143], a[132:135], a[148:151], v[140:143]
ds_read_b64_tr_b16 a[102:103], v231 offset:18432
ds_read_b64_tr_b16 a[104:105], v232 offset:16384
v_mfma_f32_16x16x32_bf16 v[132:135], a[132:135], a[144:147], v[132:135]
buffer_load_dwordx4 v217, s[28:31], s58 offen offset:1024 lds
v_fma_f32 v118, v118, s63, -v252
v_mfma_f32_16x16x32_bf16 v[160:163], a[136:139], a[144:147], v[160:163]
ds_read_b64_tr_b16 a[106:107], v232 offset:18432
ds_read_b64_tr_b16 a[108:109], v233 offset:16384
v_fma_f32 v119, v119, s63, -v252
v_mfma_f32_16x16x32_bf16 v[168:171], a[136:139], a[148:151], v[168:171]
ds_read_b64_tr_b16 a[110:111], v233 offset:18432
v_exp_f32 v112, v112
v_mfma_f32_16x16x32_bf16 v[176:179], a[136:139], a[152:155], v[176:179]
buffer_load_dwordx4 v218, s[28:31], s58 offen offset:2048 lds
v_mfma_f32_16x16x32_bf16 v[184:187], a[136:139], a[156:159], v[184:187]
v_exp_f32 v113, v113
v_exp_f32 v114, v114
v_mfma_f32_16x16x32_bf16 v[188:191], a[140:143], a[156:159], v[188:191]
buffer_load_dwordx4 v219, s[28:31], s58 offen offset:3072 lds
v_mfma_f32_16x16x32_bf16 v[180:183], a[140:143], a[152:155], v[180:183]
v_exp_f32 v115, v115
v_exp_f32 v116, v116
v_mfma_f32_16x16x32_bf16 v[172:175], a[140:143], a[148:151], v[172:175]
v_exp_f32 v117, v117
v_mfma_f32_16x16x32_bf16 v[164:167], a[140:143], a[144:147], v[164:167]
v_exp_f32 v118, v118
s_waitcnt lgkmcnt(0)
v_mfma_f32_16x16x32_bf16 v[128:131], a[96:99], a[112:115], v[128:131]
s_waitcnt vmcnt(16)
ds_read_b64_tr_b16 a[128:129], v230 offset:20480
v_exp_f32 v119, v119
v_mfma_f32_16x16x32_bf16 v[136:139], a[96:99], a[116:119], v[136:139]
ds_read_b64_tr_b16 a[130:131], v230 offset:22528
ds_read_b128 a[144:147], v234 offset:24576
v_cvt_pk_bf16_f32 v196, v112, v113
v_mfma_f32_16x16x32_bf16 v[144:147], a[96:99], a[120:123], v[144:147]
ds_read_b128 a[148:151], v234 offset:25600
ds_read_b128 a[152:155], v234 offset:26624
v_cvt_pk_bf16_f32 v197, v114, v115
v_mfma_f32_16x16x32_bf16 v[152:155], a[96:99], a[124:127], v[152:155]
s_add_u32 m0, s53, 16384
s_mov_b32 s58, 180224
buffer_load_dwordx4 v216, s[28:31], s58 offen lds
v_cvt_pk_bf16_f32 v198, v116, v117
v_mfma_f32_16x16x32_bf16 v[156:159], a[100:103], a[124:127], v[156:159]
ds_read_b128 a[156:159], v234 offset:27648
ds_read_b64_tr_b16 a[132:133], v231 offset:20480
v_cvt_pk_bf16_f32 v199, v118, v119
v_mfma_f32_16x16x32_bf16 v[148:151], a[100:103], a[120:123], v[148:151]
ds_read_b64_tr_b16 a[134:135], v231 offset:22528
ds_read_b64_tr_b16 a[136:137], v232 offset:20480
v_mfma_f32_16x16x32_bf16 v[140:143], a[100:103], a[116:119], v[140:143]
ds_read_b64_tr_b16 a[138:139], v232 offset:22528
ds_write_b128 v235, v[196:199] offset:14336
v_mfma_f32_16x16x32_bf16 a[232:235], a[240:243], v[196:199], a[232:235]
v_fma_f32 v120, v120, s63, -v253
v_fma_f32 v121, v121, s63, -v253
v_fma_f32 v122, v122, s63, -v253
v_mfma_f32_16x16x32_bf16 v[132:135], a[100:103], a[112:115], v[132:135]
buffer_load_dwordx4 v217, s[28:31], s58 offen offset:1024 lds
v_fma_f32 v123, v123, s63, -v253
v_mfma_f32_16x16x32_bf16 v[160:163], a[104:107], a[112:115], v[160:163]
ds_read_b64_tr_b16 a[140:141], v233 offset:20480
ds_read_b64_tr_b16 a[142:143], v233 offset:22528
v_fma_f32 v124, v124, s63, -v253
v_mfma_f32_16x16x32_bf16 v[168:171], a[104:107], a[116:119], v[168:171]
buffer_load_dwordx4 v218, s[28:31], s58 offen offset:2048 lds
v_fma_f32 v125, v125, s63, -v253
v_mfma_f32_16x16x32_bf16 v[176:179], a[104:107], a[120:123], v[176:179]
buffer_load_dwordx4 v219, s[28:31], s58 offen offset:3072 lds
v_fma_f32 v126, v126, s63, -v253
v_mfma_f32_16x16x32_bf16 v[184:187], a[104:107], a[124:127], v[184:187]
v_fma_f32 v127, v127, s63, -v253
v_exp_f32 v120, v120
v_mfma_f32_16x16x32_bf16 v[188:191], a[108:111], a[124:127], v[188:191]
v_exp_f32 v121, v121
v_mfma_f32_16x16x32_bf16 v[180:183], a[108:111], a[120:123], v[180:183]
v_exp_f32 v122, v122
v_exp_f32 v123, v123
v_mfma_f32_16x16x32_bf16 v[172:175], a[108:111], a[116:119], v[172:175]
v_exp_f32 v124, v124
v_mfma_f32_16x16x32_bf16 v[164:167], a[108:111], a[112:115], v[164:167]
v_exp_f32 v125, v125
s_waitcnt lgkmcnt(0)
v_mfma_f32_16x16x32_bf16 v[128:131], a[128:131], a[144:147], v[128:131]
s_waitcnt vmcnt(16)
ds_read_b64_tr_b16 a[96:97], v230 offset:0
v_mfma_f32_16x16x32_bf16 v[136:139], a[128:131], a[148:151], v[136:139]
ds_read_b64_tr_b16 a[98:99], v230 offset:2048
ds_read_b128 a[112:115], v234 offset:40960
v_exp_f32 v126, v126
v_mfma_f32_16x16x32_bf16 v[144:147], a[128:131], a[152:155], v[144:147]
ds_read_b128 a[116:119], v234 offset:41984
ds_read_b128 a[120:123], v234 offset:43008
v_mfma_f32_16x16x32_bf16 v[152:155], a[128:131], a[156:159], v[152:155]
s_add_u32 m0, s53, 20480
s_mov_b32 s58, 245760
buffer_load_dwordx4 v216, s[28:31], s58 offen lds
v_exp_f32 v127, v127
v_mfma_f32_16x16x32_bf16 v[156:159], a[132:135], a[156:159], v[156:159]
ds_read_b128 a[124:127], v234 offset:44032
ds_read_b64_tr_b16 a[100:101], v231 offset:0
v_cvt_pk_bf16_f32 v192, v120, v121
v_mfma_f32_16x16x32_bf16 v[148:151], a[132:135], a[152:155], v[148:151]
ds_read_b64_tr_b16 a[102:103], v231 offset:2048
ds_read_b64_tr_b16 a[104:105], v232 offset:0
v_cvt_pk_bf16_f32 v193, v122, v123
v_mfma_f32_16x16x32_bf16 v[140:143], a[132:135], a[148:151], v[140:143]
ds_read_b64_tr_b16 a[106:107], v232 offset:2048
v_cvt_pk_bf16_f32 v194, v124, v125
v_cvt_pk_bf16_f32 v195, v126, v127
v_mfma_f32_16x16x32_bf16 v[132:135], a[132:135], a[144:147], v[132:135]
buffer_load_dwordx4 v217, s[28:31], s58 offen offset:1024 lds
v_mfma_f32_16x16x32_bf16 v[160:163], a[136:139], a[144:147], v[160:163]
ds_read_b64_tr_b16 a[108:109], v233 offset:0
ds_read_b64_tr_b16 a[110:111], v233 offset:2048
v_mfma_f32_16x16x32_bf16 v[168:171], a[136:139], a[148:151], v[168:171]
buffer_load_dwordx4 v218, s[28:31], s58 offen offset:2048 lds
ds_write_b128 v235, v[192:195] offset:15360
v_mfma_f32_16x16x32_bf16 a[236:239], a[240:243], v[192:195], a[236:239]
v_mov_b32 v200, v242
v_mov_b32 v201, v243
v_mov_b32 v202, v244
v_mfma_f32_16x16x32_bf16 v[176:179], a[136:139], a[152:155], v[176:179]
buffer_load_dwordx4 v219, s[28:31], s58 offen offset:3072 lds
v_mfma_f32_16x16x32_bf16 v[184:187], a[136:139], a[156:159], v[184:187]
v_mov_b32 v203, v245
v_permlane32_swap_b32 v200, v202
v_mfma_f32_16x16x32_bf16 v[188:191], a[140:143], a[156:159], v[188:191]
v_permlane32_swap_b32 v201, v203
v_max_f32 v200, v200, v202
v_max_f32 v201, v201, v203
v_mfma_f32_16x16x32_bf16 v[180:183], a[140:143], a[152:155], v[180:183]
s_nop 0
v_permlane16_swap_b32 v200, v201
v_max_f32 v200, v200, v201
v_mfma_f32_16x16x32_bf16 v[172:175], a[140:143], a[148:151], v[172:175]
ds_write_b32 v239, v200 offset:1024
ds_write_b32 v239, v200 offset:17408
v_mfma_f32_16x16x32_bf16 v[164:167], a[140:143], a[144:147], v[164:167]
ds_write_b32 v239, v200 offset:33792
s_waitcnt lgkmcnt(4)
v_mfma_f32_16x16x32_bf16 v[128:131], a[96:99], a[112:115], v[128:131]
s_waitcnt vmcnt(16)
ds_read_b64_tr_b16 a[128:129], v230 offset:4096
ds_write_b32 v239, v200 offset:50176
v_mfma_f32_16x16x32_bf16 v[136:139], a[96:99], a[116:119], v[136:139]
ds_read_b64_tr_b16 a[130:131], v230 offset:6144
ds_read_b128 a[144:147], v234 offset:57344
v_mfma_f32_16x16x32_bf16 v[144:147], a[96:99], a[120:123], v[144:147]
ds_read_b128 a[148:151], v234 offset:58368
ds_read_b128 a[152:155], v234 offset:59392
v_and_b32 v239, -16, v239
v_mfma_f32_16x16x32_bf16 v[152:155], a[96:99], a[124:127], v[152:155]
s_add_u32 m0, s53, 0
s_add_u32 s58, s4, 0
buffer_load_dwordx4 v220, s[36:39], s58 offen lds
v_mfma_f32_16x16x32_bf16 v[156:159], a[100:103], a[124:127], v[156:159]
ds_read_b128 a[156:159], v234 offset:60416
ds_read_b64_tr_b16 a[132:133], v231 offset:4096
v_mfma_f32_16x16x32_bf16 v[148:151], a[100:103], a[120:123], v[148:151]
ds_read_b64_tr_b16 a[134:135], v231 offset:6144
ds_read_b64_tr_b16 a[136:137], v232 offset:4096
v_accvgpr_read_b32 v246, a224
v_mfma_f32_16x16x32_bf16 v[140:143], a[100:103], a[116:119], v[140:143]
ds_read_b64_tr_b16 a[138:139], v232 offset:6144
v_accvgpr_read_b32 v247, a228
v_accvgpr_read_b32 v248, a232
v_mfma_f32_16x16x32_bf16 v[132:135], a[100:103], a[112:115], v[132:135]
buffer_load_dwordx4 v221, s[36:39], s58 offen offset:1024 lds
v_accvgpr_read_b32 v249, a236
v_mfma_f32_16x16x32_bf16 v[160:163], a[104:107], a[112:115], v[160:163]
ds_read_b64_tr_b16 a[140:141], v233 offset:4096
ds_read_b64_tr_b16 a[142:143], v233 offset:6144
v_mfma_f32_16x16x32_bf16 v[168:171], a[104:107], a[116:119], v[168:171]
buffer_load_dwordx4 v222, s[36:39], s58 offen offset:2048 lds
ds_write_b128 v239, v[246:249] offset:0
v_mfma_f32_16x16x32_bf16 v[176:179], a[104:107], a[120:123], v[176:179]
buffer_load_dwordx4 v223, s[36:39], s58 offen offset:3072 lds
v_mfma_f32_16x16x32_bf16 v[184:187], a[104:107], a[124:127], v[184:187]
ds_write_b128 v239, v[246:249] offset:16384
v_mfma_f32_16x16x32_bf16 v[188:191], a[108:111], a[124:127], v[188:191]
v_mfma_f32_16x16x32_bf16 v[180:183], a[108:111], a[120:123], v[180:183]
v_mfma_f32_16x16x32_bf16 v[172:175], a[108:111], a[116:119], v[172:175]
ds_write_b128 v239, v[246:249] offset:32768
v_mfma_f32_16x16x32_bf16 v[164:167], a[108:111], a[112:115], v[164:167]
s_waitcnt lgkmcnt(3)
v_mfma_f32_16x16x32_bf16 v[128:131], a[128:131], a[144:147], v[128:131]
ds_write_b128 v239, v[246:249] offset:49152
s_add_u32 m0, s53, 4096
s_add_u32 s58, s4, 28672
buffer_load_dwordx4 v220, s[36:39], s58 offen lds
s_waitcnt lgkmcnt(0)
s_barrier
buffer_load_dwordx4 v221, s[36:39], s58 offen offset:1024 lds
v_mfma_f32_16x16x32_bf16 v[136:139], a[128:131], a[148:151], v[136:139]
s_waitcnt vmcnt(18)
ds_read_b64_tr_b16 a[96:97], v230 offset:8192
ds_read_b128 v[192:195], v240 offset:1024
ds_read_b128 v[196:199], v240 offset:1280
ds_read_b128 v[200:203], v240 offset:1536
ds_read_b128 v[204:207], v240 offset:1792
v_mfma_f32_16x16x32_bf16 v[144:147], a[128:131], a[152:155], v[144:147]
ds_read_b64_tr_b16 a[98:99], v230 offset:10240
ds_read_b128 a[112:115], v234 offset:12288
v_mfma_f32_16x16x32_bf16 v[152:155], a[128:131], a[156:159], v[152:155]
buffer_load_dwordx4 v222, s[36:39], s58 offen offset:2048 lds
v_mfma_f32_16x16x32_bf16 v[156:159], a[132:135], a[156:159], v[156:159]
ds_read_b128 a[116:119], v234 offset:13312
ds_read_b128 a[120:123], v234 offset:14336
v_mfma_f32_16x16x32_bf16 v[148:151], a[132:135], a[152:155], v[148:151]
ds_read_b128 a[124:127], v234 offset:15360
ds_read_b64_tr_b16 a[100:101], v231 offset:8192
v_mfma_f32_16x16x32_bf16 v[140:143], a[132:135], a[148:151], v[140:143]
ds_read_b64_tr_b16 a[102:103], v231 offset:10240
ds_read_b64_tr_b16 a[104:105], v232 offset:8192
v_mfma_f32_16x16x32_bf16 v[132:135], a[132:135], a[144:147], v[132:135]
buffer_load_dwordx4 v223, s[36:39], s58 offen offset:3072 lds
v_mfma_f32_16x16x32_bf16 v[160:163], a[136:139], a[144:147], v[160:163]
ds_read_b64_tr_b16 a[106:107], v232 offset:10240
ds_read_b64_tr_b16 a[108:109], v233 offset:8192
s_waitcnt lgkmcnt(10)
v_mfma_f32_16x16x32_bf16 v[168:171], a[136:139], a[148:151], v[168:171]
ds_read_b64_tr_b16 a[110:111], v233 offset:10240
v_max3_f32 v242, v192, v196, v200
v_max3_f32 v243, v193, v197, v201
v_mfma_f32_16x16x32_bf16 v[176:179], a[136:139], a[152:155], v[176:179]
v_max3_f32 v244, v194, v198, v202
v_max3_f32 v245, v195, v199, v203
v_max_f32 v242, v242, v204
v_mfma_f32_16x16x32_bf16 v[184:187], a[136:139], a[156:159], v[184:187]
v_max_f32 v243, v243, v205
v_max_f32 v244, v244, v206
v_max_f32 v245, v245, v207
v_mfma_f32_16x16x32_bf16 v[188:191], a[140:143], a[156:159], v[188:191]
ds_read_b128 v[192:195], v240 offset:0
ds_read_b128 v[196:199], v240 offset:256
ds_read_b128 v[200:203], v240 offset:512
ds_read_b128 v[204:207], v240 offset:768
v_fma_f32 v250, v242, s63, -v250
v_mfma_f32_16x16x32_bf16 v[180:183], a[140:143], a[152:155], v[180:183]
v_fma_f32 v251, v243, s63, -v251
v_fma_f32 v252, v244, s63, -v252
v_fma_f32 v253, v245, s63, -v253
v_mfma_f32_16x16x32_bf16 v[172:175], a[140:143], a[148:151], v[172:175]
v_max3_f32 v250, v250, v251, v252
v_max_f32 v250, v250, v253
v_cmp_lt_f32 vcc, 0x41400000, v250
v_mfma_f32_16x16x32_bf16 v[164:167], a[140:143], a[144:147], v[164:167]
s_waitcnt lgkmcnt(4)
v_mfma_f32_16x16x32_bf16 v[128:131], a[96:99], a[112:115], v[128:131]
s_waitcnt vmcnt(16)
ds_read_b64_tr_b16 a[128:129], v230 offset:12288
s_cbranch_vccnz L_fb0
v_mfma_f32_16x16x32_bf16 v[136:139], a[96:99], a[116:119], v[136:139]
ds_read_b64_tr_b16 a[130:131], v230 offset:14336
ds_read_b128 a[144:147], v234 offset:28672
v_mfma_f32_16x16x32_bf16 v[144:147], a[96:99], a[120:123], v[144:147]
ds_read_b128 a[148:151], v234 offset:29696
ds_read_b128 a[152:155], v234 offset:30720
v_mfma_f32_16x16x32_bf16 v[152:155], a[96:99], a[124:127], v[152:155]
s_add_u32 m0, s53, 8192
s_add_u32 s58, s5, 0
buffer_load_dwordx4 v220, s[36:39], s58 offen lds
s_waitcnt lgkmcnt(5)
v_mfma_f32_16x16x32_bf16 v[156:159], a[100:103], a[124:127], v[156:159]
ds_read_b128 a[156:159], v234 offset:31744
ds_read_b64_tr_b16 a[132:133], v231 offset:12288
v_add_f32 v192, v192, v196
v_mfma_f32_16x16x32_bf16 v[148:151], a[100:103], a[120:123], v[148:151]
ds_read_b64_tr_b16 a[134:135], v231 offset:14336
ds_read_b64_tr_b16 a[136:137], v232 offset:12288
v_add_f32 v193, v193, v197
v_mfma_f32_16x16x32_bf16 v[140:143], a[100:103], a[116:119], v[140:143]
ds_read_b64_tr_b16 a[138:139], v232 offset:14336
v_add_f32 v194, v194, v198
v_add_f32 v195, v195, v199
v_mfma_f32_16x16x32_bf16 v[132:135], a[100:103], a[112:115], v[132:135]
buffer_load_dwordx4 v221, s[36:39], s58 offen offset:1024 lds
v_add_f32 v200, v200, v204
v_mfma_f32_16x16x32_bf16 v[160:163], a[104:107], a[112:115], v[160:163]
ds_read_b64_tr_b16 a[140:141], v233 offset:12288
ds_read_b64_tr_b16 a[142:143], v233 offset:14336
v_add_f32 v201, v201, v205
v_mfma_f32_16x16x32_bf16 v[168:171], a[104:107], a[116:119], v[168:171]
buffer_load_dwordx4 v222, s[36:39], s58 offen offset:2048 lds
v_add_f32 v202, v202, v206
v_add_f32 v203, v203, v207
v_mfma_f32_16x16x32_bf16 v[176:179], a[104:107], a[120:123], v[176:179]
buffer_load_dwordx4 v223, s[36:39], s58 offen offset:3072 lds
v_add_f32 v192, v192, v200
v_mfma_f32_16x16x32_bf16 v[184:187], a[104:107], a[124:127], v[184:187]
v_add_f32 v193, v193, v201
v_add_f32 v194, v194, v202
v_add_f32 v195, v195, v203
v_mfma_f32_16x16x32_bf16 v[188:191], a[108:111], a[124:127], v[188:191]
v_rcp_f32 v246, v192
v_mfma_f32_16x16x32_bf16 v[180:183], a[108:111], a[120:123], v[180:183]
v_rcp_f32 v247, v193
v_rcp_f32 v248, v194
v_mfma_f32_16x16x32_bf16 v[172:175], a[108:111], a[116:119], v[172:175]
v_rcp_f32 v249, v195
v_mfma_f32_16x16x32_bf16 v[164:167], a[108:111], a[112:115], v[164:167]
s_waitcnt lgkmcnt(0)
v_mfma_f32_16x16x32_bf16 v[128:131], a[128:131], a[144:147], v[128:131]
s_waitcnt vmcnt(12)
ds_read_b64_tr_b16 a[96:97], v230 offset:16384
v_mfma_f32_16x16x32_bf16 v[136:139], a[128:131], a[148:151], v[136:139]
ds_read_b64_tr_b16 a[98:99], v230 offset:18432
ds_read_b128 a[160:163], v234 offset:45056
v_mfma_f32_16x16x32_bf16 v[144:147], a[128:131], a[152:155], v[144:147]
ds_read_b128 a[164:167], v234 offset:46080
ds_read_b128 a[168:171], v234 offset:47104
v_mfma_f32_16x16x32_bf16 v[152:155], a[128:131], a[156:159], v[152:155]
s_add_u32 m0, s53, 12288
s_add_u32 s58, s5, 28672
buffer_load_dwordx4 v220, s[36:39], s58 offen lds
v_mfma_f32_16x16x32_bf16 v[156:159], a[132:135], a[156:159], v[156:159]
ds_read_b128 a[172:175], v234 offset:48128
ds_read_b64_tr_b16 a[100:101], v231 offset:16384
v_mfma_f32_16x16x32_bf16 v[148:151], a[132:135], a[152:155], v[148:151]
ds_read_b64_tr_b16 a[102:103], v231 offset:18432
ds_read_b64_tr_b16 a[104:105], v230 offset:20480
v_mfma_f32_16x16x32_bf16 v[140:143], a[132:135], a[148:151], v[140:143]
ds_read_b64_tr_b16 a[106:107], v230 offset:22528
ds_read_b128 a[176:179], v234 offset:61440
v_mfma_f32_16x16x32_bf16 v[132:135], a[132:135], a[144:147], v[132:135]
buffer_load_dwordx4 v221, s[36:39], s58 offen offset:1024 lds
v_mfma_f32_16x16x32_bf16 v[160:163], a[136:139], a[144:147], v[160:163]
ds_read_b128 a[180:183], v234 offset:62464
ds_read_b128 a[184:187], v234 offset:63488
v_mfma_f32_16x16x32_bf16 v[168:171], a[136:139], a[148:151], v[168:171]
ds_read_b128 a[188:191], v234 offset:64512
ds_read_b64_tr_b16 a[108:109], v231 offset:20480
v_mfma_f32_16x16x32_bf16 v[176:179], a[136:139], a[152:155], v[176:179]
ds_read_b64_tr_b16 a[110:111], v231 offset:22528
v_mfma_f32_16x16x32_bf16 v[184:187], a[136:139], a[156:159], v[184:187]
buffer_load_dwordx4 v222, s[36:39], s58 offen offset:2048 lds
v_mfma_f32_16x16x32_bf16 v[188:191], a[140:143], a[156:159], v[188:191]
v_mfma_f32_16x16x32_bf16 v[180:183], a[140:143], a[152:155], v[180:183]
buffer_load_dwordx4 v223, s[36:39], s58 offen offset:3072 lds
v_mfma_f32_16x16x32_bf16 v[172:175], a[140:143], a[148:151], v[172:175]
v_mfma_f32_16x16x32_bf16 v[164:167], a[140:143], a[144:147], v[164:167]
s_waitcnt lgkmcnt(10)
v_mfma_f32_16x16x32_bf16 v[128:131], a[96:99], a[160:163], v[128:131]
ds_read_b64_tr_b16 a[128:129], v232 offset:16384
ds_read_b64_tr_b16 a[130:131], v232 offset:18432
v_mfma_f32_16x16x32_bf16 v[136:139], a[96:99], a[164:167], v[136:139]
ds_read_b64_tr_b16 a[132:133], v233 offset:16384
ds_read_b64_tr_b16 a[134:135], v233 offset:18432
v_mfma_f32_16x16x32_bf16 v[144:147], a[96:99], a[168:171], v[144:147]
ds_read_b64_tr_b16 a[136:137], v232 offset:20480
v_mfma_f32_16x16x32_bf16 v[152:155], a[96:99], a[172:175], v[152:155]
s_waitcnt lgkmcnt(5)
v_mfma_f32_16x16x32_bf16 v[156:159], a[100:103], a[172:175], v[156:159]
ds_read_b64_tr_b16 a[138:139], v232 offset:22528
v_mfma_f32_16x16x32_bf16 v[148:151], a[100:103], a[168:171], v[148:151]
ds_read_b64_tr_b16 a[140:141], v233 offset:20480
v_mfma_f32_16x16x32_bf16 v[140:143], a[100:103], a[164:167], v[140:143]
v_mfma_f32_16x16x32_bf16 v[132:135], a[100:103], a[160:163], v[132:135]
ds_read_b64_tr_b16 a[142:143], v233 offset:22528
v_mfma_f32_16x16x32_bf16 v[128:131], a[104:107], a[176:179], v[128:131]
v_mfma_f32_16x16x32_bf16 v[136:139], a[104:107], a[180:183], v[136:139]
v_mfma_f32_16x16x32_bf16 v[144:147], a[104:107], a[184:187], v[144:147]
v_mfma_f32_16x16x32_bf16 v[152:155], a[104:107], a[188:191], v[152:155]
v_mfma_f32_16x16x32_bf16 v[156:159], a[108:111], a[188:191], v[156:159]
v_mfma_f32_16x16x32_bf16 v[148:151], a[108:111], a[184:187], v[148:151]
v_mfma_f32_16x16x32_bf16 v[140:143], a[108:111], a[180:183], v[140:143]
v_mfma_f32_16x16x32_bf16 v[132:135], a[108:111], a[176:179], v[132:135]
s_waitcnt lgkmcnt(0)
v_mfma_f32_16x16x32_bf16 v[160:163], a[128:131], a[160:163], v[160:163]
s_waitcnt vmcnt(12)
ds_read_b64_tr_b16 a[96:97], v230 offset:0
v_mfma_f32_16x16x32_bf16 v[168:171], a[128:131], a[164:167], v[168:171]
ds_read_b64_tr_b16 a[98:99], v230 offset:2048
ds_read_b64_tr_b16 a[100:101], v231 offset:0
v_mfma_f32_16x16x32_bf16 v[176:179], a[128:131], a[168:171], v[176:179]
ds_read_b64_tr_b16 a[102:103], v231 offset:2048
ds_read_b64_tr_b16 a[104:105], v232 offset:0
v_mul_f32 v128, v128, v246
v_mul_f32 v129, v129, v246
v_mul_f32 v130, v130, v246
v_mfma_f32_16x16x32_bf16 v[184:187], a[128:131], a[172:175], v[184:187]
s_add_u32 m0, s53, 16384
s_add_u32 s58, s6, 0
buffer_load_dwordx4 v220, s[36:39], s58 offen lds
v_mul_f32 v131, v131, v246
v_mul_f32 v132, v132, v246
v_mul_f32 v133, v133, v246
v_mul_f32 v134, v134, v246
v_mfma_f32_16x16x32_bf16 v[188:191], a[132:135], a[172:175], v[188:191]
ds_read_b64_tr_b16 a[106:107], v232 offset:2048
v_mul_f32 v135, v135, v246
v_cvt_pk_bf16_f32 v128, v128, v129
v_cvt_pk_bf16_f32 v129, v130, v131
v_cvt_pk_bf16_f32 v130, v132, v133
v_cvt_pk_bf16_f32 v131, v134, v135
v_mfma_f32_16x16x32_bf16 v[180:183], a[132:135], a[168:171], v[180:183]
ds_read_b64_tr_b16 a[108:109], v233 offset:0
ds_write_b128 v235, v[128:131] offset:0
v_mul_f32 v136, v136, v247
v_mul_f32 v137, v137, v247
v_mul_f32 v138, v138, v247
v_mfma_f32_16x16x32_bf16 v[172:175], a[132:135], a[164:167], v[172:175]
buffer_load_dwordx4 v221, s[36:39], s58 offen offset:1024 lds
v_mul_f32 v139, v139, v247
v_mul_f32 v140, v140, v247
v_mul_f32 v141, v141, v247
v_mul_f32 v142, v142, v247
v_mfma_f32_16x16x32_bf16 v[164:167], a[132:135], a[160:163], v[164:167]
buffer_load_dwordx4 v222, s[36:39], s58 offen offset:2048 lds
v_mul_f32 v143, v143, v247
v_cvt_pk_bf16_f32 v136, v136, v137
v_cvt_pk_bf16_f32 v137, v138, v139
v_cvt_pk_bf16_f32 v138, v140, v141
v_mfma_f32_16x16x32_bf16 v[160:163], a[136:139], a[176:179], v[160:163]
ds_read_b64_tr_b16 a[110:111], v233 offset:2048
v_cvt_pk_bf16_f32 v139, v142, v143
ds_write_b128 v235, v[136:139] offset:1024
v_mul_f32 v144, v144, v248
v_mul_f32 v145, v145, v248
v_mul_f32 v146, v146, v248
v_mfma_f32_16x16x32_bf16 v[168:171], a[136:139], a[180:183], v[168:171]
buffer_load_dwordx4 v223, s[36:39], s58 offen offset:3072 lds
v_mul_f32 v147, v147, v248
v_mul_f32 v148, v148, v248
v_mul_f32 v149, v149, v248
v_mul_f32 v150, v150, v248
v_mfma_f32_16x16x32_bf16 v[176:179], a[136:139], a[184:187], v[176:179]
s_add_u32 m0, s53, 20480
s_add_u32 s58, s6, 28672
v_mul_f32 v151, v151, v248
v_cvt_pk_bf16_f32 v144, v144, v145
v_cvt_pk_bf16_f32 v145, v146, v147
v_cvt_pk_bf16_f32 v146, v148, v149
v_mfma_f32_16x16x32_bf16 v[184:187], a[136:139], a[188:191], v[184:187]
buffer_load_dwordx4 v220, s[36:39], s58 offen lds
v_cvt_pk_bf16_f32 v147, v150, v151
ds_write_b128 v235, v[144:147] offset:2048
v_mul_f32 v152, v152, v249
v_mfma_f32_16x16x32_bf16 v[188:191], a[140:143], a[188:191], v[188:191]
buffer_load_dwordx4 v221, s[36:39], s58 offen offset:1024 lds
v_mul_f32 v153, v153, v249
v_mul_f32 v154, v154, v249
v_mul_f32 v155, v155, v249
v_mul_f32 v156, v156, v249
v_mul_f32 v157, v157, v249
v_mfma_f32_16x16x32_bf16 v[180:183], a[140:143], a[184:187], v[180:183]
buffer_load_dwordx4 v222, s[36:39], s58 offen offset:2048 lds
v_mul_f32 v158, v158, v249
v_mul_f32 v159, v159, v249
v_cvt_pk_bf16_f32 v152, v152, v153
v_cvt_pk_bf16_f32 v153, v154, v155
v_cvt_pk_bf16_f32 v154, v156, v157
v_mfma_f32_16x16x32_bf16 v[172:175], a[140:143], a[180:183], v[172:175]
buffer_load_dwordx4 v223, s[36:39], s58 offen offset:3072 lds
v_cvt_pk_bf16_f32 v155, v158, v159
ds_write_b128 v235, v[152:155] offset:3072
v_mfma_f32_16x16x32_bf16 v[164:167], a[140:143], a[176:179], v[164:167]
s_waitcnt lgkmcnt(3)
v_mfma_f32_16x16x32_bf16 v[0:3], a[96:99], v[128:131], 0
s_waitcnt vmcnt(16)
ds_read_b64_tr_b16 a[128:129], v230 offset:4096
v_mfma_f32_16x16x32_bf16 v[8:11], a[96:99], v[136:139], 0
ds_read_b64_tr_b16 a[130:131], v230 offset:6144
ds_read_b64_tr_b16 a[132:133], v231 offset:4096
v_mfma_f32_16x16x32_bf16 v[16:19], a[96:99], v[144:147], 0
ds_read_b64_tr_b16 a[134:135], v231 offset:6144
ds_read_b64_tr_b16 a[136:137], v232 offset:4096
v_mul_f32 v160, v160, v246
v_mul_f32 v161, v161, v246
v_mul_f32 v162, v162, v246
v_mfma_f32_16x16x32_bf16 v[24:27], a[96:99], v[152:155], 0
s_add_u32 m0, s53, 0
s_add_u32 s58, s7, 0
buffer_load_dwordx4 v220, s[36:39], s58 offen lds
v_mul_f32 v163, v163, v246
v_mul_f32 v164, v164, v246
v_mul_f32 v165, v165, v246
v_mul_f32 v166, v166, v246
v_mfma_f32_16x16x32_bf16 v[28:31], a[100:103], v[152:155], 0
ds_read_b64_tr_b16 a[138:139], v232 offset:6144
v_mul_f32 v167, v167, v246
v_cvt_pk_bf16_f32 v160, v160, v161
v_cvt_pk_bf16_f32 v161, v162, v163
v_cvt_pk_bf16_f32 v162, v164, v165
v_cvt_pk_bf16_f32 v163, v166, v167
v_mfma_f32_16x16x32_bf16 v[20:23], a[100:103], v[144:147], 0
ds_read_b64_tr_b16 a[140:141], v233 offset:4096
ds_write_b128 v235, v[160:163] offset:4096
v_mul_f32 v168, v168, v247
v_mul_f32 v169, v169, v247
v_mul_f32 v170, v170, v247
v_mfma_f32_16x16x32_bf16 v[12:15], a[100:103], v[136:139], 0
buffer_load_dwordx4 v221, s[36:39], s58 offen offset:1024 lds
v_mul_f32 v171, v171, v247
v_mul_f32 v172, v172, v247
v_mul_f32 v173, v173, v247
v_mul_f32 v174, v174, v247
v_mfma_f32_16x16x32_bf16 v[4:7], a[100:103], v[128:131], 0
buffer_load_dwordx4 v222, s[36:39], s58 offen offset:2048 lds
v_mul_f32 v175, v175, v247
v_cvt_pk_bf16_f32 v168, v168, v169
v_cvt_pk_bf16_f32 v169, v170, v171
v_cvt_pk_bf16_f32 v170, v172, v173
v_mfma_f32_16x16x32_bf16 v[32:35], a[104:107], v[128:131], 0
ds_read_b64_tr_b16 a[142:143], v233 offset:6144
v_cvt_pk_bf16_f32 v171, v174, v175
ds_write_b128 v235, v[168:171] offset:5120
v_mul_f32 v176, v176, v248
v_mul_f32 v177, v177, v248
v_mul_f32 v178, v178, v248
v_mfma_f32_16x16x32_bf16 v[40:43], a[104:107], v[136:139], 0
buffer_load_dwordx4 v223, s[36:39], s58 offen offset:3072 lds
v_mul_f32 v179, v179, v248
v_mul_f32 v180, v180, v248
v_mul_f32 v181, v181, v248
v_mul_f32 v182, v182, v248
v_mfma_f32_16x16x32_bf16 v[48:51], a[104:107], v[144:147], 0
v_mul_f32 v183, v183, v248
v_cvt_pk_bf16_f32 v176, v176, v177
v_cvt_pk_bf16_f32 v177, v178, v179
v_cvt_pk_bf16_f32 v178, v180, v181
v_cvt_pk_bf16_f32 v179, v182, v183
v_mfma_f32_16x16x32_bf16 v[56:59], a[104:107], v[152:155], 0
ds_write_b128 v235, v[176:179] offset:6144
v_mul_f32 v184, v184, v249
v_mul_f32 v185, v185, v249
v_mul_f32 v186, v186, v249
v_mul_f32 v187, v187, v249
v_mfma_f32_16x16x32_bf16 v[60:63], a[108:111], v[152:155], 0
v_mul_f32 v188, v188, v249
v_mul_f32 v189, v189, v249
v_mul_f32 v190, v190, v249
v_mul_f32 v191, v191, v249
v_mfma_f32_16x16x32_bf16 v[52:55], a[108:111], v[144:147], 0
v_cvt_pk_bf16_f32 v184, v184, v185
v_cvt_pk_bf16_f32 v185, v186, v187
v_cvt_pk_bf16_f32 v186, v188, v189
v_mfma_f32_16x16x32_bf16 v[44:47], a[108:111], v[136:139], 0
v_cvt_pk_bf16_f32 v187, v190, v191
ds_write_b128 v235, v[184:187] offset:7168
v_mfma_f32_16x16x32_bf16 v[36:39], a[108:111], v[128:131], 0
s_waitcnt lgkmcnt(3)
v_mfma_f32_16x16x32_bf16 v[0:3], a[128:131], v[160:163], v[0:3]
s_waitcnt vmcnt(16)
ds_read_b64_tr_b16 a[96:97], v230 offset:8192
v_mfma_f32_16x16x32_bf16 v[8:11], a[128:131], v[168:171], v[8:11]
ds_read_b64_tr_b16 a[98:99], v230 offset:10240
s_add_u32 m0, s53, 4096
v_mfma_f32_16x16x32_bf16 v[16:19], a[128:131], v[176:179], v[16:19]
s_add_u32 s58, s7, 28672
buffer_load_dwordx4 v220, s[36:39], s58 offen lds
v_mfma_f32_16x16x32_bf16 v[24:27], a[128:131], v[184:187], v[24:27]
ds_read_b64_tr_b16 a[100:101], v231 offset:8192
s_waitcnt lgkmcnt(3)
s_barrier
ds_read_b128 a[0:3], v236 offset:0
ds_read_b128 a[4:7], v236 offset:1024
ds_read_b128 a[8:11], v236 offset:2048
ds_read_b128 a[12:15], v236 offset:3072
v_mfma_f32_16x16x32_bf16 v[28:31], a[132:135], v[184:187], v[28:31]
ds_read_b64_tr_b16 a[102:103], v231 offset:10240
buffer_load_dwordx4 v221, s[36:39], s58 offen offset:1024 lds
v_mfma_f32_16x16x32_bf16 v[20:23], a[132:135], v[176:179], v[20:23]
ds_read_b64_tr_b16 a[104:105], v232 offset:8192
v_lshrrev_b32 v219, 4, v234
v_mfma_f32_16x16x32_bf16 v[12:15], a[132:135], v[168:171], v[12:15]
ds_read_b64_tr_b16 a[106:107], v232 offset:10240
v_lshlrev_b32 v208, 8, v219
s_lshl_b32 s59, s52, 10
v_mfma_f32_16x16x32_bf16 v[4:7], a[132:135], v[160:163], v[4:7]
buffer_load_dwordx4 v222, s[36:39], s58 offen offset:2048 lds
v_mfma_f32_16x16x32_bf16 v[32:35], a[136:139], v[160:163], v[32:35]
ds_read_b64_tr_b16 a[108:109], v233 offset:8192
ds_read_b64_tr_b16 a[110:111], v233 offset:10240
v_mfma_f32_16x16x32_bf16 v[40:43], a[136:139], v[168:171], v[40:43]
buffer_load_dwordx4 v223, s[36:39], s58 offen offset:3072 lds
v_mfma_f32_16x16x32_bf16 v[48:51], a[136:139], v[176:179], v[48:51]
s_lshl_b32 s60, s67, 2
s_add_u32 s59, s59, s60
v_add_u32 v208, s59, v208
v_mfma_f32_16x16x32_bf16 v[56:59], a[136:139], v[184:187], v[56:59]
v_cmp_gt_u32 vcc, 4, v219
v_mov_b32 v224, 0x40000000
v_mfma_f32_16x16x32_bf16 v[60:63], a[140:143], v[184:187], v[60:63]
v_mov_b32 v209, 1
v_cndmask_b32 v208, v224, v208, vcc
v_mfma_f32_16x16x32_bf16 v[52:55], a[140:143], v[176:179], v[52:55]
v_and_b32 v219, 15, v219
s_max_u32 s59, s52, 1
s_sub_u32 s59, s59, 1
v_mfma_f32_16x16x32_bf16 v[44:47], a[140:143], v[168:171], v[44:47]
s_lshl_b32 s59, s59, 6
s_lshl_b32 s60, s67, 8
v_mfma_f32_16x16x32_bf16 v[36:39], a[140:143], v[160:163], v[36:39]
s_add_u32 s59, s59, s60
s_waitcnt lgkmcnt(8)
v_mfma_f32_16x16x32_bf16 v[0:3], a[96:99], a[0:3], v[0:3]
s_waitcnt vmcnt(16)
ds_read_b64_tr_b16 a[128:129], v230 offset:12288
s_waitcnt lgkmcnt(8)
v_mfma_f32_16x16x32_bf16 v[8:11], a[96:99], a[4:7], v[8:11]
ds_read_b64_tr_b16 a[130:131], v230 offset:14336
ds_read_b128 a[16:19], v236 offset:4096
v_lshl_add_u32 v210, v219, 2, s59
s_waitcnt lgkmcnt(9)
v_mfma_f32_16x16x32_bf16 v[16:19], a[96:99], a[8:11], v[16:19]
ds_read_b128 a[20:23], v236 offset:5120
ds_read_b128 a[24:27], v236 offset:6144
s_waitcnt lgkmcnt(10)
v_mfma_f32_16x16x32_bf16 v[24:27], a[96:99], a[12:15], v[24:27]
ds_read_b128 a[28:31], v236 offset:7168
s_waitcnt lgkmcnt(10)
v_mfma_f32_16x16x32_bf16 v[28:31], a[100:103], a[12:15], v[28:31]
ds_read_b64_tr_b16 a[132:133], v231 offset:12288
ds_read_b64_tr_b16 a[134:135], v231 offset:14336
v_mfma_f32_16x16x32_bf16 v[20:23], a[100:103], a[8:11], v[20:23]
ds_read_b64_tr_b16 a[136:137], v232 offset:12288
v_mul_u32_u24 v216, 896, v219
v_lshrrev_b32 v224, 8, v234
v_mfma_f32_16x16x32_bf16 v[12:15], a[100:103], a[4:7], v[12:15]
ds_read_b64_tr_b16 a[138:139], v232 offset:14336
v_lshl_add_u32 v216, v224, 3, v216
v_mfma_f32_16x16x32_bf16 v[4:7], a[100:103], a[0:3], v[4:7]
ds_read_b64_tr_b16 a[140:141], v233 offset:12288
v_mov_b32 v217, 0
s_waitcnt lgkmcnt(13)
v_mfma_f32_16x16x32_bf16 v[32:35], a[104:107], a[0:3], v[32:35]
ds_read_b64_tr_b16 a[142:143], v233 offset:14336
v_mov_b32 v218, 1
v_add_u32 v212, 0, v234
v_mfma_f32_16x16x32_bf16 v[40:43], a[104:107], a[4:7], v[40:43]
v_add_u32 v213, 4096, v234
v_add_u32 v214, 8192, v234
v_mfma_f32_16x16x32_bf16 v[48:51], a[104:107], a[8:11], v[48:51]
v_add_u32 v215, 12288, v234
v_bfe_u32 v219, v234, 6, 2
v_mfma_f32_16x16x32_bf16 v[56:59], a[104:107], a[12:15], v[56:59]
v_cmp_eq_u32 vcc, v219, v224
v_bfe_u32 v219, v234, 4, 1
s_waitcnt lgkmcnt(12)
v_mfma_f32_16x16x32_bf16 v[60:63], a[108:111], a[12:15], v[60:63]
s_add_u32 m0, s53, 8192
s_add_u32 s58, s4, 0
buffer_load_dwordx4 v220, s[40:43], s58 offen lds
v_lshlrev_b32 v219, 4, v219
v_mfma_f32_16x16x32_bf16 v[52:55], a[108:111], a[8:11], v[52:55]
buffer_load_dwordx4 v221, s[40:43], s58 offen offset:1024 lds
v_mfma_f32_16x16x32_bf16 v[44:47], a[108:111], a[4:7], v[44:47]
v_mov_b32 v224, 0x3f80
v_lshlrev_b32 v219, v219, v224
v_mfma_f32_16x16x32_bf16 v[36:39], a[108:111], a[0:3], v[36:39]
v_cndmask_b32 v219, 0, v219, vcc
s_waitcnt lgkmcnt(0)
v_mfma_f32_16x16x32_bf16 v[0:3], a[128:131], a[16:19], v[0:3]
s_waitcnt vmcnt(14)
ds_read_b64_tr_b16 a[96:97], v230 offset:16384
v_mfma_f32_16x16x32_bf16 v[8:11], a[128:131], a[20:23], v[8:11]
ds_read_b64_tr_b16 a[98:99], v230 offset:18432
ds_read_b128 a[32:35], v237 offset:0
v_bfe_u32 v224, v234, 5, 1
v_mfma_f32_16x16x32_bf16 v[16:19], a[128:131], a[24:27], v[16:19]
ds_read_b128 a[36:39], v237 offset:1024
ds_read_b128 a[40:43], v237 offset:2048
v_mfma_f32_16x16x32_bf16 v[24:27], a[128:131], a[28:31], v[24:27]
buffer_load_dwordx4 v222, s[40:43], s58 offen offset:2048 lds
v_mfma_f32_16x16x32_bf16 v[28:31], a[132:135], a[28:31], v[28:31]
ds_read_b128 a[44:47], v237 offset:3072
ds_read_b64_tr_b16 a[100:101], v231 offset:16384
v_mfma_f32_16x16x32_bf16 v[20:23], a[132:135], a[24:27], v[20:23]
ds_read_b64_tr_b16 a[102:103], v231 offset:18432
ds_read_b64_tr_b16 a[104:105], v232 offset:16384
v_cmp_eq_u32 vcc, 0, v224
v_mfma_f32_16x16x32_bf16 v[12:15], a[132:135], a[20:23], v[12:15]
ds_read_b64_tr_b16 a[106:107], v232 offset:18432
v_accvgpr_write_b32 a226, 0
v_mfma_f32_16x16x32_bf16 v[4:7], a[132:135], a[16:19], v[4:7]
buffer_load_dwordx4 v223, s[40:43], s58 offen offset:3072 lds
v_mfma_f32_16x16x32_bf16 v[32:35], a[136:139], a[16:19], v[32:35]
ds_read_b64_tr_b16 a[108:109], v233 offset:16384
ds_read_b64_tr_b16 a[110:111], v233 offset:18432
v_mfma_f32_16x16x32_bf16 v[40:43], a[136:139], a[20:23], v[40:43]
s_add_u32 m0, s53, 12288
s_add_u32 s58, s4, 28672
v_accvgpr_write_b32 a227, 0
v_mfma_f32_16x16x32_bf16 v[48:51], a[136:139], a[24:27], v[48:51]
buffer_load_dwordx4 v220, s[40:43], s58 offen lds
v_mfma_f32_16x16x32_bf16 v[56:59], a[136:139], a[28:31], v[56:59]
v_cndmask_b32 v224, 0, v219, vcc
v_sub_u32 v219, v219, v224
v_mfma_f32_16x16x32_bf16 v[60:63], a[140:143], a[28:31], v[60:63]
buffer_load_dwordx4 v221, s[40:43], s58 offen offset:1024 lds
v_accvgpr_write_b32 a228, 0
v_mfma_f32_16x16x32_bf16 v[52:55], a[140:143], a[24:27], v[52:55]
buffer_load_dwordx4 v222, s[40:43], s58 offen offset:2048 lds
v_mfma_f32_16x16x32_bf16 v[44:47], a[140:143], a[20:23], v[44:47]
v_accvgpr_write_b32 a229, 0
v_accvgpr_write_b32 a224, v224
v_mfma_f32_16x16x32_bf16 v[36:39], a[140:143], a[16:19], v[36:39]
v_accvgpr_write_b32 a225, v219
s_waitcnt lgkmcnt(0)
v_mfma_f32_16x16x32_bf16 v[0:3], a[96:99], a[32:35], v[0:3]
s_waitcnt vmcnt(15)
ds_read_b64_tr_b16 a[128:129], v230 offset:20480
v_accvgpr_write_b32 a230, v224
v_mfma_f32_16x16x32_bf16 v[8:11], a[96:99], a[36:39], v[8:11]
ds_read_b64_tr_b16 a[130:131], v230 offset:22528
ds_read_b128 a[48:51], v237 offset:4096
v_mfma_f32_16x16x32_bf16 v[16:19], a[96:99], a[40:43], v[16:19]
ds_read_b128 a[52:55], v237 offset:5120
ds_read_b128 a[56:59], v237 offset:6144
v_mfma_f32_16x16x32_bf16 v[24:27], a[96:99], a[44:47], v[24:27]
buffer_load_dwordx4 v223, s[40:43], s58 offen offset:3072 lds
v_accvgpr_write_b32 a231, v219
v_mfma_f32_16x16x32_bf16 v[28:31], a[100:103], a[44:47], v[28:31]
ds_read_b128 a[60:63], v237 offset:7168
ds_read_b64_tr_b16 a[132:133], v231 offset:20480
v_mfma_f32_16x16x32_bf16 v[20:23], a[100:103], a[40:43], v[20:23]
ds_read_b64_tr_b16 a[134:135], v231 offset:22528
ds_read_b64_tr_b16 a[136:137], v232 offset:20480
v_mfma_f32_16x16x32_bf16 v[12:15], a[100:103], a[36:39], v[12:15]
ds_read_b64_tr_b16 a[138:139], v232 offset:22528
s_add_u32 m0, s53, 16384
v_mfma_f32_16x16x32_bf16 v[4:7], a[100:103], a[32:35], v[4:7]
s_add_u32 s58, s5, 0
ds_read_b64_tr_b16 a[140:141], v233 offset:20480
s_lshl_b32 s59, s66, 4
v_mfma_f32_16x16x32_bf16 v[32:35], a[104:107], a[32:35], v[32:35]
ds_read_b64_tr_b16 a[142:143], v233 offset:22528
v_mfma_f32_16x16x32_bf16 v[40:43], a[104:107], a[36:39], v[40:43]
buffer_load_dwordx4 v220, s[40:43], s58 offen lds
v_mfma_f32_16x16x32_bf16 v[48:51], a[104:107], a[40:43], v[48:51]
s_add_u32 s20, s16, s59
s_addc_u32 s21, s17, 0
s_mov_b32 s22, 4
v_mfma_f32_16x16x32_bf16 v[56:59], a[104:107], a[44:47], v[56:59]
buffer_load_dwordx4 v221, s[40:43], s58 offen offset:1024 lds
v_mfma_f32_16x16x32_bf16 v[60:63], a[108:111], a[44:47], v[60:63]
s_mov_b32 s23, 0x20000
s_mul_i32 s59, s66, 917504
v_mfma_f32_16x16x32_bf16 v[52:55], a[108:111], a[40:43], v[52:55]
buffer_load_dwordx4 v222, s[40:43], s58 offen offset:2048 lds
v_mfma_f32_16x16x32_bf16 v[44:47], a[108:111], a[36:39], v[44:47]
s_add_u32 s24, s18, s59
s_addc_u32 s25, s19, 0
s_mov_b32 s26, 917504
v_mfma_f32_16x16x32_bf16 v[36:39], a[108:111], a[32:35], v[36:39]
s_mov_b32 s27, 0x20000
s_waitcnt lgkmcnt(0)
v_mfma_f32_16x16x32_bf16 v[0:3], a[128:131], a[48:51], v[0:3]
s_waitcnt vmcnt(15)
ds_read_b64_tr_b16 a[96:97], v230 offset:0
s_mov_b32 s59, 0
v_mfma_f32_16x16x32_bf16 v[8:11], a[128:131], a[52:55], v[8:11]
ds_read_b64_tr_b16 a[98:99], v230 offset:2048
ds_read_b128 a[64:67], v238 offset:0
v_mfma_f32_16x16x32_bf16 v[16:19], a[128:131], a[56:59], v[16:19]
ds_read_b128 a[68:71], v238 offset:1024
ds_read_b128 a[72:75], v238 offset:2048
v_mfma_f32_16x16x32_bf16 v[24:27], a[128:131], a[60:63], v[24:27]
buffer_load_dwordx4 v223, s[40:43], s58 offen offset:3072 lds
v_mfma_f32_16x16x32_bf16 v[28:31], a[132:135], a[60:63], v[28:31]
ds_read_b128 a[76:79], v238 offset:3072
ds_read_b64_tr_b16 a[100:101], v231 offset:0
v_mfma_f32_16x16x32_bf16 v[20:23], a[132:135], a[56:59], v[20:23]
ds_read_b64_tr_b16 a[102:103], v231 offset:2048
ds_read_b64_tr_b16 a[104:105], v232 offset:0
v_mfma_f32_16x16x32_bf16 v[12:15], a[132:135], a[52:55], v[12:15]
ds_read_b64_tr_b16 a[106:107], v232 offset:2048
s_add_u32 m0, s53, 20480
s_add_u32 s28, s14, s59
s_addc_u32 s29, s15, 0
v_mfma_f32_16x16x32_bf16 v[4:7], a[132:135], a[48:51], v[4:7]
s_add_u32 s58, s5, 28672
ds_read_b64_tr_b16 a[108:109], v233 offset:0
v_mfma_f32_16x16x32_bf16 v[32:35], a[136:139], a[48:51], v[32:35]
ds_read_b64_tr_b16 a[110:111], v233 offset:2048
s_mov_b32 s30, 57344
v_mfma_f32_16x16x32_bf16 v[40:43], a[136:139], a[52:55], v[40:43]
buffer_load_dwordx4 v220, s[40:43], s58 offen lds
s_mov_b32 s31, 0x20000
v_mfma_f32_16x16x32_bf16 v[48:51], a[136:139], a[56:59], v[48:51]
buffer_load_dwordx4 v221, s[40:43], s58 offen offset:1024 lds
v_mfma_f32_16x16x32_bf16 v[56:59], a[136:139], a[60:63], v[56:59]
s_mov_b32 s63, 0xffff0000
s_lshl_b32 s55, s67, 2
v_mfma_f32_16x16x32_bf16 v[60:63], a[140:143], a[60:63], v[60:63]
buffer_load_dwordx4 v222, s[40:43], s58 offen offset:2048 lds
s_add_u32 s55, s55, s52
v_mfma_f32_16x16x32_bf16 v[52:55], a[140:143], a[56:59], v[52:55]
buffer_load_dwordx4 v223, s[40:43], s58 offen offset:3072 lds
v_mfma_f32_16x16x32_bf16 v[44:47], a[140:143], a[52:55], v[44:47]
s_lshr_b32 s56, s55, 4
s_and_b32 s59, s55, 2
v_mfma_f32_16x16x32_bf16 v[36:39], a[140:143], a[48:51], v[36:39]
s_lshl_b32 s59, s59, 1
s_add_u32 s56, s56, s59
s_waitcnt lgkmcnt(0)
v_mfma_f32_16x16x32_bf16 v[0:3], a[96:99], a[64:67], v[0:3]
s_waitcnt vmcnt(16)
ds_read_b64_tr_b16 a[128:129], v230 offset:4096
v_mfma_f32_16x16x32_bf16 v[8:11], a[96:99], a[68:71], v[8:11]
ds_read_b64_tr_b16 a[130:131], v230 offset:6144
ds_read_b128 a[80:83], v238 offset:4096
v_mfma_f32_16x16x32_bf16 v[16:19], a[96:99], a[72:75], v[16:19]
ds_read_b128 a[84:87], v238 offset:5120
ds_read_b128 a[88:91], v238 offset:6144
s_add_u32 s56, s56, s64
v_mfma_f32_16x16x32_bf16 v[24:27], a[96:99], a[76:79], v[24:27]
s_add_u32 m0, s53, 0
s_add_u32 s58, s6, 0
buffer_load_dwordx4 v220, s[40:43], s58 offen lds
v_mfma_f32_16x16x32_bf16 v[28:31], a[100:103], a[76:79], v[28:31]
ds_read_b128 a[92:95], v238 offset:7168
ds_read_b64_tr_b16 a[132:133], v231 offset:4096
s_and_b32 s56, s56, 7
v_mfma_f32_16x16x32_bf16 v[20:23], a[100:103], a[72:75], v[20:23]
ds_read_b64_tr_b16 a[134:135], v231 offset:6144
ds_read_b64_tr_b16 a[136:137], v232 offset:4096
v_mfma_f32_16x16x32_bf16 v[12:15], a[100:103], a[68:71], v[12:15]
ds_read_b64_tr_b16 a[138:139], v232 offset:6144
s_bfe_u32 s59, s55, 0x20002
v_mfma_f32_16x16x32_bf16 v[4:7], a[100:103], a[64:67], v[4:7]
buffer_load_dwordx4 v221, s[40:43], s58 offen offset:1024 lds
s_and_b32 s60, s55, 1
v_mfma_f32_16x16x32_bf16 v[32:35], a[104:107], a[64:67], v[32:35]
ds_read_b64_tr_b16 a[140:141], v233 offset:4096
ds_read_b64_tr_b16 a[142:143], v233 offset:6144
v_mfma_f32_16x16x32_bf16 v[40:43], a[104:107], a[68:71], v[40:43]
buffer_load_dwordx4 v222, s[40:43], s58 offen offset:2048 lds
s_lshl_b32 s57, s56, 1
v_mfma_f32_16x16x32_bf16 v[48:51], a[104:107], a[72:75], v[48:51]
buffer_load_dwordx4 v223, s[40:43], s58 offen offset:3072 lds
v_mfma_f32_16x16x32_bf16 v[56:59], a[104:107], a[76:79], v[56:59]
s_add_u32 s57, s57, s60
s_lshl_b32 s9, s57, 6
v_mfma_f32_16x16x32_bf16 v[60:63], a[108:111], a[76:79], v[60:63]
s_lshl_b32 s57, s57, 2
s_add_u32 s57, s57, s59
s_lshl_b32 s57, s57, 14
v_mfma_f32_16x16x32_bf16 v[52:55], a[108:111], a[72:75], v[52:55]
s_mul_i32 s60, s59, 14336
s_add_u32 s9, s9, s60
v_mfma_f32_16x16x32_bf16 v[44:47], a[108:111], a[68:71], v[44:47]
s_cmp_eq_u32 s56, 7
s_cselect_b32 s56, 1, 0
v_mfma_f32_16x16x32_bf16 v[36:39], a[108:111], a[64:67], v[36:39]
s_cmp_ge_u32 s59, 4
s_cselect_b32 s56, 1, s56
s_waitcnt lgkmcnt(0)
v_mfma_f32_16x16x32_bf16 v[0:3], a[128:131], a[80:83], v[0:3]
s_waitcnt vmcnt(16)
ds_read_b64_tr_b16 a[96:97], v230 offset:8192
v_mfma_f32_16x16x32_bf16 v[8:11], a[128:131], a[84:87], v[8:11]
ds_read_b64_tr_b16 a[98:99], v230 offset:10240
ds_read_b64_tr_b16 a[100:101], v231 offset:8192
v_mfma_f32_16x16x32_bf16 v[16:19], a[128:131], a[88:91], v[16:19]
ds_read_b64_tr_b16 a[102:103], v231 offset:10240
ds_read_b64_tr_b16 a[104:105], v232 offset:8192
v_mfma_f32_16x16x32_bf16 v[24:27], a[128:131], a[92:95], v[24:27]
s_add_u32 m0, s53, 4096
s_add_u32 s58, s6, 28672
buffer_load_dwordx4 v220, s[40:43], s58 offen lds
v_mfma_f32_16x16x32_bf16 v[28:31], a[132:135], a[92:95], v[28:31]
ds_read_b64_tr_b16 a[106:107], v232 offset:10240
v_mfma_f32_16x16x32_bf16 v[20:23], a[132:135], a[88:91], v[20:23]
ds_read_b64_tr_b16 a[108:109], v233 offset:8192
v_mfma_f32_16x16x32_bf16 v[12:15], a[132:135], a[84:87], v[12:15]
buffer_load_dwordx4 v221, s[40:43], s58 offen offset:1024 lds
v_mfma_f32_16x16x32_bf16 v[4:7], a[132:135], a[80:83], v[4:7]
ds_read_b64_tr_b16 a[110:111], v233 offset:10240
v_mfma_f32_16x16x32_bf16 v[32:35], a[136:139], a[80:83], v[32:35]
buffer_load_dwordx4 v222, s[40:43], s58 offen offset:2048 lds
v_mfma_f32_16x16x32_bf16 v[40:43], a[136:139], a[84:87], v[40:43]
v_mfma_f32_16x16x32_bf16 v[48:51], a[136:139], a[88:91], v[48:51]
buffer_load_dwordx4 v223, s[40:43], s58 offen offset:3072 lds
v_mfma_f32_16x16x32_bf16 v[56:59], a[136:139], a[92:95], v[56:59]
v_mfma_f32_16x16x32_bf16 v[60:63], a[140:143], a[92:95], v[60:63]
v_mfma_f32_16x16x32_bf16 v[52:55], a[140:143], a[88:91], v[52:55]
v_mfma_f32_16x16x32_bf16 v[44:47], a[140:143], a[84:87], v[44:47]
v_mfma_f32_16x16x32_bf16 v[36:39], a[140:143], a[80:83], v[36:39]
s_waitcnt lgkmcnt(0)
v_mfma_f32_16x16x32_bf16 v[64:67], a[96:99], v[128:131], 0
s_waitcnt vmcnt(16)
ds_read_b64_tr_b16 a[128:129], v230 offset:12288
v_mfma_f32_16x16x32_bf16 v[72:75], a[96:99], v[136:139], 0
ds_read_b64_tr_b16 a[130:131], v230 offset:14336
ds_read_b64_tr_b16 a[132:133], v231 offset:12288
v_mfma_f32_16x16x32_bf16 v[80:83], a[96:99], v[144:147], 0
ds_read_b64_tr_b16 a[134:135], v231 offset:14336
ds_read_b64_tr_b16 a[136:137], v232 offset:12288
v_mfma_f32_16x16x32_bf16 v[88:91], a[96:99], v[152:155], 0
s_add_u32 m0, s53, 8192
s_add_u32 s58, s7, 0
buffer_load_dwordx4 v220, s[40:43], s58 offen lds
v_mfma_f32_16x16x32_bf16 v[92:95], a[100:103], v[152:155], 0
ds_read_b64_tr_b16 a[138:139], v232 offset:14336
v_cvt_pk_bf16_f32 v192, v0, v1
v_mfma_f32_16x16x32_bf16 v[84:87], a[100:103], v[144:147], 0
ds_read_b64_tr_b16 a[140:141], v233 offset:12288
v_cvt_pk_bf16_f32 v193, v2, v3
v_cvt_pk_bf16_f32 v194, v4, v5
v_mfma_f32_16x16x32_bf16 v[76:79], a[100:103], v[136:139], 0
buffer_load_dwordx4 v221, s[40:43], s58 offen offset:1024 lds
v_cvt_pk_bf16_f32 v195, v6, v7
v_mfma_f32_16x16x32_bf16 v[68:71], a[100:103], v[128:131], 0
buffer_load_dwordx4 v222, s[40:43], s58 offen offset:2048 lds
v_mfma_f32_16x16x32_bf16 v[96:99], a[104:107], v[128:131], 0
ds_read_b64_tr_b16 a[142:143], v233 offset:14336
s_mov_b32 s69, 0
buffer_store_dwordx4 v[192:195], v234, s[44:47], s69 offen sc1
v_cvt_pk_bf16_f32 v196, v8, v9
v_mfma_f32_16x16x32_bf16 v[104:107], a[104:107], v[136:139], 0
buffer_load_dwordx4 v223, s[40:43], s58 offen offset:3072 lds
v_cvt_pk_bf16_f32 v197, v10, v11
v_mfma_f32_16x16x32_bf16 v[112:115], a[104:107], v[144:147], 0
v_cvt_pk_bf16_f32 v198, v12, v13
v_cvt_pk_bf16_f32 v199, v14, v15
v_mfma_f32_16x16x32_bf16 v[120:123], a[104:107], v[152:155], 0
s_mov_b32 s69, 16384
buffer_store_dwordx4 v[196:199], v234, s[44:47], s69 offen sc1
v_cvt_pk_bf16_f32 v200, v16, v17
v_cvt_pk_bf16_f32 v201, v18, v19
v_mfma_f32_16x16x32_bf16 v[124:127], a[108:111], v[152:155], 0
v_cvt_pk_bf16_f32 v202, v20, v21
v_cvt_pk_bf16_f32 v203, v22, v23
v_mfma_f32_16x16x32_bf16 v[116:119], a[108:111], v[144:147], 0
s_mov_b32 s69, 32768
buffer_store_dwordx4 v[200:203], v234, s[44:47], s69 offen sc1
v_cvt_pk_bf16_f32 v204, v24, v25
v_cvt_pk_bf16_f32 v205, v26, v27
v_mfma_f32_16x16x32_bf16 v[108:111], a[108:111], v[136:139], 0
v_cvt_pk_bf16_f32 v206, v28, v29
v_cvt_pk_bf16_f32 v207, v30, v31
v_mfma_f32_16x16x32_bf16 v[100:103], a[108:111], v[128:131], 0
s_mov_b32 s69, 49152
buffer_store_dwordx4 v[204:207], v234, s[44:47], s69 offen sc1
s_waitcnt lgkmcnt(0)
v_mfma_f32_16x16x32_bf16 v[64:67], a[128:131], v[160:163], v[64:67]
s_waitcnt vmcnt(20)
ds_read_b64_tr_b16 a[96:97], v230 offset:16384
v_cvt_pk_bf16_f32 v192, v32, v33
v_mfma_f32_16x16x32_bf16 v[72:75], a[128:131], v[168:171], v[72:75]
ds_read_b64_tr_b16 a[98:99], v230 offset:18432
ds_read_b64_tr_b16 a[100:101], v231 offset:16384
v_cvt_pk_bf16_f32 v193, v34, v35
v_mfma_f32_16x16x32_bf16 v[80:83], a[128:131], v[176:179], v[80:83]
ds_read_b64_tr_b16 a[102:103], v231 offset:18432
ds_read_b64_tr_b16 a[104:105], v232 offset:16384
v_cvt_pk_bf16_f32 v194, v36, v37
v_mfma_f32_16x16x32_bf16 v[88:91], a[128:131], v[184:187], v[88:91]
s_add_u32 m0, s53, 12288
s_add_u32 s58, s7, 28672
buffer_load_dwordx4 v220, s[40:43], s58 offen lds
v_mfma_f32_16x16x32_bf16 v[92:95], a[132:135], v[184:187], v[92:95]
ds_read_b64_tr_b16 a[106:107], v232 offset:18432
v_cvt_pk_bf16_f32 v195, v38, v39
v_mfma_f32_16x16x32_bf16 v[84:87], a[132:135], v[176:179], v[84:87]
ds_read_b64_tr_b16 a[108:109], v233 offset:16384
s_mov_b32 s69, 65536
buffer_store_dwordx4 v[192:195], v234, s[44:47], s69 offen sc1
v_cvt_pk_bf16_f32 v196, v40, v41
v_mfma_f32_16x16x32_bf16 v[76:79], a[132:135], v[168:171], v[76:79]
buffer_load_dwordx4 v221, s[40:43], s58 offen offset:1024 lds
v_cvt_pk_bf16_f32 v197, v42, v43
v_mfma_f32_16x16x32_bf16 v[68:71], a[132:135], v[160:163], v[68:71]
ds_read_b64_tr_b16 a[110:111], v233 offset:18432
v_cvt_pk_bf16_f32 v198, v44, v45
v_cvt_pk_bf16_f32 v199, v46, v47
v_mfma_f32_16x16x32_bf16 v[96:99], a[136:139], v[160:163], v[96:99]
s_mov_b32 s69, 81920
buffer_store_dwordx4 v[196:199], v234, s[44:47], s69 offen sc1
v_mfma_f32_16x16x32_bf16 v[104:107], a[136:139], v[168:171], v[104:107]
v_cvt_pk_bf16_f32 v200, v48, v49
v_cvt_pk_bf16_f32 v201, v50, v51
v_cvt_pk_bf16_f32 v202, v52, v53
v_mfma_f32_16x16x32_bf16 v[112:115], a[136:139], v[176:179], v[112:115]
v_cvt_pk_bf16_f32 v203, v54, v55
v_mfma_f32_16x16x32_bf16 v[120:123], a[136:139], v[184:187], v[120:123]
s_mov_b32 s69, 98304
buffer_store_dwordx4 v[200:203], v234, s[44:47], s69 offen sc1
v_mfma_f32_16x16x32_bf16 v[124:127], a[140:143], v[184:187], v[124:127]
v_cvt_pk_bf16_f32 v204, v56, v57
v_cvt_pk_bf16_f32 v205, v58, v59
v_mfma_f32_16x16x32_bf16 v[116:119], a[140:143], v[176:179], v[116:119]
v_cvt_pk_bf16_f32 v206, v60, v61
v_cvt_pk_bf16_f32 v207, v62, v63
v_mfma_f32_16x16x32_bf16 v[108:111], a[140:143], v[168:171], v[108:111]
s_mov_b32 s69, 114688
buffer_store_dwordx4 v[204:207], v234, s[44:47], s69 offen sc1
v_mfma_f32_16x16x32_bf16 v[100:103], a[140:143], v[160:163], v[100:103]
s_waitcnt lgkmcnt(0)
v_mfma_f32_16x16x32_bf16 v[64:67], a[96:99], a[0:3], v[64:67]
s_waitcnt vmcnt(22)
ds_read_b64_tr_b16 a[128:129], v230 offset:20480
v_mfma_f32_16x16x32_bf16 v[72:75], a[96:99], a[4:7], v[72:75]
ds_read_b64_tr_b16 a[130:131], v230 offset:22528
ds_read_b64_tr_b16 a[132:133], v231 offset:20480
v_mfma_f32_16x16x32_bf16 v[80:83], a[96:99], a[8:11], v[80:83]
ds_read_b64_tr_b16 a[134:135], v231 offset:22528
ds_read_b64_tr_b16 a[136:137], v232 offset:20480
v_mfma_f32_16x16x32_bf16 v[88:91], a[96:99], a[12:15], v[88:91]
buffer_load_dwordx4 v222, s[40:43], s58 offen offset:2048 lds
v_mfma_f32_16x16x32_bf16 v[92:95], a[100:103], a[12:15], v[92:95]
ds_read_b64_tr_b16 a[138:139], v232 offset:22528
v_mfma_f32_16x16x32_bf16 v[84:87], a[100:103], a[8:11], v[84:87]
ds_read_b64_tr_b16 a[140:141], v233 offset:20480
v_mfma_f32_16x16x32_bf16 v[76:79], a[100:103], a[4:7], v[76:79]
v_mfma_f32_16x16x32_bf16 v[68:71], a[100:103], a[0:3], v[68:71]
buffer_load_dwordx4 v223, s[40:43], s58 offen offset:3072 lds
v_mfma_f32_16x16x32_bf16 v[96:99], a[104:107], a[0:3], v[96:99]
ds_read_b64_tr_b16 a[142:143], v233 offset:22528
v_mfma_f32_16x16x32_bf16 v[104:107], a[104:107], a[4:7], v[104:107]
v_mfma_f32_16x16x32_bf16 v[112:115], a[104:107], a[8:11], v[112:115]
v_mfma_f32_16x16x32_bf16 v[120:123], a[104:107], a[12:15], v[120:123]
v_mfma_f32_16x16x32_bf16 v[124:127], a[108:111], a[12:15], v[124:127]
v_mfma_f32_16x16x32_bf16 v[116:119], a[108:111], a[8:11], v[116:119]
v_mfma_f32_16x16x32_bf16 v[108:111], a[108:111], a[4:7], v[108:111]
v_mfma_f32_16x16x32_bf16 v[100:103], a[108:111], a[0:3], v[100:103]
s_waitcnt lgkmcnt(0)
v_mfma_f32_16x16x32_bf16 v[64:67], a[128:131], a[16:19], v[64:67]
s_waitcnt vmcnt(16)
ds_read_b64_tr_b16 a[96:97], v230 offset:0
v_mfma_f32_16x16x32_bf16 v[72:75], a[128:131], a[20:23], v[72:75]
ds_read_b64_tr_b16 a[98:99], v230 offset:2048
ds_read_b64_tr_b16 a[100:101], v231 offset:0
v_mfma_f32_16x16x32_bf16 v[80:83], a[128:131], a[24:27], v[80:83]
ds_read_b64_tr_b16 a[102:103], v231 offset:2048
ds_read_b64_tr_b16 a[104:105], v230 offset:4096
v_mfma_f32_16x16x32_bf16 v[88:91], a[128:131], a[28:31], v[88:91]
v_mfma_f32_16x16x32_bf16 v[92:95], a[132:135], a[28:31], v[92:95]
ds_read_b64_tr_b16 a[106:107], v230 offset:6144
v_mfma_f32_16x16x32_bf16 v[84:87], a[132:135], a[24:27], v[84:87]
ds_read_b64_tr_b16 a[108:109], v231 offset:4096
v_mfma_f32_16x16x32_bf16 v[76:79], a[132:135], a[20:23], v[76:79]
v_mfma_f32_16x16x32_bf16 v[68:71], a[132:135], a[16:19], v[68:71]
ds_read_b64_tr_b16 a[110:111], v231 offset:6144
v_mfma_f32_16x16x32_bf16 v[96:99], a[136:139], a[16:19], v[96:99]
v_mfma_f32_16x16x32_bf16 v[104:107], a[136:139], a[20:23], v[104:107]
v_mfma_f32_16x16x32_bf16 v[112:115], a[136:139], a[24:27], v[112:115]
v_mfma_f32_16x16x32_bf16 v[120:123], a[136:139], a[28:31], v[120:123]
v_mfma_f32_16x16x32_bf16 v[124:127], a[140:143], a[28:31], v[124:127]
v_mfma_f32_16x16x32_bf16 v[116:119], a[140:143], a[24:27], v[116:119]
v_mfma_f32_16x16x32_bf16 v[108:111], a[140:143], a[20:23], v[108:111]
v_mfma_f32_16x16x32_bf16 v[100:103], a[140:143], a[16:19], v[100:103]
s_waitcnt lgkmcnt(0)
v_mfma_f32_16x16x32_bf16 v[64:67], a[96:99], a[32:35], v[64:67]
s_waitcnt vmcnt(0)
v_mfma_f32_16x16x32_bf16 v[72:75], a[96:99], a[36:39], v[72:75]
ds_read_b64_tr_b16 a[128:129], v230 offset:8192
ds_read_b64_tr_b16 a[130:131], v230 offset:10240
v_mfma_f32_16x16x32_bf16 v[80:83], a[96:99], a[40:43], v[80:83]
ds_read_b64_tr_b16 a[132:133], v231 offset:8192
ds_read_b64_tr_b16 a[134:135], v231 offset:10240
v_mfma_f32_16x16x32_bf16 v[88:91], a[96:99], a[44:47], v[88:91]
ds_read_b64_tr_b16 a[136:137], v230 offset:12288
v_mfma_f32_16x16x32_bf16 v[92:95], a[100:103], a[44:47], v[92:95]
ds_read_b64_tr_b16 a[138:139], v230 offset:14336
v_mfma_f32_16x16x32_bf16 v[84:87], a[100:103], a[40:43], v[84:87]
ds_read_b64_tr_b16 a[140:141], v231 offset:12288
v_mfma_f32_16x16x32_bf16 v[76:79], a[100:103], a[36:39], v[76:79]
v_mfma_f32_16x16x32_bf16 v[68:71], a[100:103], a[32:35], v[68:71]
ds_read_b64_tr_b16 a[142:143], v231 offset:14336
v_mfma_f32_16x16x32_bf16 v[64:67], a[104:107], a[48:51], v[64:67]
v_mfma_f32_16x16x32_bf16 v[72:75], a[104:107], a[52:55], v[72:75]
v_mfma_f32_16x16x32_bf16 v[80:83], a[104:107], a[56:59], v[80:83]
v_mfma_f32_16x16x32_bf16 v[88:91], a[104:107], a[60:63], v[88:91]
v_mfma_f32_16x16x32_bf16 v[92:95], a[108:111], a[60:63], v[92:95]
v_mfma_f32_16x16x32_bf16 v[84:87], a[108:111], a[56:59], v[84:87]
v_mfma_f32_16x16x32_bf16 v[76:79], a[108:111], a[52:55], v[76:79]
v_mfma_f32_16x16x32_bf16 v[68:71], a[108:111], a[48:51], v[68:71]
s_waitcnt lgkmcnt(0)
v_mfma_f32_16x16x32_bf16 v[64:67], a[128:131], a[64:67], v[64:67]
ds_read_b64_tr_b16 a[96:97], v232 offset:0
ds_read_b64_tr_b16 a[98:99], v232 offset:2048
v_mfma_f32_16x16x32_bf16 v[72:75], a[128:131], a[68:71], v[72:75]
ds_read_b64_tr_b16 a[100:101], v233 offset:0
ds_read_b64_tr_b16 a[102:103], v233 offset:2048
v_mfma_f32_16x16x32_bf16 v[80:83], a[128:131], a[72:75], v[80:83]
ds_read_b64_tr_b16 a[104:105], v232 offset:4096
v_mfma_f32_16x16x32_bf16 v[88:91], a[128:131], a[76:79], v[88:91]
v_mfma_f32_16x16x32_bf16 v[92:95], a[132:135], a[76:79], v[92:95]
ds_read_b64_tr_b16 a[106:107], v232 offset:6144
v_mfma_f32_16x16x32_bf16 v[84:87], a[132:135], a[72:75], v[84:87]
ds_read_b64_tr_b16 a[108:109], v233 offset:4096
v_mfma_f32_16x16x32_bf16 v[76:79], a[132:135], a[68:71], v[76:79]
v_mfma_f32_16x16x32_bf16 v[68:71], a[132:135], a[64:67], v[68:71]
ds_read_b64_tr_b16 a[110:111], v233 offset:6144
v_mfma_f32_16x16x32_bf16 v[64:67], a[136:139], a[80:83], v[64:67]
buffer_store_dword v209, v208, s[72:75], 0 offen offset:0 sc1
v_mfma_f32_16x16x32_bf16 v[72:75], a[136:139], a[84:87], v[72:75]
v_mfma_f32_16x16x32_bf16 v[80:83], a[136:139], a[88:91], v[80:83]
v_mfma_f32_16x16x32_bf16 v[88:91], a[136:139], a[92:95], v[88:91]
v_mfma_f32_16x16x32_bf16 v[92:95], a[140:143], a[92:95], v[92:95]
v_mfma_f32_16x16x32_bf16 v[84:87], a[140:143], a[88:91], v[84:87]
v_mfma_f32_16x16x32_bf16 v[76:79], a[140:143], a[84:87], v[76:79]
v_mfma_f32_16x16x32_bf16 v[68:71], a[140:143], a[80:83], v[68:71]
s_waitcnt lgkmcnt(0)
v_mfma_f32_16x16x32_bf16 v[96:99], a[96:99], a[32:35], v[96:99]
ds_read_b64_tr_b16 a[128:129], v232 offset:8192
ds_read_b64_tr_b16 a[130:131], v232 offset:10240
v_mfma_f32_16x16x32_bf16 v[104:107], a[96:99], a[36:39], v[104:107]
ds_read_b64_tr_b16 a[132:133], v233 offset:8192
ds_read_b64_tr_b16 a[134:135], v233 offset:10240
v_mfma_f32_16x16x32_bf16 v[112:115], a[96:99], a[40:43], v[112:115]
ds_read_b64_tr_b16 a[136:137], v232 offset:12288
v_mfma_f32_16x16x32_bf16 v[120:123], a[96:99], a[44:47], v[120:123]
v_mfma_f32_16x16x32_bf16 v[124:127], a[100:103], a[44:47], v[124:127]
ds_read_b64_tr_b16 a[138:139], v232 offset:14336
v_cvt_pk_bf16_f32 v192, v64, v65
v_cvt_pk_bf16_f32 v193, v66, v67
v_mfma_f32_16x16x32_bf16 v[116:119], a[100:103], a[40:43], v[116:119]
ds_read_b64_tr_b16 a[140:141], v233 offset:12288
v_cvt_pk_bf16_f32 v194, v68, v69
v_cvt_pk_bf16_f32 v195, v70, v71
v_mfma_f32_16x16x32_bf16 v[108:111], a[100:103], a[36:39], v[108:111]
s_mov_b32 s69, 0
buffer_store_dwordx4 v[192:195], v234, s[48:51], s69 offen sc1
v_cvt_pk_bf16_f32 v196, v72, v73
v_cvt_pk_bf16_f32 v197, v74, v75
v_mfma_f32_16x16x32_bf16 v[100:103], a[100:103], a[32:35], v[100:103]
ds_read_b64_tr_b16 a[142:143], v233 offset:14336
v_cvt_pk_bf16_f32 v198, v76, v77
v_cvt_pk_bf16_f32 v199, v78, v79
v_mfma_f32_16x16x32_bf16 v[96:99], a[104:107], a[48:51], v[96:99]
s_mov_b32 s69, 16384
buffer_store_dwordx4 v[196:199], v234, s[48:51], s69 offen sc1
v_cvt_pk_bf16_f32 v200, v80, v81
v_mfma_f32_16x16x32_bf16 v[104:107], a[104:107], a[52:55], v[104:107]
v_cvt_pk_bf16_f32 v201, v82, v83
v_cvt_pk_bf16_f32 v202, v84, v85
v_cvt_pk_bf16_f32 v203, v86, v87
v_mfma_f32_16x16x32_bf16 v[112:115], a[104:107], a[56:59], v[112:115]
s_mov_b32 s69, 32768
buffer_store_dwordx4 v[200:203], v234, s[48:51], s69 offen sc1
v_cvt_pk_bf16_f32 v204, v88, v89
v_mfma_f32_16x16x32_bf16 v[120:123], a[104:107], a[60:63], v[120:123]
v_cvt_pk_bf16_f32 v205, v90, v91
v_cvt_pk_bf16_f32 v206, v92, v93
v_mfma_f32_16x16x32_bf16 v[124:127], a[108:111], a[60:63], v[124:127]
v_cvt_pk_bf16_f32 v207, v94, v95
v_mfma_f32_16x16x32_bf16 v[116:119], a[108:111], a[56:59], v[116:119]
s_mov_b32 s69, 49152
buffer_store_dwordx4 v[204:207], v234, s[48:51], s69 offen sc1
v_mfma_f32_16x16x32_bf16 v[108:111], a[108:111], a[52:55], v[108:111]
v_mfma_f32_16x16x32_bf16 v[100:103], a[108:111], a[48:51], v[100:103]
s_waitcnt lgkmcnt(0)
v_mfma_f32_16x16x32_bf16 v[96:99], a[128:131], a[64:67], v[96:99]
v_mfma_f32_16x16x32_bf16 v[104:107], a[128:131], a[68:71], v[104:107]
v_mfma_f32_16x16x32_bf16 v[112:115], a[128:131], a[72:75], v[112:115]
v_mfma_f32_16x16x32_bf16 v[120:123], a[128:131], a[76:79], v[120:123]
v_mfma_f32_16x16x32_bf16 v[124:127], a[132:135], a[76:79], v[124:127]
v_mfma_f32_16x16x32_bf16 v[116:119], a[132:135], a[72:75], v[116:119]
v_mfma_f32_16x16x32_bf16 v[108:111], a[132:135], a[68:71], v[108:111]
v_mfma_f32_16x16x32_bf16 v[100:103], a[132:135], a[64:67], v[100:103]
v_mfma_f32_16x16x32_bf16 v[96:99], a[136:139], a[80:83], v[96:99]
v_mfma_f32_16x16x32_bf16 v[104:107], a[136:139], a[84:87], v[104:107]
v_mfma_f32_16x16x32_bf16 v[112:115], a[136:139], a[88:91], v[112:115]
v_mfma_f32_16x16x32_bf16 v[120:123], a[136:139], a[92:95], v[120:123]
buffer_load_dword v211, v210, s[72:75], 0 offen sc1
v_mfma_f32_16x16x32_bf16 v[124:127], a[140:143], a[92:95], v[124:127]
v_mfma_f32_16x16x32_bf16 v[116:119], a[140:143], a[88:91], v[116:119]
v_mfma_f32_16x16x32_bf16 v[108:111], a[140:143], a[84:87], v[108:111]
v_mfma_f32_16x16x32_bf16 v[100:103], a[140:143], a[80:83], v[100:103]
v_cvt_pk_bf16_f32 v192, v96, v97
v_cvt_pk_bf16_f32 v193, v98, v99
s_nop 5
v_cvt_pk_bf16_f32 v194, v100, v101
v_cvt_pk_bf16_f32 v195, v102, v103
s_mov_b32 s69, 65536
buffer_store_dwordx4 v[192:195], v234, s[48:51], s69 offen sc1
v_cvt_pk_bf16_f32 v196, v104, v105
v_cvt_pk_bf16_f32 v197, v106, v107
v_cvt_pk_bf16_f32 v198, v108, v109
v_cvt_pk_bf16_f32 v199, v110, v111
s_mov_b32 s69, 81920
buffer_store_dwordx4 v[196:199], v234, s[48:51], s69 offen sc1
v_cvt_pk_bf16_f32 v200, v112, v113
v_cvt_pk_bf16_f32 v201, v114, v115
v_cvt_pk_bf16_f32 v202, v116, v117
v_cvt_pk_bf16_f32 v203, v118, v119
s_mov_b32 s69, 98304
buffer_store_dwordx4 v[200:203], v234, s[48:51], s69 offen sc1
v_cvt_pk_bf16_f32 v204, v120, v121
v_cvt_pk_bf16_f32 v205, v122, v123
v_cvt_pk_bf16_f32 v206, v124, v125
v_cvt_pk_bf16_f32 v207, v126, v127
s_mov_b32 s69, 114688
buffer_store_dwordx4 v[204:207], v234, s[48:51], s69 offen sc1
s_cmp_eq_u32 s56, 1
s_cbranch_scc1 L_rb0
s_waitcnt vmcnt(4)
v_cmp_eq_u32 vcc, 1, v211
s_nop 1
s_cmp_eq_u64 vcc, -1
s_cbranch_scc0 L_rb0
buffer_load_dwordx4 v[128:131], v212, s[24:27], s57 offen sc1
buffer_load_dwordx4 v[132:135], v212, s[24:27], s57 offen offset:1024 sc1
buffer_load_dwordx4 v[136:139], v212, s[24:27], s57 offen offset:2048 sc1
buffer_load_dwordx4 v[140:143], v212, s[24:27], s57 offen offset:3072 sc1
buffer_load_dwordx4 v[144:147], v213, s[24:27], s57 offen sc1
buffer_load_dwordx4 v[148:151], v213, s[24:27], s57 offen offset:1024 sc1
s_waitcnt vmcnt(10)
buffer_store_dword v209, v208, s[72:75], 0 offen offset:64 sc1
s_waitcnt vmcnt(7)
buffer_store_dword v209, v208, s[72:75], 0 offen offset:128 sc1
s_barrier
s_cmp_eq_u32 s52, 0
s_cselect_b32 s22, 4, 0
s_mov_b64 exec, 1
buffer_atomic_add v218, v217, s[20:23], 0 offen sc0
s_mov_b64 exec, -1
s_mov_b32 s22, 4
buffer_load_dwordx4 v[152:155], v213, s[24:27], s57 offen offset:2048 sc1
buffer_load_dwordx4 v[156:159], v213, s[24:27], s57 offen offset:3072 sc1
buffer_load_dwordx4 v[160:163], v214, s[24:27], s57 offen sc1
buffer_load_dwordx4 v[164:167], v214, s[24:27], s57 offen offset:1024 sc1
buffer_load_dwordx4 v[168:171], v214, s[24:27], s57 offen offset:2048 sc1
buffer_load_dwordx4 v[172:175], v214, s[24:27], s57 offen offset:3072 sc1
buffer_load_dwordx4 v[176:179], v215, s[24:27], s57 offen sc1
buffer_load_dwordx4 v[180:183], v215, s[24:27], s57 offen offset:1024 sc1
buffer_load_dwordx4 v[184:187], v215, s[24:27], s57 offen offset:2048 sc1
buffer_load_dwordx4 v[188:191], v215, s[24:27], s57 offen offset:3072 sc1
s_branch L_rsum0
L_rb0:
s_waitcnt vmcnt(4)
buffer_store_dword v209, v208, s[72:75], 0 offen offset:64 sc1
s_waitcnt vmcnt(1)
buffer_store_dword v209, v208, s[72:75], 0 offen offset:128 sc1
s_barrier
s_cmp_eq_u32 s52, 0
s_cselect_b32 s22, 4, 0
s_mov_b64 exec, 1
buffer_atomic_add v218, v217, s[20:23], 0 offen sc0
s_mov_b64 exec, -1
s_mov_b32 s22, 4
s_cmp_eq_u32 s56, 1
s_cbranch_scc1 L_rfin0
s_mov_b32 s62, 200
buffer_load_dword v24, v210, s[72:75], 0 offen sc1
L_rl0:
s_waitcnt vmcnt(0)
v_cmp_eq_u32 vcc, 1, v24
s_nop 1
s_cmp_eq_u64 vcc, -1
s_cbranch_scc1 L_rgo0
buffer_load_dword v24, v210, s[72:75], 0 offen sc1
s_sub_u32 s62, s62, 1
s_cmp_lg_u32 s62, 0
s_cbranch_scc1 L_rl0
s_lshl_b32 s59, 0x10000, s67
v_mov_b32 v219, s59
s_mov_b64 exec, 1
buffer_atomic_or v219, v217, s[20:23], 0 offen sc0
s_mov_b64 exec, -1
s_waitcnt vmcnt(0)
v_readfirstlane_b32 s59, v219
s_nop 1
s_and_b32 s59, s59, 0xff
s_cmp_eq_u32 s59, 16
s_cbranch_scc0 L_rfin0
L_rgo0:
buffer_load_dwordx4 v[128:131], v212, s[24:27], s57 offen sc1
buffer_load_dwordx4 v[132:135], v212, s[24:27], s57 offen offset:1024 sc1
buffer_load_dwordx4 v[136:139], v212, s[24:27], s57 offen offset:2048 sc1
buffer_load_dwordx4 v[140:143], v212, s[24:27], s57 offen offset:3072 sc1
buffer_load_dwordx4 v[144:147], v213, s[24:27], s57 offen sc1
buffer_load_dwordx4 v[148:151], v213, s[24:27], s57 offen offset:1024 sc1
buffer_load_dwordx4 v[152:155], v213, s[24:27], s57 offen offset:2048 sc1
buffer_load_dwordx4 v[156:159], v213, s[24:27], s57 offen offset:3072 sc1
buffer_load_dwordx4 v[160:163], v214, s[24:27], s57 offen sc1
buffer_load_dwordx4 v[164:167], v214, s[24:27], s57 offen offset:1024 sc1
buffer_load_dwordx4 v[168:171], v214, s[24:27], s57 offen offset:2048 sc1
buffer_load_dwordx4 v[172:175], v214, s[24:27], s57 offen offset:3072 sc1
buffer_load_dwordx4 v[176:179], v215, s[24:27], s57 offen sc1
buffer_load_dwordx4 v[180:183], v215, s[24:27], s57 offen offset:1024 sc1
buffer_load_dwordx4 v[184:187], v215, s[24:27], s57 offen offset:2048 sc1
buffer_load_dwordx4 v[188:191], v215, s[24:27], s57 offen offset:3072 sc1
L_rsum0:
s_waitcnt vmcnt(15)
v_mfma_f32_16x16x32_bf16 v[0:3], a[224:227], v[128:131], 0
v_mfma_f32_16x16x32_bf16 v[4:7], a[228:231], v[128:131], 0
s_waitcnt vmcnt(14)
v_mfma_f32_16x16x32_bf16 v[0:3], a[224:227], v[132:135], v[0:3]
v_mfma_f32_16x16x32_bf16 v[4:7], a[228:231], v[132:135], v[4:7]
s_waitcnt vmcnt(13)
v_mfma_f32_16x16x32_bf16 v[0:3], a[224:227], v[136:139], v[0:3]
v_mfma_f32_16x16x32_bf16 v[4:7], a[228:231], v[136:139], v[4:7]
s_waitcnt vmcnt(12)
v_mfma_f32_16x16x32_bf16 v[0:3], a[224:227], v[140:143], v[0:3]
v_mfma_f32_16x16x32_bf16 v[4:7], a[228:231], v[140:143], v[4:7]
s_waitcnt vmcnt(11)
v_mfma_f32_16x16x32_bf16 v[0:3], a[224:227], v[144:147], v[0:3]
v_mfma_f32_16x16x32_bf16 v[4:7], a[228:231], v[144:147], v[4:7]
s_waitcnt vmcnt(10)
v_mfma_f32_16x16x32_bf16 v[0:3], a[224:227], v[148:151], v[0:3]
v_mfma_f32_16x16x32_bf16 v[4:7], a[228:231], v[148:151], v[4:7]
s_waitcnt vmcnt(9)
v_mfma_f32_16x16x32_bf16 v[0:3], a[224:227], v[152:155], v[0:3]
v_mfma_f32_16x16x32_bf16 v[4:7], a[228:231], v[152:155], v[4:7]
s_waitcnt vmcnt(8)
v_mfma_f32_16x16x32_bf16 v[0:3], a[224:227], v[156:159], v[0:3]
v_mfma_f32_16x16x32_bf16 v[4:7], a[228:231], v[156:159], v[4:7]
s_waitcnt vmcnt(7)
v_mfma_f32_16x16x32_bf16 v[0:3], a[224:227], v[160:163], v[0:3]
v_mfma_f32_16x16x32_bf16 v[4:7], a[228:231], v[160:163], v[4:7]
s_waitcnt vmcnt(6)
v_mfma_f32_16x16x32_bf16 v[0:3], a[224:227], v[164:167], v[0:3]
v_mfma_f32_16x16x32_bf16 v[4:7], a[228:231], v[164:167], v[4:7]
s_waitcnt vmcnt(5)
v_mfma_f32_16x16x32_bf16 v[0:3], a[224:227], v[168:171], v[0:3]
v_mfma_f32_16x16x32_bf16 v[4:7], a[228:231], v[168:171], v[4:7]
s_waitcnt vmcnt(4)
v_mfma_f32_16x16x32_bf16 v[0:3], a[224:227], v[172:175], v[0:3]
v_mfma_f32_16x16x32_bf16 v[4:7], a[228:231], v[172:175], v[4:7]
s_waitcnt vmcnt(3)
v_mfma_f32_16x16x32_bf16 v[0:3], a[224:227], v[176:179], v[0:3]
v_mfma_f32_16x16x32_bf16 v[4:7], a[228:231], v[176:179], v[4:7]
s_waitcnt vmcnt(2)
v_mfma_f32_16x16x32_bf16 v[0:3], a[224:227], v[180:183], v[0:3]
v_mfma_f32_16x16x32_bf16 v[4:7], a[228:231], v[180:183], v[4:7]
s_waitcnt vmcnt(1)
v_mfma_f32_16x16x32_bf16 v[0:3], a[224:227], v[184:187], v[0:3]
v_mfma_f32_16x16x32_bf16 v[4:7], a[228:231], v[184:187], v[4:7]
s_waitcnt vmcnt(0)
v_mfma_f32_16x16x32_bf16 v[0:3], a[224:227], v[188:191], v[0:3]
v_mfma_f32_16x16x32_bf16 v[4:7], a[228:231], v[188:191], v[4:7]
s_nop 6
v_cvt_pk_bf16_f32 v16, v0, v1
v_cvt_pk_bf16_f32 v17, v2, v3
v_cvt_pk_bf16_f32 v18, v4, v5
v_cvt_pk_bf16_f32 v19, v6, v7
buffer_store_dwordx2 v[16:17], v216, s[28:31], s9 offen
buffer_store_dwordx2 v[18:19], v216, s[28:31], s9 offen offset:32
L_rfin0:
s_cmp_lg_u32 s52, 0
s_cbranch_scc1 L_rd0
s_waitcnt vmcnt(0)
v_readfirstlane_b32 s59, v218
s_nop 1
s_and_b32 s60, s59, 0xff
s_cmp_lg_u32 s60, 15
s_cbranch_scc1 L_rd0
s_lshr_b32 s60, s59, 16
s_cmp_eq_u32 s60, 0
s_cbranch_scc1 L_rd0
s_ff1_i32_b32 s61, s60
s_bfe_u32 s62, s59, 0x20008
s_lshl_b32 s55, s61, 2
s_add_u32 s55, s55, s62
s_add_u32 s59, s59, 0x100
s_cmp_eq_u32 s62, 3
s_cbranch_scc0 L_rk0
s_and_b32 s59, s59, 0xffff00ff
s_add_u32 s61, s61, 16
s_bitset0_b32 s59, s61
L_rk0:
v_mov_b32 v218, s59
s_lshr_b32 s56, s55, 4
s_and_b32 s59, s55, 2
s_lshl_b32 s59, s59, 1
s_add_u32 s56, s56, s59
s_add_u32 s56, s56, s64
s_and_b32 s56, s56, 7
s_bfe_u32 s59, s55, 0x20002
s_and_b32 s60, s55, 1
s_lshl_b32 s57, s56, 1
s_add_u32 s57, s57, s60
s_lshl_b32 s9, s57, 6
s_lshl_b32 s57, s57, 2
s_add_u32 s57, s57, s59
s_lshl_b32 s57, s57, 14
s_mul_i32 s60, s59, 14336
s_add_u32 s9, s9, s60
s_cmp_eq_u32 s56, 7
s_cselect_b32 s56, 1, 0
s_cmp_ge_u32 s59, 4
s_cselect_b32 s56, 1, s56
s_cmp_eq_u32 s56, 1
s_cbranch_scc1 L_rfin0
s_branch L_rgo0
L_rd0:
L_end:
s_endpgm
L_fb0:
s_waitcnt vmcnt(0) lgkmcnt(0)
s_nop 15
s_barrier
v_accvgpr_write_b32 a244, v242
v_accvgpr_write_b32 a245, v243
v_accvgpr_write_b32 a246, v244
v_accvgpr_write_b32 a247, v245
v_accvgpr_read_b32 v0, a248
s_mov_b32 s71, 0
s_nop 3
s_branch L_top
.p2align 6
L_v1:
v_accvgpr_write_b32 a248, v0
s_cmp_eq_u32 s71, 0
s_cbranch_scc1 L_ni1
v_mov_b32 v6, 0xff800000
v_accvgpr_write_b32 a244, v6
v_accvgpr_write_b32 a245, v6
v_accvgpr_write_b32 a246, v6
v_accvgpr_write_b32 a247, v6
L_ni1:
s_lshl_b32 s59, s64, 7
s_add_u32 s77, s59, 128
s_sub_u32 s69, s77, 896
s_min_u32 s77, s77, s69
s_add_u32 s78, s59, 256
s_sub_u32 s69, s78, 896
s_min_u32 s78, s78, s69
s_add_u32 s79, s59, 384
s_sub_u32 s69, s79, 896
s_min_u32 s79, s79, s69
s_add_u32 s80, s59, 768
s_sub_u32 s69, s80, 896
s_min_u32 s80, s80, s69
s_add_u32 s81, s59, 512
s_sub_u32 s69, s81, 896
s_min_u32 s81, s81, s69
s_add_u32 s82, s59, 640
s_sub_u32 s69, s82, 896
s_min_u32 s82, s82, s69
s_add_u32 s14, s14, s60
s_addc_u32 s15, s15, 0
s_lshl_b32 s66, s64, 1
s_add_u32 s66, s66, 1
s_lshl_b32 s60, s66, 12
s_add_u32 s60, s60, 33554432
s_add_u32 s72, s18, s60
s_addc_u32 s73, s19, 0
s_mov_b32 s74, 4096
s_mov_b32 s75, 0x20000
s_lshl_b32 s60, s67, 8
v_lshlrev_b32 v7, 2, v1
v_mov_b32 v8, 0
s_mov_b32 s74, s71
buffer_store_dword v8, v7, s[72:75], s60 offen sc1
s_mov_b32 s74, 4096
s_lshl_b32 s60, s64, 3
s_add_u32 s60, s60, s65
s_lshl_b32 s60, s60, 18
s_add_u32 s62, s60, s61
s_add_u32 s28, s8, s62
s_addc_u32 s29, s9, 0
s_sub_u32 s30, 262144, s61
s_mov_b32 s31, 0x20000
s_lshl_b32 s62, s52, 16
s_add_u32 s62, s62, s60
s_add_u32 s24, s6, s62
s_addc_u32 s25, s7, 0
s_mov_b32 s26, 65536
s_mov_b32 s27, 0x20000
s_add_u32 s54, s52, s64
s_and_b32 s54, s54, 7
s_lshl_b32 s62, s54, 7
s_mul_i32 s60, s67, 229376
s_add_u32 s60, s60, s62
s_add_u32 s36, s12, s60
s_addc_u32 s37, s13, 0
s_sub_u32 s38, 229376, s62
s_mov_b32 s39, 0x20000
s_mul_i32 s60, s66, 896
s_add_u32 s60, s60, s67
s_lshl_b32 s60, s60, 10
s_lshl_b32 s62, s54, 17
s_add_u32 s60, s60, s62
s_add_u32 s44, s18, s60
s_addc_u32 s45, s19, 0
s_mov_b32 s46, 131072
s_mov_b32 s47, 0x20000
s_cmp_lt_u32 s54, 7
s_cselect_b32 s38, s38, 0
s_cselect_b32 s46, s46, 0
s_add_u32 s54, s52, s64
s_add_u32 s54, s54, 4
s_and_b32 s54, s54, 7
s_lshl_b32 s62, s54, 7
s_mul_i32 s60, s67, 229376
s_add_u32 s60, s60, s62
s_add_u32 s40, s12, s60
s_addc_u32 s41, s13, 0
s_sub_u32 s42, 229376, s62
s_mov_b32 s43, 0x20000
s_mul_i32 s60, s66, 896
s_add_u32 s60, s60, s67
s_lshl_b32 s60, s60, 10
s_lshl_b32 s62, s54, 17
s_add_u32 s60, s60, s62
s_add_u32 s48, s18, s60
s_addc_u32 s49, s19, 0
s_mov_b32 s50, 131072
s_mov_b32 s51, 0x20000
s_cmp_lt_u32 s54, 7
s_cselect_b32 s42, s42, 0
s_cselect_b32 s50, s50, 0
s_add_u32 s60, s52, 0
s_and_b32 s60, s60, 3
s_lshl_b32 s54, s60, 7
s_mul_i32 s4, s60, 57344
s_lshl_b32 s60, s60, 14
v_lshl_add_u32 v235, v1, 4, s60
s_add_u32 s60, s52, 1
s_and_b32 s60, s60, 3
s_lshl_b32 s55, s60, 7
s_mul_i32 s5, s60, 57344
s_lshl_b32 s60, s60, 14
v_lshl_add_u32 v236, v1, 4, s60
s_add_u32 s60, s52, 2
s_and_b32 s60, s60, 3
s_lshl_b32 s56, s60, 7
s_mul_i32 s6, s60, 57344
s_lshl_b32 s60, s60, 14
v_lshl_add_u32 v237, v1, 4, s60
s_add_u32 s60, s52, 3
s_and_b32 s60, s60, 3
s_lshl_b32 s57, s60, 7
s_mul_i32 s7, s60, 57344
s_lshl_b32 s60, s60, 14
v_lshl_add_u32 v238, v1, 4, s60
s_mov_b32 s63, 0x3db8aa3b
v_and_b32 v11, 15, v1
v_lshrrev_b32 v6, 1, v11
v_xor_b32 v7, v6, v5
v_lshlrev_b32 v7, 4, v7
v_lshl_add_u32 v228, v11, 7, v7
v_xor_b32 v229, 64, v228
v_bfe_u32 v7, v1, 3, 2
v_lshlrev_b32 v7, 5, v7
v_and_b32 v8, 3, v1
v_lshl_add_u32 v7, v8, 3, v7
v_bfe_u32 v8, v1, 2, 2
v_lshl_add_u32 v7, v8, 7, v7
v_lshl_add_u32 v7, v5, 10, v7
v_add_u32 v230, s53, v7
v_xor_b32 v231, 32, v230
v_xor_b32 v232, 64, v230
v_xor_b32 v233, 96, v230
v_lshlrev_b32 v254, 9, v5
v_lshrrev_b32 v7, 1, v5
v_xor_b32 v7, v7, v6
v_lshlrev_b32 v7, 4, v7
v_lshl_add_u32 v7, v11, 7, v7
v_and_b32 v8, 1, v5
v_lshl_add_u32 v7, v8, 3, v7
v_add_u32 v224, s53, v7
v_xor_b32 v225, 32, v224
v_xor_b32 v226, 64, v224
v_xor_b32 v227, 96, v224
v_lshlrev_b32 v6, 9, v3
v_add_u32 v212, v6, v9
v_add_u32 v213, v6, v10
v_add_u32 v214, 6144, v212
v_add_u32 v215, 9216, v213
v_add_u32 v213, 3072, v213
v_lshlrev_b32 v12, 1, v5
v_xor_b32 v12, v4, v12
v_lshlrev_b32 v12, 4, v12
v_add_u32 v216, v6, v12
v_add_u32 v217, 3072, v216
v_add_u32 v218, 6144, v216
v_add_u32 v219, 9216, v216
v_mul_u32_u24 v6, 896, v3
v_add_u32 v220, v6, v12
v_add_u32 v221, 6144, v220
v_add_u32 v222, 12288, v220
v_add_u32 v223, 18432, v220
v_lshlrev_b32 v234, 4, v1
v_add_u32 v241, s53, v234
v_lshlrev_b32 v6, 7, v1
v_accvgpr_write_b32 a250, v6
v_and_b32 v6, 31, v1
v_lshlrev_b32 v6, 9, v6
v_lshrrev_b32 v7, 5, v1
v_lshl_add_u32 v6, v7, 16, v6
v_accvgpr_write_b32 a251, v6
v_mul_u32_u24 v6, 896, v1
v_accvgpr_write_b32 a252, v6
v_lshlrev_b32 v6, 4, v11
v_lshl_add_u32 v240, v2, 14, v6
v_lshl_add_u32 v6, v5, 2, v6
v_lshl_add_u32 v239, v2, 8, v6
s_waitcnt vmcnt(9)
s_barrier
s_add_u32 m0, s68, 24576
s_nop 0
buffer_load_dwordx4 v250, s[20:23], s77 offen lds
buffer_load_dwordx4 v251, s[20:23], s77 offen offset:1024 lds
s_add_u32 m0, s53, 8192
s_lshl_b32 s58, s77, 12
buffer_load_dwordx4 v208, s[32:35], s58 offen lds
s_waitcnt vmcnt(8)
ds_read_b64_tr_b16 a[96:97], v230 offset:0
ds_read_b64_tr_b16 a[98:99], v230 offset:512
ds_read_b128 a[112:115], v228 offset:8192
ds_read_b128 a[116:119], v228 offset:10240
ds_read_b128 a[120:123], v228 offset:12288
ds_read_b64_tr_b16 a[100:101], v231 offset:0
ds_read_b64_tr_b16 a[102:103], v231 offset:512
ds_read_b64_tr_b16 a[104:105], v232 offset:0
ds_read_b64_tr_b16 a[106:107], v232 offset:512
ds_read_b64_tr_b16 a[108:109], v233 offset:0
ds_read_b64_tr_b16 a[110:111], v233 offset:512
s_waitcnt lgkmcnt(8)
v_mfma_f32_16x16x32_bf16 v[128:131], a[96:99], a[112:115], 0
buffer_load_dwordx4 v209, s[32:35], s58 offen offset:1024 lds
buffer_load_dwordx4 v210, s[32:35], s58 offen offset:2048 lds
buffer_load_dwordx4 v211, s[32:35], s58 offen offset:3072 lds
s_add_u32 m0, s53, 12288
s_lshl_b32 s58, s77, 12
s_add_u32 s58, s58, 262144
buffer_load_dwordx4 v208, s[32:35], s58 offen lds
s_waitcnt vmcnt(8)
s_waitcnt lgkmcnt(7)
v_mfma_f32_16x16x32_bf16 v[136:139], a[96:99], a[116:119], 0
ds_read_b64_tr_b16 a[128:129], v230 offset:4096
ds_read_b64_tr_b16 a[130:131], v230 offset:4608
s_waitcnt lgkmcnt(8)
v_mfma_f32_16x16x32_bf16 v[144:147], a[96:99], a[120:123], 0
ds_read_b128 a[144:147], v229 offset:8192
s_waitcnt lgkmcnt(7)
v_mfma_f32_16x16x32_bf16 v[148:151], a[100:103], a[120:123], 0
buffer_load_dwordx4 v209, s[32:35], s58 offen offset:1024 lds
v_mfma_f32_16x16x32_bf16 v[140:143], a[100:103], a[116:119], 0
ds_read_b128 a[148:151], v229 offset:10240
ds_read_b128 a[152:155], v229 offset:12288
v_mfma_f32_16x16x32_bf16 v[132:135], a[100:103], a[112:115], 0
ds_read_b64_tr_b16 a[132:133], v231 offset:4096
ds_read_b64_tr_b16 a[134:135], v231 offset:4608
s_waitcnt lgkmcnt(9)
v_mfma_f32_16x16x32_bf16 v[160:163], a[104:107], a[112:115], 0
ds_read_b64_tr_b16 a[136:137], v232 offset:4096
ds_read_b64_tr_b16 a[138:139], v232 offset:4608
v_mfma_f32_16x16x32_bf16 v[168:171], a[104:107], a[116:119], 0
buffer_load_dwordx4 v210, s[32:35], s58 offen offset:2048 lds
v_mfma_f32_16x16x32_bf16 v[176:179], a[104:107], a[120:123], 0
ds_read_b64_tr_b16 a[140:141], v233 offset:4096
ds_read_b64_tr_b16 a[142:143], v233 offset:4608
s_waitcnt lgkmcnt(11)
v_mfma_f32_16x16x32_bf16 v[180:183], a[108:111], a[120:123], 0
buffer_load_dwordx4 v211, s[32:35], s58 offen offset:3072 lds
v_mfma_f32_16x16x32_bf16 v[172:175], a[108:111], a[116:119], 0
s_add_u32 m0, s68, 40960
v_mfma_f32_16x16x32_bf16 v[164:167], a[108:111], a[112:115], 0
s_waitcnt lgkmcnt(6)
v_mfma_f32_16x16x32_bf16 v[128:131], a[128:131], a[144:147], v[128:131]
s_waitcnt vmcnt(8)
s_barrier
buffer_load_dwordx4 v250, s[20:23], s78 offen lds
v_mfma_f32_16x16x32_bf16 v[136:139], a[128:131], a[148:151], v[136:139]
buffer_load_dwordx4 v251, s[20:23], s78 offen offset:1024 lds
s_add_u32 m0, s68, 0
s_nop 0
buffer_load_dwordx4 v250, s[20:23], s79 offen lds
buffer_load_dwordx4 v251, s[20:23], s79 offen offset:1024 lds
s_waitcnt vmcnt(8)
v_mfma_f32_16x16x32_bf16 v[144:147], a[128:131], a[152:155], v[144:147]
ds_read_b64_tr_b16 a[96:97], v230 offset:8192
s_waitcnt lgkmcnt(1)
v_mfma_f32_16x16x32_bf16 v[148:151], a[132:135], a[152:155], v[148:151]
s_add_u32 m0, s68, 16384
s_nop 0
buffer_load_dwordx4 v250, s[20:23], s80 offen lds
v_mfma_f32_16x16x32_bf16 v[140:143], a[132:135], a[148:151], v[140:143]
ds_read_b64_tr_b16 a[98:99], v230 offset:8704
ds_read_b128 a[112:115], v228 offset:24576
v_mfma_f32_16x16x32_bf16 v[132:135], a[132:135], a[144:147], v[132:135]
ds_read_b128 a[116:119], v228 offset:26624
ds_read_b128 a[120:123], v228 offset:28672
v_mfma_f32_16x16x32_bf16 v[160:163], a[136:139], a[144:147], v[160:163]
ds_read_b64_tr_b16 a[100:101], v231 offset:8192
ds_read_b64_tr_b16 a[102:103], v231 offset:8704
v_mfma_f32_16x16x32_bf16 v[168:171], a[136:139], a[148:151], v[168:171]
ds_read_b64_tr_b16 a[104:105], v232 offset:8192
ds_read_b64_tr_b16 a[106:107], v232 offset:8704
v_mfma_f32_16x16x32_bf16 v[176:179], a[136:139], a[152:155], v[176:179]
ds_read_b64_tr_b16 a[108:109], v233 offset:8192
ds_read_b64_tr_b16 a[110:111], v233 offset:8704
v_mfma_f32_16x16x32_bf16 v[180:183], a[140:143], a[152:155], v[180:183]
buffer_load_dwordx4 v251, s[20:23], s80 offen offset:1024 lds
v_mfma_f32_16x16x32_bf16 v[172:175], a[140:143], a[148:151], v[172:175]
s_add_u32 m0, s53, 16384
s_lshl_b32 s58, s78, 12
v_mfma_f32_16x16x32_bf16 v[164:167], a[140:143], a[144:147], v[164:167]
s_waitcnt lgkmcnt(6)
v_mfma_f32_16x16x32_bf16 v[128:131], a[96:99], a[112:115], v[128:131]
buffer_load_dwordx4 v208, s[32:35], s58 offen lds
buffer_load_dwordx4 v209, s[32:35], s58 offen offset:1024 lds
s_waitcnt vmcnt(8)
v_mfma_f32_16x16x32_bf16 v[136:139], a[96:99], a[116:119], v[136:139]
ds_read_b64_tr_b16 a[128:129], v230 offset:12288
ds_read_b64_tr_b16 a[130:131], v230 offset:12800
v_mfma_f32_16x16x32_bf16 v[144:147], a[96:99], a[120:123], v[144:147]
ds_read_b128 a[144:147], v229 offset:24576
s_waitcnt lgkmcnt(3)
v_mfma_f32_16x16x32_bf16 v[148:151], a[100:103], a[120:123], v[148:151]
buffer_load_dwordx4 v210, s[32:35], s58 offen offset:2048 lds
v_mfma_f32_16x16x32_bf16 v[140:143], a[100:103], a[116:119], v[140:143]
ds_read_b128 a[148:151], v229 offset:26624
ds_read_b128 a[152:155], v229 offset:28672
v_mfma_f32_16x16x32_bf16 v[132:135], a[100:103], a[112:115], v[132:135]
ds_read_b64_tr_b16 a[132:133], v231 offset:12288
ds_read_b64_tr_b16 a[134:135], v231 offset:12800
v_mfma_f32_16x16x32_bf16 v[160:163], a[104:107], a[112:115], v[160:163]
ds_read_b64_tr_b16 a[136:137], v232 offset:12288
ds_read_b64_tr_b16 a[138:139], v232 offset:12800
v_mfma_f32_16x16x32_bf16 v[168:171], a[104:107], a[116:119], v[168:171]
buffer_load_dwordx4 v211, s[32:35], s58 offen offset:3072 lds
v_mfma_f32_16x16x32_bf16 v[176:179], a[104:107], a[120:123], v[176:179]
ds_read_b64_tr_b16 a[140:141], v233 offset:12288
ds_read_b64_tr_b16 a[142:143], v233 offset:12800
v_mfma_f32_16x16x32_bf16 v[180:183], a[108:111], a[120:123], v[180:183]
s_add_u32 m0, s53, 20480
s_lshl_b32 s58, s78, 12
v_mfma_f32_16x16x32_bf16 v[172:175], a[108:111], a[116:119], v[172:175]
s_add_u32 s58, s58, 262144
v_mfma_f32_16x16x32_bf16 v[164:167], a[108:111], a[112:115], v[164:167]
s_waitcnt lgkmcnt(6)
v_mfma_f32_16x16x32_bf16 v[128:131], a[128:131], a[144:147], v[128:131]
buffer_load_dwordx4 v208, s[32:35], s58 offen lds
buffer_load_dwordx4 v209, s[32:35], s58 offen offset:1024 lds
buffer_load_dwordx4 v210, s[32:35], s58 offen offset:2048 lds
buffer_load_dwordx4 v211, s[32:35], s58 offen offset:3072 lds
s_waitcnt vmcnt(8)
s_barrier
v_mfma_f32_16x16x32_bf16 v[136:139], a[128:131], a[148:151], v[136:139]
s_add_u32 m0, s53, 0
s_add_u32 s58, s54, 0
buffer_load_dwordx4 v212, s[24:27], s58 offen lds
buffer_load_dwordx4 v213, s[24:27], s58 offen offset:1024 lds
buffer_load_dwordx4 v214, s[24:27], s58 offen offset:2048 lds
buffer_load_dwordx4 v215, s[24:27], s58 offen offset:3072 lds
s_waitcnt vmcnt(8)
v_mfma_f32_16x16x32_bf16 v[144:147], a[128:131], a[152:155], v[144:147]
ds_read_b64_tr_b16 a[96:97], v230 offset:16384
s_waitcnt lgkmcnt(1)
v_mfma_f32_16x16x32_bf16 v[148:151], a[132:135], a[152:155], v[148:151]
s_add_u32 m0, s53, 4096
s_add_u32 s58, s54, 16384
buffer_load_dwordx4 v212, s[24:27], s58 offen lds
v_mfma_f32_16x16x32_bf16 v[140:143], a[132:135], a[148:151], v[140:143]
ds_read_b64_tr_b16 a[98:99], v230 offset:16896
ds_read_b128 a[112:115], v228 offset:40960
v_mfma_f32_16x16x32_bf16 v[132:135], a[132:135], a[144:147], v[132:135]
ds_read_b128 a[116:119], v228 offset:43008
ds_read_b128 a[120:123], v228 offset:45056
v_mfma_f32_16x16x32_bf16 v[160:163], a[136:139], a[144:147], v[160:163]
ds_read_b64_tr_b16 a[100:101], v231 offset:16384
ds_read_b64_tr_b16 a[102:103], v231 offset:16896
v_mfma_f32_16x16x32_bf16 v[168:171], a[136:139], a[148:151], v[168:171]
ds_read_b64_tr_b16 a[104:105], v232 offset:16384
ds_read_b64_tr_b16 a[106:107], v232 offset:16896
v_mfma_f32_16x16x32_bf16 v[176:179], a[136:139], a[152:155], v[176:179]
ds_read_b64_tr_b16 a[108:109], v233 offset:16384
ds_read_b64_tr_b16 a[110:111], v233 offset:16896
v_mfma_f32_16x16x32_bf16 v[180:183], a[140:143], a[152:155], v[180:183]
buffer_load_dwordx4 v213, s[24:27], s58 offen offset:1024 lds
v_mfma_f32_16x16x32_bf16 v[172:175], a[140:143], a[148:151], v[172:175]
v_mfma_f32_16x16x32_bf16 v[164:167], a[140:143], a[144:147], v[164:167]
s_waitcnt lgkmcnt(6)
v_mfma_f32_16x16x32_bf16 v[128:131], a[96:99], a[112:115], v[128:131]
buffer_load_dwordx4 v214, s[24:27], s58 offen offset:2048 lds
buffer_load_dwordx4 v215, s[24:27], s58 offen offset:3072 lds
s_waitcnt vmcnt(8)
v_mfma_f32_16x16x32_bf16 v[136:139], a[96:99], a[116:119], v[136:139]
ds_read_b64_tr_b16 a[128:129], v230 offset:20480
ds_read_b64_tr_b16 a[130:131], v230 offset:20992
v_mfma_f32_16x16x32_bf16 v[144:147], a[96:99], a[120:123], v[144:147]
ds_read_b128 a[144:147], v229 offset:40960
s_waitcnt lgkmcnt(3)
v_mfma_f32_16x16x32_bf16 v[148:151], a[100:103], a[120:123], v[148:151]
s_add_u32 m0, s53, 8192
s_lshl_b32 s58, s79, 12
v_mfma_f32_16x16x32_bf16 v[140:143], a[100:103], a[116:119], v[140:143]
ds_read_b128 a[148:151], v229 offset:43008
ds_read_b128 a[152:155], v229 offset:45056
v_mfma_f32_16x16x32_bf16 v[132:135], a[100:103], a[112:115], v[132:135]
ds_read_b64_tr_b16 a[132:133], v231 offset:20480
ds_read_b64_tr_b16 a[134:135], v231 offset:20992
v_mfma_f32_16x16x32_bf16 v[160:163], a[104:107], a[112:115], v[160:163]
ds_read_b64_tr_b16 a[136:137], v232 offset:20480
ds_read_b64_tr_b16 a[138:139], v232 offset:20992
buffer_load_dwordx4 v208, s[32:35], s58 offen lds
v_mfma_f32_16x16x32_bf16 v[168:171], a[104:107], a[116:119], v[168:171]
ds_read_b64_tr_b16 a[140:141], v233 offset:20480
ds_read_b64_tr_b16 a[142:143], v233 offset:20992
v_mfma_f32_16x16x32_bf16 v[176:179], a[104:107], a[120:123], v[176:179]
buffer_load_dwordx4 v209, s[32:35], s58 offen offset:1024 lds
v_mfma_f32_16x16x32_bf16 v[180:183], a[108:111], a[120:123], v[180:183]
v_mfma_f32_16x16x32_bf16 v[172:175], a[108:111], a[116:119], v[172:175]
buffer_load_dwordx4 v210, s[32:35], s58 offen offset:2048 lds
v_mfma_f32_16x16x32_bf16 v[164:167], a[108:111], a[112:115], v[164:167]
s_waitcnt lgkmcnt(6)
v_mfma_f32_16x16x32_bf16 v[128:131], a[128:131], a[144:147], v[128:131]
buffer_load_dwordx4 v211, s[32:35], s58 offen offset:3072 lds
s_add_u32 m0, s53, 12288
s_lshl_b32 s58, s79, 12
s_add_u32 s58, s58, 262144
buffer_load_dwordx4 v208, s[32:35], s58 offen lds
buffer_load_dwordx4 v209, s[32:35], s58 offen offset:1024 lds
buffer_load_dwordx4 v210, s[32:35], s58 offen offset:2048 lds
buffer_load_dwordx4 v211, s[32:35], s58 offen offset:3072 lds
s_add_u32 m0, s53, 16384
s_lshl_b32 s58, s80, 12
buffer_load_dwordx4 v208, s[32:35], s58 offen lds
buffer_load_dwordx4 v209, s[32:35], s58 offen offset:1024 lds
buffer_load_dwordx4 v210, s[32:35], s58 offen offset:2048 lds
buffer_load_dwordx4 v211, s[32:35], s58 offen offset:3072 lds
s_waitcnt vmcnt(8)
v_mfma_f32_16x16x32_bf16 v[136:139], a[128:131], a[148:151], v[136:139]
ds_read_b64_tr_b16 a[96:97], v230 offset:8192
ds_read_b64_tr_b16 a[98:99], v230 offset:8704
v_mfma_f32_16x16x32_bf16 v[144:147], a[128:131], a[152:155], v[144:147]
ds_read_b128 a[112:115], v228 offset:0
s_waitcnt lgkmcnt(3)
v_mfma_f32_16x16x32_bf16 v[148:151], a[132:135], a[152:155], v[148:151]
s_add_u32 m0, s68, 32768
s_nop 0
buffer_load_dwordx4 v250, s[20:23], s81 offen lds
v_mfma_f32_16x16x32_bf16 v[140:143], a[132:135], a[148:151], v[140:143]
ds_read_b128 a[116:119], v228 offset:2048
ds_read_b128 a[120:123], v228 offset:4096
v_mfma_f32_16x16x32_bf16 v[132:135], a[132:135], a[144:147], v[132:135]
ds_read_b64_tr_b16 a[100:101], v231 offset:8192
ds_read_b64_tr_b16 a[102:103], v231 offset:8704
v_mfma_f32_16x16x32_bf16 v[160:163], a[136:139], a[144:147], v[160:163]
ds_read_b64_tr_b16 a[104:105], v232 offset:8192
ds_read_b64_tr_b16 a[106:107], v232 offset:8704
v_mfma_f32_16x16x32_bf16 v[168:171], a[136:139], a[148:151], v[168:171]
buffer_load_dwordx4 v251, s[20:23], s81 offen offset:1024 lds
v_mfma_f32_16x16x32_bf16 v[176:179], a[136:139], a[152:155], v[176:179]
ds_read_b64_tr_b16 a[108:109], v233 offset:8192
ds_read_b64_tr_b16 a[110:111], v233 offset:8704
v_mfma_f32_16x16x32_bf16 v[180:183], a[140:143], a[152:155], v[180:183]
s_add_u32 m0, s53, 20480
s_lshl_b32 s58, s80, 12
v_mfma_f32_16x16x32_bf16 v[172:175], a[140:143], a[148:151], v[172:175]
s_add_u32 s58, s58, 262144
v_mfma_f32_16x16x32_bf16 v[164:167], a[140:143], a[144:147], v[164:167]
s_waitcnt lgkmcnt(6)
v_mfma_f32_16x16x32_bf16 v[128:131], a[96:99], a[112:115], v[128:131]
buffer_load_dwordx4 v208, s[32:35], s58 offen lds
buffer_load_dwordx4 v209, s[32:35], s58 offen offset:1024 lds
s_waitcnt vmcnt(8)
v_mfma_f32_16x16x32_bf16 v[136:139], a[96:99], a[116:119], v[136:139]
ds_read_b64_tr_b16 a[128:129], v230 offset:12288
ds_read_b64_tr_b16 a[130:131], v230 offset:12800
v_mfma_f32_16x16x32_bf16 v[144:147], a[96:99], a[120:123], v[144:147]
ds_read_b128 a[144:147], v229 offset:0
s_waitcnt lgkmcnt(3)
v_mfma_f32_16x16x32_bf16 v[148:151], a[100:103], a[120:123], v[148:151]
buffer_load_dwordx4 v210, s[32:35], s58 offen offset:2048 lds
v_mfma_f32_16x16x32_bf16 v[140:143], a[100:103], a[116:119], v[140:143]
ds_read_b128 a[148:151], v229 offset:2048
ds_read_b128 a[152:155], v229 offset:4096
v_mfma_f32_16x16x32_bf16 v[132:135], a[100:103], a[112:115], v[132:135]
ds_read_b64_tr_b16 a[132:133], v231 offset:12288
ds_read_b64_tr_b16 a[134:135], v231 offset:12800
v_mfma_f32_16x16x32_bf16 v[160:163], a[104:107], a[112:115], v[160:163]
ds_read_b64_tr_b16 a[136:137], v232 offset:12288
ds_read_b64_tr_b16 a[138:139], v232 offset:12800
v_mfma_f32_16x16x32_bf16 v[168:171], a[104:107], a[116:119], v[168:171]
buffer_load_dwordx4 v211, s[32:35], s58 offen offset:3072 lds
v_mfma_f32_16x16x32_bf16 v[176:179], a[104:107], a[120:123], v[176:179]
ds_read_b64_tr_b16 a[140:141], v233 offset:12288
ds_read_b64_tr_b16 a[142:143], v233 offset:12800
v_mfma_f32_16x16x32_bf16 v[180:183], a[108:111], a[120:123], v[180:183]
s_add_u32 m0, s68, 49152
v_mfma_f32_16x16x32_bf16 v[172:175], a[108:111], a[116:119], v[172:175]
buffer_load_dwordx4 v250, s[20:23], s82 offen lds
v_mfma_f32_16x16x32_bf16 v[164:167], a[108:111], a[112:115], v[164:167]
s_waitcnt lgkmcnt(6)
v_mfma_f32_16x16x32_bf16 v[128:131], a[128:131], a[144:147], v[128:131]
buffer_load_dwordx4 v251, s[20:23], s82 offen offset:1024 lds
s_waitcnt vmcnt(8)
v_mfma_f32_16x16x32_bf16 v[136:139], a[128:131], a[148:151], v[136:139]
ds_read_b64_tr_b16 a[96:97], v230 offset:16384
ds_read_b64_tr_b16 a[98:99], v230 offset:16896
v_mfma_f32_16x16x32_bf16 v[144:147], a[128:131], a[152:155], v[144:147]
ds_read_b128 a[112:115], v228 offset:16384
s_waitcnt lgkmcnt(3)
v_mfma_f32_16x16x32_bf16 v[148:151], a[132:135], a[152:155], v[148:151]
s_add_u32 m0, s53, 8192
s_lshl_b32 s58, s81, 12
v_mfma_f32_16x16x32_bf16 v[140:143], a[132:135], a[148:151], v[140:143]
ds_read_b128 a[116:119], v228 offset:18432
ds_read_b128 a[120:123], v228 offset:20480
v_mfma_f32_16x16x32_bf16 v[132:135], a[132:135], a[144:147], v[132:135]
ds_read_b64_tr_b16 a[100:101], v231 offset:16384
ds_read_b64_tr_b16 a[102:103], v231 offset:16896
v_mfma_f32_16x16x32_bf16 v[160:163], a[136:139], a[144:147], v[160:163]
ds_read_b64_tr_b16 a[104:105], v232 offset:16384
ds_read_b64_tr_b16 a[106:107], v232 offset:16896
buffer_load_dwordx4 v208, s[32:35], s58 offen lds
v_mfma_f32_16x16x32_bf16 v[168:171], a[136:139], a[148:151], v[168:171]
ds_read_b64_tr_b16 a[108:109], v233 offset:16384
ds_read_b64_tr_b16 a[110:111], v233 offset:16896
v_mfma_f32_16x16x32_bf16 v[176:179], a[136:139], a[152:155], v[176:179]
buffer_load_dwordx4 v209, s[32:35], s58 offen offset:1024 lds
v_mfma_f32_16x16x32_bf16 v[180:183], a[140:143], a[152:155], v[180:183]
v_mfma_f32_16x16x32_bf16 v[172:175], a[140:143], a[148:151], v[172:175]
buffer_load_dwordx4 v210, s[32:35], s58 offen offset:2048 lds
v_mfma_f32_16x16x32_bf16 v[164:167], a[140:143], a[144:147], v[164:167]
s_waitcnt lgkmcnt(6)
v_mfma_f32_16x16x32_bf16 v[128:131], a[96:99], a[112:115], v[128:131]
buffer_load_dwordx4 v211, s[32:35], s58 offen offset:3072 lds
s_add_u32 m0, s53, 12288
s_lshl_b32 s58, s81, 12
s_add_u32 s58, s58, 262144
buffer_load_dwordx4 v208, s[32:35], s58 offen lds
buffer_load_dwordx4 v209, s[32:35], s58 offen offset:1024 lds
s_waitcnt vmcnt(8)
buffer_load_dwordx4 v210, s[32:35], s58 offen offset:2048 lds
v_mfma_f32_16x16x32_bf16 v[136:139], a[96:99], a[116:119], v[136:139]
ds_read_b64_tr_b16 a[128:129], v230 offset:20480
ds_read_b64_tr_b16 a[130:131], v230 offset:20992
v_mfma_f32_16x16x32_bf16 v[144:147], a[96:99], a[120:123], v[144:147]
ds_read_b128 a[144:147], v229 offset:16384
s_waitcnt lgkmcnt(3)
v_mfma_f32_16x16x32_bf16 v[148:151], a[100:103], a[120:123], v[148:151]
buffer_load_dwordx4 v211, s[32:35], s58 offen offset:3072 lds
v_mfma_f32_16x16x32_bf16 v[140:143], a[100:103], a[116:119], v[140:143]
ds_read_b128 a[148:151], v229 offset:18432
ds_read_b128 a[152:155], v229 offset:20480
v_mfma_f32_16x16x32_bf16 v[132:135], a[100:103], a[112:115], v[132:135]
ds_read_b64_tr_b16 a[132:133], v231 offset:20480
ds_read_b64_tr_b16 a[134:135], v231 offset:20992
v_mfma_f32_16x16x32_bf16 v[160:163], a[104:107], a[112:115], v[160:163]
ds_read_b64_tr_b16 a[136:137], v232 offset:20480
ds_read_b64_tr_b16 a[138:139], v232 offset:20992
v_mfma_f32_16x16x32_bf16 v[168:171], a[104:107], a[116:119], v[168:171]
s_add_u32 m0, s53, 16384
s_lshl_b32 s58, s82, 12
v_mfma_f32_16x16x32_bf16 v[176:179], a[104:107], a[120:123], v[176:179]
ds_read_b64_tr_b16 a[140:141], v233 offset:20480
ds_read_b64_tr_b16 a[142:143], v233 offset:20992
v_mfma_f32_16x16x32_bf16 v[180:183], a[108:111], a[120:123], v[180:183]
buffer_load_dwordx4 v208, s[32:35], s58 offen lds
v_mfma_f32_16x16x32_bf16 v[172:175], a[108:111], a[116:119], v[172:175]
v_mfma_f32_16x16x32_bf16 v[164:167], a[108:111], a[112:115], v[164:167]
s_waitcnt lgkmcnt(6)
v_mfma_f32_16x16x32_bf16 v[128:131], a[128:131], a[144:147], v[128:131]
s_waitcnt vmcnt(9)
s_barrier
buffer_load_dwordx4 v209, s[32:35], s58 offen offset:1024 lds
v_mfma_f32_16x16x32_bf16 v[136:139], a[128:131], a[148:151], v[136:139]
buffer_load_dwordx4 v210, s[32:35], s58 offen offset:2048 lds
buffer_load_dwordx4 v211, s[32:35], s58 offen offset:3072 lds
s_waitcnt vmcnt(8)
v_mfma_f32_16x16x32_bf16 v[144:147], a[128:131], a[152:155], v[144:147]
ds_read_b64_tr_b16 a[96:97], v230 offset:8192
s_waitcnt lgkmcnt(1)
v_mfma_f32_16x16x32_bf16 v[148:151], a[132:135], a[152:155], v[148:151]
s_add_u32 m0, s53, 20480
s_lshl_b32 s58, s82, 12
v_mfma_f32_16x16x32_bf16 v[140:143], a[132:135], a[148:151], v[140:143]
ds_read_b64_tr_b16 a[98:99], v230 offset:8704
ds_read_b128 a[112:115], v228 offset:32768
v_mfma_f32_16x16x32_bf16 v[132:135], a[132:135], a[144:147], v[132:135]
ds_read_b128 a[116:119], v228 offset:34816
ds_read_b128 a[120:123], v228 offset:36864
v_mfma_f32_16x16x32_bf16 v[160:163], a[136:139], a[144:147], v[160:163]
ds_read_b64_tr_b16 a[100:101], v231 offset:8192
ds_read_b64_tr_b16 a[102:103], v231 offset:8704
v_mfma_f32_16x16x32_bf16 v[168:171], a[136:139], a[148:151], v[168:171]
ds_read_b64_tr_b16 a[104:105], v232 offset:8192
ds_read_b64_tr_b16 a[106:107], v232 offset:8704
v_mfma_f32_16x16x32_bf16 v[176:179], a[136:139], a[152:155], v[176:179]
ds_read_b64_tr_b16 a[108:109], v233 offset:8192
ds_read_b64_tr_b16 a[110:111], v233 offset:8704
v_mfma_f32_16x16x32_bf16 v[180:183], a[140:143], a[152:155], v[180:183]
s_add_u32 s58, s58, 262144
buffer_load_dwordx4 v208, s[32:35], s58 offen lds
v_mfma_f32_16x16x32_bf16 v[172:175], a[140:143], a[148:151], v[172:175]
v_mfma_f32_16x16x32_bf16 v[164:167], a[140:143], a[144:147], v[164:167]
s_waitcnt lgkmcnt(6)
v_mfma_f32_16x16x32_bf16 v[128:131], a[96:99], a[112:115], v[128:131]
buffer_load_dwordx4 v209, s[32:35], s58 offen offset:1024 lds
buffer_load_dwordx4 v210, s[32:35], s58 offen offset:2048 lds
buffer_load_dwordx4 v211, s[32:35], s58 offen offset:3072 lds
s_waitcnt vmcnt(8)
v_mfma_f32_16x16x32_bf16 v[136:139], a[96:99], a[116:119], v[136:139]
ds_read_b64_tr_b16 a[128:129], v230 offset:12288
ds_read_b64_tr_b16 a[130:131], v230 offset:12800
v_mfma_f32_16x16x32_bf16 v[144:147], a[96:99], a[120:123], v[144:147]
ds_read_b128 a[144:147], v229 offset:32768
s_waitcnt lgkmcnt(3)
v_mfma_f32_16x16x32_bf16 v[148:151], a[100:103], a[120:123], v[148:151]
s_add_u32 m0, s53, 8192
s_add_u32 s58, s55, 16384
v_mfma_f32_16x16x32_bf16 v[140:143], a[100:103], a[116:119], v[140:143]
ds_read_b128 a[148:151], v229 offset:34816
ds_read_b128 a[152:155], v229 offset:36864
v_mfma_f32_16x16x32_bf16 v[132:135], a[100:103], a[112:115], v[132:135]
ds_read_b64_tr_b16 a[132:133], v231 offset:12288
ds_read_b64_tr_b16 a[134:135], v231 offset:12800
v_mfma_f32_16x16x32_bf16 v[160:163], a[104:107], a[112:115], v[160:163]
ds_read_b64_tr_b16 a[136:137], v232 offset:12288
ds_read_b64_tr_b16 a[138:139], v232 offset:12800
buffer_load_dwordx4 v212, s[24:27], s58 offen lds
v_mfma_f32_16x16x32_bf16 v[168:171], a[104:107], a[116:119], v[168:171]
ds_read_b64_tr_b16 a[140:141], v233 offset:12288
ds_read_b64_tr_b16 a[142:143], v233 offset:12800
v_mfma_f32_16x16x32_bf16 v[176:179], a[104:107], a[120:123], v[176:179]
buffer_load_dwordx4 v213, s[24:27], s58 offen offset:1024 lds
v_mfma_f32_16x16x32_bf16 v[180:183], a[108:111], a[120:123], v[180:183]
v_mfma_f32_16x16x32_bf16 v[172:175], a[108:111], a[116:119], v[172:175]
buffer_load_dwordx4 v214, s[24:27], s58 offen offset:2048 lds
v_mfma_f32_16x16x32_bf16 v[164:167], a[108:111], a[112:115], v[164:167]
s_waitcnt lgkmcnt(6)
v_mfma_f32_16x16x32_bf16 v[128:131], a[128:131], a[144:147], v[128:131]
buffer_load_dwordx4 v215, s[24:27], s58 offen offset:3072 lds
s_waitcnt vmcnt(4)
v_mfma_f32_16x16x32_bf16 v[136:139], a[128:131], a[148:151], v[136:139]
ds_read_b64_tr_b16 a[96:97], v230 offset:16384
ds_read_b64_tr_b16 a[98:99], v230 offset:16896
v_mfma_f32_16x16x32_bf16 v[144:147], a[128:131], a[152:155], v[144:147]
ds_read_b128 a[160:163], v228 offset:49152
s_waitcnt lgkmcnt(3)
v_mfma_f32_16x16x32_bf16 v[148:151], a[132:135], a[152:155], v[148:151]
ds_read_b128 a[164:167], v228 offset:51200
ds_read_b128 a[168:171], v228 offset:53248
v_mfma_f32_16x16x32_bf16 v[140:143], a[132:135], a[148:151], v[140:143]
ds_read_b64_tr_b16 a[100:101], v231 offset:16384
ds_read_b64_tr_b16 a[102:103], v231 offset:16896
v_mfma_f32_16x16x32_bf16 v[132:135], a[132:135], a[144:147], v[132:135]
ds_read_b64_tr_b16 a[104:105], v230 offset:20480
ds_read_b64_tr_b16 a[106:107], v230 offset:20992
v_mfma_f32_16x16x32_bf16 v[160:163], a[136:139], a[144:147], v[160:163]
ds_read_b128 a[176:179], v229 offset:49152
ds_read_b128 a[180:183], v229 offset:51200
v_mfma_f32_16x16x32_bf16 v[168:171], a[136:139], a[148:151], v[168:171]
ds_read_b128 a[184:187], v229 offset:53248
ds_read_b64_tr_b16 a[108:109], v231 offset:20480
v_mfma_f32_16x16x32_bf16 v[176:179], a[136:139], a[152:155], v[176:179]
ds_read_b64_tr_b16 a[110:111], v231 offset:20992
s_add_u32 m0, s53, 12288
v_mfma_f32_16x16x32_bf16 v[180:183], a[140:143], a[152:155], v[180:183]
s_add_u32 s58, s56, 16384
buffer_load_dwordx4 v212, s[24:27], s58 offen lds
v_mfma_f32_16x16x32_bf16 v[172:175], a[140:143], a[148:151], v[172:175]
v_mfma_f32_16x16x32_bf16 v[164:167], a[140:143], a[144:147], v[164:167]
s_waitcnt lgkmcnt(9)
v_mfma_f32_16x16x32_bf16 v[128:131], a[96:99], a[160:163], v[128:131]
buffer_load_dwordx4 v213, s[24:27], s58 offen offset:1024 lds
buffer_load_dwordx4 v214, s[24:27], s58 offen offset:2048 lds
buffer_load_dwordx4 v215, s[24:27], s58 offen offset:3072 lds
v_mfma_f32_16x16x32_bf16 v[136:139], a[96:99], a[164:167], v[136:139]
ds_read_b64_tr_b16 a[128:129], v232 offset:16384
ds_read_b64_tr_b16 a[130:131], v232 offset:16896
v_mfma_f32_16x16x32_bf16 v[144:147], a[96:99], a[168:171], v[144:147]
ds_read_b64_tr_b16 a[132:133], v233 offset:16384
s_waitcnt lgkmcnt(3)
v_mfma_f32_16x16x32_bf16 v[148:151], a[100:103], a[168:171], v[148:151]
ds_read_b64_tr_b16 a[134:135], v233 offset:16896
ds_read_b64_tr_b16 a[136:137], v232 offset:20480
v_mfma_f32_16x16x32_bf16 v[140:143], a[100:103], a[164:167], v[140:143]
ds_read_b64_tr_b16 a[138:139], v232 offset:20992
ds_read_b64_tr_b16 a[140:141], v233 offset:20480
v_mfma_f32_16x16x32_bf16 v[132:135], a[100:103], a[160:163], v[132:135]
ds_read_b64_tr_b16 a[142:143], v233 offset:20992
v_mfma_f32_16x16x32_bf16 v[128:131], a[104:107], a[176:179], v[128:131]
v_mfma_f32_16x16x32_bf16 v[136:139], a[104:107], a[180:183], v[136:139]
v_mfma_f32_16x16x32_bf16 v[144:147], a[104:107], a[184:187], v[144:147]
v_mfma_f32_16x16x32_bf16 v[148:151], a[108:111], a[184:187], v[148:151]
v_mfma_f32_16x16x32_bf16 v[140:143], a[108:111], a[180:183], v[140:143]
v_mfma_f32_16x16x32_bf16 v[132:135], a[108:111], a[176:179], v[132:135]
s_waitcnt lgkmcnt(0)
v_mfma_f32_16x16x32_bf16 v[160:163], a[128:131], a[160:163], v[160:163]
ds_read_b64 a[96:97], v224 offset:0
ds_read_b64 a[98:99], v225 offset:0
v_mfma_f32_16x16x32_bf16 v[168:171], a[128:131], a[164:167], v[168:171]
ds_read_b64 a[100:101], v224 offset:2048
ds_read_b64 a[102:103], v225 offset:2048
v_mfma_f32_16x16x32_bf16 v[176:179], a[128:131], a[168:171], v[176:179]
ds_read_b64 a[104:105], v226 offset:2048
s_add_u32 m0, s53, 16384
v_cvt_pk_bf16_f32 v128, v128, v129
v_mfma_f32_16x16x32_bf16 v[180:183], a[132:135], a[168:171], v[180:183]
s_add_u32 s58, s54, 32768
buffer_load_dwordx4 v212, s[24:27], s58 offen lds
v_cvt_pk_bf16_f32 v129, v130, v131
v_cvt_pk_bf16_f32 v130, v132, v133
v_mfma_f32_16x16x32_bf16 v[172:175], a[132:135], a[164:167], v[172:175]
ds_read_b64 a[106:107], v227 offset:2048
ds_read_b64 a[108:109], v226 offset:0
v_cvt_pk_bf16_f32 v131, v134, v135
v_mfma_f32_16x16x32_bf16 v[164:167], a[132:135], a[160:163], v[164:167]
ds_read_b64 a[110:111], v227 offset:0
ds_write_b128 v235, v[128:131] offset:8192
v_cvt_pk_bf16_f32 v136, v136, v137
v_cvt_pk_bf16_f32 v137, v138, v139
v_mfma_f32_16x16x32_bf16 v[160:163], a[136:139], a[176:179], v[160:163]
buffer_load_dwordx4 v213, s[24:27], s58 offen offset:1024 lds
v_cvt_pk_bf16_f32 v138, v140, v141
v_cvt_pk_bf16_f32 v139, v142, v143
v_mfma_f32_16x16x32_bf16 v[168:171], a[136:139], a[180:183], v[168:171]
buffer_load_dwordx4 v214, s[24:27], s58 offen offset:2048 lds
ds_write_b128 v235, v[136:139] offset:9216
v_mfma_f32_16x16x32_bf16 v[176:179], a[136:139], a[184:187], v[176:179]
v_cvt_pk_bf16_f32 v144, v144, v145
v_cvt_pk_bf16_f32 v145, v146, v147
v_cvt_pk_bf16_f32 v146, v148, v149
v_cvt_pk_bf16_f32 v147, v150, v151
v_mfma_f32_16x16x32_bf16 v[180:183], a[140:143], a[184:187], v[180:183]
buffer_load_dwordx4 v215, s[24:27], s58 offen offset:3072 lds
ds_write_b128 v235, v[144:147] offset:10240
v_mfma_f32_16x16x32_bf16 v[172:175], a[140:143], a[180:183], v[172:175]
s_add_u32 m0, s53, 20480
s_add_u32 s58, s55, 0
v_mfma_f32_16x16x32_bf16 v[164:167], a[140:143], a[176:179], v[164:167]
s_waitcnt lgkmcnt(3)
v_mfma_f32_16x16x32_bf16 v[0:3], a[96:99], v[128:131], 0
ds_read_b64 a[128:129], v224 offset:4096
ds_read_b64 a[130:131], v225 offset:4096
v_mfma_f32_16x16x32_bf16 v[8:11], a[96:99], v[136:139], 0
ds_read_b64 a[132:133], v224 offset:6144
ds_read_b64 a[134:135], v225 offset:6144
v_mfma_f32_16x16x32_bf16 v[16:19], a[96:99], v[144:147], 0
ds_read_b64 a[136:137], v226 offset:6144
v_cvt_pk_bf16_f32 v160, v160, v161
v_cvt_pk_bf16_f32 v161, v162, v163
v_cvt_pk_bf16_f32 v162, v164, v165
v_cvt_pk_bf16_f32 v163, v166, v167
ds_write_b128 v235, v[160:163] offset:12288
v_cvt_pk_bf16_f32 v168, v168, v169
v_mfma_f32_16x16x32_bf16 v[20:23], a[100:103], v[144:147], 0
buffer_load_dwordx4 v212, s[24:27], s58 offen lds
v_cvt_pk_bf16_f32 v169, v170, v171
v_cvt_pk_bf16_f32 v170, v172, v173
v_cvt_pk_bf16_f32 v171, v174, v175
ds_write_b128 v235, v[168:171] offset:13312
v_cvt_pk_bf16_f32 v176, v176, v177
v_cvt_pk_bf16_f32 v177, v178, v179
v_cvt_pk_bf16_f32 v178, v180, v181
v_cvt_pk_bf16_f32 v179, v182, v183
v_mfma_f32_16x16x32_bf16 v[12:15], a[100:103], v[136:139], 0
ds_read_b64 a[138:139], v227 offset:6144
ds_read_b64 a[140:141], v226 offset:4096
v_mfma_f32_16x16x32_bf16 v[4:7], a[100:103], v[128:131], 0
ds_read_b64 a[142:143], v227 offset:4096
ds_write_b128 v235, v[176:179] offset:14336
v_mfma_f32_16x16x32_bf16 v[4:7], a[104:107], v[160:163], v[4:7]
buffer_load_dwordx4 v213, s[24:27], s58 offen offset:1024 lds
v_mfma_f32_16x16x32_bf16 v[12:15], a[104:107], v[168:171], v[12:15]
s_waitcnt lgkmcnt(0)
s_barrier
v_mfma_f32_16x16x32_bf16 v[20:23], a[104:107], v[176:179], v[20:23]
buffer_load_dwordx4 v214, s[24:27], s58 offen offset:2048 lds
v_mfma_f32_16x16x32_bf16 v[16:19], a[108:111], v[176:179], v[16:19]
v_sub_u32 v230, v230, v254
v_sub_u32 v231, v231, v254
v_sub_u32 v232, v232, v254
v_sub_u32 v233, v233, v254
v_mfma_f32_16x16x32_bf16 v[8:11], a[108:111], v[168:171], v[8:11]
v_mfma_f32_16x16x32_bf16 v[0:3], a[108:111], v[160:163], v[0:3]
v_mfma_f32_16x16x32_bf16 v[32:35], a[128:131], v[128:131], 0
buffer_load_dwordx4 v215, s[24:27], s58 offen offset:3072 lds
s_add_u32 m0, s53, 0
s_add_u32 s58, s56, 0
buffer_load_dwordx4 v212, s[24:27], s58 offen lds
buffer_load_dwordx4 v213, s[24:27], s58 offen offset:1024 lds
buffer_load_dwordx4 v214, s[24:27], s58 offen offset:2048 lds
buffer_load_dwordx4 v215, s[24:27], s58 offen offset:3072 lds
s_waitcnt vmcnt(8)
v_mfma_f32_16x16x32_bf16 v[40:43], a[128:131], v[136:139], 0
ds_read_b64 a[96:97], v224 offset:16384
ds_read_b64 a[98:99], v225 offset:16384
v_mfma_f32_16x16x32_bf16 v[48:51], a[128:131], v[144:147], 0
ds_read_b64 a[100:101], v224 offset:18432
ds_read_b64 a[102:103], v225 offset:18432
v_mfma_f32_16x16x32_bf16 v[52:55], a[132:135], v[144:147], 0
s_add_u32 m0, s53, 4096
s_add_u32 s58, s57, 0
buffer_load_dwordx4 v212, s[24:27], s58 offen lds
v_mfma_f32_16x16x32_bf16 v[44:47], a[132:135], v[136:139], 0
ds_read_b64 a[104:105], v226 offset:18432
ds_read_b64 a[106:107], v227 offset:18432
v_mfma_f32_16x16x32_bf16 v[36:39], a[132:135], v[128:131], 0
ds_read_b64 a[108:109], v226 offset:16384
ds_read_b64 a[110:111], v227 offset:16384
v_mfma_f32_16x16x32_bf16 v[36:39], a[136:139], v[160:163], v[36:39]
buffer_load_dwordx4 v213, s[24:27], s58 offen offset:1024 lds
v_mfma_f32_16x16x32_bf16 v[44:47], a[136:139], v[168:171], v[44:47]
v_mfma_f32_16x16x32_bf16 v[52:55], a[136:139], v[176:179], v[52:55]
buffer_load_dwordx4 v214, s[24:27], s58 offen offset:2048 lds
v_mfma_f32_16x16x32_bf16 v[48:51], a[140:143], v[176:179], v[48:51]
v_mfma_f32_16x16x32_bf16 v[40:43], a[140:143], v[168:171], v[40:43]
buffer_load_dwordx4 v215, s[24:27], s58 offen offset:3072 lds
v_mfma_f32_16x16x32_bf16 v[32:35], a[140:143], v[160:163], v[32:35]
s_waitcnt lgkmcnt(0)
v_mfma_f32_16x16x32_bf16 v[64:67], a[96:99], v[128:131], 0
s_waitcnt vmcnt(8)
v_mfma_f32_16x16x32_bf16 v[72:75], a[96:99], v[136:139], 0
ds_read_b64 a[128:129], v224 offset:20480
ds_read_b64 a[130:131], v225 offset:20480
v_mfma_f32_16x16x32_bf16 v[80:83], a[96:99], v[144:147], 0
ds_read_b128 a[0:3], v236 offset:8192
ds_read_b128 a[4:7], v236 offset:9216
v_mfma_f32_16x16x32_bf16 v[84:87], a[100:103], v[144:147], 0
s_add_u32 m0, s53, 16384
s_add_u32 s58, s54, 49152
buffer_load_dwordx4 v212, s[24:27], s58 offen lds
v_mfma_f32_16x16x32_bf16 v[76:79], a[100:103], v[136:139], 0
ds_read_b128 a[8:11], v236 offset:10240
ds_read_b64 a[132:133], v224 offset:22528
v_mfma_f32_16x16x32_bf16 v[68:71], a[100:103], v[128:131], 0
ds_read_b64 a[134:135], v225 offset:22528
ds_read_b64 a[136:137], v226 offset:22528
v_mfma_f32_16x16x32_bf16 v[68:71], a[104:107], v[160:163], v[68:71]
ds_read_b64 a[138:139], v227 offset:22528
ds_read_b128 a[16:19], v236 offset:12288
v_mfma_f32_16x16x32_bf16 v[76:79], a[104:107], v[168:171], v[76:79]
ds_read_b128 a[20:23], v236 offset:13312
ds_read_b128 a[24:27], v236 offset:14336
v_mfma_f32_16x16x32_bf16 v[84:87], a[104:107], v[176:179], v[84:87]
ds_read_b64 a[140:141], v226 offset:20480
ds_read_b64 a[142:143], v227 offset:20480
v_mfma_f32_16x16x32_bf16 v[80:83], a[108:111], v[176:179], v[80:83]
buffer_load_dwordx4 v213, s[24:27], s58 offen offset:1024 lds
v_mfma_f32_16x16x32_bf16 v[72:75], a[108:111], v[168:171], v[72:75]
v_mfma_f32_16x16x32_bf16 v[64:67], a[108:111], v[160:163], v[64:67]
s_waitcnt lgkmcnt(9)
v_mfma_f32_16x16x32_bf16 v[0:3], a[128:131], a[0:3], v[0:3]
buffer_load_dwordx4 v214, s[24:27], s58 offen offset:2048 lds
buffer_load_dwordx4 v215, s[24:27], s58 offen offset:3072 lds
s_waitcnt vmcnt(8)
v_mfma_f32_16x16x32_bf16 v[8:11], a[128:131], a[4:7], v[8:11]
ds_read_b64 a[96:97], v224 offset:0
ds_read_b64 a[98:99], v225 offset:0
v_mfma_f32_16x16x32_bf16 v[16:19], a[128:131], a[8:11], v[16:19]
ds_read_b128 a[32:35], v237 offset:8192
s_waitcnt lgkmcnt(3)
v_mfma_f32_16x16x32_bf16 v[20:23], a[132:135], a[8:11], v[20:23]
ds_read_b128 a[36:39], v237 offset:9216
ds_read_b128 a[40:43], v237 offset:10240
v_mfma_f32_16x16x32_bf16 v[12:15], a[132:135], a[4:7], v[12:15]
ds_read_b64 a[100:101], v224 offset:2048
ds_read_b64 a[102:103], v225 offset:2048
v_mfma_f32_16x16x32_bf16 v[4:7], a[132:135], a[0:3], v[4:7]
ds_read_b64 a[104:105], v226 offset:2048
ds_read_b64 a[106:107], v227 offset:2048
v_mfma_f32_16x16x32_bf16 v[4:7], a[136:139], a[16:19], v[4:7]
ds_read_b128 a[48:51], v237 offset:12288
ds_read_b128 a[52:55], v237 offset:13312
v_mfma_f32_16x16x32_bf16 v[12:15], a[136:139], a[20:23], v[12:15]
ds_read_b128 a[56:59], v237 offset:14336
ds_read_b64 a[108:109], v226 offset:0
v_mfma_f32_16x16x32_bf16 v[20:23], a[136:139], a[24:27], v[20:23]
ds_read_b64 a[110:111], v227 offset:0
s_add_u32 m0, s53, 20480
v_mfma_f32_16x16x32_bf16 v[16:19], a[140:143], a[24:27], v[16:19]
s_add_u32 s58, s55, 49152
buffer_load_dwordx4 v212, s[24:27], s58 offen lds
v_mfma_f32_16x16x32_bf16 v[8:11], a[140:143], a[20:23], v[8:11]
v_mfma_f32_16x16x32_bf16 v[0:3], a[140:143], a[16:19], v[0:3]
s_waitcnt lgkmcnt(9)
v_mfma_f32_16x16x32_bf16 v[0:3], a[96:99], a[32:35], v[0:3]
buffer_load_dwordx4 v213, s[24:27], s58 offen offset:1024 lds
buffer_load_dwordx4 v214, s[24:27], s58 offen offset:2048 lds
buffer_load_dwordx4 v215, s[24:27], s58 offen offset:3072 lds
s_waitcnt vmcnt(8)
v_mfma_f32_16x16x32_bf16 v[8:11], a[96:99], a[36:39], v[8:11]
ds_read_b64 a[128:129], v224 offset:4096
ds_read_b64 a[130:131], v225 offset:4096
v_mfma_f32_16x16x32_bf16 v[16:19], a[96:99], a[40:43], v[16:19]
ds_read_b128 a[64:67], v238 offset:8192
s_waitcnt lgkmcnt(3)
v_mfma_f32_16x16x32_bf16 v[20:23], a[100:103], a[40:43], v[20:23]
ds_read_b128 a[68:71], v238 offset:9216
ds_read_b128 a[72:75], v238 offset:10240
v_mfma_f32_16x16x32_bf16 v[12:15], a[100:103], a[36:39], v[12:15]
ds_read_b64 a[132:133], v224 offset:6144
ds_read_b64 a[134:135], v225 offset:6144
v_mfma_f32_16x16x32_bf16 v[4:7], a[100:103], a[32:35], v[4:7]
ds_read_b64 a[136:137], v226 offset:6144
ds_read_b64 a[138:139], v227 offset:6144
v_mfma_f32_16x16x32_bf16 v[4:7], a[104:107], a[48:51], v[4:7]
ds_read_b128 a[80:83], v238 offset:12288
ds_read_b128 a[84:87], v238 offset:13312
v_mfma_f32_16x16x32_bf16 v[12:15], a[104:107], a[52:55], v[12:15]
ds_read_b128 a[88:91], v238 offset:14336
ds_read_b64 a[140:141], v226 offset:4096
v_mfma_f32_16x16x32_bf16 v[20:23], a[104:107], a[56:59], v[20:23]
ds_read_b64 a[142:143], v227 offset:4096
s_add_u32 m0, s53, 0
v_mfma_f32_16x16x32_bf16 v[16:19], a[108:111], a[56:59], v[16:19]
s_add_u32 s58, s57, 16384
buffer_load_dwordx4 v212, s[24:27], s58 offen lds
v_mfma_f32_16x16x32_bf16 v[8:11], a[108:111], a[52:55], v[8:11]
v_mfma_f32_16x16x32_bf16 v[0:3], a[108:111], a[48:51], v[0:3]
s_waitcnt lgkmcnt(9)
v_mfma_f32_16x16x32_bf16 v[0:3], a[128:131], a[64:67], v[0:3]
ds_read_b64 a[96:97], v224 offset:8192
ds_read_b64 a[98:99], v225 offset:8192
v_mfma_f32_16x16x32_bf16 v[8:11], a[128:131], a[68:71], v[8:11]
ds_read_b64 a[100:101], v224 offset:10240
ds_read_b64 a[102:103], v225 offset:10240
v_mfma_f32_16x16x32_bf16 v[16:19], a[128:131], a[72:75], v[16:19]
ds_read_b64 a[104:105], v226 offset:10240
s_waitcnt lgkmcnt(5)
v_mfma_f32_16x16x32_bf16 v[20:23], a[132:135], a[72:75], v[20:23]
buffer_load_dwordx4 v213, s[24:27], s58 offen offset:1024 lds
v_mfma_f32_16x16x32_bf16 v[12:15], a[132:135], a[68:71], v[12:15]
ds_read_b64 a[106:107], v227 offset:10240
ds_read_b64 a[108:109], v226 offset:8192
v_mfma_f32_16x16x32_bf16 v[4:7], a[132:135], a[64:67], v[4:7]
ds_read_b64 a[110:111], v227 offset:8192
v_mfma_f32_16x16x32_bf16 v[4:7], a[136:139], a[80:83], v[4:7]
buffer_load_dwordx4 v214, s[24:27], s58 offen offset:2048 lds
v_mfma_f32_16x16x32_bf16 v[12:15], a[136:139], a[84:87], v[12:15]
v_mfma_f32_16x16x32_bf16 v[20:23], a[136:139], a[88:91], v[20:23]
v_mfma_f32_16x16x32_bf16 v[16:19], a[140:143], a[88:91], v[16:19]
v_mfma_f32_16x16x32_bf16 v[8:11], a[140:143], a[84:87], v[8:11]
v_mfma_f32_16x16x32_bf16 v[0:3], a[140:143], a[80:83], v[0:3]
s_waitcnt lgkmcnt(0)
v_mfma_f32_16x16x32_bf16 v[32:35], a[96:99], a[0:3], v[32:35]
ds_read_b64 a[128:129], v224 offset:12288
ds_read_b64 a[130:131], v225 offset:12288
v_mfma_f32_16x16x32_bf16 v[40:43], a[96:99], a[4:7], v[40:43]
ds_read_b64 a[132:133], v224 offset:14336
ds_read_b64 a[134:135], v225 offset:14336
v_mfma_f32_16x16x32_bf16 v[48:51], a[96:99], a[8:11], v[48:51]
ds_read_b64 a[136:137], v226 offset:14336
v_mfma_f32_16x16x32_bf16 v[52:55], a[100:103], a[8:11], v[52:55]
ds_read_b64 a[138:139], v227 offset:14336
v_mfma_f32_16x16x32_bf16 v[44:47], a[100:103], a[4:7], v[44:47]
ds_read_b64 a[140:141], v226 offset:12288
v_max_f32 v242, v0, v1
v_max_f32 v243, v8, v9
v_max_f32 v244, v16, v17
v_mfma_f32_16x16x32_bf16 v[36:39], a[100:103], a[0:3], v[36:39]
ds_read_b64 a[142:143], v227 offset:12288
v_max3_f32 v242, v2, v3, v242
v_max3_f32 v243, v10, v11, v243
v_max3_f32 v244, v18, v19, v244
v_mfma_f32_16x16x32_bf16 v[36:39], a[104:107], a[16:19], v[36:39]
v_max3_f32 v242, v4, v5, v242
v_max3_f32 v243, v12, v13, v243
v_max3_f32 v244, v20, v21, v244
v_max3_f32 v242, v6, v7, v242
v_mfma_f32_16x16x32_bf16 v[44:47], a[104:107], a[20:23], v[44:47]
v_max3_f32 v243, v14, v15, v243
v_max3_f32 v244, v22, v23, v244
v_mov_b32 v200, v242
v_mfma_f32_16x16x32_bf16 v[52:55], a[104:107], a[24:27], v[52:55]
v_mov_b32 v201, v243
v_mov_b32 v202, v244
v_mov_b32 v203, v244
v_mfma_f32_16x16x32_bf16 v[48:51], a[108:111], a[24:27], v[48:51]
v_permlane32_swap_b32 v200, v202
v_permlane32_swap_b32 v201, v203
v_max_f32 v200, v200, v202
v_max_f32 v201, v201, v203
v_mfma_f32_16x16x32_bf16 v[40:43], a[108:111], a[20:23], v[40:43]
s_nop 0
v_permlane16_swap_b32 v200, v201
v_max_f32 v200, v200, v201
ds_write_b32 v239, v200 offset:0
v_mfma_f32_16x16x32_bf16 v[32:35], a[108:111], a[16:19], v[32:35]
ds_write_b32 v239, v200 offset:16384
ds_write_b32 v239, v200 offset:32768
s_waitcnt lgkmcnt(3)
v_mfma_f32_16x16x32_bf16 v[32:35], a[128:131], a[32:35], v[32:35]
buffer_load_dwordx4 v215, s[24:27], s58 offen offset:3072 lds
s_add_u32 m0, s53, 4096
s_add_u32 s58, s55, 32768
buffer_load_dwordx4 v212, s[24:27], s58 offen lds
buffer_load_dwordx4 v213, s[24:27], s58 offen offset:1024 lds
buffer_load_dwordx4 v214, s[24:27], s58 offen offset:2048 lds
buffer_load_dwordx4 v215, s[24:27], s58 offen offset:3072 lds
s_add_u32 m0, s53, 8192
s_add_u32 s58, s56, 32768
buffer_load_dwordx4 v212, s[24:27], s58 offen lds
buffer_load_dwordx4 v213, s[24:27], s58 offen offset:1024 lds
buffer_load_dwordx4 v214, s[24:27], s58 offen offset:2048 lds
buffer_load_dwordx4 v215, s[24:27], s58 offen offset:3072 lds
s_waitcnt vmcnt(8)
ds_write_b32 v239, v200 offset:49152
v_mov_b32 v246, 0x3f803f80
v_mfma_f32_16x16x32_bf16 v[40:43], a[128:131], a[36:39], v[40:43]
ds_read_b64 a[96:97], v224 offset:0
ds_read_b64 a[98:99], v225 offset:0
v_accvgpr_write_b32 a240, v246
v_mfma_f32_16x16x32_bf16 v[48:51], a[128:131], a[40:43], v[48:51]
ds_read_b64 a[100:101], v224 offset:2048
ds_read_b64 a[102:103], v225 offset:2048
v_accvgpr_write_b32 a241, v246
v_accvgpr_write_b32 a242, v246
v_mfma_f32_16x16x32_bf16 v[52:55], a[132:135], a[40:43], v[52:55]
s_add_u32 m0, s53, 12288
s_add_u32 s58, s57, 32768
buffer_load_dwordx4 v212, s[24:27], s58 offen lds
v_accvgpr_write_b32 a243, v246
v_mfma_f32_16x16x32_bf16 v[44:47], a[132:135], a[36:39], v[44:47]
ds_read_b64 a[104:105], v226 offset:2048
ds_read_b64 a[106:107], v227 offset:2048
v_mfma_f32_16x16x32_bf16 v[36:39], a[132:135], a[32:35], v[36:39]
ds_read_b64 a[108:109], v226 offset:0
ds_read_b64 a[110:111], v227 offset:0
v_mfma_f32_16x16x32_bf16 v[36:39], a[136:139], a[48:51], v[36:39]
buffer_load_dwordx4 v213, s[24:27], s58 offen offset:1024 lds
v_mfma_f32_16x16x32_bf16 v[44:47], a[136:139], a[52:55], v[44:47]
s_waitcnt lgkmcnt(8)
s_barrier
ds_read_b128 v[192:195], v240 offset:0
ds_read_b128 v[196:199], v240 offset:256
ds_read_b128 v[200:203], v240 offset:512
ds_read_b128 v[204:207], v240 offset:768
v_mfma_f32_16x16x32_bf16 v[52:55], a[136:139], a[56:59], v[52:55]
buffer_load_dwordx4 v214, s[24:27], s58 offen offset:2048 lds
v_mfma_f32_16x16x32_bf16 v[48:51], a[140:143], a[56:59], v[48:51]
v_mfma_f32_16x16x32_bf16 v[40:43], a[140:143], a[52:55], v[40:43]
buffer_load_dwordx4 v215, s[24:27], s58 offen offset:3072 lds
v_mfma_f32_16x16x32_bf16 v[32:35], a[140:143], a[48:51], v[32:35]
s_waitcnt lgkmcnt(4)
v_mfma_f32_16x16x32_bf16 v[32:35], a[96:99], a[64:67], v[32:35]
s_waitcnt vmcnt(8)
ds_read_b64 a[128:129], v224 offset:4096
v_mfma_f32_16x16x32_bf16 v[40:43], a[96:99], a[68:71], v[40:43]
ds_read_b64 a[130:131], v225 offset:4096
ds_read_b64 a[132:133], v224 offset:6144
v_mfma_f32_16x16x32_bf16 v[48:51], a[96:99], a[72:75], v[48:51]
ds_read_b64 a[134:135], v225 offset:6144
ds_read_b64 a[136:137], v226 offset:6144
s_waitcnt lgkmcnt(5)
v_max3_f32 v250, v192, v196, v200
v_max3_f32 v251, v193, v197, v201
v_max3_f32 v252, v194, v198, v202
v_accvgpr_read_b32 v192, a244
v_accvgpr_read_b32 v193, a245
v_accvgpr_read_b32 v194, a246
v_max3_f32 v250, v250, v204, v192
v_max3_f32 v251, v251, v205, v193
v_max3_f32 v252, v252, v206, v194
v_mul_f32 v250, s63, v250
v_mul_f32 v251, s63, v251
v_mfma_f32_16x16x32_bf16 v[52:55], a[100:103], a[72:75], v[52:55]
s_add_u32 m0, s53, 0
s_mov_b32 s58, 0
buffer_load_dwordx4 v216, s[28:31], s58 offen lds
v_mul_f32 v252, s63, v252
v_mfma_f32_16x16x32_bf16 v[44:47], a[100:103], a[68:71], v[44:47]
ds_read_b64 a[138:139], v227 offset:6144
ds_read_b64 a[140:141], v226 offset:4096
v_fma_f32 v0, v0, s63, -v250
v_fma_f32 v1, v1, s63, -v250
v_mfma_f32_16x16x32_bf16 v[36:39], a[100:103], a[64:67], v[36:39]
ds_read_b64 a[142:143], v227 offset:4096
v_fma_f32 v2, v2, s63, -v250
v_fma_f32 v3, v3, s63, -v250
v_mfma_f32_16x16x32_bf16 v[36:39], a[104:107], a[80:83], v[36:39]
buffer_load_dwordx4 v217, s[28:31], s58 offen offset:1024 lds
v_fma_f32 v4, v4, s63, -v250
v_mfma_f32_16x16x32_bf16 v[44:47], a[104:107], a[84:87], v[44:47]
buffer_load_dwordx4 v218, s[28:31], s58 offen offset:2048 lds
v_fma_f32 v5, v5, s63, -v250
v_fma_f32 v6, v6, s63, -v250
v_mfma_f32_16x16x32_bf16 v[52:55], a[104:107], a[88:91], v[52:55]
buffer_load_dwordx4 v219, s[28:31], s58 offen offset:3072 lds
v_fma_f32 v7, v7, s63, -v250
v_mfma_f32_16x16x32_bf16 v[48:51], a[108:111], a[88:91], v[48:51]
v_exp_f32 v0, v0
v_mfma_f32_16x16x32_bf16 v[40:43], a[108:111], a[84:87], v[40:43]
v_exp_f32 v1, v1
v_exp_f32 v2, v2
v_mfma_f32_16x16x32_bf16 v[32:35], a[108:111], a[80:83], v[32:35]
v_exp_f32 v3, v3
s_waitcnt lgkmcnt(0)
v_mfma_f32_16x16x32_bf16 v[64:67], a[128:131], a[0:3], v[64:67]
s_waitcnt vmcnt(8)
ds_read_b64 a[96:97], v224 offset:8192
v_exp_f32 v4, v4
v_mfma_f32_16x16x32_bf16 v[72:75], a[128:131], a[4:7], v[72:75]
ds_read_b64 a[98:99], v225 offset:8192
ds_read_b64 a[100:101], v224 offset:10240
v_exp_f32 v5, v5
v_mfma_f32_16x16x32_bf16 v[80:83], a[128:131], a[8:11], v[80:83]
ds_read_b64 a[102:103], v225 offset:10240
ds_read_b64 a[104:105], v226 offset:10240
v_mfma_f32_16x16x32_bf16 v[84:87], a[132:135], a[8:11], v[84:87]
s_add_u32 m0, s53, 4096
s_mov_b32 s58, 65536
buffer_load_dwordx4 v216, s[28:31], s58 offen lds
v_exp_f32 v6, v6
v_mfma_f32_16x16x32_bf16 v[76:79], a[132:135], a[4:7], v[76:79]
ds_read_b64 a[106:107], v227 offset:10240
ds_read_b64 a[108:109], v226 offset:8192
v_exp_f32 v7, v7
v_mfma_f32_16x16x32_bf16 v[68:71], a[132:135], a[0:3], v[68:71]
ds_read_b64 a[110:111], v227 offset:8192
v_cvt_pk_bf16_f32 v196, v0, v1
v_cvt_pk_bf16_f32 v197, v2, v3
v_mfma_f32_16x16x32_bf16 v[68:71], a[136:139], a[16:19], v[68:71]
buffer_load_dwordx4 v217, s[28:31], s58 offen offset:1024 lds
v_cvt_pk_bf16_f32 v198, v4, v5
v_cvt_pk_bf16_f32 v199, v6, v7
v_mfma_f32_16x16x32_bf16 v[76:79], a[136:139], a[20:23], v[76:79]
buffer_load_dwordx4 v218, s[28:31], s58 offen offset:2048 lds
v_mfma_f32_16x16x32_bf16 v[84:87], a[136:139], a[24:27], v[84:87]
ds_write_b128 v235, v[196:199] offset:0
v_mfma_f32_16x16x32_bf16 a[224:227], a[240:243], v[196:199], 0
v_fma_f32 v8, v8, s63, -v251
v_fma_f32 v9, v9, s63, -v251
v_fma_f32 v10, v10, s63, -v251
v_fma_f32 v11, v11, s63, -v251
v_mfma_f32_16x16x32_bf16 v[80:83], a[140:143], a[24:27], v[80:83]
buffer_load_dwordx4 v219, s[28:31], s58 offen offset:3072 lds
v_fma_f32 v12, v12, s63, -v251
v_fma_f32 v13, v13, s63, -v251
v_mfma_f32_16x16x32_bf16 v[72:75], a[140:143], a[20:23], v[72:75]
v_fma_f32 v14, v14, s63, -v251
v_fma_f32 v15, v15, s63, -v251
v_mfma_f32_16x16x32_bf16 v[64:67], a[140:143], a[16:19], v[64:67]
v_exp_f32 v8, v8
s_waitcnt lgkmcnt(1)
v_mfma_f32_16x16x32_bf16 v[64:67], a[96:99], a[32:35], v[64:67]
s_waitcnt vmcnt(8)
ds_read_b64 a[128:129], v224 offset:12288
v_exp_f32 v9, v9
v_mfma_f32_16x16x32_bf16 v[72:75], a[96:99], a[36:39], v[72:75]
ds_read_b64 a[130:131], v225 offset:12288
ds_read_b64 a[132:133], v224 offset:14336
v_exp_f32 v10, v10
v_mfma_f32_16x16x32_bf16 v[80:83], a[96:99], a[40:43], v[80:83]
ds_read_b64 a[134:135], v225 offset:14336
ds_read_b64 a[136:137], v226 offset:14336
v_mfma_f32_16x16x32_bf16 v[84:87], a[100:103], a[40:43], v[84:87]
s_add_u32 m0, s53, 8192
s_add_u32 s58, s56, 49152
buffer_load_dwordx4 v212, s[24:27], s58 offen lds
v_exp_f32 v11, v11
v_mfma_f32_16x16x32_bf16 v[76:79], a[100:103], a[36:39], v[76:79]
ds_read_b64 a[138:139], v227 offset:14336
ds_read_b64 a[140:141], v226 offset:12288
v_exp_f32 v12, v12
v_mfma_f32_16x16x32_bf16 v[68:71], a[100:103], a[32:35], v[68:71]
ds_read_b64 a[142:143], v227 offset:12288
v_exp_f32 v13, v13
v_mfma_f32_16x16x32_bf16 v[68:71], a[104:107], a[48:51], v[68:71]
buffer_load_dwordx4 v213, s[24:27], s58 offen offset:1024 lds
v_exp_f32 v14, v14
v_mfma_f32_16x16x32_bf16 v[76:79], a[104:107], a[52:55], v[76:79]
buffer_load_dwordx4 v214, s[24:27], s58 offen offset:2048 lds
v_mfma_f32_16x16x32_bf16 v[84:87], a[104:107], a[56:59], v[84:87]
v_exp_f32 v15, v15
v_cvt_pk_bf16_f32 v192, v8, v9
v_cvt_pk_bf16_f32 v193, v10, v11
v_cvt_pk_bf16_f32 v194, v12, v13
v_mfma_f32_16x16x32_bf16 v[80:83], a[108:111], a[56:59], v[80:83]
v_cvt_pk_bf16_f32 v195, v14, v15
ds_write_b128 v235, v[192:195] offset:1024
v_mfma_f32_16x16x32_bf16 v[72:75], a[108:111], a[52:55], v[72:75]
v_mfma_f32_16x16x32_bf16 a[228:231], a[240:243], v[192:195], 0
v_fma_f32 v16, v16, s63, -v252
v_fma_f32 v17, v17, s63, -v252
v_fma_f32 v18, v18, s63, -v252
v_mfma_f32_16x16x32_bf16 v[64:67], a[108:111], a[48:51], v[64:67]
v_fma_f32 v19, v19, s63, -v252
v_fma_f32 v20, v20, s63, -v252
v_fma_f32 v21, v21, s63, -v252
s_waitcnt lgkmcnt(1)
v_mfma_f32_16x16x32_bf16 v[64:67], a[128:131], a[64:67], v[64:67]
ds_read_b64 a[96:97], v224 offset:16384
ds_read_b64 a[98:99], v225 offset:16384
v_fma_f32 v22, v22, s63, -v252
v_mfma_f32_16x16x32_bf16 v[72:75], a[128:131], a[68:71], v[72:75]
ds_read_b64 a[100:101], v224 offset:18432
ds_read_b64 a[102:103], v225 offset:18432
v_fma_f32 v23, v23, s63, -v252
v_mfma_f32_16x16x32_bf16 v[80:83], a[128:131], a[72:75], v[80:83]
ds_read_b64 a[104:105], v226 offset:18432
v_exp_f32 v16, v16
v_mfma_f32_16x16x32_bf16 v[84:87], a[132:135], a[72:75], v[84:87]
ds_read_b64 a[106:107], v227 offset:18432
v_exp_f32 v17, v17
v_mfma_f32_16x16x32_bf16 v[76:79], a[132:135], a[68:71], v[76:79]
ds_read_b64 a[108:109], v226 offset:16384
v_exp_f32 v18, v18
v_mfma_f32_16x16x32_bf16 v[68:71], a[132:135], a[64:67], v[68:71]
ds_read_b64 a[110:111], v227 offset:16384
v_exp_f32 v19, v19
v_exp_f32 v20, v20
v_mfma_f32_16x16x32_bf16 v[68:71], a[136:139], a[80:83], v[68:71]
v_exp_f32 v21, v21
v_mfma_f32_16x16x32_bf16 v[76:79], a[136:139], a[84:87], v[76:79]
v_exp_f32 v22, v22
v_exp_f32 v23, v23
v_mfma_f32_16x16x32_bf16 v[84:87], a[136:139], a[88:91], v[84:87]
v_cvt_pk_bf16_f32 v196, v16, v17
v_cvt_pk_bf16_f32 v197, v18, v19
v_cvt_pk_bf16_f32 v198, v20, v21
v_cvt_pk_bf16_f32 v199, v22, v23
v_mfma_f32_16x16x32_bf16 v[80:83], a[140:143], a[88:91], v[80:83]
ds_write_b128 v235, v[196:199] offset:2048
v_mfma_f32_16x16x32_bf16 a[232:235], a[240:243], v[196:199], 0
v_max3_f32 v242, v32, v33, v242
v_max3_f32 v243, v40, v41, v243
v_max3_f32 v244, v48, v49, v244
v_mfma_f32_16x16x32_bf16 v[72:75], a[140:143], a[84:87], v[72:75]
v_max3_f32 v242, v34, v35, v242
v_max3_f32 v243, v42, v43, v243
v_max3_f32 v244, v50, v51, v244
v_mfma_f32_16x16x32_bf16 v[64:67], a[140:143], a[80:83], v[64:67]
v_max3_f32 v242, v36, v37, v242
v_max3_f32 v243, v44, v45, v243
s_waitcnt lgkmcnt(1)
v_mfma_f32_16x16x32_bf16 v[96:99], a[96:99], v[128:131], 0
ds_read_b64 a[128:129], v224 offset:20480
ds_read_b64 a[130:131], v225 offset:20480
v_max3_f32 v244, v52, v53, v244
v_max3_f32 v242, v38, v39, v242
v_mfma_f32_16x16x32_bf16 v[104:107], a[96:99], v[136:139], 0
ds_read_b64 a[132:133], v224 offset:22528
ds_read_b64 a[134:135], v225 offset:22528
buffer_load_dwordx4 v215, s[24:27], s58 offen offset:3072 lds
v_max3_f32 v243, v46, v47, v243
v_mfma_f32_16x16x32_bf16 v[112:115], a[96:99], v[144:147], 0
ds_read_b64 a[136:137], v226 offset:22528
s_add_u32 m0, s53, 12288
v_max3_f32 v244, v54, v55, v244
v_mfma_f32_16x16x32_bf16 v[116:119], a[100:103], v[144:147], 0
s_add_u32 s58, s57, 49152
ds_read_b64 a[138:139], v227 offset:22528
v_fma_f32 v32, v32, s63, -v250
v_fma_f32 v33, v33, s63, -v250
v_mfma_f32_16x16x32_bf16 v[108:111], a[100:103], v[136:139], 0
ds_read_b64 a[140:141], v226 offset:20480
v_fma_f32 v34, v34, s63, -v250
v_fma_f32 v35, v35, s63, -v250
v_mfma_f32_16x16x32_bf16 v[100:103], a[100:103], v[128:131], 0
ds_read_b64 a[142:143], v227 offset:20480
v_fma_f32 v36, v36, s63, -v250
v_fma_f32 v37, v37, s63, -v250
v_mfma_f32_16x16x32_bf16 v[100:103], a[104:107], v[160:163], v[100:103]
buffer_load_dwordx4 v212, s[24:27], s58 offen lds
v_fma_f32 v38, v38, s63, -v250
v_mfma_f32_16x16x32_bf16 v[108:111], a[104:107], v[168:171], v[108:111]
buffer_load_dwordx4 v213, s[24:27], s58 offen offset:1024 lds
v_fma_f32 v39, v39, s63, -v250
v_mfma_f32_16x16x32_bf16 v[116:119], a[104:107], v[176:179], v[116:119]
v_exp_f32 v32, v32
v_exp_f32 v33, v33
v_mfma_f32_16x16x32_bf16 v[112:115], a[108:111], v[176:179], v[112:115]
buffer_load_dwordx4 v214, s[24:27], s58 offen offset:2048 lds
v_mfma_f32_16x16x32_bf16 v[104:107], a[108:111], v[168:171], v[104:107]
v_exp_f32 v34, v34
v_exp_f32 v35, v35
v_mfma_f32_16x16x32_bf16 v[96:99], a[108:111], v[160:163], v[96:99]
v_exp_f32 v36, v36
s_waitcnt lgkmcnt(0)
v_mfma_f32_16x16x32_bf16 v[96:99], a[128:131], a[0:3], v[96:99]
buffer_load_dwordx4 v215, s[24:27], s58 offen offset:3072 lds
s_add_u32 m0, s53, 16384
s_mov_b32 s58, 147456
buffer_load_dwordx4 v216, s[28:31], s58 offen lds
buffer_load_dwordx4 v217, s[28:31], s58 offen offset:1024 lds
buffer_load_dwordx4 v218, s[28:31], s58 offen offset:2048 lds
buffer_load_dwordx4 v219, s[28:31], s58 offen offset:3072 lds
s_waitcnt vmcnt(8)
v_exp_f32 v37, v37
v_mfma_f32_16x16x32_bf16 v[104:107], a[128:131], a[4:7], v[104:107]
ds_read_b64 a[96:97], v224 offset:8192
ds_read_b64 a[98:99], v225 offset:8192
v_mfma_f32_16x16x32_bf16 v[112:115], a[128:131], a[8:11], v[112:115]
ds_read_b64 a[100:101], v224 offset:10240
ds_read_b64 a[102:103], v225 offset:10240
v_exp_f32 v38, v38
v_mfma_f32_16x16x32_bf16 v[116:119], a[132:135], a[8:11], v[116:119]
s_add_u32 m0, s53, 20480
s_mov_b32 s58, 212992
buffer_load_dwordx4 v216, s[28:31], s58 offen lds
v_exp_f32 v39, v39
v_mfma_f32_16x16x32_bf16 v[108:111], a[132:135], a[4:7], v[108:111]
ds_read_b64 a[104:105], v226 offset:10240
ds_read_b64 a[106:107], v227 offset:10240
v_cvt_pk_bf16_f32 v192, v32, v33
v_mfma_f32_16x16x32_bf16 v[100:103], a[132:135], a[0:3], v[100:103]
ds_read_b64 a[108:109], v226 offset:8192
ds_read_b64 a[110:111], v227 offset:8192
v_cvt_pk_bf16_f32 v193, v34, v35
v_cvt_pk_bf16_f32 v194, v36, v37
v_mfma_f32_16x16x32_bf16 v[100:103], a[136:139], a[16:19], v[100:103]
buffer_load_dwordx4 v217, s[28:31], s58 offen offset:1024 lds
v_cvt_pk_bf16_f32 v195, v38, v39
v_mfma_f32_16x16x32_bf16 v[108:111], a[136:139], a[20:23], v[108:111]
buffer_load_dwordx4 v218, s[28:31], s58 offen offset:2048 lds
v_mfma_f32_16x16x32_bf16 v[116:119], a[136:139], a[24:27], v[116:119]
ds_write_b128 v235, v[192:195] offset:4096
v_mfma_f32_16x16x32_bf16 a[224:227], a[240:243], v[192:195], a[224:227]
v_fma_f32 v40, v40, s63, -v251
v_fma_f32 v41, v41, s63, -v251
v_fma_f32 v42, v42, s63, -v251
v_fma_f32 v43, v43, s63, -v251
v_fma_f32 v44, v44, s63, -v251
v_mfma_f32_16x16x32_bf16 v[112:115], a[140:143], a[24:27], v[112:115]
buffer_load_dwordx4 v219, s[28:31], s58 offen offset:3072 lds
v_fma_f32 v45, v45, s63, -v251
v_mfma_f32_16x16x32_bf16 v[104:107], a[140:143], a[20:23], v[104:107]
v_fma_f32 v46, v46, s63, -v251
v_fma_f32 v47, v47, s63, -v251
v_mfma_f32_16x16x32_bf16 v[96:99], a[140:143], a[16:19], v[96:99]
v_exp_f32 v40, v40
s_waitcnt lgkmcnt(1)
v_mfma_f32_16x16x32_bf16 v[96:99], a[96:99], a[32:35], v[96:99]
s_waitcnt vmcnt(8)
ds_read_b64 a[128:129], v224 offset:12288
v_exp_f32 v41, v41
v_mfma_f32_16x16x32_bf16 v[104:107], a[96:99], a[36:39], v[104:107]
ds_read_b64 a[130:131], v225 offset:12288
ds_read_b64 a[132:133], v224 offset:14336
v_exp_f32 v42, v42
v_mfma_f32_16x16x32_bf16 v[112:115], a[96:99], a[40:43], v[112:115]
ds_read_b64 a[134:135], v225 offset:14336
ds_read_b64 a[136:137], v226 offset:14336
v_mfma_f32_16x16x32_bf16 v[116:119], a[100:103], a[40:43], v[116:119]
s_add_u32 m0, s53, 8192
s_mov_b32 s58, 131072
buffer_load_dwordx4 v216, s[28:31], s58 offen lds
v_exp_f32 v43, v43
v_mfma_f32_16x16x32_bf16 v[108:111], a[100:103], a[36:39], v[108:111]
ds_read_b64 a[138:139], v227 offset:14336
ds_read_b64 a[140:141], v226 offset:12288
v_exp_f32 v44, v44
v_mfma_f32_16x16x32_bf16 v[100:103], a[100:103], a[32:35], v[100:103]
ds_read_b64 a[142:143], v227 offset:12288
v_exp_f32 v45, v45
v_mfma_f32_16x16x32_bf16 v[100:103], a[104:107], a[48:51], v[100:103]
buffer_load_dwordx4 v217, s[28:31], s58 offen offset:1024 lds
v_mfma_f32_16x16x32_bf16 v[108:111], a[104:107], a[52:55], v[108:111]
v_exp_f32 v46, v46
v_exp_f32 v47, v47
v_cvt_pk_bf16_f32 v196, v40, v41
v_mfma_f32_16x16x32_bf16 v[116:119], a[104:107], a[56:59], v[116:119]
buffer_load_dwordx4 v218, s[28:31], s58 offen offset:2048 lds
v_cvt_pk_bf16_f32 v197, v42, v43
v_mfma_f32_16x16x32_bf16 v[112:115], a[108:111], a[56:59], v[112:115]
v_cvt_pk_bf16_f32 v198, v44, v45
v_cvt_pk_bf16_f32 v199, v46, v47
v_mfma_f32_16x16x32_bf16 v[104:107], a[108:111], a[52:55], v[104:107]
ds_write_b128 v235, v[196:199] offset:5120
v_mfma_f32_16x16x32_bf16 a[228:231], a[240:243], v[196:199], a[228:231]
v_fma_f32 v48, v48, s63, -v252
v_fma_f32 v49, v49, s63, -v252
v_fma_f32 v50, v50, s63, -v252
v_fma_f32 v51, v51, s63, -v252
v_fma_f32 v52, v52, s63, -v252
v_mfma_f32_16x16x32_bf16 v[96:99], a[108:111], a[48:51], v[96:99]
v_fma_f32 v53, v53, s63, -v252
v_fma_f32 v54, v54, s63, -v252
s_waitcnt lgkmcnt(1)
v_mfma_f32_16x16x32_bf16 v[96:99], a[128:131], a[64:67], v[96:99]
s_waitcnt lgkmcnt(0)
s_barrier
buffer_load_dwordx4 v219, s[28:31], s58 offen offset:3072 lds
v_fma_f32 v55, v55, s63, -v252
v_mfma_f32_16x16x32_bf16 v[104:107], a[128:131], a[68:71], v[104:107]
ds_read_b64_tr_b16 a[96:97], v230 offset:0
ds_read_b64_tr_b16 a[98:99], v230 offset:2048
v_mfma_f32_16x16x32_bf16 v[112:115], a[128:131], a[72:75], v[112:115]
ds_read_b128 a[112:115], v234 offset:0
ds_read_b128 a[116:119], v234 offset:1024
v_exp_f32 v48, v48
v_mfma_f32_16x16x32_bf16 v[116:119], a[132:135], a[72:75], v[116:119]
s_add_u32 m0, s53, 12288
s_mov_b32 s58, 196608
v_exp_f32 v49, v49
v_mfma_f32_16x16x32_bf16 v[108:111], a[132:135], a[68:71], v[108:111]
ds_read_b128 a[120:123], v234 offset:2048
ds_read_b64_tr_b16 a[100:101], v231 offset:0
v_mfma_f32_16x16x32_bf16 v[100:103], a[132:135], a[64:67], v[100:103]
ds_read_b64_tr_b16 a[102:103], v231 offset:2048
ds_read_b64_tr_b16 a[104:105], v232 offset:0
buffer_load_dwordx4 v216, s[28:31], s58 offen lds
v_exp_f32 v50, v50
v_mfma_f32_16x16x32_bf16 v[100:103], a[136:139], a[80:83], v[100:103]
ds_read_b64_tr_b16 a[106:107], v232 offset:2048
ds_read_b64_tr_b16 a[108:109], v233 offset:0
v_exp_f32 v51, v51
v_mfma_f32_16x16x32_bf16 v[108:111], a[136:139], a[84:87], v[108:111]
buffer_load_dwordx4 v217, s[28:31], s58 offen offset:1024 lds
v_mfma_f32_16x16x32_bf16 v[116:119], a[136:139], a[88:91], v[116:119]
ds_read_b64_tr_b16 a[110:111], v233 offset:2048
v_exp_f32 v52, v52
v_mfma_f32_16x16x32_bf16 v[112:115], a[140:143], a[88:91], v[112:115]
buffer_load_dwordx4 v218, s[28:31], s58 offen offset:2048 lds
v_exp_f32 v53, v53
v_mfma_f32_16x16x32_bf16 v[104:107], a[140:143], a[84:87], v[104:107]
v_exp_f32 v54, v54
v_exp_f32 v55, v55
v_mfma_f32_16x16x32_bf16 v[96:99], a[140:143], a[80:83], v[96:99]
v_cvt_pk_bf16_f32 v192, v48, v49
v_cvt_pk_bf16_f32 v193, v50, v51
s_waitcnt lgkmcnt(6)
v_mfma_f32_16x16x32_bf16 v[128:131], a[96:99], a[112:115], 0
ds_read_b64_tr_b16 a[128:129], v230 offset:4096
ds_read_b64_tr_b16 a[130:131], v230 offset:6144
v_cvt_pk_bf16_f32 v194, v52, v53
v_mfma_f32_16x16x32_bf16 v[136:139], a[96:99], a[116:119], 0
ds_read_b128 a[144:147], v234 offset:16384
ds_read_b128 a[148:151], v234 offset:17408
v_cvt_pk_bf16_f32 v195, v54, v55
v_mfma_f32_16x16x32_bf16 v[144:147], a[96:99], a[120:123], 0
ds_read_b128 a[152:155], v234 offset:18432
ds_write_b128 v235, v[192:195] offset:6144
s_waitcnt lgkmcnt(6)
v_mfma_f32_16x16x32_bf16 v[148:151], a[100:103], a[120:123], 0
ds_read_b64_tr_b16 a[132:133], v231 offset:4096
ds_read_b64_tr_b16 a[134:135], v231 offset:6144
v_mfma_f32_16x16x32_bf16 a[232:235], a[240:243], v[192:195], a[232:235]
v_max3_f32 v242, v64, v65, v242
v_max3_f32 v243, v72, v73, v243
v_max3_f32 v244, v80, v81, v244
v_mfma_f32_16x16x32_bf16 v[140:143], a[100:103], a[116:119], 0
ds_read_b64_tr_b16 a[136:137], v232 offset:4096
ds_read_b64_tr_b16 a[138:139], v232 offset:6144
v_max3_f32 v242, v66, v67, v242
v_mfma_f32_16x16x32_bf16 v[132:135], a[100:103], a[112:115], 0
ds_read_b64_tr_b16 a[140:141], v233 offset:4096
v_max3_f32 v243, v74, v75, v243
v_max3_f32 v244, v82, v83, v244
v_max3_f32 v242, v68, v69, v242
v_mfma_f32_16x16x32_bf16 v[160:163], a[104:107], a[112:115], 0
ds_read_b64_tr_b16 a[142:143], v233 offset:6144
v_max3_f32 v243, v76, v77, v243
v_max3_f32 v244, v84, v85, v244
v_mfma_f32_16x16x32_bf16 v[168:171], a[104:107], a[116:119], 0
v_max3_f32 v242, v70, v71, v242
v_max3_f32 v243, v78, v79, v243
v_max3_f32 v244, v86, v87, v244
v_mfma_f32_16x16x32_bf16 v[176:179], a[104:107], a[120:123], 0
v_fma_f32 v64, v64, s63, -v250
v_fma_f32 v65, v65, s63, -v250
v_fma_f32 v66, v66, s63, -v250
v_mfma_f32_16x16x32_bf16 v[180:183], a[108:111], a[120:123], 0
buffer_load_dwordx4 v219, s[28:31], s58 offen offset:3072 lds
v_fma_f32 v67, v67, s63, -v250
v_fma_f32 v68, v68, s63, -v250
v_mfma_f32_16x16x32_bf16 v[172:175], a[108:111], a[116:119], 0
s_add_u32 m0, s53, 0
s_mov_b32 s58, 16384
v_fma_f32 v69, v69, s63, -v250
v_mfma_f32_16x16x32_bf16 v[164:167], a[108:111], a[112:115], 0
v_fma_f32 v70, v70, s63, -v250
v_fma_f32 v71, v71, s63, -v250
s_waitcnt lgkmcnt(0)
v_mfma_f32_16x16x32_bf16 v[128:131], a[128:131], a[144:147], v[128:131]
buffer_load_dwordx4 v216, s[28:31], s58 offen lds
buffer_load_dwordx4 v217, s[28:31], s58 offen offset:1024 lds
buffer_load_dwordx4 v218, s[28:31], s58 offen offset:2048 lds
buffer_load_dwordx4 v219, s[28:31], s58 offen offset:3072 lds
s_waitcnt vmcnt(8)
v_mfma_f32_16x16x32_bf16 v[136:139], a[128:131], a[148:151], v[136:139]
ds_read_b64_tr_b16 a[96:97], v230 offset:8192
ds_read_b64_tr_b16 a[98:99], v230 offset:10240
v_exp_f32 v64, v64
v_mfma_f32_16x16x32_bf16 v[144:147], a[128:131], a[152:155], v[144:147]
ds_read_b128 a[112:115], v234 offset:32768
ds_read_b128 a[116:119], v234 offset:33792
v_exp_f32 v65, v65
v_mfma_f32_16x16x32_bf16 v[148:151], a[132:135], a[152:155], v[148:151]
s_add_u32 m0, s53, 4096
s_mov_b32 s58, 81920
buffer_load_dwordx4 v216, s[28:31], s58 offen lds
v_mfma_f32_16x16x32_bf16 v[140:143], a[132:135], a[148:151], v[140:143]
ds_read_b128 a[120:123], v234 offset:34816
ds_read_b64_tr_b16 a[100:101], v231 offset:8192
v_exp_f32 v66, v66
v_mfma_f32_16x16x32_bf16 v[132:135], a[132:135], a[144:147], v[132:135]
ds_read_b64_tr_b16 a[102:103], v231 offset:10240
ds_read_b64_tr_b16 a[104:105], v232 offset:8192
v_exp_f32 v67, v67
v_mfma_f32_16x16x32_bf16 v[160:163], a[136:139], a[144:147], v[160:163]
ds_read_b64_tr_b16 a[106:107], v232 offset:10240
ds_read_b64_tr_b16 a[108:109], v233 offset:8192
v_mfma_f32_16x16x32_bf16 v[168:171], a[136:139], a[148:151], v[168:171]
buffer_load_dwordx4 v217, s[28:31], s58 offen offset:1024 lds
v_exp_f32 v68, v68
v_mfma_f32_16x16x32_bf16 v[176:179], a[136:139], a[152:155], v[176:179]
ds_read_b64_tr_b16 a[110:111], v233 offset:10240
v_exp_f32 v69, v69
v_mfma_f32_16x16x32_bf16 v[180:183], a[140:143], a[152:155], v[180:183]
buffer_load_dwordx4 v218, s[28:31], s58 offen offset:2048 lds
v_exp_f32 v70, v70
v_mfma_f32_16x16x32_bf16 v[172:175], a[140:143], a[148:151], v[172:175]
buffer_load_dwordx4 v219, s[28:31], s58 offen offset:3072 lds
v_mfma_f32_16x16x32_bf16 v[164:167], a[140:143], a[144:147], v[164:167]
v_exp_f32 v71, v71
v_cvt_pk_bf16_f32 v196, v64, v65
v_cvt_pk_bf16_f32 v197, v66, v67
s_waitcnt lgkmcnt(6)
v_mfma_f32_16x16x32_bf16 v[128:131], a[96:99], a[112:115], v[128:131]
s_waitcnt vmcnt(8)
ds_read_b64_tr_b16 a[128:129], v230 offset:12288
v_cvt_pk_bf16_f32 v198, v68, v69
v_mfma_f32_16x16x32_bf16 v[136:139], a[96:99], a[116:119], v[136:139]
ds_read_b64_tr_b16 a[130:131], v230 offset:14336
ds_read_b128 a[144:147], v234 offset:49152
v_cvt_pk_bf16_f32 v199, v70, v71
v_mfma_f32_16x16x32_bf16 v[144:147], a[96:99], a[120:123], v[144:147]
ds_read_b128 a[148:151], v234 offset:50176
ds_write_b128 v235, v[196:199] offset:8192
s_waitcnt lgkmcnt(5)
v_mfma_f32_16x16x32_bf16 v[148:151], a[100:103], a[120:123], v[148:151]
s_add_u32 m0, s53, 8192
s_mov_b32 s58, 49152
buffer_load_dwordx4 v216, s[28:31], s58 offen lds
v_mfma_f32_16x16x32_bf16 a[224:227], a[240:243], v[196:199], a[224:227]
v_fma_f32 v72, v72, s63, -v251
v_fma_f32 v73, v73, s63, -v251
v_fma_f32 v74, v74, s63, -v251
v_mfma_f32_16x16x32_bf16 v[140:143], a[100:103], a[116:119], v[140:143]
ds_read_b128 a[152:155], v234 offset:51200
ds_read_b64_tr_b16 a[132:133], v231 offset:12288
v_fma_f32 v75, v75, s63, -v251
v_mfma_f32_16x16x32_bf16 v[132:135], a[100:103], a[112:115], v[132:135]
ds_read_b64_tr_b16 a[134:135], v231 offset:14336
ds_read_b64_tr_b16 a[136:137], v232 offset:12288
v_fma_f32 v76, v76, s63, -v251
v_mfma_f32_16x16x32_bf16 v[160:163], a[104:107], a[112:115], v[160:163]
ds_read_b64_tr_b16 a[138:139], v232 offset:14336
ds_read_b64_tr_b16 a[140:141], v233 offset:12288
v_fma_f32 v77, v77, s63, -v251
v_fma_f32 v78, v78, s63, -v251
v_mfma_f32_16x16x32_bf16 v[168:171], a[104:107], a[116:119], v[168:171]
buffer_load_dwordx4 v217, s[28:31], s58 offen offset:1024 lds
v_fma_f32 v79, v79, s63, -v251
v_mfma_f32_16x16x32_bf16 v[176:179], a[104:107], a[120:123], v[176:179]
ds_read_b64_tr_b16 a[142:143], v233 offset:14336
v_exp_f32 v72, v72
v_mfma_f32_16x16x32_bf16 v[180:183], a[108:111], a[120:123], v[180:183]
buffer_load_dwordx4 v218, s[28:31], s58 offen offset:2048 lds
v_exp_f32 v73, v73
v_mfma_f32_16x16x32_bf16 v[172:175], a[108:111], a[116:119], v[172:175]
buffer_load_dwordx4 v219, s[28:31], s58 offen offset:3072 lds
v_mfma_f32_16x16x32_bf16 v[164:167], a[108:111], a[112:115], v[164:167]
v_exp_f32 v74, v74
s_waitcnt lgkmcnt(6)
v_mfma_f32_16x16x32_bf16 v[128:131], a[128:131], a[144:147], v[128:131]
s_barrier
v_exp_f32 v75, v75
v_mfma_f32_16x16x32_bf16 v[136:139], a[128:131], a[148:151], v[136:139]
s_waitcnt vmcnt(8)
ds_read_b64_tr_b16 a[96:97], v230 offset:0
v_exp_f32 v76, v76
v_mfma_f32_16x16x32_bf16 v[144:147], a[128:131], a[152:155], v[144:147]
ds_read_b64_tr_b16 a[98:99], v230 offset:2048
s_waitcnt lgkmcnt(2)
v_mfma_f32_16x16x32_bf16 v[148:151], a[132:135], a[152:155], v[148:151]
s_add_u32 m0, s53, 12288
s_mov_b32 s58, 114688
buffer_load_dwordx4 v216, s[28:31], s58 offen lds
v_exp_f32 v77, v77
v_mfma_f32_16x16x32_bf16 v[140:143], a[132:135], a[148:151], v[140:143]
ds_read_b128 a[112:115], v234 offset:4096
ds_read_b128 a[116:119], v234 offset:5120
v_exp_f32 v78, v78
v_mfma_f32_16x16x32_bf16 v[132:135], a[132:135], a[144:147], v[132:135]
ds_read_b128 a[120:123], v234 offset:6144
ds_read_b64_tr_b16 a[100:101], v231 offset:0
v_exp_f32 v79, v79
v_mfma_f32_16x16x32_bf16 v[160:163], a[136:139], a[144:147], v[160:163]
ds_read_b64_tr_b16 a[102:103], v231 offset:2048
ds_read_b64_tr_b16 a[104:105], v232 offset:0
v_cvt_pk_bf16_f32 v192, v72, v73
v_mfma_f32_16x16x32_bf16 v[168:171], a[136:139], a[148:151], v[168:171]
ds_read_b64_tr_b16 a[106:107], v232 offset:2048
ds_read_b64_tr_b16 a[108:109], v233 offset:0
v_cvt_pk_bf16_f32 v193, v74, v75
v_mfma_f32_16x16x32_bf16 v[176:179], a[136:139], a[152:155], v[176:179]
ds_read_b64_tr_b16 a[110:111], v233 offset:2048
buffer_load_dwordx4 v217, s[28:31], s58 offen offset:1024 lds
v_cvt_pk_bf16_f32 v194, v76, v77
v_cvt_pk_bf16_f32 v195, v78, v79
v_mfma_f32_16x16x32_bf16 v[180:183], a[140:143], a[152:155], v[180:183]
buffer_load_dwordx4 v218, s[28:31], s58 offen offset:2048 lds
v_mfma_f32_16x16x32_bf16 v[172:175], a[140:143], a[148:151], v[172:175]
ds_write_b128 v235, v[192:195] offset:9216
v_mfma_f32_16x16x32_bf16 a[228:231], a[240:243], v[192:195], a[228:231]
v_fma_f32 v80, v80, s63, -v252
v_fma_f32 v81, v81, s63, -v252
v_fma_f32 v82, v82, s63, -v252
v_fma_f32 v83, v83, s63, -v252
v_mfma_f32_16x16x32_bf16 v[164:167], a[140:143], a[144:147], v[164:167]
v_fma_f32 v84, v84, s63, -v252
v_fma_f32 v85, v85, s63, -v252
v_fma_f32 v86, v86, s63, -v252
s_waitcnt lgkmcnt(1)
v_mfma_f32_16x16x32_bf16 v[128:131], a[96:99], a[112:115], v[128:131]
buffer_load_dwordx4 v219, s[28:31], s58 offen offset:3072 lds
s_waitcnt vmcnt(8)
v_fma_f32 v87, v87, s63, -v252
v_mfma_f32_16x16x32_bf16 v[136:139], a[96:99], a[116:119], v[136:139]
ds_read_b64_tr_b16 a[128:129], v230 offset:4096
ds_read_b64_tr_b16 a[130:131], v230 offset:6144
v_mfma_f32_16x16x32_bf16 v[144:147], a[96:99], a[120:123], v[144:147]
ds_read_b128 a[144:147], v234 offset:20480
ds_read_b128 a[148:151], v234 offset:21504
v_exp_f32 v80, v80
v_mfma_f32_16x16x32_bf16 v[148:151], a[100:103], a[120:123], v[148:151]
s_add_u32 m0, s53, 0
s_mov_b32 s58, 32768
v_exp_f32 v81, v81
v_mfma_f32_16x16x32_bf16 v[140:143], a[100:103], a[116:119], v[140:143]
ds_read_b128 a[152:155], v234 offset:22528
ds_read_b64_tr_b16 a[132:133], v231 offset:4096
v_exp_f32 v82, v82
v_mfma_f32_16x16x32_bf16 v[132:135], a[100:103], a[112:115], v[132:135]
ds_read_b64_tr_b16 a[134:135], v231 offset:6144
ds_read_b64_tr_b16 a[136:137], v232 offset:4096
buffer_load_dwordx4 v216, s[28:31], s58 offen lds
v_mfma_f32_16x16x32_bf16 v[160:163], a[104:107], a[112:115], v[160:163]
ds_read_b64_tr_b16 a[138:139], v232 offset:6144
ds_read_b64_tr_b16 a[140:141], v233 offset:4096
v_exp_f32 v83, v83
v_mfma_f32_16x16x32_bf16 v[168:171], a[104:107], a[116:119], v[168:171]
buffer_load_dwordx4 v217, s[28:31], s58 offen offset:1024 lds
v_exp_f32 v84, v84
v_mfma_f32_16x16x32_bf16 v[176:179], a[104:107], a[120:123], v[176:179]
ds_read_b64_tr_b16 a[142:143], v233 offset:6144
v_exp_f32 v85, v85
v_mfma_f32_16x16x32_bf16 v[180:183], a[108:111], a[120:123], v[180:183]
buffer_load_dwordx4 v218, s[28:31], s58 offen offset:2048 lds
v_exp_f32 v86, v86
v_mfma_f32_16x16x32_bf16 v[172:175], a[108:111], a[116:119], v[172:175]
v_exp_f32 v87, v87
v_cvt_pk_bf16_f32 v196, v80, v81
v_mfma_f32_16x16x32_bf16 v[164:167], a[108:111], a[112:115], v[164:167]
v_cvt_pk_bf16_f32 v197, v82, v83
v_cvt_pk_bf16_f32 v198, v84, v85
s_waitcnt lgkmcnt(6)
v_mfma_f32_16x16x32_bf16 v[128:131], a[128:131], a[144:147], v[128:131]
ds_read_b64_tr_b16 a[96:97], v230 offset:16384
ds_read_b64_tr_b16 a[98:99], v230 offset:18432
v_cvt_pk_bf16_f32 v199, v86, v87
v_mfma_f32_16x16x32_bf16 v[136:139], a[128:131], a[148:151], v[136:139]
ds_read_b128 a[112:115], v234 offset:36864
ds_read_b128 a[116:119], v234 offset:37888
ds_write_b128 v235, v[196:199] offset:10240
v_mfma_f32_16x16x32_bf16 v[144:147], a[128:131], a[152:155], v[144:147]
ds_read_b128 a[120:123], v234 offset:38912
v_mfma_f32_16x16x32_bf16 a[232:235], a[240:243], v[196:199], a[232:235]
v_max3_f32 v242, v96, v97, v242
v_max3_f32 v243, v104, v105, v243
v_max3_f32 v244, v112, v113, v244
v_max3_f32 v242, v98, v99, v242
s_waitcnt lgkmcnt(6)
v_mfma_f32_16x16x32_bf16 v[148:151], a[132:135], a[152:155], v[148:151]
ds_read_b64_tr_b16 a[100:101], v231 offset:16384
ds_read_b64_tr_b16 a[102:103], v231 offset:18432
v_max3_f32 v243, v106, v107, v243
v_mfma_f32_16x16x32_bf16 v[140:143], a[132:135], a[148:151], v[140:143]
ds_read_b64_tr_b16 a[104:105], v232 offset:16384
ds_read_b64_tr_b16 a[106:107], v232 offset:18432
v_max3_f32 v244, v114, v115, v244
v_mfma_f32_16x16x32_bf16 v[132:135], a[132:135], a[144:147], v[132:135]
ds_read_b64_tr_b16 a[108:109], v233 offset:16384
v_max3_f32 v242, v100, v101, v242
v_max3_f32 v243, v108, v109, v243
v_max3_f32 v244, v116, v117, v244
v_mfma_f32_16x16x32_bf16 v[160:163], a[136:139], a[144:147], v[160:163]
ds_read_b64_tr_b16 a[110:111], v233 offset:18432
v_max3_f32 v242, v102, v103, v242
v_max3_f32 v243, v110, v111, v243
v_mfma_f32_16x16x32_bf16 v[168:171], a[136:139], a[148:151], v[168:171]
v_max3_f32 v244, v118, v119, v244
v_fma_f32 v96, v96, s63, -v250
v_fma_f32 v97, v97, s63, -v250
v_mfma_f32_16x16x32_bf16 v[176:179], a[136:139], a[152:155], v[176:179]
v_fma_f32 v98, v98, s63, -v250
v_fma_f32 v99, v99, s63, -v250
v_fma_f32 v100, v100, s63, -v250
v_fma_f32 v101, v101, s63, -v250
v_mfma_f32_16x16x32_bf16 v[180:183], a[140:143], a[152:155], v[180:183]
v_fma_f32 v102, v102, s63, -v250
v_fma_f32 v103, v103, s63, -v250
v_mfma_f32_16x16x32_bf16 v[172:175], a[140:143], a[148:151], v[172:175]
v_exp_f32 v96, v96
v_exp_f32 v97, v97
v_mfma_f32_16x16x32_bf16 v[164:167], a[140:143], a[144:147], v[164:167]
buffer_load_dwordx4 v219, s[28:31], s58 offen offset:3072 lds
v_exp_f32 v98, v98
s_waitcnt lgkmcnt(0)
v_mfma_f32_16x16x32_bf16 v[128:131], a[96:99], a[112:115], v[128:131]
ds_read_b64_tr_b16 a[128:129], v230 offset:20480
ds_read_b64_tr_b16 a[130:131], v230 offset:22528
v_mfma_f32_16x16x32_bf16 v[136:139], a[96:99], a[116:119], v[136:139]
ds_read_b128 a[144:147], v234 offset:53248
ds_read_b128 a[148:151], v234 offset:54272
v_exp_f32 v99, v99
v_mfma_f32_16x16x32_bf16 v[144:147], a[96:99], a[120:123], v[144:147]
ds_read_b128 a[152:155], v234 offset:55296
ds_read_b64_tr_b16 a[132:133], v231 offset:20480
v_mfma_f32_16x16x32_bf16 v[148:151], a[100:103], a[120:123], v[148:151]
s_add_u32 m0, s53, 4096
s_mov_b32 s58, 98304
v_exp_f32 v100, v100
v_mfma_f32_16x16x32_bf16 v[140:143], a[100:103], a[116:119], v[140:143]
ds_read_b64_tr_b16 a[134:135], v231 offset:22528
ds_read_b64_tr_b16 a[136:137], v232 offset:20480
buffer_load_dwordx4 v216, s[28:31], s58 offen lds
v_exp_f32 v101, v101
v_mfma_f32_16x16x32_bf16 v[132:135], a[100:103], a[112:115], v[132:135]
ds_read_b64_tr_b16 a[138:139], v232 offset:22528
ds_read_b64_tr_b16 a[140:141], v233 offset:20480
v_exp_f32 v102, v102
v_mfma_f32_16x16x32_bf16 v[160:163], a[104:107], a[112:115], v[160:163]
ds_read_b64_tr_b16 a[142:143], v233 offset:22528
v_exp_f32 v103, v103
v_mfma_f32_16x16x32_bf16 v[168:171], a[104:107], a[116:119], v[168:171]
buffer_load_dwordx4 v217, s[28:31], s58 offen offset:1024 lds
v_cvt_pk_bf16_f32 v192, v96, v97
v_mfma_f32_16x16x32_bf16 v[176:179], a[104:107], a[120:123], v[176:179]
buffer_load_dwordx4 v218, s[28:31], s58 offen offset:2048 lds
v_cvt_pk_bf16_f32 v193, v98, v99
v_cvt_pk_bf16_f32 v194, v100, v101
v_mfma_f32_16x16x32_bf16 v[180:183], a[108:111], a[120:123], v[180:183]
v_cvt_pk_bf16_f32 v195, v102, v103
ds_write_b128 v235, v[192:195] offset:12288
v_mfma_f32_16x16x32_bf16 v[172:175], a[108:111], a[116:119], v[172:175]
v_mfma_f32_16x16x32_bf16 a[224:227], a[240:243], v[192:195], a[224:227]
v_fma_f32 v104, v104, s63, -v251
v_fma_f32 v105, v105, s63, -v251
v_fma_f32 v106, v106, s63, -v251
v_mfma_f32_16x16x32_bf16 v[164:167], a[108:111], a[112:115], v[164:167]
v_fma_f32 v107, v107, s63, -v251
v_fma_f32 v108, v108, s63, -v251
v_fma_f32 v109, v109, s63, -v251
s_waitcnt lgkmcnt(1)
v_mfma_f32_16x16x32_bf16 v[128:131], a[128:131], a[144:147], v[128:131]
s_waitcnt lgkmcnt(0)
s_barrier
buffer_load_dwordx4 v219, s[28:31], s58 offen offset:3072 lds
v_fma_f32 v110, v110, s63, -v251
v_mfma_f32_16x16x32_bf16 v[136:139], a[128:131], a[148:151], v[136:139]
s_add_u32 m0, s53, 16384
s_mov_b32 s58, 163840
buffer_load_dwordx4 v216, s[28:31], s58 offen lds
buffer_load_dwordx4 v217, s[28:31], s58 offen offset:1024 lds
buffer_load_dwordx4 v218, s[28:31], s58 offen offset:2048 lds
buffer_load_dwordx4 v219, s[28:31], s58 offen offset:3072 lds
s_waitcnt vmcnt(8)
v_fma_f32 v111, v111, s63, -v251
v_mfma_f32_16x16x32_bf16 v[144:147], a[128:131], a[152:155], v[144:147]
ds_read_b64_tr_b16 a[96:97], v230 offset:0
ds_read_b64_tr_b16 a[98:99], v230 offset:2048
v_mfma_f32_16x16x32_bf16 v[148:151], a[132:135], a[152:155], v[148:151]
s_add_u32 m0, s53, 20480
s_mov_b32 s58, 229376
buffer_load_dwordx4 v216, s[28:31], s58 offen lds
v_exp_f32 v104, v104
v_mfma_f32_16x16x32_bf16 v[140:143], a[132:135], a[148:151], v[140:143]
ds_read_b128 a[112:115], v234 offset:8192
ds_read_b128 a[116:119], v234 offset:9216
v_exp_f32 v105, v105
v_mfma_f32_16x16x32_bf16 v[132:135], a[132:135], a[144:147], v[132:135]
ds_read_b128 a[120:123], v234 offset:10240
ds_read_b64_tr_b16 a[100:101], v231 offset:0
v_exp_f32 v106, v106
v_mfma_f32_16x16x32_bf16 v[160:163], a[136:139], a[144:147], v[160:163]
ds_read_b64_tr_b16 a[102:103], v231 offset:2048
ds_read_b64_tr_b16 a[104:105], v232 offset:0
v_mfma_f32_16x16x32_bf16 v[168:171], a[136:139], a[148:151], v[168:171]
ds_read_b64_tr_b16 a[106:107], v232 offset:2048
ds_read_b64_tr_b16 a[108:109], v233 offset:0
v_exp_f32 v107, v107
v_mfma_f32_16x16x32_bf16 v[176:179], a[136:139], a[152:155], v[176:179]
ds_read_b64_tr_b16 a[110:111], v233 offset:2048
buffer_load_dwordx4 v217, s[28:31], s58 offen offset:1024 lds
v_exp_f32 v108, v108
v_mfma_f32_16x16x32_bf16 v[180:183], a[140:143], a[152:155], v[180:183]
buffer_load_dwordx4 v218, s[28:31], s58 offen offset:2048 lds
v_mfma_f32_16x16x32_bf16 v[172:175], a[140:143], a[148:151], v[172:175]
v_exp_f32 v109, v109
v_exp_f32 v110, v110
v_mfma_f32_16x16x32_bf16 v[164:167], a[140:143], a[144:147], v[164:167]
v_exp_f32 v111, v111
v_cvt_pk_bf16_f32 v196, v104, v105
s_waitcnt lgkmcnt(6)
v_mfma_f32_16x16x32_bf16 v[128:131], a[96:99], a[112:115], v[128:131]
buffer_load_dwordx4 v219, s[28:31], s58 offen offset:3072 lds
s_waitcnt vmcnt(8)
v_cvt_pk_bf16_f32 v197, v106, v107
v_cvt_pk_bf16_f32 v198, v108, v109
v_mfma_f32_16x16x32_bf16 v[136:139], a[96:99], a[116:119], v[136:139]
ds_read_b64_tr_b16 a[128:129], v230 offset:4096
ds_read_b64_tr_b16 a[130:131], v230 offset:6144
v_cvt_pk_bf16_f32 v199, v110, v111
v_mfma_f32_16x16x32_bf16 v[144:147], a[96:99], a[120:123], v[144:147]
ds_read_b128 a[144:147], v234 offset:24576
s_waitcnt lgkmcnt(3)
v_mfma_f32_16x16x32_bf16 v[148:151], a[100:103], a[120:123], v[148:151]
s_add_u32 m0, s53, 0
s_add_u32 s58, s4, 0
ds_write_b128 v235, v[196:199] offset:13312
v_mfma_f32_16x16x32_bf16 a[228:231], a[240:243], v[196:199], a[228:231]
v_fma_f32 v112, v112, s63, -v252
v_fma_f32 v113, v113, s63, -v252
v_fma_f32 v114, v114, s63, -v252
v_mfma_f32_16x16x32_bf16 v[140:143], a[100:103], a[116:119], v[140:143]
ds_read_b128 a[148:151], v234 offset:25600
ds_read_b128 a[152:155], v234 offset:26624
buffer_load_dwordx4 v220, s[36:39], s58 offen lds
v_fma_f32 v115, v115, s63, -v252
v_mfma_f32_16x16x32_bf16 v[132:135], a[100:103], a[112:115], v[132:135]
ds_read_b64_tr_b16 a[132:133], v231 offset:4096
ds_read_b64_tr_b16 a[134:135], v231 offset:6144
v_fma_f32 v116, v116, s63, -v252
v_fma_f32 v117, v117, s63, -v252
v_mfma_f32_16x16x32_bf16 v[160:163], a[104:107], a[112:115], v[160:163]
ds_read_b64_tr_b16 a[136:137], v232 offset:4096
ds_read_b64_tr_b16 a[138:139], v232 offset:6144
v_fma_f32 v118, v118, s63, -v252
v_mfma_f32_16x16x32_bf16 v[168:171], a[104:107], a[116:119], v[168:171]
buffer_load_dwordx4 v221, s[36:39], s58 offen offset:1024 lds
v_fma_f32 v119, v119, s63, -v252
v_mfma_f32_16x16x32_bf16 v[176:179], a[104:107], a[120:123], v[176:179]
ds_read_b64_tr_b16 a[140:141], v233 offset:4096
ds_read_b64_tr_b16 a[142:143], v233 offset:6144
v_exp_f32 v112, v112
v_mfma_f32_16x16x32_bf16 v[180:183], a[108:111], a[120:123], v[180:183]
buffer_load_dwordx4 v222, s[36:39], s58 offen offset:2048 lds
v_exp_f32 v113, v113
v_mfma_f32_16x16x32_bf16 v[172:175], a[108:111], a[116:119], v[172:175]
buffer_load_dwordx4 v223, s[36:39], s58 offen offset:3072 lds
v_mfma_f32_16x16x32_bf16 v[164:167], a[108:111], a[112:115], v[164:167]
v_exp_f32 v114, v114
v_exp_f32 v115, v115
s_waitcnt lgkmcnt(6)
v_mfma_f32_16x16x32_bf16 v[128:131], a[128:131], a[144:147], v[128:131]
s_waitcnt vmcnt(8)
ds_read_b64_tr_b16 a[96:97], v230 offset:16384
v_mfma_f32_16x16x32_bf16 v[136:139], a[128:131], a[148:151], v[136:139]
ds_read_b64_tr_b16 a[98:99], v230 offset:18432
ds_read_b128 a[112:115], v234 offset:40960
v_exp_f32 v116, v116
v_mfma_f32_16x16x32_bf16 v[144:147], a[128:131], a[152:155], v[144:147]
ds_read_b128 a[116:119], v234 offset:41984
v_exp_f32 v117, v117
s_waitcnt lgkmcnt(4)
v_mfma_f32_16x16x32_bf16 v[148:151], a[132:135], a[152:155], v[148:151]
s_add_u32 m0, s53, 4096
s_add_u32 s58, s4, 28672
buffer_load_dwordx4 v220, s[36:39], s58 offen lds
v_exp_f32 v118, v118
v_mfma_f32_16x16x32_bf16 v[140:143], a[132:135], a[148:151], v[140:143]
ds_read_b128 a[120:123], v234 offset:43008
ds_read_b64_tr_b16 a[100:101], v231 offset:16384
v_exp_f32 v119, v119
v_mfma_f32_16x16x32_bf16 v[132:135], a[132:135], a[144:147], v[132:135]
ds_read_b64_tr_b16 a[102:103], v231 offset:18432
ds_read_b64_tr_b16 a[104:105], v232 offset:16384
v_cvt_pk_bf16_f32 v192, v112, v113
v_mfma_f32_16x16x32_bf16 v[160:163], a[136:139], a[144:147], v[160:163]
ds_read_b64_tr_b16 a[106:107], v232 offset:18432
ds_read_b64_tr_b16 a[108:109], v233 offset:16384
v_cvt_pk_bf16_f32 v193, v114, v115
v_cvt_pk_bf16_f32 v194, v116, v117
v_mfma_f32_16x16x32_bf16 v[168:171], a[136:139], a[148:151], v[168:171]
buffer_load_dwordx4 v221, s[36:39], s58 offen offset:1024 lds
v_cvt_pk_bf16_f32 v195, v118, v119
v_mfma_f32_16x16x32_bf16 v[176:179], a[136:139], a[152:155], v[176:179]
ds_read_b64_tr_b16 a[110:111], v233 offset:18432
ds_write_b128 v235, v[192:195] offset:14336
v_mfma_f32_16x16x32_bf16 a[232:235], a[240:243], v[192:195], a[232:235]
v_mov_b32 v200, v242
v_mov_b32 v201, v243
v_mov_b32 v202, v244
v_mov_b32 v203, v244
v_mfma_f32_16x16x32_bf16 v[180:183], a[140:143], a[152:155], v[180:183]
buffer_load_dwordx4 v222, s[36:39], s58 offen offset:2048 lds
v_mfma_f32_16x16x32_bf16 v[172:175], a[140:143], a[148:151], v[172:175]
v_permlane32_swap_b32 v200, v202
v_permlane32_swap_b32 v201, v203
v_max_f32 v200, v200, v202
v_max_f32 v201, v201, v203
v_mfma_f32_16x16x32_bf16 v[164:167], a[140:143], a[144:147], v[164:167]
s_waitcnt lgkmcnt(7)
v_mfma_f32_16x16x32_bf16 v[128:131], a[96:99], a[112:115], v[128:131]
buffer_load_dwordx4 v223, s[36:39], s58 offen offset:3072 lds
s_waitcnt vmcnt(8)
v_permlane16_swap_b32 v200, v201
v_mfma_f32_16x16x32_bf16 v[136:139], a[96:99], a[116:119], v[136:139]
ds_read_b64_tr_b16 a[128:129], v230 offset:20480
ds_read_b64_tr_b16 a[130:131], v230 offset:22528
v_max_f32 v200, v200, v201
v_mfma_f32_16x16x32_bf16 v[144:147], a[96:99], a[120:123], v[144:147]
ds_read_b128 a[144:147], v234 offset:57344
ds_write_b32 v239, v200 offset:1024
ds_write_b32 v239, v200 offset:17408
s_waitcnt lgkmcnt(6)
v_mfma_f32_16x16x32_bf16 v[148:151], a[100:103], a[120:123], v[148:151]
s_add_u32 m0, s53, 16384
s_mov_b32 s58, 180224
ds_write_b32 v239, v200 offset:33792
ds_write_b32 v239, v200 offset:50176
v_mfma_f32_16x16x32_bf16 v[140:143], a[100:103], a[116:119], v[140:143]
ds_read_b128 a[148:151], v234 offset:58368
ds_read_b128 a[152:155], v234 offset:59392
v_and_b32 v239, -16, v239
v_mfma_f32_16x16x32_bf16 v[132:135], a[100:103], a[112:115], v[132:135]
ds_read_b64_tr_b16 a[132:133], v231 offset:20480
ds_read_b64_tr_b16 a[134:135], v231 offset:22528
buffer_load_dwordx4 v216, s[28:31], s58 offen lds
v_mfma_f32_16x16x32_bf16 v[160:163], a[104:107], a[112:115], v[160:163]
ds_read_b64_tr_b16 a[136:137], v232 offset:20480
ds_read_b64_tr_b16 a[138:139], v232 offset:22528
v_accvgpr_read_b32 v246, a224
v_accvgpr_read_b32 v247, a228
v_accvgpr_read_b32 v248, a232
v_mfma_f32_16x16x32_bf16 v[168:171], a[104:107], a[116:119], v[168:171]
buffer_load_dwordx4 v217, s[28:31], s58 offen offset:1024 lds
ds_write_b128 v239, v[246:249] offset:0
v_mfma_f32_16x16x32_bf16 v[176:179], a[104:107], a[120:123], v[176:179]
ds_read_b64_tr_b16 a[140:141], v233 offset:20480
ds_read_b64_tr_b16 a[142:143], v233 offset:22528
v_mfma_f32_16x16x32_bf16 v[180:183], a[108:111], a[120:123], v[180:183]
buffer_load_dwordx4 v218, s[28:31], s58 offen offset:2048 lds
ds_write_b128 v239, v[246:249] offset:16384
v_mfma_f32_16x16x32_bf16 v[172:175], a[108:111], a[116:119], v[172:175]
v_mfma_f32_16x16x32_bf16 v[164:167], a[108:111], a[112:115], v[164:167]
s_waitcnt lgkmcnt(8)
v_mfma_f32_16x16x32_bf16 v[128:131], a[128:131], a[144:147], v[128:131]
ds_write_b128 v239, v[246:249] offset:32768
ds_write_b128 v239, v[246:249] offset:49152
s_waitcnt lgkmcnt(0)
s_barrier
v_mfma_f32_16x16x32_bf16 v[136:139], a[128:131], a[148:151], v[136:139]
ds_read_b64_tr_b16 a[96:97], v230 offset:8192
ds_read_b64_tr_b16 a[98:99], v230 offset:10240
ds_read_b128 v[192:195], v240 offset:1024
ds_read_b128 v[196:199], v240 offset:1280
ds_read_b128 v[200:203], v240 offset:1536
ds_read_b128 v[204:207], v240 offset:1792
v_mfma_f32_16x16x32_bf16 v[144:147], a[128:131], a[152:155], v[144:147]
ds_read_b128 a[112:115], v234 offset:12288
ds_read_b128 a[116:119], v234 offset:13312
v_mfma_f32_16x16x32_bf16 v[148:151], a[132:135], a[152:155], v[148:151]
ds_read_b128 a[120:123], v234 offset:14336
ds_read_b64_tr_b16 a[100:101], v231 offset:8192
v_mfma_f32_16x16x32_bf16 v[140:143], a[132:135], a[148:151], v[140:143]
ds_read_b64_tr_b16 a[102:103], v231 offset:10240
ds_read_b64_tr_b16 a[104:105], v232 offset:8192
v_mfma_f32_16x16x32_bf16 v[132:135], a[132:135], a[144:147], v[132:135]
ds_read_b64_tr_b16 a[106:107], v232 offset:10240
ds_read_b64_tr_b16 a[108:109], v233 offset:8192
v_mfma_f32_16x16x32_bf16 v[160:163], a[136:139], a[144:147], v[160:163]
ds_read_b64_tr_b16 a[110:111], v233 offset:10240
v_mfma_f32_16x16x32_bf16 v[168:171], a[136:139], a[148:151], v[168:171]
v_mfma_f32_16x16x32_bf16 v[176:179], a[136:139], a[152:155], v[176:179]
s_waitcnt lgkmcnt(9)
v_max3_f32 v242, v192, v196, v200
v_max3_f32 v243, v193, v197, v201
v_mfma_f32_16x16x32_bf16 v[180:183], a[140:143], a[152:155], v[180:183]
buffer_load_dwordx4 v219, s[28:31], s58 offen offset:3072 lds
v_max3_f32 v244, v194, v198, v202
v_mfma_f32_16x16x32_bf16 v[172:175], a[140:143], a[148:151], v[172:175]
s_add_u32 m0, s53, 20480
s_mov_b32 s58, 245760
v_max_f32 v242, v242, v204
v_mfma_f32_16x16x32_bf16 v[164:167], a[140:143], a[144:147], v[164:167]
v_max_f32 v243, v243, v205
v_max_f32 v244, v244, v206
s_waitcnt lgkmcnt(0)
v_mfma_f32_16x16x32_bf16 v[128:131], a[96:99], a[112:115], v[128:131]
ds_read_b64_tr_b16 a[128:129], v230 offset:12288
ds_read_b64_tr_b16 a[130:131], v230 offset:14336
v_mfma_f32_16x16x32_bf16 v[136:139], a[96:99], a[116:119], v[136:139]
ds_read_b128 a[144:147], v234 offset:28672
ds_read_b128 a[148:151], v234 offset:29696
ds_read_b128 v[192:195], v240 offset:0
ds_read_b128 v[196:199], v240 offset:256
ds_read_b128 v[200:203], v240 offset:512
ds_read_b128 v[204:207], v240 offset:768
v_fma_f32 v250, v242, s63, -v250
v_mfma_f32_16x16x32_bf16 v[144:147], a[96:99], a[120:123], v[144:147]
ds_read_b128 a[152:155], v234 offset:30720
ds_read_b64_tr_b16 a[132:133], v231 offset:12288
buffer_load_dwordx4 v216, s[28:31], s58 offen lds
v_fma_f32 v251, v243, s63, -v251
v_mfma_f32_16x16x32_bf16 v[148:151], a[100:103], a[120:123], v[148:151]
buffer_load_dwordx4 v217, s[28:31], s58 offen offset:1024 lds
v_fma_f32 v252, v244, s63, -v252
v_mfma_f32_16x16x32_bf16 v[140:143], a[100:103], a[116:119], v[140:143]
ds_read_b64_tr_b16 a[134:135], v231 offset:14336
ds_read_b64_tr_b16 a[136:137], v232 offset:12288
v_max3_f32 v250, v250, v251, v252
v_mfma_f32_16x16x32_bf16 v[132:135], a[100:103], a[112:115], v[132:135]
ds_read_b64_tr_b16 a[138:139], v232 offset:14336
ds_read_b64_tr_b16 a[140:141], v233 offset:12288
v_cmp_lt_f32 vcc, 0x41400000, v250
v_mfma_f32_16x16x32_bf16 v[160:163], a[104:107], a[112:115], v[160:163]
ds_read_b64_tr_b16 a[142:143], v233 offset:14336
v_mfma_f32_16x16x32_bf16 v[168:171], a[104:107], a[116:119], v[168:171]
buffer_load_dwordx4 v218, s[28:31], s58 offen offset:2048 lds
s_cbranch_vccnz L_fb1
v_mfma_f32_16x16x32_bf16 v[176:179], a[104:107], a[120:123], v[176:179]
v_mfma_f32_16x16x32_bf16 v[180:183], a[108:111], a[120:123], v[180:183]
buffer_load_dwordx4 v219, s[28:31], s58 offen offset:3072 lds
v_mfma_f32_16x16x32_bf16 v[172:175], a[108:111], a[116:119], v[172:175]
s_add_u32 m0, s53, 8192
s_add_u32 s58, s5, 0
s_waitcnt lgkmcnt(7)
v_mfma_f32_16x16x32_bf16 v[164:167], a[108:111], a[112:115], v[164:167]
v_add_f32 v192, v192, v196
v_add_f32 v193, v193, v197
s_waitcnt lgkmcnt(0)
v_mfma_f32_16x16x32_bf16 v[128:131], a[128:131], a[144:147], v[128:131]
buffer_load_dwordx4 v220, s[36:39], s58 offen lds
buffer_load_dwordx4 v221, s[36:39], s58 offen offset:1024 lds
buffer_load_dwordx4 v222, s[36:39], s58 offen offset:2048 lds
buffer_load_dwordx4 v223, s[36:39], s58 offen offset:3072 lds
s_add_u32 m0, s53, 12288
s_add_u32 s58, s5, 28672
buffer_load_dwordx4 v220, s[36:39], s58 offen lds
buffer_load_dwordx4 v221, s[36:39], s58 offen offset:1024 lds
buffer_load_dwordx4 v222, s[36:39], s58 offen offset:2048 lds
buffer_load_dwordx4 v223, s[36:39], s58 offen offset:3072 lds
s_waitcnt vmcnt(8)
v_add_f32 v194, v194, v198
v_add_f32 v200, v200, v204
v_mfma_f32_16x16x32_bf16 v[136:139], a[128:131], a[148:151], v[136:139]
ds_read_b64_tr_b16 a[96:97], v230 offset:16384
ds_read_b64_tr_b16 a[98:99], v230 offset:18432
v_add_f32 v201, v201, v205
v_mfma_f32_16x16x32_bf16 v[144:147], a[128:131], a[152:155], v[144:147]
ds_read_b128 a[160:163], v234 offset:45056
ds_read_b128 a[164:167], v234 offset:46080
v_add_f32 v202, v202, v206
v_add_f32 v192, v192, v200
v_mfma_f32_16x16x32_bf16 v[148:151], a[132:135], a[152:155], v[148:151]
ds_read_b128 a[168:171], v234 offset:47104
ds_read_b64_tr_b16 a[100:101], v231 offset:16384
v_add_f32 v193, v193, v201
v_mfma_f32_16x16x32_bf16 v[140:143], a[132:135], a[148:151], v[140:143]
ds_read_b64_tr_b16 a[102:103], v231 offset:18432
ds_read_b64_tr_b16 a[104:105], v230 offset:20480
v_add_f32 v194, v194, v202
v_mfma_f32_16x16x32_bf16 v[132:135], a[132:135], a[144:147], v[132:135]
ds_read_b64_tr_b16 a[106:107], v230 offset:22528
ds_read_b128 a[176:179], v234 offset:61440
v_rcp_f32 v246, v192
v_mfma_f32_16x16x32_bf16 v[160:163], a[136:139], a[144:147], v[160:163]
ds_read_b128 a[180:183], v234 offset:62464
ds_read_b128 a[184:187], v234 offset:63488
v_rcp_f32 v247, v193
v_mfma_f32_16x16x32_bf16 v[168:171], a[136:139], a[148:151], v[168:171]
ds_read_b64_tr_b16 a[108:109], v231 offset:20480
ds_read_b64_tr_b16 a[110:111], v231 offset:22528
v_mfma_f32_16x16x32_bf16 v[176:179], a[136:139], a[152:155], v[176:179]
v_rcp_f32 v248, v194
v_mfma_f32_16x16x32_bf16 v[180:183], a[140:143], a[152:155], v[180:183]
v_mfma_f32_16x16x32_bf16 v[172:175], a[140:143], a[148:151], v[172:175]
v_mfma_f32_16x16x32_bf16 v[164:167], a[140:143], a[144:147], v[164:167]
s_waitcnt lgkmcnt(9)
v_mfma_f32_16x16x32_bf16 v[128:131], a[96:99], a[160:163], v[128:131]
ds_read_b64_tr_b16 a[128:129], v232 offset:16384
ds_read_b64_tr_b16 a[130:131], v232 offset:18432
v_mfma_f32_16x16x32_bf16 v[136:139], a[96:99], a[164:167], v[136:139]
ds_read_b64_tr_b16 a[132:133], v233 offset:16384
ds_read_b64_tr_b16 a[134:135], v233 offset:18432
v_mfma_f32_16x16x32_bf16 v[144:147], a[96:99], a[168:171], v[144:147]
ds_read_b64_tr_b16 a[136:137], v232 offset:20480
s_waitcnt lgkmcnt(5)
v_mfma_f32_16x16x32_bf16 v[148:151], a[100:103], a[168:171], v[148:151]
ds_read_b64_tr_b16 a[138:139], v232 offset:22528
v_mfma_f32_16x16x32_bf16 v[140:143], a[100:103], a[164:167], v[140:143]
ds_read_b64_tr_b16 a[140:141], v233 offset:20480
v_mfma_f32_16x16x32_bf16 v[132:135], a[100:103], a[160:163], v[132:135]
ds_read_b64_tr_b16 a[142:143], v233 offset:22528
v_mfma_f32_16x16x32_bf16 v[128:131], a[104:107], a[176:179], v[128:131]
v_mfma_f32_16x16x32_bf16 v[136:139], a[104:107], a[180:183], v[136:139]
v_mfma_f32_16x16x32_bf16 v[144:147], a[104:107], a[184:187], v[144:147]
v_mfma_f32_16x16x32_bf16 v[148:151], a[108:111], a[184:187], v[148:151]
v_mfma_f32_16x16x32_bf16 v[140:143], a[108:111], a[180:183], v[140:143]
v_mfma_f32_16x16x32_bf16 v[132:135], a[108:111], a[176:179], v[132:135]
s_waitcnt lgkmcnt(0)
v_mfma_f32_16x16x32_bf16 v[160:163], a[128:131], a[160:163], v[160:163]
ds_read_b64_tr_b16 a[96:97], v230 offset:0
ds_read_b64_tr_b16 a[98:99], v230 offset:2048
v_mfma_f32_16x16x32_bf16 v[168:171], a[128:131], a[164:167], v[168:171]
ds_read_b64_tr_b16 a[100:101], v231 offset:0
ds_read_b64_tr_b16 a[102:103], v231 offset:2048
v_mfma_f32_16x16x32_bf16 v[176:179], a[128:131], a[168:171], v[176:179]
ds_read_b64_tr_b16 a[104:105], v232 offset:0
s_add_u32 m0, s53, 16384
v_mul_f32 v128, v128, v246
v_mul_f32 v129, v129, v246
v_mul_f32 v130, v130, v246
v_mul_f32 v131, v131, v246
v_mfma_f32_16x16x32_bf16 v[180:183], a[132:135], a[168:171], v[180:183]
s_add_u32 s58, s6, 0
buffer_load_dwordx4 v220, s[36:39], s58 offen lds
v_mul_f32 v132, v132, v246
v_mul_f32 v133, v133, v246
v_mul_f32 v134, v134, v246
v_mul_f32 v135, v135, v246
v_mfma_f32_16x16x32_bf16 v[172:175], a[132:135], a[164:167], v[172:175]
ds_read_b64_tr_b16 a[106:107], v232 offset:2048
ds_read_b64_tr_b16 a[108:109], v233 offset:0
v_cvt_pk_bf16_f32 v128, v128, v129
v_cvt_pk_bf16_f32 v129, v130, v131
v_cvt_pk_bf16_f32 v130, v132, v133
v_cvt_pk_bf16_f32 v131, v134, v135
v_mfma_f32_16x16x32_bf16 v[164:167], a[132:135], a[160:163], v[164:167]
ds_read_b64_tr_b16 a[110:111], v233 offset:2048
ds_write_b128 v235, v[128:131] offset:0
v_mul_f32 v136, v136, v247
v_mul_f32 v137, v137, v247
v_mul_f32 v138, v138, v247
v_mul_f32 v139, v139, v247
v_mul_f32 v140, v140, v247
v_mfma_f32_16x16x32_bf16 v[160:163], a[136:139], a[176:179], v[160:163]
buffer_load_dwordx4 v221, s[36:39], s58 offen offset:1024 lds
v_mul_f32 v141, v141, v247
v_mul_f32 v142, v142, v247
v_mul_f32 v143, v143, v247
v_cvt_pk_bf16_f32 v136, v136, v137
v_cvt_pk_bf16_f32 v137, v138, v139
v_mfma_f32_16x16x32_bf16 v[168:171], a[136:139], a[180:183], v[168:171]
buffer_load_dwordx4 v222, s[36:39], s58 offen offset:2048 lds
v_cvt_pk_bf16_f32 v138, v140, v141
v_cvt_pk_bf16_f32 v139, v142, v143
ds_write_b128 v235, v[136:139] offset:1024
v_mfma_f32_16x16x32_bf16 v[176:179], a[136:139], a[184:187], v[176:179]
buffer_load_dwordx4 v223, s[36:39], s58 offen offset:3072 lds
v_mul_f32 v144, v144, v248
v_mul_f32 v145, v145, v248
v_mul_f32 v146, v146, v248
v_mul_f32 v147, v147, v248
v_mul_f32 v148, v148, v248
v_mul_f32 v149, v149, v248
v_mfma_f32_16x16x32_bf16 v[180:183], a[140:143], a[184:187], v[180:183]
s_add_u32 m0, s53, 20480
s_add_u32 s58, s6, 28672
v_mul_f32 v150, v150, v248
v_mul_f32 v151, v151, v248
v_cvt_pk_bf16_f32 v144, v144, v145
v_cvt_pk_bf16_f32 v145, v146, v147
v_cvt_pk_bf16_f32 v146, v148, v149
v_mfma_f32_16x16x32_bf16 v[172:175], a[140:143], a[180:183], v[172:175]
buffer_load_dwordx4 v220, s[36:39], s58 offen lds
v_cvt_pk_bf16_f32 v147, v150, v151
ds_write_b128 v235, v[144:147] offset:2048
v_mfma_f32_16x16x32_bf16 v[164:167], a[140:143], a[176:179], v[164:167]
s_waitcnt lgkmcnt(3)
v_mfma_f32_16x16x32_bf16 v[0:3], a[96:99], v[128:131], 0
ds_read_b64_tr_b16 a[128:129], v230 offset:4096
ds_read_b64_tr_b16 a[130:131], v230 offset:6144
v_mfma_f32_16x16x32_bf16 v[8:11], a[96:99], v[136:139], 0
ds_read_b64_tr_b16 a[132:133], v231 offset:4096
ds_read_b64_tr_b16 a[134:135], v231 offset:6144
v_mfma_f32_16x16x32_bf16 v[16:19], a[96:99], v[144:147], 0
ds_read_b64_tr_b16 a[136:137], v232 offset:4096
v_mul_f32 v160, v160, v246
v_mul_f32 v161, v161, v246
v_mul_f32 v162, v162, v246
v_mul_f32 v163, v163, v246
v_mul_f32 v164, v164, v246
v_mfma_f32_16x16x32_bf16 v[20:23], a[100:103], v[144:147], 0
buffer_load_dwordx4 v221, s[36:39], s58 offen offset:1024 lds
v_mul_f32 v165, v165, v246
v_mul_f32 v166, v166, v246
v_mul_f32 v167, v167, v246
v_cvt_pk_bf16_f32 v160, v160, v161
v_mfma_f32_16x16x32_bf16 v[12:15], a[100:103], v[136:139], 0
ds_read_b64_tr_b16 a[138:139], v232 offset:6144
ds_read_b64_tr_b16 a[140:141], v233 offset:4096
v_cvt_pk_bf16_f32 v161, v162, v163
v_cvt_pk_bf16_f32 v162, v164, v165
v_cvt_pk_bf16_f32 v163, v166, v167
ds_write_b128 v235, v[160:163] offset:4096
v_mfma_f32_16x16x32_bf16 v[4:7], a[100:103], v[128:131], 0
ds_read_b64_tr_b16 a[142:143], v233 offset:6144
v_mul_f32 v168, v168, v247
v_mul_f32 v169, v169, v247
v_mul_f32 v170, v170, v247
v_mul_f32 v171, v171, v247
v_mul_f32 v172, v172, v247
v_mfma_f32_16x16x32_bf16 v[32:35], a[104:107], v[128:131], 0
buffer_load_dwordx4 v222, s[36:39], s58 offen offset:2048 lds
v_mul_f32 v173, v173, v247
v_mul_f32 v174, v174, v247
v_mul_f32 v175, v175, v247
v_cvt_pk_bf16_f32 v168, v168, v169
v_cvt_pk_bf16_f32 v169, v170, v171
v_mfma_f32_16x16x32_bf16 v[40:43], a[104:107], v[136:139], 0
buffer_load_dwordx4 v223, s[36:39], s58 offen offset:3072 lds
v_cvt_pk_bf16_f32 v170, v172, v173
v_cvt_pk_bf16_f32 v171, v174, v175
ds_write_b128 v235, v[168:171] offset:5120
v_mfma_f32_16x16x32_bf16 v[48:51], a[104:107], v[144:147], 0
s_add_u32 m0, s53, 0
s_add_u32 s58, s7, 0
v_mul_f32 v176, v176, v248
v_mul_f32 v177, v177, v248
v_mul_f32 v178, v178, v248
v_mul_f32 v179, v179, v248
v_mul_f32 v180, v180, v248
v_mul_f32 v181, v181, v248
v_mfma_f32_16x16x32_bf16 v[52:55], a[108:111], v[144:147], 0
buffer_load_dwordx4 v220, s[36:39], s58 offen lds
v_mul_f32 v182, v182, v248
v_mul_f32 v183, v183, v248
v_cvt_pk_bf16_f32 v176, v176, v177
v_cvt_pk_bf16_f32 v177, v178, v179
v_cvt_pk_bf16_f32 v178, v180, v181
v_mfma_f32_16x16x32_bf16 v[44:47], a[108:111], v[136:139], 0
buffer_load_dwordx4 v221, s[36:39], s58 offen offset:1024 lds
v_cvt_pk_bf16_f32 v179, v182, v183
v_mfma_f32_16x16x32_bf16 v[36:39], a[108:111], v[128:131], 0
s_waitcnt lgkmcnt(1)
v_mfma_f32_16x16x32_bf16 v[0:3], a[128:131], v[160:163], v[0:3]
s_waitcnt vmcnt(14)
ds_read_b64_tr_b16 a[96:97], v230 offset:8192
v_mfma_f32_16x16x32_bf16 v[8:11], a[128:131], v[168:171], v[8:11]
ds_read_b64_tr_b16 a[98:99], v230 offset:10240
ds_write_b128 v235, v[176:179] offset:6144
v_mfma_f32_16x16x32_bf16 v[16:19], a[128:131], v[176:179], v[16:19]
ds_read_b64_tr_b16 a[100:101], v231 offset:8192
v_mfma_f32_16x16x32_bf16 v[20:23], a[132:135], v[176:179], v[20:23]
buffer_load_dwordx4 v222, s[36:39], s58 offen offset:2048 lds
v_mfma_f32_16x16x32_bf16 v[12:15], a[132:135], v[168:171], v[12:15]
ds_read_b64_tr_b16 a[102:103], v231 offset:10240
ds_read_b64_tr_b16 a[104:105], v232 offset:8192
v_mfma_f32_16x16x32_bf16 v[4:7], a[132:135], v[160:163], v[4:7]
ds_read_b64_tr_b16 a[106:107], v232 offset:10240
ds_read_b64_tr_b16 a[108:109], v233 offset:8192
s_waitcnt lgkmcnt(5)
s_barrier
ds_read_b128 a[0:3], v236 offset:0
ds_read_b128 a[4:7], v236 offset:1024
ds_read_b128 a[8:11], v236 offset:2048
v_mfma_f32_16x16x32_bf16 v[32:35], a[136:139], v[160:163], v[32:35]
ds_read_b64_tr_b16 a[110:111], v233 offset:10240
buffer_load_dwordx4 v223, s[36:39], s58 offen offset:3072 lds
v_mfma_f32_16x16x32_bf16 v[40:43], a[136:139], v[168:171], v[40:43]
s_add_u32 m0, s53, 4096
s_add_u32 s58, s7, 28672
v_lshrrev_b32 v219, 4, v234
v_mfma_f32_16x16x32_bf16 v[48:51], a[136:139], v[176:179], v[48:51]
buffer_load_dwordx4 v220, s[36:39], s58 offen lds
v_lshlrev_b32 v208, 8, v219
v_mfma_f32_16x16x32_bf16 v[52:55], a[140:143], v[176:179], v[52:55]
buffer_load_dwordx4 v221, s[36:39], s58 offen offset:1024 lds
v_mfma_f32_16x16x32_bf16 v[44:47], a[140:143], v[168:171], v[44:47]
s_lshl_b32 s59, s52, 10
s_lshl_b32 s60, s67, 2
s_add_u32 s59, s59, s60
v_mfma_f32_16x16x32_bf16 v[36:39], a[140:143], v[160:163], v[36:39]
v_add_u32 v208, s59, v208
s_waitcnt lgkmcnt(3)
v_mfma_f32_16x16x32_bf16 v[0:3], a[96:99], a[0:3], v[0:3]
s_waitcnt vmcnt(14)
ds_read_b64_tr_b16 a[128:129], v230 offset:12288
v_cmp_gt_u32 vcc, 4, v219
s_waitcnt lgkmcnt(3)
v_mfma_f32_16x16x32_bf16 v[8:11], a[96:99], a[4:7], v[8:11]
ds_read_b64_tr_b16 a[130:131], v230 offset:14336
ds_read_b128 a[16:19], v236 offset:4096
s_waitcnt lgkmcnt(4)
v_mfma_f32_16x16x32_bf16 v[16:19], a[96:99], a[8:11], v[16:19]
ds_read_b128 a[20:23], v236 offset:5120
v_mov_b32 v224, 0x40000000
v_mfma_f32_16x16x32_bf16 v[20:23], a[100:103], a[8:11], v[20:23]
buffer_load_dwordx4 v222, s[36:39], s58 offen offset:2048 lds
v_mfma_f32_16x16x32_bf16 v[12:15], a[100:103], a[4:7], v[12:15]
ds_read_b128 a[24:27], v236 offset:6144
ds_read_b64_tr_b16 a[132:133], v231 offset:12288
v_mov_b32 v209, 1
v_mfma_f32_16x16x32_bf16 v[4:7], a[100:103], a[0:3], v[4:7]
ds_read_b64_tr_b16 a[134:135], v231 offset:14336
ds_read_b64_tr_b16 a[136:137], v232 offset:12288
v_mfma_f32_16x16x32_bf16 v[32:35], a[104:107], a[0:3], v[32:35]
ds_read_b64_tr_b16 a[138:139], v232 offset:14336
ds_read_b64_tr_b16 a[140:141], v233 offset:12288
v_cndmask_b32 v208, v224, v208, vcc
v_mfma_f32_16x16x32_bf16 v[40:43], a[104:107], a[4:7], v[40:43]
buffer_load_dwordx4 v223, s[36:39], s58 offen offset:3072 lds
v_and_b32 v219, 15, v219
v_mfma_f32_16x16x32_bf16 v[48:51], a[104:107], a[8:11], v[48:51]
ds_read_b64_tr_b16 a[142:143], v233 offset:14336
s_max_u32 s59, s52, 1
s_waitcnt lgkmcnt(11)
v_mfma_f32_16x16x32_bf16 v[52:55], a[108:111], a[8:11], v[52:55]
s_add_u32 m0, s53, 8192
s_add_u32 s58, s4, 0
s_sub_u32 s59, s59, 1
v_mfma_f32_16x16x32_bf16 v[44:47], a[108:111], a[4:7], v[44:47]
buffer_load_dwordx4 v220, s[40:43], s58 offen lds
v_mfma_f32_16x16x32_bf16 v[36:39], a[108:111], a[0:3], v[36:39]
s_lshl_b32 s59, s59, 6
s_lshl_b32 s60, s67, 8
s_waitcnt lgkmcnt(6)
v_mfma_f32_16x16x32_bf16 v[0:3], a[128:131], a[16:19], v[0:3]
s_waitcnt vmcnt(13)
ds_read_b64_tr_b16 a[96:97], v230 offset:16384
s_add_u32 s59, s59, s60
v_mfma_f32_16x16x32_bf16 v[8:11], a[128:131], a[20:23], v[8:11]
ds_read_b64_tr_b16 a[98:99], v230 offset:18432
ds_read_b128 a[32:35], v237 offset:0
v_mfma_f32_16x16x32_bf16 v[16:19], a[128:131], a[24:27], v[16:19]
ds_read_b128 a[36:39], v237 offset:1024
v_lshl_add_u32 v210, v219, 2, s59
s_waitcnt lgkmcnt(4)
v_mfma_f32_16x16x32_bf16 v[20:23], a[132:135], a[24:27], v[20:23]
buffer_load_dwordx4 v221, s[40:43], s58 offen offset:1024 lds
v_mfma_f32_16x16x32_bf16 v[12:15], a[132:135], a[20:23], v[12:15]
ds_read_b128 a[40:43], v237 offset:2048
ds_read_b64_tr_b16 a[100:101], v231 offset:16384
v_mul_u32_u24 v216, 896, v219
v_mfma_f32_16x16x32_bf16 v[4:7], a[132:135], a[16:19], v[4:7]
ds_read_b64_tr_b16 a[102:103], v231 offset:18432
ds_read_b64_tr_b16 a[104:105], v232 offset:16384
v_lshrrev_b32 v224, 8, v234
v_mfma_f32_16x16x32_bf16 v[32:35], a[136:139], a[16:19], v[32:35]
ds_read_b64_tr_b16 a[106:107], v232 offset:18432
ds_read_b64_tr_b16 a[108:109], v233 offset:16384
v_mfma_f32_16x16x32_bf16 v[40:43], a[136:139], a[20:23], v[40:43]
buffer_load_dwordx4 v222, s[40:43], s58 offen offset:2048 lds
v_lshl_add_u32 v216, v224, 3, v216
v_mfma_f32_16x16x32_bf16 v[48:51], a[136:139], a[24:27], v[48:51]
ds_read_b64_tr_b16 a[110:111], v233 offset:18432
v_mov_b32 v217, 0
v_mov_b32 v218, 1
v_mfma_f32_16x16x32_bf16 v[52:55], a[140:143], a[24:27], v[52:55]
buffer_load_dwordx4 v223, s[40:43], s58 offen offset:3072 lds
v_mfma_f32_16x16x32_bf16 v[44:47], a[140:143], a[20:23], v[44:47]
s_add_u32 m0, s53, 12288
s_add_u32 s58, s4, 28672
v_add_u32 v212, 0, v234
v_mfma_f32_16x16x32_bf16 v[36:39], a[140:143], a[16:19], v[36:39]
v_add_u32 v213, 4096, v234
v_add_u32 v214, 8192, v234
s_waitcnt lgkmcnt(6)
v_mfma_f32_16x16x32_bf16 v[0:3], a[96:99], a[32:35], v[0:3]
s_waitcnt vmcnt(12)
ds_read_b64_tr_b16 a[128:129], v230 offset:20480
v_mfma_f32_16x16x32_bf16 v[8:11], a[96:99], a[36:39], v[8:11]
ds_read_b64_tr_b16 a[130:131], v230 offset:22528
ds_read_b128 a[48:51], v237 offset:4096
v_add_u32 v215, 12288, v234
v_mfma_f32_16x16x32_bf16 v[16:19], a[96:99], a[40:43], v[16:19]
ds_read_b128 a[52:55], v237 offset:5120
v_bfe_u32 v219, v234, 6, 2
s_waitcnt lgkmcnt(4)
v_mfma_f32_16x16x32_bf16 v[20:23], a[100:103], a[40:43], v[20:23]
buffer_load_dwordx4 v220, s[40:43], s58 offen lds
v_mfma_f32_16x16x32_bf16 v[12:15], a[100:103], a[36:39], v[12:15]
ds_read_b128 a[56:59], v237 offset:6144
ds_read_b64_tr_b16 a[132:133], v231 offset:20480
v_cmp_eq_u32 vcc, v219, v224
v_mfma_f32_16x16x32_bf16 v[4:7], a[100:103], a[32:35], v[4:7]
ds_read_b64_tr_b16 a[134:135], v231 offset:22528
ds_read_b64_tr_b16 a[136:137], v232 offset:20480
v_bfe_u32 v219, v234, 4, 1
v_mfma_f32_16x16x32_bf16 v[32:35], a[104:107], a[32:35], v[32:35]
ds_read_b64_tr_b16 a[138:139], v232 offset:22528
ds_read_b64_tr_b16 a[140:141], v233 offset:20480
v_mfma_f32_16x16x32_bf16 v[40:43], a[104:107], a[36:39], v[40:43]
buffer_load_dwordx4 v221, s[40:43], s58 offen offset:1024 lds
v_lshlrev_b32 v219, 4, v219
v_mfma_f32_16x16x32_bf16 v[48:51], a[104:107], a[40:43], v[48:51]
ds_read_b64_tr_b16 a[142:143], v233 offset:22528
v_mov_b32 v224, 0x3f80
v_lshlrev_b32 v219, v219, v224
v_mfma_f32_16x16x32_bf16 v[52:55], a[108:111], a[40:43], v[52:55]
buffer_load_dwordx4 v222, s[40:43], s58 offen offset:2048 lds
v_cndmask_b32 v219, 0, v219, vcc
v_mfma_f32_16x16x32_bf16 v[44:47], a[108:111], a[36:39], v[44:47]
buffer_load_dwordx4 v223, s[40:43], s58 offen offset:3072 lds
v_mfma_f32_16x16x32_bf16 v[36:39], a[108:111], a[32:35], v[36:39]
s_add_u32 m0, s53, 16384
v_bfe_u32 v224, v234, 5, 1
s_waitcnt lgkmcnt(6)
v_mfma_f32_16x16x32_bf16 v[0:3], a[128:131], a[48:51], v[0:3]
s_waitcnt vmcnt(12)
ds_read_b64_tr_b16 a[96:97], v230 offset:0
v_cmp_eq_u32 vcc, 0, v224
v_mfma_f32_16x16x32_bf16 v[8:11], a[128:131], a[52:55], v[8:11]
ds_read_b64_tr_b16 a[98:99], v230 offset:2048
ds_read_b128 a[64:67], v238 offset:0
v_accvgpr_write_b32 a226, 0
v_mfma_f32_16x16x32_bf16 v[16:19], a[128:131], a[56:59], v[16:19]
ds_read_b128 a[68:71], v238 offset:1024
v_accvgpr_write_b32 a227, 0
s_waitcnt lgkmcnt(4)
v_mfma_f32_16x16x32_bf16 v[20:23], a[132:135], a[56:59], v[20:23]
s_add_u32 s58, s5, 0
ds_read_b128 a[72:75], v238 offset:2048
v_mfma_f32_16x16x32_bf16 v[12:15], a[132:135], a[52:55], v[12:15]
ds_read_b64_tr_b16 a[100:101], v231 offset:0
ds_read_b64_tr_b16 a[102:103], v231 offset:2048
buffer_load_dwordx4 v220, s[40:43], s58 offen lds
v_cndmask_b32 v224, 0, v219, vcc
v_mfma_f32_16x16x32_bf16 v[4:7], a[132:135], a[48:51], v[4:7]
ds_read_b64_tr_b16 a[104:105], v232 offset:0
ds_read_b64_tr_b16 a[106:107], v232 offset:2048
v_sub_u32 v219, v219, v224
v_mfma_f32_16x16x32_bf16 v[32:35], a[136:139], a[48:51], v[32:35]
ds_read_b64_tr_b16 a[108:109], v233 offset:0
ds_read_b64_tr_b16 a[110:111], v233 offset:2048
v_accvgpr_write_b32 a228, 0
v_mfma_f32_16x16x32_bf16 v[40:43], a[136:139], a[52:55], v[40:43]
buffer_load_dwordx4 v221, s[40:43], s58 offen offset:1024 lds
v_accvgpr_write_b32 a229, 0
v_mfma_f32_16x16x32_bf16 v[48:51], a[136:139], a[56:59], v[48:51]
buffer_load_dwordx4 v222, s[40:43], s58 offen offset:2048 lds
v_mfma_f32_16x16x32_bf16 v[52:55], a[140:143], a[56:59], v[52:55]
v_accvgpr_write_b32 a224, v224
v_accvgpr_write_b32 a225, v219
v_accvgpr_write_b32 a230, v224
v_mfma_f32_16x16x32_bf16 v[44:47], a[140:143], a[52:55], v[44:47]
buffer_load_dwordx4 v223, s[40:43], s58 offen offset:3072 lds
v_accvgpr_write_b32 a231, v219
v_mfma_f32_16x16x32_bf16 v[36:39], a[140:143], a[48:51], v[36:39]
s_add_u32 m0, s53, 20480
s_lshl_b32 s59, s66, 4
s_waitcnt lgkmcnt(0)
v_mfma_f32_16x16x32_bf16 v[0:3], a[96:99], a[64:67], v[0:3]
s_waitcnt vmcnt(12)
ds_read_b64_tr_b16 a[128:129], v230 offset:4096
v_mfma_f32_16x16x32_bf16 v[8:11], a[96:99], a[68:71], v[8:11]
ds_read_b64_tr_b16 a[130:131], v230 offset:6144
ds_read_b128 a[80:83], v238 offset:4096
s_add_u32 s20, s16, s59
s_addc_u32 s21, s17, 0
v_mfma_f32_16x16x32_bf16 v[16:19], a[96:99], a[72:75], v[16:19]
ds_read_b128 a[84:87], v238 offset:5120
ds_read_b128 a[88:91], v238 offset:6144
s_mov_b32 s22, 4
v_mfma_f32_16x16x32_bf16 v[20:23], a[100:103], a[72:75], v[20:23]
s_add_u32 s58, s5, 28672
ds_read_b64_tr_b16 a[132:133], v231 offset:4096
buffer_load_dwordx4 v220, s[40:43], s58 offen lds
s_mov_b32 s23, 0x20000
v_mfma_f32_16x16x32_bf16 v[12:15], a[100:103], a[68:71], v[12:15]
ds_read_b64_tr_b16 a[134:135], v231 offset:6144
ds_read_b64_tr_b16 a[136:137], v232 offset:4096
v_mfma_f32_16x16x32_bf16 v[4:7], a[100:103], a[64:67], v[4:7]
ds_read_b64_tr_b16 a[138:139], v232 offset:6144
ds_read_b64_tr_b16 a[140:141], v233 offset:4096
s_mul_i32 s59, s66, 917504
v_mfma_f32_16x16x32_bf16 v[32:35], a[104:107], a[64:67], v[32:35]
ds_read_b64_tr_b16 a[142:143], v233 offset:6144
s_add_u32 s24, s18, s59
s_addc_u32 s25, s19, 0
v_mfma_f32_16x16x32_bf16 v[40:43], a[104:107], a[68:71], v[40:43]
buffer_load_dwordx4 v221, s[40:43], s58 offen offset:1024 lds
s_mov_b32 s26, 917504
v_mfma_f32_16x16x32_bf16 v[48:51], a[104:107], a[72:75], v[48:51]
buffer_load_dwordx4 v222, s[40:43], s58 offen offset:2048 lds
s_mov_b32 s27, 0x20000
v_mfma_f32_16x16x32_bf16 v[52:55], a[108:111], a[72:75], v[52:55]
buffer_load_dwordx4 v223, s[40:43], s58 offen offset:3072 lds
s_mov_b32 s59, 0
v_mfma_f32_16x16x32_bf16 v[44:47], a[108:111], a[68:71], v[44:47]
s_add_u32 m0, s53, 0
s_add_u32 s58, s6, 0
v_mfma_f32_16x16x32_bf16 v[36:39], a[108:111], a[64:67], v[36:39]
s_add_u32 s28, s14, s59
s_addc_u32 s29, s15, 0
s_mov_b32 s30, 43008
s_waitcnt lgkmcnt(0)
v_mfma_f32_16x16x32_bf16 v[0:3], a[128:131], a[80:83], v[0:3]
s_waitcnt vmcnt(12)
ds_read_b64_tr_b16 a[96:97], v230 offset:8192
s_mov_b32 s31, 0x20000
v_mfma_f32_16x16x32_bf16 v[8:11], a[128:131], a[84:87], v[8:11]
ds_read_b64_tr_b16 a[98:99], v230 offset:10240
ds_read_b64_tr_b16 a[100:101], v231 offset:8192
s_mov_b32 s63, 0xffff0000
v_mfma_f32_16x16x32_bf16 v[16:19], a[128:131], a[88:91], v[16:19]
ds_read_b64_tr_b16 a[102:103], v231 offset:10240
ds_read_b64_tr_b16 a[104:105], v232 offset:8192
buffer_load_dwordx4 v220, s[40:43], s58 offen lds
s_lshl_b32 s55, s67, 2
v_mfma_f32_16x16x32_bf16 v[20:23], a[132:135], a[88:91], v[20:23]
buffer_load_dwordx4 v221, s[40:43], s58 offen offset:1024 lds
s_add_u32 s55, s55, s52
v_mfma_f32_16x16x32_bf16 v[12:15], a[132:135], a[84:87], v[12:15]
ds_read_b64_tr_b16 a[106:107], v232 offset:10240
ds_read_b64_tr_b16 a[108:109], v233 offset:8192
s_lshr_b32 s56, s55, 4
v_mfma_f32_16x16x32_bf16 v[4:7], a[132:135], a[80:83], v[4:7]
ds_read_b64_tr_b16 a[110:111], v233 offset:10240
s_and_b32 s59, s55, 2
s_lshl_b32 s59, s59, 1
v_mfma_f32_16x16x32_bf16 v[32:35], a[136:139], a[80:83], v[32:35]
buffer_load_dwordx4 v222, s[40:43], s58 offen offset:2048 lds
s_add_u32 s56, s56, s59
s_add_u32 s56, s56, s64
v_mfma_f32_16x16x32_bf16 v[40:43], a[136:139], a[84:87], v[40:43]
buffer_load_dwordx4 v223, s[40:43], s58 offen offset:3072 lds
s_and_b32 s56, s56, 7
v_mfma_f32_16x16x32_bf16 v[48:51], a[136:139], a[88:91], v[48:51]
s_add_u32 m0, s53, 4096
s_add_u32 s58, s6, 28672
s_bfe_u32 s59, s55, 0x20002
v_mfma_f32_16x16x32_bf16 v[52:55], a[140:143], a[88:91], v[52:55]
buffer_load_dwordx4 v220, s[40:43], s58 offen lds
s_and_b32 s60, s55, 1
v_mfma_f32_16x16x32_bf16 v[44:47], a[140:143], a[84:87], v[44:47]
buffer_load_dwordx4 v221, s[40:43], s58 offen offset:1024 lds
s_lshl_b32 s57, s56, 1
v_mfma_f32_16x16x32_bf16 v[36:39], a[140:143], a[80:83], v[36:39]
s_add_u32 s57, s57, s60
s_lshl_b32 s9, s57, 6
s_waitcnt lgkmcnt(0)
v_mfma_f32_16x16x32_bf16 v[64:67], a[96:99], v[128:131], 0
s_waitcnt vmcnt(14)
ds_read_b64_tr_b16 a[128:129], v230 offset:12288
s_lshl_b32 s57, s57, 2
v_mfma_f32_16x16x32_bf16 v[72:75], a[96:99], v[136:139], 0
ds_read_b64_tr_b16 a[130:131], v230 offset:14336
ds_read_b64_tr_b16 a[132:133], v231 offset:12288
s_add_u32 s57, s57, s59
s_lshl_b32 s57, s57, 14
v_mfma_f32_16x16x32_bf16 v[80:83], a[96:99], v[144:147], 0
ds_read_b64_tr_b16 a[134:135], v231 offset:14336
ds_read_b64_tr_b16 a[136:137], v232 offset:12288
s_mul_i32 s60, s59, 14336
v_mfma_f32_16x16x32_bf16 v[84:87], a[100:103], v[144:147], 0
buffer_load_dwordx4 v222, s[40:43], s58 offen offset:2048 lds
s_add_u32 s9, s9, s60
v_mfma_f32_16x16x32_bf16 v[76:79], a[100:103], v[136:139], 0
ds_read_b64_tr_b16 a[138:139], v232 offset:14336
ds_read_b64_tr_b16 a[140:141], v233 offset:12288
v_mfma_f32_16x16x32_bf16 v[68:71], a[100:103], v[128:131], 0
ds_read_b64_tr_b16 a[142:143], v233 offset:14336
s_cmp_eq_u32 s56, 7
s_cselect_b32 s56, 1, 0
s_cmp_ge_u32 s59, 3
s_cselect_b32 s56, 1, s56
v_mfma_f32_16x16x32_bf16 v[96:99], a[104:107], v[128:131], 0
buffer_load_dwordx4 v223, s[40:43], s58 offen offset:3072 lds
v_cvt_pk_bf16_f32 v192, v0, v1
v_mfma_f32_16x16x32_bf16 v[104:107], a[104:107], v[136:139], 0
s_add_u32 m0, s53, 8192
s_add_u32 s58, s7, 0
v_cvt_pk_bf16_f32 v193, v2, v3
v_mfma_f32_16x16x32_bf16 v[112:115], a[104:107], v[144:147], 0
buffer_load_dwordx4 v220, s[40:43], s58 offen lds
v_cvt_pk_bf16_f32 v194, v4, v5
v_cvt_pk_bf16_f32 v195, v6, v7
v_mfma_f32_16x16x32_bf16 v[116:119], a[108:111], v[144:147], 0
buffer_load_dwordx4 v221, s[40:43], s58 offen offset:1024 lds
v_mfma_f32_16x16x32_bf16 v[108:111], a[108:111], v[136:139], 0
s_mov_b32 s69, 0
buffer_store_dwordx4 v[192:195], v234, s[44:47], s69 offen sc1
v_cvt_pk_bf16_f32 v196, v8, v9
v_cvt_pk_bf16_f32 v197, v10, v11
v_mfma_f32_16x16x32_bf16 v[100:103], a[108:111], v[128:131], 0
v_cvt_pk_bf16_f32 v198, v12, v13
v_cvt_pk_bf16_f32 v199, v14, v15
s_waitcnt lgkmcnt(0)
v_mfma_f32_16x16x32_bf16 v[64:67], a[128:131], v[160:163], v[64:67]
s_waitcnt vmcnt(15)
ds_read_b64_tr_b16 a[96:97], v230 offset:16384
s_mov_b32 s69, 16384
buffer_store_dwordx4 v[196:199], v234, s[44:47], s69 offen sc1
v_mfma_f32_16x16x32_bf16 v[72:75], a[128:131], v[168:171], v[72:75]
ds_read_b64_tr_b16 a[98:99], v230 offset:18432
ds_read_b64_tr_b16 a[100:101], v231 offset:16384
v_cvt_pk_bf16_f32 v200, v16, v17
v_mfma_f32_16x16x32_bf16 v[80:83], a[128:131], v[176:179], v[80:83]
ds_read_b64_tr_b16 a[102:103], v231 offset:18432
ds_read_b64_tr_b16 a[104:105], v232 offset:16384
v_cvt_pk_bf16_f32 v201, v18, v19
v_cvt_pk_bf16_f32 v202, v20, v21
v_mfma_f32_16x16x32_bf16 v[84:87], a[132:135], v[176:179], v[84:87]
buffer_load_dwordx4 v222, s[40:43], s58 offen offset:2048 lds
v_cvt_pk_bf16_f32 v203, v22, v23
v_mfma_f32_16x16x32_bf16 v[76:79], a[132:135], v[168:171], v[76:79]
ds_read_b64_tr_b16 a[106:107], v232 offset:18432
ds_read_b64_tr_b16 a[108:109], v233 offset:16384
s_mov_b32 s69, 32768
buffer_store_dwordx4 v[200:203], v234, s[44:47], s69 offen sc1
v_mfma_f32_16x16x32_bf16 v[68:71], a[132:135], v[160:163], v[68:71]
ds_read_b64_tr_b16 a[110:111], v233 offset:18432
v_cvt_pk_bf16_f32 v204, v32, v33
v_cvt_pk_bf16_f32 v205, v34, v35
v_mfma_f32_16x16x32_bf16 v[96:99], a[136:139], v[160:163], v[96:99]
v_cvt_pk_bf16_f32 v206, v36, v37
v_cvt_pk_bf16_f32 v207, v38, v39
s_mov_b32 s69, 65536
buffer_store_dwordx4 v[204:207], v234, s[44:47], s69 offen sc1
v_mfma_f32_16x16x32_bf16 v[104:107], a[136:139], v[168:171], v[104:107]
v_cvt_pk_bf16_f32 v192, v40, v41
v_cvt_pk_bf16_f32 v193, v42, v43
v_cvt_pk_bf16_f32 v194, v44, v45
v_mfma_f32_16x16x32_bf16 v[112:115], a[136:139], v[176:179], v[112:115]
v_cvt_pk_bf16_f32 v195, v46, v47
s_mov_b32 s69, 81920
buffer_store_dwordx4 v[192:195], v234, s[44:47], s69 offen sc1
v_mfma_f32_16x16x32_bf16 v[116:119], a[140:143], v[176:179], v[116:119]
v_cvt_pk_bf16_f32 v196, v48, v49
v_cvt_pk_bf16_f32 v197, v50, v51
v_mfma_f32_16x16x32_bf16 v[108:111], a[140:143], v[168:171], v[108:111]
v_cvt_pk_bf16_f32 v198, v52, v53
v_cvt_pk_bf16_f32 v199, v54, v55
v_mfma_f32_16x16x32_bf16 v[100:103], a[140:143], v[160:163], v[100:103]
s_mov_b32 s69, 98304
buffer_store_dwordx4 v[196:199], v234, s[44:47], s69 offen sc1
s_waitcnt lgkmcnt(0)
v_mfma_f32_16x16x32_bf16 v[64:67], a[96:99], a[0:3], v[64:67]
s_waitcnt vmcnt(17)
ds_read_b64_tr_b16 a[128:129], v230 offset:20480
v_mfma_f32_16x16x32_bf16 v[72:75], a[96:99], a[4:7], v[72:75]
ds_read_b64_tr_b16 a[130:131], v230 offset:22528
ds_read_b64_tr_b16 a[132:133], v231 offset:20480
v_mfma_f32_16x16x32_bf16 v[80:83], a[96:99], a[8:11], v[80:83]
ds_read_b64_tr_b16 a[134:135], v231 offset:22528
ds_read_b64_tr_b16 a[136:137], v232 offset:20480
v_mfma_f32_16x16x32_bf16 v[84:87], a[100:103], a[8:11], v[84:87]
ds_read_b64_tr_b16 a[138:139], v232 offset:22528
v_mfma_f32_16x16x32_bf16 v[76:79], a[100:103], a[4:7], v[76:79]
ds_read_b64_tr_b16 a[140:141], v233 offset:20480
buffer_load_dwordx4 v223, s[40:43], s58 offen offset:3072 lds
v_mfma_f32_16x16x32_bf16 v[68:71], a[100:103], a[0:3], v[68:71]
ds_read_b64_tr_b16 a[142:143], v233 offset:22528
s_add_u32 m0, s53, 12288
v_mfma_f32_16x16x32_bf16 v[96:99], a[104:107], a[0:3], v[96:99]
s_add_u32 s58, s7, 28672
v_mfma_f32_16x16x32_bf16 v[104:107], a[104:107], a[4:7], v[104:107]
buffer_load_dwordx4 v220, s[40:43], s58 offen lds
v_mfma_f32_16x16x32_bf16 v[112:115], a[104:107], a[8:11], v[112:115]
v_mfma_f32_16x16x32_bf16 v[116:119], a[108:111], a[8:11], v[116:119]
v_mfma_f32_16x16x32_bf16 v[108:111], a[108:111], a[4:7], v[108:111]
buffer_load_dwordx4 v221, s[40:43], s58 offen offset:1024 lds
v_mfma_f32_16x16x32_bf16 v[100:103], a[108:111], a[0:3], v[100:103]
s_waitcnt lgkmcnt(0)
v_mfma_f32_16x16x32_bf16 v[64:67], a[128:131], a[16:19], v[64:67]
s_waitcnt vmcnt(12)
ds_read_b64_tr_b16 a[96:97], v230 offset:0
v_mfma_f32_16x16x32_bf16 v[72:75], a[128:131], a[20:23], v[72:75]
ds_read_b64_tr_b16 a[98:99], v230 offset:2048
ds_read_b64_tr_b16 a[100:101], v231 offset:0
v_mfma_f32_16x16x32_bf16 v[80:83], a[128:131], a[24:27], v[80:83]
ds_read_b64_tr_b16 a[102:103], v231 offset:2048
ds_read_b64_tr_b16 a[104:105], v230 offset:4096
v_mfma_f32_16x16x32_bf16 v[84:87], a[132:135], a[24:27], v[84:87]
buffer_load_dwordx4 v222, s[40:43], s58 offen offset:2048 lds
v_mfma_f32_16x16x32_bf16 v[76:79], a[132:135], a[20:23], v[76:79]
ds_read_b64_tr_b16 a[106:107], v230 offset:6144
ds_read_b64_tr_b16 a[108:109], v231 offset:4096
v_mfma_f32_16x16x32_bf16 v[68:71], a[132:135], a[16:19], v[68:71]
ds_read_b64_tr_b16 a[110:111], v231 offset:6144
v_mfma_f32_16x16x32_bf16 v[96:99], a[136:139], a[16:19], v[96:99]
buffer_load_dwordx4 v223, s[40:43], s58 offen offset:3072 lds
v_mfma_f32_16x16x32_bf16 v[104:107], a[136:139], a[20:23], v[104:107]
v_mfma_f32_16x16x32_bf16 v[112:115], a[136:139], a[24:27], v[112:115]
v_mfma_f32_16x16x32_bf16 v[116:119], a[140:143], a[24:27], v[116:119]
v_mfma_f32_16x16x32_bf16 v[108:111], a[140:143], a[20:23], v[108:111]
v_mfma_f32_16x16x32_bf16 v[100:103], a[140:143], a[16:19], v[100:103]
s_waitcnt lgkmcnt(0)
v_mfma_f32_16x16x32_bf16 v[64:67], a[96:99], a[32:35], v[64:67]
s_waitcnt vmcnt(0)
v_mfma_f32_16x16x32_bf16 v[72:75], a[96:99], a[36:39], v[72:75]
ds_read_b64_tr_b16 a[128:129], v230 offset:8192
ds_read_b64_tr_b16 a[130:131], v230 offset:10240
v_mfma_f32_16x16x32_bf16 v[80:83], a[96:99], a[40:43], v[80:83]
ds_read_b64_tr_b16 a[132:133], v231 offset:8192
ds_read_b64_tr_b16 a[134:135], v231 offset:10240
v_mfma_f32_16x16x32_bf16 v[84:87], a[100:103], a[40:43], v[84:87]
ds_read_b64_tr_b16 a[136:137], v230 offset:12288
ds_read_b64_tr_b16 a[138:139], v230 offset:14336
v_mfma_f32_16x16x32_bf16 v[76:79], a[100:103], a[36:39], v[76:79]
ds_read_b64_tr_b16 a[140:141], v231 offset:12288
v_mfma_f32_16x16x32_bf16 v[68:71], a[100:103], a[32:35], v[68:71]
ds_read_b64_tr_b16 a[142:143], v231 offset:14336
v_mfma_f32_16x16x32_bf16 v[64:67], a[104:107], a[48:51], v[64:67]
v_mfma_f32_16x16x32_bf16 v[72:75], a[104:107], a[52:55], v[72:75]
v_mfma_f32_16x16x32_bf16 v[80:83], a[104:107], a[56:59], v[80:83]
v_mfma_f32_16x16x32_bf16 v[84:87], a[108:111], a[56:59], v[84:87]
v_mfma_f32_16x16x32_bf16 v[76:79], a[108:111], a[52:55], v[76:79]
v_mfma_f32_16x16x32_bf16 v[68:71], a[108:111], a[48:51], v[68:71]
s_waitcnt lgkmcnt(0)
v_mfma_f32_16x16x32_bf16 v[64:67], a[128:131], a[64:67], v[64:67]
ds_read_b64_tr_b16 a[96:97], v232 offset:0
ds_read_b64_tr_b16 a[98:99], v232 offset:2048
v_mfma_f32_16x16x32_bf16 v[72:75], a[128:131], a[68:71], v[72:75]
ds_read_b64_tr_b16 a[100:101], v233 offset:0
ds_read_b64_tr_b16 a[102:103], v233 offset:2048
v_mfma_f32_16x16x32_bf16 v[80:83], a[128:131], a[72:75], v[80:83]
ds_read_b64_tr_b16 a[104:105], v232 offset:4096
v_mfma_f32_16x16x32_bf16 v[84:87], a[132:135], a[72:75], v[84:87]
ds_read_b64_tr_b16 a[106:107], v232 offset:6144
v_mfma_f32_16x16x32_bf16 v[76:79], a[132:135], a[68:71], v[76:79]
ds_read_b64_tr_b16 a[108:109], v233 offset:4096
v_mfma_f32_16x16x32_bf16 v[68:71], a[132:135], a[64:67], v[68:71]
ds_read_b64_tr_b16 a[110:111], v233 offset:6144
v_mfma_f32_16x16x32_bf16 v[64:67], a[136:139], a[80:83], v[64:67]
buffer_store_dword v209, v208, s[72:75], 0 offen offset:0 sc1
v_mfma_f32_16x16x32_bf16 v[72:75], a[136:139], a[84:87], v[72:75]
v_mfma_f32_16x16x32_bf16 v[80:83], a[136:139], a[88:91], v[80:83]
v_mfma_f32_16x16x32_bf16 v[84:87], a[140:143], a[88:91], v[84:87]
v_mfma_f32_16x16x32_bf16 v[76:79], a[140:143], a[84:87], v[76:79]
v_mfma_f32_16x16x32_bf16 v[68:71], a[140:143], a[80:83], v[68:71]
s_waitcnt lgkmcnt(0)
v_mfma_f32_16x16x32_bf16 v[96:99], a[96:99], a[32:35], v[96:99]
ds_read_b64_tr_b16 a[128:129], v232 offset:8192
ds_read_b64_tr_b16 a[130:131], v232 offset:10240
v_mfma_f32_16x16x32_bf16 v[104:107], a[96:99], a[36:39], v[104:107]
ds_read_b64_tr_b16 a[132:133], v233 offset:8192
ds_read_b64_tr_b16 a[134:135], v233 offset:10240
v_mfma_f32_16x16x32_bf16 v[112:115], a[96:99], a[40:43], v[112:115]
ds_read_b64_tr_b16 a[136:137], v232 offset:12288
v_mfma_f32_16x16x32_bf16 v[116:119], a[100:103], a[40:43], v[116:119]
ds_read_b64_tr_b16 a[138:139], v232 offset:14336
v_mfma_f32_16x16x32_bf16 v[108:111], a[100:103], a[36:39], v[108:111]
ds_read_b64_tr_b16 a[140:141], v233 offset:12288
v_cvt_pk_bf16_f32 v192, v64, v65
v_cvt_pk_bf16_f32 v193, v66, v67
v_mfma_f32_16x16x32_bf16 v[100:103], a[100:103], a[32:35], v[100:103]
ds_read_b64_tr_b16 a[142:143], v233 offset:14336
v_cvt_pk_bf16_f32 v194, v68, v69
v_cvt_pk_bf16_f32 v195, v70, v71
v_mfma_f32_16x16x32_bf16 v[96:99], a[104:107], a[48:51], v[96:99]
s_mov_b32 s69, 0
buffer_store_dwordx4 v[192:195], v234, s[48:51], s69 offen sc1
v_cvt_pk_bf16_f32 v196, v72, v73
v_cvt_pk_bf16_f32 v197, v74, v75
v_cvt_pk_bf16_f32 v198, v76, v77
v_mfma_f32_16x16x32_bf16 v[104:107], a[104:107], a[52:55], v[104:107]
v_cvt_pk_bf16_f32 v199, v78, v79
s_mov_b32 s69, 16384
buffer_store_dwordx4 v[196:199], v234, s[48:51], s69 offen sc1
v_mfma_f32_16x16x32_bf16 v[112:115], a[104:107], a[56:59], v[112:115]
v_cvt_pk_bf16_f32 v200, v80, v81
v_cvt_pk_bf16_f32 v201, v82, v83
v_cvt_pk_bf16_f32 v202, v84, v85
v_mfma_f32_16x16x32_bf16 v[116:119], a[108:111], a[56:59], v[116:119]
v_cvt_pk_bf16_f32 v203, v86, v87
v_mfma_f32_16x16x32_bf16 v[108:111], a[108:111], a[52:55], v[108:111]
s_mov_b32 s69, 32768
buffer_store_dwordx4 v[200:203], v234, s[48:51], s69 offen sc1
v_mfma_f32_16x16x32_bf16 v[100:103], a[108:111], a[48:51], v[100:103]
s_waitcnt lgkmcnt(0)
v_mfma_f32_16x16x32_bf16 v[96:99], a[128:131], a[64:67], v[96:99]
v_mfma_f32_16x16x32_bf16 v[104:107], a[128:131], a[68:71], v[104:107]
v_mfma_f32_16x16x32_bf16 v[112:115], a[128:131], a[72:75], v[112:115]
v_mfma_f32_16x16x32_bf16 v[116:119], a[132:135], a[72:75], v[116:119]
v_mfma_f32_16x16x32_bf16 v[108:111], a[132:135], a[68:71], v[108:111]
v_mfma_f32_16x16x32_bf16 v[100:103], a[132:135], a[64:67], v[100:103]
v_mfma_f32_16x16x32_bf16 v[96:99], a[136:139], a[80:83], v[96:99]
v_mfma_f32_16x16x32_bf16 v[104:107], a[136:139], a[84:87], v[104:107]
buffer_load_dword v211, v210, s[72:75], 0 offen sc1
v_mfma_f32_16x16x32_bf16 v[112:115], a[136:139], a[88:91], v[112:115]
v_mfma_f32_16x16x32_bf16 v[116:119], a[140:143], a[88:91], v[116:119]
v_mfma_f32_16x16x32_bf16 v[108:111], a[140:143], a[84:87], v[108:111]
v_mfma_f32_16x16x32_bf16 v[100:103], a[140:143], a[80:83], v[100:103]
s_nop 1
v_cvt_pk_bf16_f32 v192, v96, v97
v_cvt_pk_bf16_f32 v193, v98, v99
s_nop 3
v_cvt_pk_bf16_f32 v194, v100, v101
v_cvt_pk_bf16_f32 v195, v102, v103
s_mov_b32 s69, 65536
buffer_store_dwordx4 v[192:195], v234, s[48:51], s69 offen sc1
v_cvt_pk_bf16_f32 v196, v104, v105
v_cvt_pk_bf16_f32 v197, v106, v107
v_cvt_pk_bf16_f32 v198, v108, v109
v_cvt_pk_bf16_f32 v199, v110, v111
s_mov_b32 s69, 81920
buffer_store_dwordx4 v[196:199], v234, s[48:51], s69 offen sc1
v_cvt_pk_bf16_f32 v200, v112, v113
v_cvt_pk_bf16_f32 v201, v114, v115
v_cvt_pk_bf16_f32 v202, v116, v117
v_cvt_pk_bf16_f32 v203, v118, v119
s_mov_b32 s69, 98304
buffer_store_dwordx4 v[200:203], v234, s[48:51], s69 offen sc1
s_cmp_eq_u32 s56, 1
s_cbranch_scc1 L_rb1
s_waitcnt vmcnt(3)
v_cmp_eq_u32 vcc, 1, v211
s_nop 1
s_cmp_eq_u64 vcc, -1
s_cbranch_scc0 L_rb1
buffer_load_dwordx4 v[128:131], v212, s[24:27], s57 offen sc1
buffer_load_dwordx4 v[132:135], v212, s[24:27], s57 offen offset:1024 sc1
buffer_load_dwordx4 v[136:139], v212, s[24:27], s57 offen offset:2048 sc1
buffer_load_dwordx4 v[140:143], v212, s[24:27], s57 offen offset:3072 sc1
buffer_load_dwordx4 v[144:147], v213, s[24:27], s57 offen sc1
buffer_load_dwordx4 v[148:151], v213, s[24:27], s57 offen offset:1024 sc1
s_waitcnt vmcnt(9)
buffer_store_dword v209, v208, s[72:75], 0 offen offset:64 sc1
s_waitcnt vmcnt(7)
buffer_store_dword v209, v208, s[72:75], 0 offen offset:128 sc1
s_barrier
s_cmp_eq_u32 s52, 0
s_cselect_b32 s22, 4, 0
s_mov_b64 exec, 1
buffer_atomic_add v218, v217, s[20:23], 0 offen sc0
s_mov_b64 exec, -1
s_mov_b32 s22, 4
buffer_load_dwordx4 v[152:155], v213, s[24:27], s57 offen offset:2048 sc1
buffer_load_dwordx4 v[156:159], v213, s[24:27], s57 offen offset:3072 sc1
buffer_load_dwordx4 v[160:163], v214, s[24:27], s57 offen sc1
buffer_load_dwordx4 v[164:167], v214, s[24:27], s57 offen offset:1024 sc1
buffer_load_dwordx4 v[168:171], v214, s[24:27], s57 offen offset:2048 sc1
buffer_load_dwordx4 v[172:175], v214, s[24:27], s57 offen offset:3072 sc1
buffer_load_dwordx4 v[176:179], v215, s[24:27], s57 offen sc1
buffer_load_dwordx4 v[180:183], v215, s[24:27], s57 offen offset:1024 sc1
buffer_load_dwordx4 v[184:187], v215, s[24:27], s57 offen offset:2048 sc1
buffer_load_dwordx4 v[188:191], v215, s[24:27], s57 offen offset:3072 sc1
s_branch L_rsum1
L_rb1:
s_waitcnt vmcnt(3)
buffer_store_dword v209, v208, s[72:75], 0 offen offset:64 sc1
s_waitcnt vmcnt(1)
buffer_store_dword v209, v208, s[72:75], 0 offen offset:128 sc1
s_barrier
s_cmp_eq_u32 s52, 0
s_cselect_b32 s22, 4, 0
s_mov_b64 exec, 1
buffer_atomic_add v218, v217, s[20:23], 0 offen sc0
s_mov_b64 exec, -1
s_mov_b32 s22, 4
s_cmp_eq_u32 s56, 1
s_cbranch_scc1 L_rfin1
s_mov_b32 s62, 200
buffer_load_dword v24, v210, s[72:75], 0 offen sc1
L_rl1:
s_waitcnt vmcnt(0)
v_cmp_eq_u32 vcc, 1, v24
s_nop 1
s_cmp_eq_u64 vcc, -1
s_cbranch_scc1 L_rgo1
buffer_load_dword v24, v210, s[72:75], 0 offen sc1
s_sub_u32 s62, s62, 1
s_cmp_lg_u32 s62, 0
s_cbranch_scc1 L_rl1
s_lshl_b32 s59, 0x10000, s67
v_mov_b32 v219, s59
s_mov_b64 exec, 1
buffer_atomic_or v219, v217, s[20:23], 0 offen sc0
s_mov_b64 exec, -1
s_waitcnt vmcnt(0)
v_readfirstlane_b32 s59, v219
s_nop 1
s_and_b32 s59, s59, 0xff
s_cmp_eq_u32 s59, 16
s_cbranch_scc0 L_rfin1
L_rgo1:
buffer_load_dwordx4 v[128:131], v212, s[24:27], s57 offen sc1
buffer_load_dwordx4 v[132:135], v212, s[24:27], s57 offen offset:1024 sc1
buffer_load_dwordx4 v[136:139], v212, s[24:27], s57 offen offset:2048 sc1
buffer_load_dwordx4 v[140:143], v212, s[24:27], s57 offen offset:3072 sc1
buffer_load_dwordx4 v[144:147], v213, s[24:27], s57 offen sc1
buffer_load_dwordx4 v[148:151], v213, s[24:27], s57 offen offset:1024 sc1
buffer_load_dwordx4 v[152:155], v213, s[24:27], s57 offen offset:2048 sc1
buffer_load_dwordx4 v[156:159], v213, s[24:27], s57 offen offset:3072 sc1
buffer_load_dwordx4 v[160:163], v214, s[24:27], s57 offen sc1
buffer_load_dwordx4 v[164:167], v214, s[24:27], s57 offen offset:1024 sc1
buffer_load_dwordx4 v[168:171], v214, s[24:27], s57 offen offset:2048 sc1
buffer_load_dwordx4 v[172:175], v214, s[24:27], s57 offen offset:3072 sc1
buffer_load_dwordx4 v[176:179], v215, s[24:27], s57 offen sc1
buffer_load_dwordx4 v[180:183], v215, s[24:27], s57 offen offset:1024 sc1
buffer_load_dwordx4 v[184:187], v215, s[24:27], s57 offen offset:2048 sc1
buffer_load_dwordx4 v[188:191], v215, s[24:27], s57 offen offset:3072 sc1
L_rsum1:
s_waitcnt vmcnt(15)
v_mfma_f32_16x16x32_bf16 v[0:3], a[224:227], v[128:131], 0
v_mfma_f32_16x16x32_bf16 v[4:7], a[228:231], v[128:131], 0
s_waitcnt vmcnt(14)
v_mfma_f32_16x16x32_bf16 v[0:3], a[224:227], v[132:135], v[0:3]
v_mfma_f32_16x16x32_bf16 v[4:7], a[228:231], v[132:135], v[4:7]
s_waitcnt vmcnt(13)
v_mfma_f32_16x16x32_bf16 v[0:3], a[224:227], v[136:139], v[0:3]
v_mfma_f32_16x16x32_bf16 v[4:7], a[228:231], v[136:139], v[4:7]
s_waitcnt vmcnt(12)
v_mfma_f32_16x16x32_bf16 v[0:3], a[224:227], v[140:143], v[0:3]
v_mfma_f32_16x16x32_bf16 v[4:7], a[228:231], v[140:143], v[4:7]
s_waitcnt vmcnt(11)
v_mfma_f32_16x16x32_bf16 v[0:3], a[224:227], v[144:147], v[0:3]
v_mfma_f32_16x16x32_bf16 v[4:7], a[228:231], v[144:147], v[4:7]
s_waitcnt vmcnt(10)
v_mfma_f32_16x16x32_bf16 v[0:3], a[224:227], v[148:151], v[0:3]
v_mfma_f32_16x16x32_bf16 v[4:7], a[228:231], v[148:151], v[4:7]
s_waitcnt vmcnt(9)
v_mfma_f32_16x16x32_bf16 v[0:3], a[224:227], v[152:155], v[0:3]
v_mfma_f32_16x16x32_bf16 v[4:7], a[228:231], v[152:155], v[4:7]
s_waitcnt vmcnt(8)
v_mfma_f32_16x16x32_bf16 v[0:3], a[224:227], v[156:159], v[0:3]
v_mfma_f32_16x16x32_bf16 v[4:7], a[228:231], v[156:159], v[4:7]
s_waitcnt vmcnt(7)
v_mfma_f32_16x16x32_bf16 v[0:3], a[224:227], v[160:163], v[0:3]
v_mfma_f32_16x16x32_bf16 v[4:7], a[228:231], v[160:163], v[4:7]
s_waitcnt vmcnt(6)
v_mfma_f32_16x16x32_bf16 v[0:3], a[224:227], v[164:167], v[0:3]
v_mfma_f32_16x16x32_bf16 v[4:7], a[228:231], v[164:167], v[4:7]
s_waitcnt vmcnt(5)
v_mfma_f32_16x16x32_bf16 v[0:3], a[224:227], v[168:171], v[0:3]
v_mfma_f32_16x16x32_bf16 v[4:7], a[228:231], v[168:171], v[4:7]
s_waitcnt vmcnt(4)
v_mfma_f32_16x16x32_bf16 v[0:3], a[224:227], v[172:175], v[0:3]
v_mfma_f32_16x16x32_bf16 v[4:7], a[228:231], v[172:175], v[4:7]
s_waitcnt vmcnt(3)
v_mfma_f32_16x16x32_bf16 v[0:3], a[224:227], v[176:179], v[0:3]
v_mfma_f32_16x16x32_bf16 v[4:7], a[228:231], v[176:179], v[4:7]
s_waitcnt vmcnt(2)
v_mfma_f32_16x16x32_bf16 v[0:3], a[224:227], v[180:183], v[0:3]
v_mfma_f32_16x16x32_bf16 v[4:7], a[228:231], v[180:183], v[4:7]
s_waitcnt vmcnt(1)
v_mfma_f32_16x16x32_bf16 v[0:3], a[224:227], v[184:187], v[0:3]
v_mfma_f32_16x16x32_bf16 v[4:7], a[228:231], v[184:187], v[4:7]
s_waitcnt vmcnt(0)
v_mfma_f32_16x16x32_bf16 v[0:3], a[224:227], v[188:191], v[0:3]
v_mfma_f32_16x16x32_bf16 v[4:7], a[228:231], v[188:191], v[4:7]
s_nop 6
v_cvt_pk_bf16_f32 v16, v0, v1
v_cvt_pk_bf16_f32 v17, v2, v3
v_cvt_pk_bf16_f32 v18, v4, v5
v_cvt_pk_bf16_f32 v19, v6, v7
buffer_store_dwordx2 v[16:17], v216, s[28:31], s9 offen
buffer_store_dwordx2 v[18:19], v216, s[28:31], s9 offen offset:32
L_rfin1:
s_cmp_lg_u32 s52, 0
s_cbranch_scc1 L_rd1
s_waitcnt vmcnt(0)
v_readfirstlane_b32 s59, v218
s_nop 1
s_and_b32 s60, s59, 0xff
s_cmp_lg_u32 s60, 15
s_cbranch_scc1 L_rd1
s_lshr_b32 s60, s59, 16
s_cmp_eq_u32 s60, 0
s_cbranch_scc1 L_rd1
s_ff1_i32_b32 s61, s60
s_bfe_u32 s62, s59, 0x20008
s_lshl_b32 s55, s61, 2
s_add_u32 s55, s55, s62
s_add_u32 s59, s59, 0x100
s_cmp_eq_u32 s62, 3
s_cbranch_scc0 L_rk1
s_and_b32 s59, s59, 0xffff00ff
s_add_u32 s61, s61, 16
s_bitset0_b32 s59, s61
L_rk1:
v_mov_b32 v218, s59
s_lshr_b32 s56, s55, 4
s_and_b32 s59, s55, 2
s_lshl_b32 s59, s59, 1
s_add_u32 s56, s56, s59
s_add_u32 s56, s56, s64
s_and_b32 s56, s56, 7
s_bfe_u32 s59, s55, 0x20002
s_and_b32 s60, s55, 1
s_lshl_b32 s57, s56, 1
s_add_u32 s57, s57, s60
s_lshl_b32 s9, s57, 6
s_lshl_b32 s57, s57, 2
s_add_u32 s57, s57, s59
s_lshl_b32 s57, s57, 14
s_mul_i32 s60, s59, 14336
s_add_u32 s9, s9, s60
s_cmp_eq_u32 s56, 7
s_cselect_b32 s56, 1, 0
s_cmp_ge_u32 s59, 3
s_cselect_b32 s56, 1, s56
s_cmp_eq_u32 s56, 1
s_cbranch_scc1 L_rfin1
s_branch L_rgo1
L_rd1:
s_endpgm
L_fb1:
s_waitcnt vmcnt(0) lgkmcnt(0)
s_nop 15
s_barrier
v_accvgpr_write_b32 a244, v242
v_accvgpr_write_b32 a245, v243
v_accvgpr_write_b32 a246, v244
v_accvgpr_read_b32 v0, a248
s_mov_b32 s71, 0
s_nop 3
s_branch L_top
.p2align 6
L_v2:
v_accvgpr_write_b32 a248, v0
s_cmp_eq_u32 s71, 0
s_cbranch_scc1 L_ni2
v_mov_b32 v6, 0xff800000
v_accvgpr_write_b32 a244, v6
v_accvgpr_write_b32 a245, v6
v_accvgpr_write_b32 a246, v6
v_accvgpr_write_b32 a247, v6
L_ni2:
s_lshl_b32 s59, s64, 7
s_add_u32 s77, s59, 640
s_sub_u32 s69, s77, 896
s_min_u32 s77, s77, s69
s_add_u32 s78, s59, 768
s_sub_u32 s69, s78, 896
s_min_u32 s78, s78, s69
s_add_u32 s79, s59, 384
s_sub_u32 s69, s79, 896
s_min_u32 s79, s79, s69
s_add_u32 s80, s59, 0
s_sub_u32 s69, s80, 896
s_min_u32 s80, s80, s69
s_add_u32 s81, s59, 128
s_sub_u32 s69, s81, 896
s_min_u32 s81, s81, s69
s_add_u32 s82, s59, 256
s_sub_u32 s69, s82, 896
s_min_u32 s82, s82, s69
s_add_u32 s14, s14, s60
s_addc_u32 s15, s15, 0
s_lshl_b32 s66, s64, 1
s_lshl_b32 s60, s66, 12
s_add_u32 s60, s60, 33554432
s_add_u32 s72, s18, s60
s_addc_u32 s73, s19, 0
s_mov_b32 s74, 4096
s_mov_b32 s75, 0x20000
s_lshl_b32 s60, s67, 8
v_lshlrev_b32 v7, 2, v1
v_mov_b32 v8, 0
s_mov_b32 s74, s71
buffer_store_dword v8, v7, s[72:75], s60 offen sc1
s_mov_b32 s74, 4096
s_lshl_b32 s60, s64, 3
s_add_u32 s60, s60, s65
s_lshl_b32 s60, s60, 18
s_add_u32 s62, s60, s61
s_add_u32 s28, s8, s62
s_addc_u32 s29, s9, 0
s_sub_u32 s30, 262144, s61
s_mov_b32 s31, 0x20000
s_lshl_b32 s62, s52, 16
s_add_u32 s62, s62, s60
s_add_u32 s24, s6, s62
s_addc_u32 s25, s7, 0
s_mov_b32 s26, 65536
s_mov_b32 s27, 0x20000
s_add_u32 s54, s52, s64
s_and_b32 s54, s54, 7
s_lshl_b32 s62, s54, 7
s_mul_i32 s60, s67, 229376
s_add_u32 s60, s60, s62
s_add_u32 s36, s12, s60
s_addc_u32 s37, s13, 0
s_sub_u32 s38, 229376, s62
s_mov_b32 s39, 0x20000
s_mul_i32 s60, s66, 896
s_add_u32 s60, s60, s67
s_lshl_b32 s60, s60, 10
s_lshl_b32 s62, s54, 17
s_add_u32 s60, s60, s62
s_add_u32 s44, s18, s60
s_addc_u32 s45, s19, 0
s_mov_b32 s46, 131072
s_mov_b32 s47, 0x20000
s_cmp_lt_u32 s54, 7
s_cselect_b32 s38, s38, 0
s_cselect_b32 s46, s46, 0
s_add_u32 s54, s52, s64
s_add_u32 s54, s54, 4
s_and_b32 s54, s54, 7
s_lshl_b32 s62, s54, 7
s_mul_i32 s60, s67, 229376
s_add_u32 s60, s60, s62
s_add_u32 s40, s12, s60
s_addc_u32 s41, s13, 0
s_sub_u32 s42, 229376, s62
s_mov_b32 s43, 0x20000
s_mul_i32 s60, s66, 896
s_add_u32 s60, s60, s67
s_lshl_b32 s60, s60, 10
s_lshl_b32 s62, s54, 17
s_add_u32 s60, s60, s62
s_add_u32 s48, s18, s60
s_addc_u32 s49, s19, 0
s_mov_b32 s50, 131072
s_mov_b32 s51, 0x20000
s_cmp_lt_u32 s54, 7
s_cselect_b32 s42, s42, 0
s_cselect_b32 s50, s50, 0
s_add_u32 s60, s52, 0
s_and_b32 s60, s60, 3
s_lshl_b32 s54, s60, 7
s_mul_i32 s4, s60, 57344
s_lshl_b32 s60, s60, 14
v_lshl_add_u32 v235, v1, 4, s60
s_add_u32 s60, s52, 1
s_and_b32 s60, s60, 3
s_lshl_b32 s55, s60, 7
s_mul_i32 s5, s60, 57344
s_lshl_b32 s60, s60, 14
v_lshl_add_u32 v236, v1, 4, s60
s_add_u32 s60, s52, 2
s_and_b32 s60, s60, 3
s_lshl_b32 s56, s60, 7
s_mul_i32 s6, s60, 57344
s_lshl_b32 s60, s60, 14
v_lshl_add_u32 v237, v1, 4, s60
s_add_u32 s60, s52, 3
s_and_b32 s60, s60, 3
s_lshl_b32 s57, s60, 7
s_mul_i32 s7, s60, 57344
s_lshl_b32 s60, s60, 14
v_lshl_add_u32 v238, v1, 4, s60
s_mov_b32 s63, 0x3db8aa3b
v_and_b32 v11, 15, v1
v_lshrrev_b32 v6, 1, v11
v_xor_b32 v7, v6, v5
v_lshlrev_b32 v7, 4, v7
v_lshl_add_u32 v228, v11, 7, v7
v_xor_b32 v229, 64, v228
v_bfe_u32 v7, v1, 3, 2
v_lshlrev_b32 v7, 5, v7
v_and_b32 v8, 3, v1
v_lshl_add_u32 v7, v8, 3, v7
v_bfe_u32 v8, v1, 2, 2
v_lshl_add_u32 v7, v8, 7, v7
v_lshl_add_u32 v7, v5, 10, v7
v_add_u32 v230, s53, v7
v_xor_b32 v231, 32, v230
v_xor_b32 v232, 64, v230
v_xor_b32 v233, 96, v230
v_lshlrev_b32 v254, 9, v5
v_lshrrev_b32 v7, 1, v5
v_xor_b32 v7, v7, v6
v_lshlrev_b32 v7, 4, v7
v_lshl_add_u32 v7, v11, 7, v7
v_and_b32 v8, 1, v5
v_lshl_add_u32 v7, v8, 3, v7
v_add_u32 v224, s53, v7
v_xor_b32 v225, 32, v224
v_xor_b32 v226, 64, v224
v_xor_b32 v227, 96, v224
v_lshlrev_b32 v6, 9, v3
v_add_u32 v212, v6, v9
v_add_u32 v213, v6, v10
v_add_u32 v214, 6144, v212
v_add_u32 v215, 9216, v213
v_add_u32 v213, 3072, v213
v_lshlrev_b32 v12, 1, v5
v_xor_b32 v12, v4, v12
v_lshlrev_b32 v12, 4, v12
v_add_u32 v216, v6, v12
v_add_u32 v217, 3072, v216
v_add_u32 v218, 6144, v216
v_add_u32 v219, 9216, v216
v_mul_u32_u24 v6, 896, v3
v_add_u32 v220, v6, v12
v_add_u32 v221, 6144, v220
v_add_u32 v222, 12288, v220
v_add_u32 v223, 18432, v220
v_lshlrev_b32 v234, 4, v1
v_add_u32 v241, s53, v234
v_lshlrev_b32 v6, 7, v1
v_accvgpr_write_b32 a250, v6
v_and_b32 v6, 31, v1
v_lshlrev_b32 v6, 9, v6
v_lshrrev_b32 v7, 5, v1
v_lshl_add_u32 v6, v7, 16, v6
v_accvgpr_write_b32 a251, v6
v_mul_u32_u24 v6, 896, v1
v_accvgpr_write_b32 a252, v6
v_lshlrev_b32 v6, 4, v11
v_lshl_add_u32 v240, v2, 14, v6
v_lshl_add_u32 v6, v5, 2, v6
v_lshl_add_u32 v239, v2, 8, v6
s_add_u32 m0, s53, 0
s_lshl_b32 s58, s76, 12
buffer_load_dwordx4 v208, s[32:35], s58 offen lds
buffer_load_dwordx4 v209, s[32:35], s58 offen offset:1024 lds
buffer_load_dwordx4 v210, s[32:35], s58 offen offset:2048 lds
buffer_load_dwordx4 v211, s[32:35], s58 offen offset:3072 lds
s_add_u32 m0, s53, 4096
s_lshl_b32 s58, s76, 12
s_add_u32 s58, s58, 262144
buffer_load_dwordx4 v208, s[32:35], s58 offen lds
buffer_load_dwordx4 v209, s[32:35], s58 offen offset:1024 lds
buffer_load_dwordx4 v210, s[32:35], s58 offen offset:2048 lds
s_waitcnt vmcnt(8)
s_barrier
buffer_load_dwordx4 v211, s[32:35], s58 offen offset:3072 lds
s_add_u32 m0, s53, 8192
s_lshl_b32 s58, s77, 12
buffer_load_dwordx4 v208, s[32:35], s58 offen lds
buffer_load_dwordx4 v209, s[32:35], s58 offen offset:1024 lds
buffer_load_dwordx4 v210, s[32:35], s58 offen offset:2048 lds
buffer_load_dwordx4 v211, s[32:35], s58 offen offset:3072 lds
s_waitcnt vmcnt(8)
ds_read_b64_tr_b16 a[96:97], v230 offset:0
ds_read_b64_tr_b16 a[98:99], v230 offset:512
ds_read_b128 a[112:115], v228 offset:8192
ds_read_b128 a[116:119], v228 offset:10240
ds_read_b128 a[120:123], v228 offset:12288
ds_read_b128 a[124:127], v228 offset:14336
ds_read_b64_tr_b16 a[100:101], v231 offset:0
ds_read_b64_tr_b16 a[102:103], v231 offset:512
ds_read_b64_tr_b16 a[104:105], v232 offset:0
ds_read_b64_tr_b16 a[106:107], v232 offset:512
ds_read_b64_tr_b16 a[108:109], v233 offset:0
ds_read_b64_tr_b16 a[110:111], v233 offset:512
s_waitcnt lgkmcnt(9)
v_mfma_f32_16x16x32_bf16 v[128:131], a[96:99], a[112:115], 0
s_add_u32 m0, s68, 16384
s_nop 0
buffer_load_dwordx4 v250, s[20:23], s80 offen lds
buffer_load_dwordx4 v251, s[20:23], s80 offen offset:1024 lds
s_add_u32 m0, s53, 12288
s_lshl_b32 s58, s77, 12
s_add_u32 s58, s58, 262144
buffer_load_dwordx4 v208, s[32:35], s58 offen lds
buffer_load_dwordx4 v209, s[32:35], s58 offen offset:1024 lds
s_waitcnt vmcnt(8)
buffer_load_dwordx4 v210, s[32:35], s58 offen offset:2048 lds
s_waitcnt lgkmcnt(8)
v_mfma_f32_16x16x32_bf16 v[136:139], a[96:99], a[116:119], 0
ds_read_b64_tr_b16 a[128:129], v230 offset:4096
ds_read_b64_tr_b16 a[130:131], v230 offset:4608
s_waitcnt lgkmcnt(9)
v_mfma_f32_16x16x32_bf16 v[144:147], a[96:99], a[120:123], 0
ds_read_b128 a[144:147], v229 offset:8192
ds_read_b128 a[148:151], v229 offset:10240
s_waitcnt lgkmcnt(10)
v_mfma_f32_16x16x32_bf16 v[152:155], a[96:99], a[124:127], 0
ds_read_b128 a[152:155], v229 offset:12288
s_waitcnt lgkmcnt(9)
v_mfma_f32_16x16x32_bf16 v[156:159], a[100:103], a[124:127], 0
ds_read_b128 a[156:159], v229 offset:14336
ds_read_b64_tr_b16 a[132:133], v231 offset:4096
v_mfma_f32_16x16x32_bf16 v[148:151], a[100:103], a[120:123], 0
ds_read_b64_tr_b16 a[134:135], v231 offset:4608
ds_read_b64_tr_b16 a[136:137], v232 offset:4096
v_mfma_f32_16x16x32_bf16 v[140:143], a[100:103], a[116:119], 0
ds_read_b64_tr_b16 a[138:139], v232 offset:4608
buffer_load_dwordx4 v211, s[32:35], s58 offen offset:3072 lds
v_mfma_f32_16x16x32_bf16 v[132:135], a[100:103], a[112:115], 0
s_add_u32 m0, s53, 16384
s_lshl_b32 s58, s78, 12
s_waitcnt lgkmcnt(12)
v_mfma_f32_16x16x32_bf16 v[160:163], a[104:107], a[112:115], 0
ds_read_b64_tr_b16 a[140:141], v233 offset:4096
ds_read_b64_tr_b16 a[142:143], v233 offset:4608
v_mfma_f32_16x16x32_bf16 v[168:171], a[104:107], a[116:119], 0
buffer_load_dwordx4 v208, s[32:35], s58 offen lds
v_mfma_f32_16x16x32_bf16 v[176:179], a[104:107], a[120:123], 0
v_mfma_f32_16x16x32_bf16 v[184:187], a[104:107], a[124:127], 0
buffer_load_dwordx4 v209, s[32:35], s58 offen offset:1024 lds
s_waitcnt lgkmcnt(12)
v_mfma_f32_16x16x32_bf16 v[188:191], a[108:111], a[124:127], 0
buffer_load_dwordx4 v210, s[32:35], s58 offen offset:2048 lds
v_mfma_f32_16x16x32_bf16 v[180:183], a[108:111], a[120:123], 0
v_mfma_f32_16x16x32_bf16 v[172:175], a[108:111], a[116:119], 0
buffer_load_dwordx4 v211, s[32:35], s58 offen offset:3072 lds
v_mfma_f32_16x16x32_bf16 v[164:167], a[108:111], a[112:115], 0
s_add_u32 m0, s68, 32768
s_waitcnt lgkmcnt(0)
v_mfma_f32_16x16x32_bf16 v[128:131], a[128:131], a[144:147], v[128:131]
s_waitcnt vmcnt(10)
ds_read_b64_tr_b16 a[96:97], v230 offset:8192
v_mfma_f32_16x16x32_bf16 v[136:139], a[128:131], a[148:151], v[136:139]
ds_read_b64_tr_b16 a[98:99], v230 offset:8704
ds_read_b128 a[112:115], v228 offset:24576
v_mfma_f32_16x16x32_bf16 v[144:147], a[128:131], a[152:155], v[144:147]
ds_read_b128 a[116:119], v228 offset:26624
ds_read_b128 a[120:123], v228 offset:28672
v_mfma_f32_16x16x32_bf16 v[152:155], a[128:131], a[156:159], v[152:155]
buffer_load_dwordx4 v250, s[20:23], s81 offen lds
v_mfma_f32_16x16x32_bf16 v[156:159], a[132:135], a[156:159], v[156:159]
ds_read_b128 a[124:127], v228 offset:30720
ds_read_b64_tr_b16 a[100:101], v231 offset:8192
v_mfma_f32_16x16x32_bf16 v[148:151], a[132:135], a[152:155], v[148:151]
ds_read_b64_tr_b16 a[102:103], v231 offset:8704
ds_read_b64_tr_b16 a[104:105], v232 offset:8192
v_mfma_f32_16x16x32_bf16 v[140:143], a[132:135], a[148:151], v[140:143]
ds_read_b64_tr_b16 a[106:107], v232 offset:8704
v_mfma_f32_16x16x32_bf16 v[132:135], a[132:135], a[144:147], v[132:135]
buffer_load_dwordx4 v251, s[20:23], s81 offen offset:1024 lds
v_mfma_f32_16x16x32_bf16 v[160:163], a[136:139], a[144:147], v[160:163]
ds_read_b64_tr_b16 a[108:109], v233 offset:8192
ds_read_b64_tr_b16 a[110:111], v233 offset:8704
v_mfma_f32_16x16x32_bf16 v[168:171], a[136:139], a[148:151], v[168:171]
s_add_u32 m0, s53, 20480
s_lshl_b32 s58, s78, 12
v_mfma_f32_16x16x32_bf16 v[176:179], a[136:139], a[152:155], v[176:179]
s_add_u32 s58, s58, 262144
v_mfma_f32_16x16x32_bf16 v[184:187], a[136:139], a[156:159], v[184:187]
buffer_load_dwordx4 v208, s[32:35], s58 offen lds
v_mfma_f32_16x16x32_bf16 v[188:191], a[140:143], a[156:159], v[188:191]
v_mfma_f32_16x16x32_bf16 v[180:183], a[140:143], a[152:155], v[180:183]
buffer_load_dwordx4 v209, s[32:35], s58 offen offset:1024 lds
v_mfma_f32_16x16x32_bf16 v[172:175], a[140:143], a[148:151], v[172:175]
v_mfma_f32_16x16x32_bf16 v[164:167], a[140:143], a[144:147], v[164:167]
s_waitcnt lgkmcnt(0)
v_mfma_f32_16x16x32_bf16 v[128:131], a[96:99], a[112:115], v[128:131]
s_waitcnt vmcnt(8)
v_mfma_f32_16x16x32_bf16 v[136:139], a[96:99], a[116:119], v[136:139]
ds_read_b64_tr_b16 a[128:129], v230 offset:12288
ds_read_b64_tr_b16 a[130:131], v230 offset:12800
buffer_load_dwordx4 v210, s[32:35], s58 offen offset:2048 lds
v_mfma_f32_16x16x32_bf16 v[144:147], a[96:99], a[120:123], v[144:147]
ds_read_b128 a[144:147], v229 offset:24576
ds_read_b128 a[148:151], v229 offset:26624
v_mfma_f32_16x16x32_bf16 v[152:155], a[96:99], a[124:127], v[152:155]
buffer_load_dwordx4 v211, s[32:35], s58 offen offset:3072 lds
v_mfma_f32_16x16x32_bf16 v[156:159], a[100:103], a[124:127], v[156:159]
ds_read_b128 a[152:155], v229 offset:28672
ds_read_b128 a[156:159], v229 offset:30720
v_mfma_f32_16x16x32_bf16 v[148:151], a[100:103], a[120:123], v[148:151]
ds_read_b64_tr_b16 a[132:133], v231 offset:12288
ds_read_b64_tr_b16 a[134:135], v231 offset:12800
v_mfma_f32_16x16x32_bf16 v[140:143], a[100:103], a[116:119], v[140:143]
ds_read_b64_tr_b16 a[136:137], v232 offset:12288
ds_read_b64_tr_b16 a[138:139], v232 offset:12800
v_mfma_f32_16x16x32_bf16 v[132:135], a[100:103], a[112:115], v[132:135]
s_add_u32 m0, s53, 0
s_lshl_b32 s58, s79, 12
v_mfma_f32_16x16x32_bf16 v[160:163], a[104:107], a[112:115], v[160:163]
ds_read_b64_tr_b16 a[140:141], v233 offset:12288
ds_read_b64_tr_b16 a[142:143], v233 offset:12800
v_mfma_f32_16x16x32_bf16 v[168:171], a[104:107], a[116:119], v[168:171]
buffer_load_dwordx4 v208, s[32:35], s58 offen lds
v_mfma_f32_16x16x32_bf16 v[176:179], a[104:107], a[120:123], v[176:179]
v_mfma_f32_16x16x32_bf16 v[184:187], a[104:107], a[124:127], v[184:187]
buffer_load_dwordx4 v209, s[32:35], s58 offen offset:1024 lds
v_mfma_f32_16x16x32_bf16 v[188:191], a[108:111], a[124:127], v[188:191]
v_mfma_f32_16x16x32_bf16 v[180:183], a[108:111], a[120:123], v[180:183]
buffer_load_dwordx4 v210, s[32:35], s58 offen offset:2048 lds
v_mfma_f32_16x16x32_bf16 v[172:175], a[108:111], a[116:119], v[172:175]
v_mfma_f32_16x16x32_bf16 v[164:167], a[108:111], a[112:115], v[164:167]
s_waitcnt lgkmcnt(0)
v_mfma_f32_16x16x32_bf16 v[128:131], a[128:131], a[144:147], v[128:131]
s_waitcnt vmcnt(9)
ds_read_b64_tr_b16 a[96:97], v230 offset:16384
v_mfma_f32_16x16x32_bf16 v[136:139], a[128:131], a[148:151], v[136:139]
ds_read_b64_tr_b16 a[98:99], v230 offset:16896
ds_read_b128 a[112:115], v228 offset:40960
v_mfma_f32_16x16x32_bf16 v[144:147], a[128:131], a[152:155], v[144:147]
ds_read_b128 a[116:119], v228 offset:43008
ds_read_b128 a[120:123], v228 offset:45056
v_mfma_f32_16x16x32_bf16 v[152:155], a[128:131], a[156:159], v[152:155]
buffer_load_dwordx4 v211, s[32:35], s58 offen offset:3072 lds
v_mfma_f32_16x16x32_bf16 v[156:159], a[132:135], a[156:159], v[156:159]
ds_read_b128 a[124:127], v228 offset:47104
ds_read_b64_tr_b16 a[100:101], v231 offset:16384
v_mfma_f32_16x16x32_bf16 v[148:151], a[132:135], a[152:155], v[148:151]
ds_read_b64_tr_b16 a[102:103], v231 offset:16896
ds_read_b64_tr_b16 a[104:105], v232 offset:16384
v_mfma_f32_16x16x32_bf16 v[140:143], a[132:135], a[148:151], v[140:143]
ds_read_b64_tr_b16 a[106:107], v232 offset:16896
s_add_u32 m0, s68, 49152
v_mfma_f32_16x16x32_bf16 v[132:135], a[132:135], a[144:147], v[132:135]
buffer_load_dwordx4 v250, s[20:23], s82 offen lds
v_mfma_f32_16x16x32_bf16 v[160:163], a[136:139], a[144:147], v[160:163]
ds_read_b64_tr_b16 a[108:109], v233 offset:16384
ds_read_b64_tr_b16 a[110:111], v233 offset:16896
v_mfma_f32_16x16x32_bf16 v[168:171], a[136:139], a[148:151], v[168:171]
buffer_load_dwordx4 v251, s[20:23], s82 offen offset:1024 lds
v_mfma_f32_16x16x32_bf16 v[176:179], a[136:139], a[152:155], v[176:179]
s_add_u32 m0, s53, 4096
s_lshl_b32 s58, s79, 12
v_mfma_f32_16x16x32_bf16 v[184:187], a[136:139], a[156:159], v[184:187]
s_add_u32 s58, s58, 262144
v_mfma_f32_16x16x32_bf16 v[188:191], a[140:143], a[156:159], v[188:191]
buffer_load_dwordx4 v208, s[32:35], s58 offen lds
v_mfma_f32_16x16x32_bf16 v[180:183], a[140:143], a[152:155], v[180:183]
v_mfma_f32_16x16x32_bf16 v[172:175], a[140:143], a[148:151], v[172:175]
buffer_load_dwordx4 v209, s[32:35], s58 offen offset:1024 lds
v_mfma_f32_16x16x32_bf16 v[164:167], a[140:143], a[144:147], v[164:167]
s_waitcnt lgkmcnt(0)
v_mfma_f32_16x16x32_bf16 v[128:131], a[96:99], a[112:115], v[128:131]
s_waitcnt vmcnt(8)
v_mfma_f32_16x16x32_bf16 v[136:139], a[96:99], a[116:119], v[136:139]
ds_read_b64_tr_b16 a[128:129], v230 offset:20480
ds_read_b64_tr_b16 a[130:131], v230 offset:20992
v_mfma_f32_16x16x32_bf16 v[144:147], a[96:99], a[120:123], v[144:147]
ds_read_b128 a[144:147], v229 offset:40960
ds_read_b128 a[148:151], v229 offset:43008
v_mfma_f32_16x16x32_bf16 v[152:155], a[96:99], a[124:127], v[152:155]
buffer_load_dwordx4 v210, s[32:35], s58 offen offset:2048 lds
v_mfma_f32_16x16x32_bf16 v[156:159], a[100:103], a[124:127], v[156:159]
ds_read_b128 a[152:155], v229 offset:45056
ds_read_b128 a[156:159], v229 offset:47104
v_mfma_f32_16x16x32_bf16 v[148:151], a[100:103], a[120:123], v[148:151]
ds_read_b64_tr_b16 a[132:133], v231 offset:20480
ds_read_b64_tr_b16 a[134:135], v231 offset:20992
v_mfma_f32_16x16x32_bf16 v[140:143], a[100:103], a[116:119], v[140:143]
ds_read_b64_tr_b16 a[136:137], v232 offset:20480
ds_read_b64_tr_b16 a[138:139], v232 offset:20992
v_mfma_f32_16x16x32_bf16 v[132:135], a[100:103], a[112:115], v[132:135]
buffer_load_dwordx4 v211, s[32:35], s58 offen offset:3072 lds
v_mfma_f32_16x16x32_bf16 v[160:163], a[104:107], a[112:115], v[160:163]
ds_read_b64_tr_b16 a[140:141], v233 offset:20480
ds_read_b64_tr_b16 a[142:143], v233 offset:20992
v_mfma_f32_16x16x32_bf16 v[168:171], a[104:107], a[116:119], v[168:171]
s_add_u32 m0, s53, 8192
s_lshl_b32 s58, s80, 12
v_mfma_f32_16x16x32_bf16 v[176:179], a[104:107], a[120:123], v[176:179]
buffer_load_dwordx4 v208, s[32:35], s58 offen lds
v_mfma_f32_16x16x32_bf16 v[184:187], a[104:107], a[124:127], v[184:187]
v_mfma_f32_16x16x32_bf16 v[188:191], a[108:111], a[124:127], v[188:191]
buffer_load_dwordx4 v209, s[32:35], s58 offen offset:1024 lds
v_mfma_f32_16x16x32_bf16 v[180:183], a[108:111], a[120:123], v[180:183]
v_mfma_f32_16x16x32_bf16 v[172:175], a[108:111], a[116:119], v[172:175]
buffer_load_dwordx4 v210, s[32:35], s58 offen offset:2048 lds
v_mfma_f32_16x16x32_bf16 v[164:167], a[108:111], a[112:115], v[164:167]
s_waitcnt lgkmcnt(0)
v_mfma_f32_16x16x32_bf16 v[128:131], a[128:131], a[144:147], v[128:131]
s_waitcnt vmcnt(9)
ds_read_b64_tr_b16 a[96:97], v230 offset:0
v_mfma_f32_16x16x32_bf16 v[136:139], a[128:131], a[148:151], v[136:139]
ds_read_b64_tr_b16 a[98:99], v230 offset:512
ds_read_b128 a[112:115], v228 offset:0
v_mfma_f32_16x16x32_bf16 v[144:147], a[128:131], a[152:155], v[144:147]
ds_read_b128 a[116:119], v228 offset:2048
ds_read_b128 a[120:123], v228 offset:4096
v_mfma_f32_16x16x32_bf16 v[152:155], a[128:131], a[156:159], v[152:155]
buffer_load_dwordx4 v211, s[32:35], s58 offen offset:3072 lds
v_mfma_f32_16x16x32_bf16 v[156:159], a[132:135], a[156:159], v[156:159]
ds_read_b128 a[124:127], v228 offset:6144
ds_read_b64_tr_b16 a[100:101], v231 offset:0
v_mfma_f32_16x16x32_bf16 v[148:151], a[132:135], a[152:155], v[148:151]
ds_read_b64_tr_b16 a[102:103], v231 offset:512
ds_read_b64_tr_b16 a[104:105], v232 offset:0
v_mfma_f32_16x16x32_bf16 v[140:143], a[132:135], a[148:151], v[140:143]
ds_read_b64_tr_b16 a[106:107], v232 offset:512
s_add_u32 m0, s53, 12288
v_mfma_f32_16x16x32_bf16 v[132:135], a[132:135], a[144:147], v[132:135]
s_lshl_b32 s58, s80, 12
s_add_u32 s58, s58, 262144
v_mfma_f32_16x16x32_bf16 v[160:163], a[136:139], a[144:147], v[160:163]
ds_read_b64_tr_b16 a[108:109], v233 offset:0
ds_read_b64_tr_b16 a[110:111], v233 offset:512
v_mfma_f32_16x16x32_bf16 v[168:171], a[136:139], a[148:151], v[168:171]
buffer_load_dwordx4 v208, s[32:35], s58 offen lds
v_mfma_f32_16x16x32_bf16 v[176:179], a[136:139], a[152:155], v[176:179]
v_mfma_f32_16x16x32_bf16 v[184:187], a[136:139], a[156:159], v[184:187]
buffer_load_dwordx4 v209, s[32:35], s58 offen offset:1024 lds
v_mfma_f32_16x16x32_bf16 v[188:191], a[140:143], a[156:159], v[188:191]
v_mfma_f32_16x16x32_bf16 v[180:183], a[140:143], a[152:155], v[180:183]
buffer_load_dwordx4 v210, s[32:35], s58 offen offset:2048 lds
v_mfma_f32_16x16x32_bf16 v[172:175], a[140:143], a[148:151], v[172:175]
v_mfma_f32_16x16x32_bf16 v[164:167], a[140:143], a[144:147], v[164:167]
s_waitcnt lgkmcnt(0)
v_mfma_f32_16x16x32_bf16 v[128:131], a[96:99], a[112:115], v[128:131]
buffer_load_dwordx4 v211, s[32:35], s58 offen offset:3072 lds
s_waitcnt vmcnt(8)
v_mfma_f32_16x16x32_bf16 v[136:139], a[96:99], a[116:119], v[136:139]
ds_read_b64_tr_b16 a[128:129], v230 offset:4096
ds_read_b64_tr_b16 a[130:131], v230 offset:4608
v_mfma_f32_16x16x32_bf16 v[144:147], a[96:99], a[120:123], v[144:147]
ds_read_b128 a[144:147], v229 offset:0
ds_read_b128 a[148:151], v229 offset:2048
v_mfma_f32_16x16x32_bf16 v[152:155], a[96:99], a[124:127], v[152:155]
s_add_u32 m0, s53, 16384
s_lshl_b32 s58, s81, 12
buffer_load_dwordx4 v208, s[32:35], s58 offen lds
v_mfma_f32_16x16x32_bf16 v[156:159], a[100:103], a[124:127], v[156:159]
ds_read_b128 a[152:155], v229 offset:4096
ds_read_b128 a[156:159], v229 offset:6144
v_mfma_f32_16x16x32_bf16 v[148:151], a[100:103], a[120:123], v[148:151]
ds_read_b64_tr_b16 a[132:133], v231 offset:4096
ds_read_b64_tr_b16 a[134:135], v231 offset:4608
v_mfma_f32_16x16x32_bf16 v[140:143], a[100:103], a[116:119], v[140:143]
ds_read_b64_tr_b16 a[136:137], v232 offset:4096
ds_read_b64_tr_b16 a[138:139], v232 offset:4608
v_mfma_f32_16x16x32_bf16 v[132:135], a[100:103], a[112:115], v[132:135]
buffer_load_dwordx4 v209, s[32:35], s58 offen offset:1024 lds
v_mfma_f32_16x16x32_bf16 v[160:163], a[104:107], a[112:115], v[160:163]
ds_read_b64_tr_b16 a[140:141], v233 offset:4096
ds_read_b64_tr_b16 a[142:143], v233 offset:4608
v_mfma_f32_16x16x32_bf16 v[168:171], a[104:107], a[116:119], v[168:171]
buffer_load_dwordx4 v210, s[32:35], s58 offen offset:2048 lds
v_mfma_f32_16x16x32_bf16 v[176:179], a[104:107], a[120:123], v[176:179]
v_mfma_f32_16x16x32_bf16 v[184:187], a[104:107], a[124:127], v[184:187]
buffer_load_dwordx4 v211, s[32:35], s58 offen offset:3072 lds
v_mfma_f32_16x16x32_bf16 v[188:191], a[108:111], a[124:127], v[188:191]
s_add_u32 m0, s53, 20480
s_lshl_b32 s58, s81, 12
v_mfma_f32_16x16x32_bf16 v[180:183], a[108:111], a[120:123], v[180:183]
s_add_u32 s58, s58, 262144
v_mfma_f32_16x16x32_bf16 v[172:175], a[108:111], a[116:119], v[172:175]
buffer_load_dwordx4 v208, s[32:35], s58 offen lds
v_mfma_f32_16x16x32_bf16 v[164:167], a[108:111], a[112:115], v[164:167]
s_waitcnt lgkmcnt(0)
v_mfma_f32_16x16x32_bf16 v[128:131], a[128:131], a[144:147], v[128:131]
s_barrier
v_mfma_f32_16x16x32_bf16 v[136:139], a[128:131], a[148:151], v[136:139]
s_waitcnt vmcnt(9)
ds_read_b64_tr_b16 a[96:97], v230 offset:8192
buffer_load_dwordx4 v209, s[32:35], s58 offen offset:1024 lds
v_mfma_f32_16x16x32_bf16 v[144:147], a[128:131], a[152:155], v[144:147]
ds_read_b64_tr_b16 a[98:99], v230 offset:8704
ds_read_b128 a[112:115], v228 offset:16384
v_mfma_f32_16x16x32_bf16 v[152:155], a[128:131], a[156:159], v[152:155]
buffer_load_dwordx4 v210, s[32:35], s58 offen offset:2048 lds
v_mfma_f32_16x16x32_bf16 v[156:159], a[132:135], a[156:159], v[156:159]
ds_read_b128 a[116:119], v228 offset:18432
ds_read_b128 a[120:123], v228 offset:20480
v_mfma_f32_16x16x32_bf16 v[148:151], a[132:135], a[152:155], v[148:151]
ds_read_b128 a[124:127], v228 offset:22528
ds_read_b64_tr_b16 a[100:101], v231 offset:8192
v_mfma_f32_16x16x32_bf16 v[140:143], a[132:135], a[148:151], v[140:143]
ds_read_b64_tr_b16 a[102:103], v231 offset:8704
ds_read_b64_tr_b16 a[104:105], v232 offset:8192
v_mfma_f32_16x16x32_bf16 v[132:135], a[132:135], a[144:147], v[132:135]
buffer_load_dwordx4 v211, s[32:35], s58 offen offset:3072 lds
v_mfma_f32_16x16x32_bf16 v[160:163], a[136:139], a[144:147], v[160:163]
ds_read_b64_tr_b16 a[106:107], v232 offset:8704
ds_read_b64_tr_b16 a[108:109], v233 offset:8192
v_mfma_f32_16x16x32_bf16 v[168:171], a[136:139], a[148:151], v[168:171]
ds_read_b64_tr_b16 a[110:111], v233 offset:8704
s_add_u32 m0, s53, 0
v_mfma_f32_16x16x32_bf16 v[176:179], a[136:139], a[152:155], v[176:179]
s_lshl_b32 s58, s82, 12
v_mfma_f32_16x16x32_bf16 v[184:187], a[136:139], a[156:159], v[184:187]
buffer_load_dwordx4 v208, s[32:35], s58 offen lds
v_mfma_f32_16x16x32_bf16 v[188:191], a[140:143], a[156:159], v[188:191]
v_mfma_f32_16x16x32_bf16 v[180:183], a[140:143], a[152:155], v[180:183]
buffer_load_dwordx4 v209, s[32:35], s58 offen offset:1024 lds
v_mfma_f32_16x16x32_bf16 v[172:175], a[140:143], a[148:151], v[172:175]
v_mfma_f32_16x16x32_bf16 v[164:167], a[140:143], a[144:147], v[164:167]
s_waitcnt lgkmcnt(0)
v_mfma_f32_16x16x32_bf16 v[128:131], a[96:99], a[112:115], v[128:131]
s_waitcnt vmcnt(10)
ds_read_b64_tr_b16 a[128:129], v230 offset:12288
v_mfma_f32_16x16x32_bf16 v[136:139], a[96:99], a[116:119], v[136:139]
ds_read_b64_tr_b16 a[130:131], v230 offset:12800
ds_read_b128 a[144:147], v229 offset:16384
v_mfma_f32_16x16x32_bf16 v[144:147], a[96:99], a[120:123], v[144:147]
ds_read_b128 a[148:151], v229 offset:18432
ds_read_b128 a[152:155], v229 offset:20480
v_mfma_f32_16x16x32_bf16 v[152:155], a[96:99], a[124:127], v[152:155]
buffer_load_dwordx4 v210, s[32:35], s58 offen offset:2048 lds
v_mfma_f32_16x16x32_bf16 v[156:159], a[100:103], a[124:127], v[156:159]
ds_read_b128 a[156:159], v229 offset:22528
ds_read_b64_tr_b16 a[132:133], v231 offset:12288
v_mfma_f32_16x16x32_bf16 v[148:151], a[100:103], a[120:123], v[148:151]
ds_read_b64_tr_b16 a[134:135], v231 offset:12800
ds_read_b64_tr_b16 a[136:137], v232 offset:12288
v_mfma_f32_16x16x32_bf16 v[140:143], a[100:103], a[116:119], v[140:143]
ds_read_b64_tr_b16 a[138:139], v232 offset:12800
v_mfma_f32_16x16x32_bf16 v[132:135], a[100:103], a[112:115], v[132:135]
buffer_load_dwordx4 v211, s[32:35], s58 offen offset:3072 lds
v_mfma_f32_16x16x32_bf16 v[160:163], a[104:107], a[112:115], v[160:163]
ds_read_b64_tr_b16 a[140:141], v233 offset:12288
ds_read_b64_tr_b16 a[142:143], v233 offset:12800
v_mfma_f32_16x16x32_bf16 v[168:171], a[104:107], a[116:119], v[168:171]
s_add_u32 m0, s53, 4096
s_lshl_b32 s58, s82, 12
v_mfma_f32_16x16x32_bf16 v[176:179], a[104:107], a[120:123], v[176:179]
s_add_u32 s58, s58, 262144
v_mfma_f32_16x16x32_bf16 v[184:187], a[104:107], a[124:127], v[184:187]
buffer_load_dwordx4 v208, s[32:35], s58 offen lds
v_mfma_f32_16x16x32_bf16 v[188:191], a[108:111], a[124:127], v[188:191]
v_mfma_f32_16x16x32_bf16 v[180:183], a[108:111], a[120:123], v[180:183]
buffer_load_dwordx4 v209, s[32:35], s58 offen offset:1024 lds
v_mfma_f32_16x16x32_bf16 v[172:175], a[108:111], a[116:119], v[172:175]
v_mfma_f32_16x16x32_bf16 v[164:167], a[108:111], a[112:115], v[164:167]
s_waitcnt lgkmcnt(0)
v_mfma_f32_16x16x32_bf16 v[128:131], a[128:131], a[144:147], v[128:131]
s_waitcnt vmcnt(10)
ds_read_b64_tr_b16 a[96:97], v230 offset:16384
v_mfma_f32_16x16x32_bf16 v[136:139], a[128:131], a[148:151], v[136:139]
ds_read_b64_tr_b16 a[98:99], v230 offset:16896
ds_read_b128 a[112:115], v228 offset:32768
v_mfma_f32_16x16x32_bf16 v[144:147], a[128:131], a[152:155], v[144:147]
ds_read_b128 a[116:119], v228 offset:34816
ds_read_b128 a[120:123], v228 offset:36864
v_mfma_f32_16x16x32_bf16 v[152:155], a[128:131], a[156:159], v[152:155]
buffer_load_dwordx4 v210, s[32:35], s58 offen offset:2048 lds
v_mfma_f32_16x16x32_bf16 v[156:159], a[132:135], a[156:159], v[156:159]
ds_read_b128 a[124:127], v228 offset:38912
ds_read_b64_tr_b16 a[100:101], v231 offset:16384
v_mfma_f32_16x16x32_bf16 v[148:151], a[132:135], a[152:155], v[148:151]
ds_read_b64_tr_b16 a[102:103], v231 offset:16896
ds_read_b64_tr_b16 a[104:105], v232 offset:16384
v_mfma_f32_16x16x32_bf16 v[140:143], a[132:135], a[148:151], v[140:143]
ds_read_b64_tr_b16 a[106:107], v232 offset:16896
v_mfma_f32_16x16x32_bf16 v[132:135], a[132:135], a[144:147], v[132:135]
buffer_load_dwordx4 v211, s[32:35], s58 offen offset:3072 lds
v_mfma_f32_16x16x32_bf16 v[160:163], a[136:139], a[144:147], v[160:163]
ds_read_b64_tr_b16 a[108:109], v233 offset:16384
ds_read_b64_tr_b16 a[110:111], v233 offset:16896
v_mfma_f32_16x16x32_bf16 v[168:171], a[136:139], a[148:151], v[168:171]
s_add_u32 m0, s53, 8192
s_add_u32 s58, s54, 0
v_mfma_f32_16x16x32_bf16 v[176:179], a[136:139], a[152:155], v[176:179]
buffer_load_dwordx4 v212, s[24:27], s58 offen lds
v_mfma_f32_16x16x32_bf16 v[184:187], a[136:139], a[156:159], v[184:187]
v_mfma_f32_16x16x32_bf16 v[188:191], a[140:143], a[156:159], v[188:191]
buffer_load_dwordx4 v213, s[24:27], s58 offen offset:1024 lds
v_mfma_f32_16x16x32_bf16 v[180:183], a[140:143], a[152:155], v[180:183]
v_mfma_f32_16x16x32_bf16 v[172:175], a[140:143], a[148:151], v[172:175]
buffer_load_dwordx4 v214, s[24:27], s58 offen offset:2048 lds
v_mfma_f32_16x16x32_bf16 v[164:167], a[140:143], a[144:147], v[164:167]
s_waitcnt lgkmcnt(0)
v_mfma_f32_16x16x32_bf16 v[128:131], a[96:99], a[112:115], v[128:131]
s_waitcnt vmcnt(11)
ds_read_b64_tr_b16 a[128:129], v230 offset:20480
v_mfma_f32_16x16x32_bf16 v[136:139], a[96:99], a[116:119], v[136:139]
ds_read_b64_tr_b16 a[130:131], v230 offset:20992
ds_read_b128 a[144:147], v229 offset:32768
v_mfma_f32_16x16x32_bf16 v[144:147], a[96:99], a[120:123], v[144:147]
ds_read_b128 a[148:151], v229 offset:34816
ds_read_b128 a[152:155], v229 offset:36864
v_mfma_f32_16x16x32_bf16 v[152:155], a[96:99], a[124:127], v[152:155]
buffer_load_dwordx4 v215, s[24:27], s58 offen offset:3072 lds
v_mfma_f32_16x16x32_bf16 v[156:159], a[100:103], a[124:127], v[156:159]
ds_read_b128 a[156:159], v229 offset:38912
ds_read_b64_tr_b16 a[132:133], v231 offset:20480
v_mfma_f32_16x16x32_bf16 v[148:151], a[100:103], a[120:123], v[148:151]
ds_read_b64_tr_b16 a[134:135], v231 offset:20992
ds_read_b64_tr_b16 a[136:137], v232 offset:20480
v_mfma_f32_16x16x32_bf16 v[140:143], a[100:103], a[116:119], v[140:143]
ds_read_b64_tr_b16 a[138:139], v232 offset:20992
s_add_u32 m0, s53, 12288
v_mfma_f32_16x16x32_bf16 v[132:135], a[100:103], a[112:115], v[132:135]
s_add_u32 s58, s54, 16384
ds_read_b64_tr_b16 a[140:141], v233 offset:20480
v_mfma_f32_16x16x32_bf16 v[160:163], a[104:107], a[112:115], v[160:163]
ds_read_b64_tr_b16 a[142:143], v233 offset:20992
v_mfma_f32_16x16x32_bf16 v[168:171], a[104:107], a[116:119], v[168:171]
buffer_load_dwordx4 v212, s[24:27], s58 offen lds
v_mfma_f32_16x16x32_bf16 v[176:179], a[104:107], a[120:123], v[176:179]
v_mfma_f32_16x16x32_bf16 v[184:187], a[104:107], a[124:127], v[184:187]
buffer_load_dwordx4 v213, s[24:27], s58 offen offset:1024 lds
v_mfma_f32_16x16x32_bf16 v[188:191], a[108:111], a[124:127], v[188:191]
v_mfma_f32_16x16x32_bf16 v[180:183], a[108:111], a[120:123], v[180:183]
buffer_load_dwordx4 v214, s[24:27], s58 offen offset:2048 lds
v_mfma_f32_16x16x32_bf16 v[172:175], a[108:111], a[116:119], v[172:175]
v_mfma_f32_16x16x32_bf16 v[164:167], a[108:111], a[112:115], v[164:167]
s_waitcnt lgkmcnt(0)
v_mfma_f32_16x16x32_bf16 v[128:131], a[128:131], a[144:147], v[128:131]
buffer_load_dwordx4 v215, s[24:27], s58 offen offset:3072 lds
s_waitcnt vmcnt(8)
v_mfma_f32_16x16x32_bf16 v[136:139], a[128:131], a[148:151], v[136:139]
ds_read_b64_tr_b16 a[96:97], v230 offset:0
ds_read_b64_tr_b16 a[98:99], v230 offset:512
v_mfma_f32_16x16x32_bf16 v[144:147], a[128:131], a[152:155], v[144:147]
ds_read_b128 a[160:163], v228 offset:49152
ds_read_b128 a[164:167], v228 offset:51200
v_mfma_f32_16x16x32_bf16 v[152:155], a[128:131], a[156:159], v[152:155]
s_add_u32 m0, s53, 16384
s_add_u32 s58, s56, 32768
buffer_load_dwordx4 v212, s[24:27], s58 offen lds
v_mfma_f32_16x16x32_bf16 v[156:159], a[132:135], a[156:159], v[156:159]
ds_read_b128 a[168:171], v228 offset:53248
ds_read_b128 a[172:175], v228 offset:55296
v_mfma_f32_16x16x32_bf16 v[148:151], a[132:135], a[152:155], v[148:151]
ds_read_b64_tr_b16 a[100:101], v231 offset:0
ds_read_b64_tr_b16 a[102:103], v231 offset:512
v_mfma_f32_16x16x32_bf16 v[140:143], a[132:135], a[148:151], v[140:143]
ds_read_b64_tr_b16 a[104:105], v230 offset:4096
ds_read_b64_tr_b16 a[106:107], v230 offset:4608
v_mfma_f32_16x16x32_bf16 v[132:135], a[132:135], a[144:147], v[132:135]
buffer_load_dwordx4 v213, s[24:27], s58 offen offset:1024 lds
v_mfma_f32_16x16x32_bf16 v[160:163], a[136:139], a[144:147], v[160:163]
ds_read_b128 a[176:179], v229 offset:49152
ds_read_b128 a[180:183], v229 offset:51200
v_mfma_f32_16x16x32_bf16 v[168:171], a[136:139], a[148:151], v[168:171]
ds_read_b128 a[184:187], v229 offset:53248
ds_read_b128 a[188:191], v229 offset:55296
v_mfma_f32_16x16x32_bf16 v[176:179], a[136:139], a[152:155], v[176:179]
ds_read_b64_tr_b16 a[108:109], v231 offset:4096
ds_read_b64_tr_b16 a[110:111], v231 offset:4608
v_mfma_f32_16x16x32_bf16 v[184:187], a[136:139], a[156:159], v[184:187]
buffer_load_dwordx4 v214, s[24:27], s58 offen offset:2048 lds
v_mfma_f32_16x16x32_bf16 v[188:191], a[140:143], a[156:159], v[188:191]
v_mfma_f32_16x16x32_bf16 v[180:183], a[140:143], a[152:155], v[180:183]
buffer_load_dwordx4 v215, s[24:27], s58 offen offset:3072 lds
v_mfma_f32_16x16x32_bf16 v[172:175], a[140:143], a[148:151], v[172:175]
s_add_u32 m0, s53, 20480
s_add_u32 s58, s57, 32768
v_mfma_f32_16x16x32_bf16 v[164:167], a[140:143], a[144:147], v[164:167]
s_waitcnt lgkmcnt(10)
v_mfma_f32_16x16x32_bf16 v[128:131], a[96:99], a[160:163], v[128:131]
ds_read_b64_tr_b16 a[128:129], v232 offset:0
ds_read_b64_tr_b16 a[130:131], v232 offset:512
v_mfma_f32_16x16x32_bf16 v[136:139], a[96:99], a[164:167], v[136:139]
ds_read_b64_tr_b16 a[132:133], v233 offset:0
ds_read_b64_tr_b16 a[134:135], v233 offset:512
v_mfma_f32_16x16x32_bf16 v[144:147], a[96:99], a[168:171], v[144:147]
ds_read_b64_tr_b16 a[136:137], v232 offset:4096
v_mfma_f32_16x16x32_bf16 v[152:155], a[96:99], a[172:175], v[152:155]
s_waitcnt lgkmcnt(5)
v_mfma_f32_16x16x32_bf16 v[156:159], a[100:103], a[172:175], v[156:159]
ds_read_b64_tr_b16 a[138:139], v232 offset:4608
buffer_load_dwordx4 v212, s[24:27], s58 offen lds
v_mfma_f32_16x16x32_bf16 v[148:151], a[100:103], a[168:171], v[148:151]
ds_read_b64_tr_b16 a[140:141], v233 offset:4096
v_mfma_f32_16x16x32_bf16 v[140:143], a[100:103], a[164:167], v[140:143]
buffer_load_dwordx4 v213, s[24:27], s58 offen offset:1024 lds
v_mfma_f32_16x16x32_bf16 v[132:135], a[100:103], a[160:163], v[132:135]
ds_read_b64_tr_b16 a[142:143], v233 offset:4608
v_mfma_f32_16x16x32_bf16 v[128:131], a[104:107], a[176:179], v[128:131]
buffer_load_dwordx4 v214, s[24:27], s58 offen offset:2048 lds
v_mfma_f32_16x16x32_bf16 v[136:139], a[104:107], a[180:183], v[136:139]
v_mfma_f32_16x16x32_bf16 v[144:147], a[104:107], a[184:187], v[144:147]
buffer_load_dwordx4 v215, s[24:27], s58 offen offset:3072 lds
v_mfma_f32_16x16x32_bf16 v[152:155], a[104:107], a[188:191], v[152:155]
v_mfma_f32_16x16x32_bf16 v[156:159], a[108:111], a[188:191], v[156:159]
v_mfma_f32_16x16x32_bf16 v[148:151], a[108:111], a[184:187], v[148:151]
v_mfma_f32_16x16x32_bf16 v[140:143], a[108:111], a[180:183], v[140:143]
v_mfma_f32_16x16x32_bf16 v[132:135], a[108:111], a[176:179], v[132:135]
s_waitcnt lgkmcnt(0)
v_mfma_f32_16x16x32_bf16 v[160:163], a[128:131], a[160:163], v[160:163]
s_waitcnt vmcnt(12)
ds_read_b64 a[96:97], v224 offset:8192
v_mfma_f32_16x16x32_bf16 v[168:171], a[128:131], a[164:167], v[168:171]
ds_read_b64 a[98:99], v225 offset:8192
ds_read_b64 a[100:101], v224 offset:10240
v_mfma_f32_16x16x32_bf16 v[176:179], a[128:131], a[168:171], v[176:179]
ds_read_b64 a[102:103], v225 offset:10240
ds_read_b64 a[104:105], v226 offset:10240
v_cvt_pk_bf16_f32 v128, v128, v129
v_mfma_f32_16x16x32_bf16 v[184:187], a[128:131], a[172:175], v[184:187]
s_add_u32 m0, s53, 0
s_add_u32 s58, s54, 32768
buffer_load_dwordx4 v212, s[24:27], s58 offen lds
v_cvt_pk_bf16_f32 v129, v130, v131
v_cvt_pk_bf16_f32 v130, v132, v133
v_mfma_f32_16x16x32_bf16 v[188:191], a[132:135], a[172:175], v[188:191]
ds_read_b64 a[106:107], v227 offset:10240
v_cvt_pk_bf16_f32 v131, v134, v135
ds_write_b128 v235, v[128:131] offset:8192
v_mfma_f32_16x16x32_bf16 v[180:183], a[132:135], a[168:171], v[180:183]
ds_read_b64 a[108:109], v226 offset:8192
v_cvt_pk_bf16_f32 v136, v136, v137
v_cvt_pk_bf16_f32 v137, v138, v139
v_mfma_f32_16x16x32_bf16 v[172:175], a[132:135], a[164:167], v[172:175]
buffer_load_dwordx4 v213, s[24:27], s58 offen offset:1024 lds
v_cvt_pk_bf16_f32 v138, v140, v141
v_cvt_pk_bf16_f32 v139, v142, v143
v_mfma_f32_16x16x32_bf16 v[164:167], a[132:135], a[160:163], v[164:167]
buffer_load_dwordx4 v214, s[24:27], s58 offen offset:2048 lds
ds_write_b128 v235, v[136:139] offset:9216
v_mfma_f32_16x16x32_bf16 v[160:163], a[136:139], a[176:179], v[160:163]
ds_read_b64 a[110:111], v227 offset:8192
v_cvt_pk_bf16_f32 v144, v144, v145
v_cvt_pk_bf16_f32 v145, v146, v147
v_cvt_pk_bf16_f32 v146, v148, v149
v_mfma_f32_16x16x32_bf16 v[168:171], a[136:139], a[180:183], v[168:171]
v_cvt_pk_bf16_f32 v147, v150, v151
ds_write_b128 v235, v[144:147] offset:10240
v_mfma_f32_16x16x32_bf16 v[176:179], a[136:139], a[184:187], v[176:179]
v_cvt_pk_bf16_f32 v152, v152, v153
v_cvt_pk_bf16_f32 v153, v154, v155
v_cvt_pk_bf16_f32 v154, v156, v157
v_cvt_pk_bf16_f32 v155, v158, v159
v_mfma_f32_16x16x32_bf16 v[184:187], a[136:139], a[188:191], v[184:187]
ds_write_b128 v235, v[152:155] offset:11264
v_mfma_f32_16x16x32_bf16 v[188:191], a[140:143], a[188:191], v[188:191]
v_mfma_f32_16x16x32_bf16 v[180:183], a[140:143], a[184:187], v[180:183]
v_mfma_f32_16x16x32_bf16 v[172:175], a[140:143], a[180:183], v[172:175]
v_mfma_f32_16x16x32_bf16 v[164:167], a[140:143], a[176:179], v[164:167]
s_waitcnt lgkmcnt(2)
v_mfma_f32_16x16x32_bf16 v[0:3], a[96:99], v[128:131], 0
s_waitcnt vmcnt(11)
ds_read_b64 a[128:129], v224 offset:12288
v_mfma_f32_16x16x32_bf16 v[8:11], a[96:99], v[136:139], 0
ds_read_b64 a[130:131], v225 offset:12288
ds_read_b64 a[132:133], v224 offset:14336
v_mfma_f32_16x16x32_bf16 v[16:19], a[96:99], v[144:147], 0
ds_read_b64 a[134:135], v225 offset:14336
ds_read_b64 a[136:137], v226 offset:14336
v_cvt_pk_bf16_f32 v160, v160, v161
v_cvt_pk_bf16_f32 v161, v162, v163
v_cvt_pk_bf16_f32 v162, v164, v165
v_cvt_pk_bf16_f32 v163, v166, v167
v_mfma_f32_16x16x32_bf16 v[24:27], a[96:99], v[152:155], 0
ds_write_b128 v235, v[160:163] offset:12288
v_cvt_pk_bf16_f32 v168, v168, v169
v_cvt_pk_bf16_f32 v169, v170, v171
v_cvt_pk_bf16_f32 v170, v172, v173
v_cvt_pk_bf16_f32 v171, v174, v175
v_mfma_f32_16x16x32_bf16 v[28:31], a[100:103], v[152:155], 0
ds_read_b64 a[138:139], v227 offset:14336
ds_write_b128 v235, v[168:171] offset:13312
v_cvt_pk_bf16_f32 v176, v176, v177
v_cvt_pk_bf16_f32 v177, v178, v179
v_cvt_pk_bf16_f32 v178, v180, v181
v_cvt_pk_bf16_f32 v179, v182, v183
v_mfma_f32_16x16x32_bf16 v[20:23], a[100:103], v[144:147], 0
ds_read_b64 a[140:141], v226 offset:12288
ds_write_b128 v235, v[176:179] offset:14336
v_cvt_pk_bf16_f32 v184, v184, v185
v_cvt_pk_bf16_f32 v185, v186, v187
v_cvt_pk_bf16_f32 v186, v188, v189
v_cvt_pk_bf16_f32 v187, v190, v191
v_mfma_f32_16x16x32_bf16 v[12:15], a[100:103], v[136:139], 0
v_mfma_f32_16x16x32_bf16 v[4:7], a[100:103], v[128:131], 0
ds_read_b64 a[142:143], v227 offset:12288
v_mfma_f32_16x16x32_bf16 v[4:7], a[104:107], v[160:163], v[4:7]
ds_write_b128 v235, v[184:187] offset:15360
v_mfma_f32_16x16x32_bf16 v[12:15], a[104:107], v[168:171], v[12:15]
v_mfma_f32_16x16x32_bf16 v[20:23], a[104:107], v[176:179], v[20:23]
s_waitcnt lgkmcnt(0)
s_barrier
v_mfma_f32_16x16x32_bf16 v[28:31], a[104:107], v[184:187], v[28:31]
buffer_load_dwordx4 v215, s[24:27], s58 offen offset:3072 lds
v_mfma_f32_16x16x32_bf16 v[24:27], a[108:111], v[184:187], v[24:27]
s_add_u32 m0, s53, 4096
s_add_u32 s58, s55, 0
v_mfma_f32_16x16x32_bf16 v[16:19], a[108:111], v[176:179], v[16:19]
buffer_load_dwordx4 v212, s[24:27], s58 offen lds
v_mfma_f32_16x16x32_bf16 v[8:11], a[108:111], v[168:171], v[8:11]
v_sub_u32 v230, v230, v254
v_sub_u32 v231, v231, v254
v_sub_u32 v232, v232, v254
v_sub_u32 v233, v233, v254
v_mfma_f32_16x16x32_bf16 v[0:3], a[108:111], v[160:163], v[0:3]
v_mfma_f32_16x16x32_bf16 v[32:35], a[128:131], v[128:131], 0
buffer_load_dwordx4 v213, s[24:27], s58 offen offset:1024 lds
buffer_load_dwordx4 v214, s[24:27], s58 offen offset:2048 lds
buffer_load_dwordx4 v215, s[24:27], s58 offen offset:3072 lds
s_add_u32 m0, s53, 8192
s_add_u32 s58, s56, 0
buffer_load_dwordx4 v212, s[24:27], s58 offen lds
buffer_load_dwordx4 v213, s[24:27], s58 offen offset:1024 lds
buffer_load_dwordx4 v214, s[24:27], s58 offen offset:2048 lds
buffer_load_dwordx4 v215, s[24:27], s58 offen offset:3072 lds
s_waitcnt vmcnt(8)
v_mfma_f32_16x16x32_bf16 v[40:43], a[128:131], v[136:139], 0
ds_read_b64 a[96:97], v224 offset:0
ds_read_b64 a[98:99], v225 offset:0
v_mfma_f32_16x16x32_bf16 v[48:51], a[128:131], v[144:147], 0
ds_read_b64 a[100:101], v224 offset:2048
ds_read_b64 a[102:103], v225 offset:2048
v_mfma_f32_16x16x32_bf16 v[56:59], a[128:131], v[152:155], 0
s_add_u32 m0, s53, 12288
s_add_u32 s58, s57, 0
buffer_load_dwordx4 v212, s[24:27], s58 offen lds
v_mfma_f32_16x16x32_bf16 v[60:63], a[132:135], v[152:155], 0
ds_read_b64 a[104:105], v226 offset:2048
ds_read_b64 a[106:107], v227 offset:2048
v_mfma_f32_16x16x32_bf16 v[52:55], a[132:135], v[144:147], 0
ds_read_b64 a[108:109], v226 offset:0
v_mfma_f32_16x16x32_bf16 v[44:47], a[132:135], v[136:139], 0
buffer_load_dwordx4 v213, s[24:27], s58 offen offset:1024 lds
v_mfma_f32_16x16x32_bf16 v[36:39], a[132:135], v[128:131], 0
ds_read_b64 a[110:111], v227 offset:0
v_mfma_f32_16x16x32_bf16 v[36:39], a[136:139], v[160:163], v[36:39]
buffer_load_dwordx4 v214, s[24:27], s58 offen offset:2048 lds
v_mfma_f32_16x16x32_bf16 v[44:47], a[136:139], v[168:171], v[44:47]
v_mfma_f32_16x16x32_bf16 v[52:55], a[136:139], v[176:179], v[52:55]
buffer_load_dwordx4 v215, s[24:27], s58 offen offset:3072 lds
v_mfma_f32_16x16x32_bf16 v[60:63], a[136:139], v[184:187], v[60:63]
v_mfma_f32_16x16x32_bf16 v[56:59], a[140:143], v[184:187], v[56:59]
v_mfma_f32_16x16x32_bf16 v[48:51], a[140:143], v[176:179], v[48:51]
v_mfma_f32_16x16x32_bf16 v[40:43], a[140:143], v[168:171], v[40:43]
v_mfma_f32_16x16x32_bf16 v[32:35], a[140:143], v[160:163], v[32:35]
s_waitcnt lgkmcnt(0)
v_mfma_f32_16x16x32_bf16 v[64:67], a[96:99], v[128:131], 0
s_waitcnt vmcnt(8)
ds_read_b64 a[128:129], v224 offset:4096
v_mfma_f32_16x16x32_bf16 v[72:75], a[96:99], v[136:139], 0
ds_read_b64 a[130:131], v225 offset:4096
ds_read_b128 a[0:3], v236 offset:8192
v_mfma_f32_16x16x32_bf16 v[80:83], a[96:99], v[144:147], 0
ds_read_b128 a[4:7], v236 offset:9216
ds_read_b128 a[8:11], v236 offset:10240
v_mfma_f32_16x16x32_bf16 v[88:91], a[96:99], v[152:155], 0
s_add_u32 m0, s53, 0
s_add_u32 s58, s55, 16384
buffer_load_dwordx4 v212, s[24:27], s58 offen lds
v_mfma_f32_16x16x32_bf16 v[92:95], a[100:103], v[152:155], 0
ds_read_b128 a[12:15], v236 offset:11264
ds_read_b64 a[132:133], v224 offset:6144
v_mfma_f32_16x16x32_bf16 v[84:87], a[100:103], v[144:147], 0
ds_read_b64 a[134:135], v225 offset:6144
ds_read_b64 a[136:137], v226 offset:6144
v_mfma_f32_16x16x32_bf16 v[76:79], a[100:103], v[136:139], 0
ds_read_b64 a[138:139], v227 offset:6144
ds_read_b128 a[16:19], v236 offset:12288
v_mfma_f32_16x16x32_bf16 v[68:71], a[100:103], v[128:131], 0
buffer_load_dwordx4 v213, s[24:27], s58 offen offset:1024 lds
v_mfma_f32_16x16x32_bf16 v[68:71], a[104:107], v[160:163], v[68:71]
ds_read_b128 a[20:23], v236 offset:13312
ds_read_b128 a[24:27], v236 offset:14336
v_mfma_f32_16x16x32_bf16 v[76:79], a[104:107], v[168:171], v[76:79]
ds_read_b128 a[28:31], v236 offset:15360
ds_read_b64 a[140:141], v226 offset:4096
v_mfma_f32_16x16x32_bf16 v[84:87], a[104:107], v[176:179], v[84:87]
ds_read_b64 a[142:143], v227 offset:4096
v_mfma_f32_16x16x32_bf16 v[92:95], a[104:107], v[184:187], v[92:95]
buffer_load_dwordx4 v214, s[24:27], s58 offen offset:2048 lds
v_mfma_f32_16x16x32_bf16 v[88:91], a[108:111], v[184:187], v[88:91]
v_mfma_f32_16x16x32_bf16 v[80:83], a[108:111], v[176:179], v[80:83]
buffer_load_dwordx4 v215, s[24:27], s58 offen offset:3072 lds
v_mfma_f32_16x16x32_bf16 v[72:75], a[108:111], v[168:171], v[72:75]
v_mfma_f32_16x16x32_bf16 v[64:67], a[108:111], v[160:163], v[64:67]
s_waitcnt lgkmcnt(10)
v_mfma_f32_16x16x32_bf16 v[0:3], a[128:131], a[0:3], v[0:3]
s_waitcnt vmcnt(8)
ds_read_b64 a[96:97], v224 offset:8192
v_mfma_f32_16x16x32_bf16 v[8:11], a[128:131], a[4:7], v[8:11]
ds_read_b64 a[98:99], v225 offset:8192
ds_read_b128 a[32:35], v237 offset:8192
v_mfma_f32_16x16x32_bf16 v[16:19], a[128:131], a[8:11], v[16:19]
ds_read_b128 a[36:39], v237 offset:9216
ds_read_b128 a[40:43], v237 offset:10240
v_mfma_f32_16x16x32_bf16 v[24:27], a[128:131], a[12:15], v[24:27]
ds_read_b128 a[44:47], v237 offset:11264
s_waitcnt lgkmcnt(6)
v_mfma_f32_16x16x32_bf16 v[28:31], a[132:135], a[12:15], v[28:31]
ds_read_b64 a[100:101], v224 offset:10240
ds_read_b64 a[102:103], v225 offset:10240
v_mfma_f32_16x16x32_bf16 v[20:23], a[132:135], a[8:11], v[20:23]
ds_read_b64 a[104:105], v226 offset:10240
ds_read_b64 a[106:107], v227 offset:10240
v_mfma_f32_16x16x32_bf16 v[12:15], a[132:135], a[4:7], v[12:15]
ds_read_b128 a[48:51], v237 offset:12288
ds_read_b128 a[52:55], v237 offset:13312
v_mfma_f32_16x16x32_bf16 v[4:7], a[132:135], a[0:3], v[4:7]
s_add_u32 m0, s53, 4096
s_add_u32 s58, s56, 16384
buffer_load_dwordx4 v212, s[24:27], s58 offen lds
v_mfma_f32_16x16x32_bf16 v[4:7], a[136:139], a[16:19], v[4:7]
ds_read_b128 a[56:59], v237 offset:14336
ds_read_b128 a[60:63], v237 offset:15360
v_mfma_f32_16x16x32_bf16 v[12:15], a[136:139], a[20:23], v[12:15]
ds_read_b64 a[108:109], v226 offset:8192
ds_read_b64 a[110:111], v227 offset:8192
v_mfma_f32_16x16x32_bf16 v[20:23], a[136:139], a[24:27], v[20:23]
buffer_load_dwordx4 v213, s[24:27], s58 offen offset:1024 lds
v_mfma_f32_16x16x32_bf16 v[28:31], a[136:139], a[28:31], v[28:31]
v_mfma_f32_16x16x32_bf16 v[24:27], a[140:143], a[28:31], v[24:27]
buffer_load_dwordx4 v214, s[24:27], s58 offen offset:2048 lds
v_mfma_f32_16x16x32_bf16 v[16:19], a[140:143], a[24:27], v[16:19]
v_mfma_f32_16x16x32_bf16 v[8:11], a[140:143], a[20:23], v[8:11]
buffer_load_dwordx4 v215, s[24:27], s58 offen offset:3072 lds
v_mfma_f32_16x16x32_bf16 v[0:3], a[140:143], a[16:19], v[0:3]
s_waitcnt lgkmcnt(0)
v_mfma_f32_16x16x32_bf16 v[0:3], a[96:99], a[32:35], v[0:3]
s_waitcnt vmcnt(8)
ds_read_b64 a[128:129], v224 offset:12288
v_mfma_f32_16x16x32_bf16 v[8:11], a[96:99], a[36:39], v[8:11]
ds_read_b64 a[130:131], v225 offset:12288
ds_read_b128 a[64:67], v238 offset:8192
v_mfma_f32_16x16x32_bf16 v[16:19], a[96:99], a[40:43], v[16:19]
ds_read_b128 a[68:71], v238 offset:9216
ds_read_b128 a[72:75], v238 offset:10240
v_mfma_f32_16x16x32_bf16 v[24:27], a[96:99], a[44:47], v[24:27]
s_add_u32 m0, s53, 8192
s_add_u32 s58, s57, 16384
v_mfma_f32_16x16x32_bf16 v[28:31], a[100:103], a[44:47], v[28:31]
ds_read_b128 a[76:79], v238 offset:11264
ds_read_b64 a[132:133], v224 offset:14336
v_mfma_f32_16x16x32_bf16 v[20:23], a[100:103], a[40:43], v[20:23]
ds_read_b64 a[134:135], v225 offset:14336
ds_read_b64 a[136:137], v226 offset:14336
buffer_load_dwordx4 v212, s[24:27], s58 offen lds
v_mfma_f32_16x16x32_bf16 v[12:15], a[100:103], a[36:39], v[12:15]
ds_read_b64 a[138:139], v227 offset:14336
ds_read_b128 a[80:83], v238 offset:12288
v_mfma_f32_16x16x32_bf16 v[4:7], a[100:103], a[32:35], v[4:7]
buffer_load_dwordx4 v213, s[24:27], s58 offen offset:1024 lds
v_mfma_f32_16x16x32_bf16 v[4:7], a[104:107], a[48:51], v[4:7]
ds_read_b128 a[84:87], v238 offset:13312
ds_read_b128 a[88:91], v238 offset:14336
v_mfma_f32_16x16x32_bf16 v[12:15], a[104:107], a[52:55], v[12:15]
ds_read_b128 a[92:95], v238 offset:15360
ds_read_b64 a[140:141], v226 offset:12288
v_mfma_f32_16x16x32_bf16 v[20:23], a[104:107], a[56:59], v[20:23]
ds_read_b64 a[142:143], v227 offset:12288
v_mfma_f32_16x16x32_bf16 v[28:31], a[104:107], a[60:63], v[28:31]
buffer_load_dwordx4 v214, s[24:27], s58 offen offset:2048 lds
v_mfma_f32_16x16x32_bf16 v[24:27], a[108:111], a[60:63], v[24:27]
v_mfma_f32_16x16x32_bf16 v[16:19], a[108:111], a[56:59], v[16:19]
buffer_load_dwordx4 v215, s[24:27], s58 offen offset:3072 lds
v_mfma_f32_16x16x32_bf16 v[8:11], a[108:111], a[52:55], v[8:11]
v_mfma_f32_16x16x32_bf16 v[0:3], a[108:111], a[48:51], v[0:3]
s_waitcnt lgkmcnt(10)
v_mfma_f32_16x16x32_bf16 v[0:3], a[128:131], a[64:67], v[0:3]
s_waitcnt vmcnt(8)
ds_read_b64 a[96:97], v224 offset:0
v_mfma_f32_16x16x32_bf16 v[8:11], a[128:131], a[68:71], v[8:11]
ds_read_b64 a[98:99], v225 offset:0
ds_read_b64 a[100:101], v224 offset:2048
v_mfma_f32_16x16x32_bf16 v[16:19], a[128:131], a[72:75], v[16:19]
ds_read_b64 a[102:103], v225 offset:2048
ds_read_b64 a[104:105], v226 offset:2048
v_mfma_f32_16x16x32_bf16 v[24:27], a[128:131], a[76:79], v[24:27]
s_waitcnt lgkmcnt(5)
v_mfma_f32_16x16x32_bf16 v[28:31], a[132:135], a[76:79], v[28:31]
ds_read_b64 a[106:107], v227 offset:2048
s_add_u32 m0, s53, 12288
v_mfma_f32_16x16x32_bf16 v[20:23], a[132:135], a[72:75], v[20:23]
ds_read_b64 a[108:109], v226 offset:0
s_add_u32 s58, s55, 32768
buffer_load_dwordx4 v212, s[24:27], s58 offen lds
v_mfma_f32_16x16x32_bf16 v[12:15], a[132:135], a[68:71], v[12:15]
v_mfma_f32_16x16x32_bf16 v[4:7], a[132:135], a[64:67], v[4:7]
buffer_load_dwordx4 v213, s[24:27], s58 offen offset:1024 lds
v_mfma_f32_16x16x32_bf16 v[4:7], a[136:139], a[80:83], v[4:7]
ds_read_b64 a[110:111], v227 offset:0
v_mfma_f32_16x16x32_bf16 v[12:15], a[136:139], a[84:87], v[12:15]
buffer_load_dwordx4 v214, s[24:27], s58 offen offset:2048 lds
v_mfma_f32_16x16x32_bf16 v[20:23], a[136:139], a[88:91], v[20:23]
v_mfma_f32_16x16x32_bf16 v[28:31], a[136:139], a[92:95], v[28:31]
buffer_load_dwordx4 v215, s[24:27], s58 offen offset:3072 lds
v_mfma_f32_16x16x32_bf16 v[24:27], a[140:143], a[92:95], v[24:27]
v_mfma_f32_16x16x32_bf16 v[16:19], a[140:143], a[88:91], v[16:19]
v_mfma_f32_16x16x32_bf16 v[8:11], a[140:143], a[84:87], v[8:11]
v_mfma_f32_16x16x32_bf16 v[0:3], a[140:143], a[80:83], v[0:3]
s_waitcnt lgkmcnt(0)
v_mfma_f32_16x16x32_bf16 v[32:35], a[96:99], a[0:3], v[32:35]
s_waitcnt vmcnt(8)
ds_read_b64 a[128:129], v224 offset:4096
v_mfma_f32_16x16x32_bf16 v[40:43], a[96:99], a[4:7], v[40:43]
ds_read_b64 a[130:131], v225 offset:4096
ds_read_b64 a[132:133], v224 offset:6144
v_mfma_f32_16x16x32_bf16 v[48:51], a[96:99], a[8:11], v[48:51]
ds_read_b64 a[134:135], v225 offset:6144
ds_read_b64 a[136:137], v226 offset:6144
v_mfma_f32_16x16x32_bf16 v[56:59], a[96:99], a[12:15], v[56:59]
s_add_u32 m0, s53, 0
s_add_u32 s58, s54, 49152
buffer_load_dwordx4 v212, s[24:27], s58 offen lds
v_mfma_f32_16x16x32_bf16 v[60:63], a[100:103], a[12:15], v[60:63]
ds_read_b64 a[138:139], v227 offset:6144
v_max_f32 v242, v0, v1
v_max_f32 v243, v8, v9
v_mfma_f32_16x16x32_bf16 v[52:55], a[100:103], a[8:11], v[52:55]
ds_read_b64 a[140:141], v226 offset:4096
v_max_f32 v244, v16, v17
v_max_f32 v245, v24, v25
v_max3_f32 v242, v2, v3, v242
v_mfma_f32_16x16x32_bf16 v[44:47], a[100:103], a[4:7], v[44:47]
buffer_load_dwordx4 v213, s[24:27], s58 offen offset:1024 lds
v_max3_f32 v243, v10, v11, v243
v_mfma_f32_16x16x32_bf16 v[36:39], a[100:103], a[0:3], v[36:39]
buffer_load_dwordx4 v214, s[24:27], s58 offen offset:2048 lds
v_max3_f32 v244, v18, v19, v244
v_max3_f32 v245, v26, v27, v245
v_mfma_f32_16x16x32_bf16 v[36:39], a[104:107], a[16:19], v[36:39]
ds_read_b64 a[142:143], v227 offset:4096
v_max3_f32 v242, v4, v5, v242
v_max3_f32 v243, v12, v13, v243
v_mfma_f32_16x16x32_bf16 v[44:47], a[104:107], a[20:23], v[44:47]
buffer_load_dwordx4 v215, s[24:27], s58 offen offset:3072 lds
v_max3_f32 v244, v20, v21, v244
v_max3_f32 v245, v28, v29, v245
v_mfma_f32_16x16x32_bf16 v[52:55], a[104:107], a[24:27], v[52:55]
v_max3_f32 v242, v6, v7, v242
v_max3_f32 v243, v14, v15, v243
v_max3_f32 v244, v22, v23, v244
v_max3_f32 v245, v30, v31, v245
v_mfma_f32_16x16x32_bf16 v[60:63], a[104:107], a[28:31], v[60:63]
v_mov_b32 v200, v242
v_mov_b32 v201, v243
v_mov_b32 v202, v244
v_mfma_f32_16x16x32_bf16 v[56:59], a[108:111], a[28:31], v[56:59]
v_mov_b32 v203, v245
v_permlane32_swap_b32 v200, v202
v_mfma_f32_16x16x32_bf16 v[48:51], a[108:111], a[24:27], v[48:51]
v_permlane32_swap_b32 v201, v203
v_max_f32 v200, v200, v202
v_max_f32 v201, v201, v203
v_mfma_f32_16x16x32_bf16 v[40:43], a[108:111], a[20:23], v[40:43]
s_nop 0
v_permlane16_swap_b32 v200, v201
v_max_f32 v200, v200, v201
ds_write_b32 v239, v200 offset:0
v_mfma_f32_16x16x32_bf16 v[32:35], a[108:111], a[16:19], v[32:35]
ds_write_b32 v239, v200 offset:16384
ds_write_b32 v239, v200 offset:32768
ds_write_b32 v239, v200 offset:49152
s_waitcnt lgkmcnt(4)
v_mfma_f32_16x16x32_bf16 v[32:35], a[128:131], a[32:35], v[32:35]
s_waitcnt vmcnt(8)
ds_read_b64 a[96:97], v224 offset:8192
v_mov_b32 v246, 0x3f803f80
v_mfma_f32_16x16x32_bf16 v[40:43], a[128:131], a[36:39], v[40:43]
ds_read_b64 a[98:99], v225 offset:8192
ds_read_b64 a[100:101], v224 offset:10240
v_accvgpr_write_b32 a240, v246
v_mfma_f32_16x16x32_bf16 v[48:51], a[128:131], a[40:43], v[48:51]
ds_read_b64 a[102:103], v225 offset:10240
ds_read_b64 a[104:105], v226 offset:10240
v_accvgpr_write_b32 a241, v246
v_mfma_f32_16x16x32_bf16 v[56:59], a[128:131], a[44:47], v[56:59]
s_add_u32 m0, s53, 4096
s_add_u32 s58, s55, 49152
buffer_load_dwordx4 v212, s[24:27], s58 offen lds
v_accvgpr_write_b32 a242, v246
v_accvgpr_write_b32 a243, v246
v_mfma_f32_16x16x32_bf16 v[60:63], a[132:135], a[44:47], v[60:63]
ds_read_b64 a[106:107], v227 offset:10240
v_mfma_f32_16x16x32_bf16 v[52:55], a[132:135], a[40:43], v[52:55]
ds_read_b64 a[108:109], v226 offset:8192
v_mfma_f32_16x16x32_bf16 v[44:47], a[132:135], a[36:39], v[44:47]
buffer_load_dwordx4 v213, s[24:27], s58 offen offset:1024 lds
v_mfma_f32_16x16x32_bf16 v[36:39], a[132:135], a[32:35], v[36:39]
ds_read_b64 a[110:111], v227 offset:8192
s_waitcnt lgkmcnt(8)
s_barrier
v_mfma_f32_16x16x32_bf16 v[36:39], a[136:139], a[48:51], v[36:39]
buffer_load_dwordx4 v214, s[24:27], s58 offen offset:2048 lds
ds_read_b128 v[192:195], v240 offset:0
ds_read_b128 v[196:199], v240 offset:256
ds_read_b128 v[200:203], v240 offset:512
ds_read_b128 v[204:207], v240 offset:768
v_mfma_f32_16x16x32_bf16 v[44:47], a[136:139], a[52:55], v[44:47]
buffer_load_dwordx4 v215, s[24:27], s58 offen offset:3072 lds
v_mfma_f32_16x16x32_bf16 v[52:55], a[136:139], a[56:59], v[52:55]
v_mfma_f32_16x16x32_bf16 v[60:63], a[136:139], a[60:63], v[60:63]
v_mfma_f32_16x16x32_bf16 v[56:59], a[140:143], a[60:63], v[56:59]
v_mfma_f32_16x16x32_bf16 v[48:51], a[140:143], a[56:59], v[48:51]
v_mfma_f32_16x16x32_bf16 v[40:43], a[140:143], a[52:55], v[40:43]
v_mfma_f32_16x16x32_bf16 v[32:35], a[140:143], a[48:51], v[32:35]
s_waitcnt lgkmcnt(0)
v_max3_f32 v250, v192, v196, v200
v_max3_f32 v251, v193, v197, v201
v_max3_f32 v252, v194, v198, v202
v_max3_f32 v253, v195, v199, v203
v_accvgpr_read_b32 v192, a244
v_accvgpr_read_b32 v193, a245
v_accvgpr_read_b32 v194, a246
v_accvgpr_read_b32 v195, a247
v_max3_f32 v250, v250, v204, v192
v_max3_f32 v251, v251, v205, v193
v_max3_f32 v252, v252, v206, v194
v_max3_f32 v253, v253, v207, v195
v_mul_f32 v250, s63, v250
v_mul_f32 v251, s63, v251
v_mul_f32 v252, s63, v252
v_mfma_f32_16x16x32_bf16 v[32:35], a[96:99], a[64:67], v[32:35]
s_waitcnt vmcnt(8)
ds_read_b64 a[128:129], v224 offset:12288
v_mul_f32 v253, s63, v253
v_mfma_f32_16x16x32_bf16 v[40:43], a[96:99], a[68:71], v[40:43]
ds_read_b64 a[130:131], v225 offset:12288
ds_read_b64 a[132:133], v224 offset:14336
v_fma_f32 v0, v0, s63, -v250
v_mfma_f32_16x16x32_bf16 v[48:51], a[96:99], a[72:75], v[48:51]
ds_read_b64 a[134:135], v225 offset:14336
ds_read_b64 a[136:137], v226 offset:14336
v_fma_f32 v1, v1, s63, -v250
v_fma_f32 v2, v2, s63, -v250
v_mfma_f32_16x16x32_bf16 v[56:59], a[96:99], a[76:79], v[56:59]
s_add_u32 m0, s53, 8192
s_add_u32 s58, s56, 49152
buffer_load_dwordx4 v212, s[24:27], s58 offen lds
v_fma_f32 v3, v3, s63, -v250
v_mfma_f32_16x16x32_bf16 v[60:63], a[100:103], a[76:79], v[60:63]
ds_read_b64 a[138:139], v227 offset:14336
v_fma_f32 v4, v4, s63, -v250
v_fma_f32 v5, v5, s63, -v250
v_mfma_f32_16x16x32_bf16 v[52:55], a[100:103], a[72:75], v[52:55]
ds_read_b64 a[140:141], v226 offset:12288
v_fma_f32 v6, v6, s63, -v250
v_fma_f32 v7, v7, s63, -v250
v_mfma_f32_16x16x32_bf16 v[44:47], a[100:103], a[68:71], v[44:47]
buffer_load_dwordx4 v213, s[24:27], s58 offen offset:1024 lds
v_exp_f32 v0, v0
v_mfma_f32_16x16x32_bf16 v[36:39], a[100:103], a[64:67], v[36:39]
buffer_load_dwordx4 v214, s[24:27], s58 offen offset:2048 lds
v_mfma_f32_16x16x32_bf16 v[36:39], a[104:107], a[80:83], v[36:39]
ds_read_b64 a[142:143], v227 offset:12288
v_exp_f32 v1, v1
v_exp_f32 v2, v2
v_mfma_f32_16x16x32_bf16 v[44:47], a[104:107], a[84:87], v[44:47]
buffer_load_dwordx4 v215, s[24:27], s58 offen offset:3072 lds
v_mfma_f32_16x16x32_bf16 v[52:55], a[104:107], a[88:91], v[52:55]
v_exp_f32 v3, v3
v_exp_f32 v4, v4
v_mfma_f32_16x16x32_bf16 v[60:63], a[104:107], a[92:95], v[60:63]
v_exp_f32 v5, v5
v_mfma_f32_16x16x32_bf16 v[56:59], a[108:111], a[92:95], v[56:59]
v_exp_f32 v6, v6
v_exp_f32 v7, v7
v_cvt_pk_bf16_f32 v196, v0, v1
v_mfma_f32_16x16x32_bf16 v[48:51], a[108:111], a[88:91], v[48:51]
v_cvt_pk_bf16_f32 v197, v2, v3
v_cvt_pk_bf16_f32 v198, v4, v5
v_cvt_pk_bf16_f32 v199, v6, v7
v_mfma_f32_16x16x32_bf16 v[40:43], a[108:111], a[84:87], v[40:43]
ds_write_b128 v235, v[196:199] offset:0
v_mfma_f32_16x16x32_bf16 a[224:227], a[240:243], v[196:199], 0
v_fma_f32 v8, v8, s63, -v251
v_fma_f32 v9, v9, s63, -v251
v_fma_f32 v10, v10, s63, -v251
v_mfma_f32_16x16x32_bf16 v[32:35], a[108:111], a[80:83], v[32:35]
v_fma_f32 v11, v11, s63, -v251
v_fma_f32 v12, v12, s63, -v251
v_fma_f32 v13, v13, s63, -v251
s_waitcnt lgkmcnt(1)
v_mfma_f32_16x16x32_bf16 v[64:67], a[128:131], a[0:3], v[64:67]
ds_read_b64 a[96:97], v224 offset:16384
ds_read_b64 a[98:99], v225 offset:16384
v_fma_f32 v14, v14, s63, -v251
v_mfma_f32_16x16x32_bf16 v[72:75], a[128:131], a[4:7], v[72:75]
ds_read_b64 a[100:101], v224 offset:18432
ds_read_b64 a[102:103], v225 offset:18432
v_fma_f32 v15, v15, s63, -v251
v_mfma_f32_16x16x32_bf16 v[80:83], a[128:131], a[8:11], v[80:83]
ds_read_b64 a[104:105], v226 offset:18432
s_add_u32 m0, s53, 12288
v_mfma_f32_16x16x32_bf16 v[88:91], a[128:131], a[12:15], v[88:91]
s_add_u32 s58, s57, 49152
buffer_load_dwordx4 v212, s[24:27], s58 offen lds
v_exp_f32 v8, v8
v_mfma_f32_16x16x32_bf16 v[92:95], a[132:135], a[12:15], v[92:95]
ds_read_b64 a[106:107], v227 offset:18432
v_exp_f32 v9, v9
v_mfma_f32_16x16x32_bf16 v[84:87], a[132:135], a[8:11], v[84:87]
ds_read_b64 a[108:109], v226 offset:16384
v_exp_f32 v10, v10
v_mfma_f32_16x16x32_bf16 v[76:79], a[132:135], a[4:7], v[76:79]
buffer_load_dwordx4 v213, s[24:27], s58 offen offset:1024 lds
v_exp_f32 v11, v11
v_mfma_f32_16x16x32_bf16 v[68:71], a[132:135], a[0:3], v[68:71]
buffer_load_dwordx4 v214, s[24:27], s58 offen offset:2048 lds
v_exp_f32 v12, v12
v_mfma_f32_16x16x32_bf16 v[68:71], a[136:139], a[16:19], v[68:71]
ds_read_b64 a[110:111], v227 offset:16384
v_exp_f32 v13, v13
v_mfma_f32_16x16x32_bf16 v[76:79], a[136:139], a[20:23], v[76:79]
buffer_load_dwordx4 v215, s[24:27], s58 offen offset:3072 lds
v_mfma_f32_16x16x32_bf16 v[84:87], a[136:139], a[24:27], v[84:87]
v_exp_f32 v14, v14
v_exp_f32 v15, v15
v_cvt_pk_bf16_f32 v192, v8, v9
v_mfma_f32_16x16x32_bf16 v[92:95], a[136:139], a[28:31], v[92:95]
v_cvt_pk_bf16_f32 v193, v10, v11
v_cvt_pk_bf16_f32 v194, v12, v13
v_cvt_pk_bf16_f32 v195, v14, v15
v_mfma_f32_16x16x32_bf16 v[88:91], a[140:143], a[28:31], v[88:91]
ds_write_b128 v235, v[192:195] offset:1024
v_mfma_f32_16x16x32_bf16 a[228:231], a[240:243], v[192:195], 0
v_fma_f32 v16, v16, s63, -v252
v_fma_f32 v17, v17, s63, -v252
v_fma_f32 v18, v18, s63, -v252
v_mfma_f32_16x16x32_bf16 v[80:83], a[140:143], a[24:27], v[80:83]
v_fma_f32 v19, v19, s63, -v252
v_fma_f32 v20, v20, s63, -v252
v_fma_f32 v21, v21, s63, -v252
v_mfma_f32_16x16x32_bf16 v[72:75], a[140:143], a[20:23], v[72:75]
v_fma_f32 v22, v22, s63, -v252
v_fma_f32 v23, v23, s63, -v252
v_exp_f32 v16, v16
v_mfma_f32_16x16x32_bf16 v[64:67], a[140:143], a[16:19], v[64:67]
v_exp_f32 v17, v17
s_waitcnt lgkmcnt(1)
v_mfma_f32_16x16x32_bf16 v[64:67], a[96:99], a[32:35], v[64:67]
ds_read_b64 a[128:129], v224 offset:20480
ds_read_b64 a[130:131], v225 offset:20480
v_mfma_f32_16x16x32_bf16 v[72:75], a[96:99], a[36:39], v[72:75]
ds_read_b64 a[132:133], v224 offset:22528
ds_read_b64 a[134:135], v225 offset:22528
v_exp_f32 v18, v18
v_mfma_f32_16x16x32_bf16 v[80:83], a[96:99], a[40:43], v[80:83]
ds_read_b64 a[136:137], v226 offset:22528
s_add_u32 m0, s53, 16384
v_mfma_f32_16x16x32_bf16 v[88:91], a[96:99], a[44:47], v[88:91]
s_mov_b32 s58, 0
buffer_load_dwordx4 v216, s[28:31], s58 offen lds
v_exp_f32 v19, v19
v_mfma_f32_16x16x32_bf16 v[92:95], a[100:103], a[44:47], v[92:95]
ds_read_b64 a[138:139], v227 offset:22528
v_exp_f32 v20, v20
v_mfma_f32_16x16x32_bf16 v[84:87], a[100:103], a[40:43], v[84:87]
ds_read_b64 a[140:141], v226 offset:20480
v_exp_f32 v21, v21
v_mfma_f32_16x16x32_bf16 v[76:79], a[100:103], a[36:39], v[76:79]
buffer_load_dwordx4 v217, s[28:31], s58 offen offset:1024 lds
v_exp_f32 v22, v22
v_mfma_f32_16x16x32_bf16 v[68:71], a[100:103], a[32:35], v[68:71]
buffer_load_dwordx4 v218, s[28:31], s58 offen offset:2048 lds
v_exp_f32 v23, v23
v_mfma_f32_16x16x32_bf16 v[68:71], a[104:107], a[48:51], v[68:71]
ds_read_b64 a[142:143], v227 offset:20480
v_cvt_pk_bf16_f32 v196, v16, v17
v_cvt_pk_bf16_f32 v197, v18, v19
v_mfma_f32_16x16x32_bf16 v[76:79], a[104:107], a[52:55], v[76:79]
buffer_load_dwordx4 v219, s[28:31], s58 offen offset:3072 lds
v_cvt_pk_bf16_f32 v198, v20, v21
v_mfma_f32_16x16x32_bf16 v[84:87], a[104:107], a[56:59], v[84:87]
v_cvt_pk_bf16_f32 v199, v22, v23
ds_write_b128 v235, v[196:199] offset:2048
v_mfma_f32_16x16x32_bf16 v[92:95], a[104:107], a[60:63], v[92:95]
v_mfma_f32_16x16x32_bf16 a[232:235], a[240:243], v[196:199], 0
v_fma_f32 v24, v24, s63, -v253
v_fma_f32 v25, v25, s63, -v253
v_fma_f32 v26, v26, s63, -v253
v_fma_f32 v27, v27, s63, -v253
v_mfma_f32_16x16x32_bf16 v[88:91], a[108:111], a[60:63], v[88:91]
v_fma_f32 v28, v28, s63, -v253
v_fma_f32 v29, v29, s63, -v253
v_fma_f32 v30, v30, s63, -v253
v_mfma_f32_16x16x32_bf16 v[80:83], a[108:111], a[56:59], v[80:83]
v_fma_f32 v31, v31, s63, -v253
v_exp_f32 v24, v24
v_mfma_f32_16x16x32_bf16 v[72:75], a[108:111], a[52:55], v[72:75]
v_exp_f32 v25, v25
v_mfma_f32_16x16x32_bf16 v[64:67], a[108:111], a[48:51], v[64:67]
v_exp_f32 v26, v26
v_exp_f32 v27, v27
s_waitcnt lgkmcnt(1)
v_mfma_f32_16x16x32_bf16 v[64:67], a[128:131], a[64:67], v[64:67]
s_waitcnt vmcnt(16)
ds_read_b64 a[96:97], v224 offset:0
v_mfma_f32_16x16x32_bf16 v[72:75], a[128:131], a[68:71], v[72:75]
ds_read_b64 a[98:99], v225 offset:0
ds_read_b64 a[100:101], v224 offset:2048
v_exp_f32 v28, v28
v_mfma_f32_16x16x32_bf16 v[80:83], a[128:131], a[72:75], v[80:83]
ds_read_b64 a[102:103], v225 offset:2048
ds_read_b64 a[104:105], v226 offset:2048
v_mfma_f32_16x16x32_bf16 v[88:91], a[128:131], a[76:79], v[88:91]
s_add_u32 m0, s53, 20480
s_mov_b32 s58, 65536
buffer_load_dwordx4 v216, s[28:31], s58 offen lds
v_exp_f32 v29, v29
v_mfma_f32_16x16x32_bf16 v[92:95], a[132:135], a[76:79], v[92:95]
ds_read_b64 a[106:107], v227 offset:2048
v_exp_f32 v30, v30
v_mfma_f32_16x16x32_bf16 v[84:87], a[132:135], a[72:75], v[84:87]
ds_read_b64 a[108:109], v226 offset:0
v_exp_f32 v31, v31
v_cvt_pk_bf16_f32 v192, v24, v25
v_mfma_f32_16x16x32_bf16 v[76:79], a[132:135], a[68:71], v[76:79]
buffer_load_dwordx4 v217, s[28:31], s58 offen offset:1024 lds
v_cvt_pk_bf16_f32 v193, v26, v27
v_mfma_f32_16x16x32_bf16 v[68:71], a[132:135], a[64:67], v[68:71]
buffer_load_dwordx4 v218, s[28:31], s58 offen offset:2048 lds
v_cvt_pk_bf16_f32 v194, v28, v29
v_mfma_f32_16x16x32_bf16 v[68:71], a[136:139], a[80:83], v[68:71]
ds_read_b64 a[110:111], v227 offset:0
v_cvt_pk_bf16_f32 v195, v30, v31
ds_write_b128 v235, v[192:195] offset:3072
v_mfma_f32_16x16x32_bf16 v[76:79], a[136:139], a[84:87], v[76:79]
buffer_load_dwordx4 v219, s[28:31], s58 offen offset:3072 lds
v_mfma_f32_16x16x32_bf16 a[236:239], a[240:243], v[192:195], 0
v_max3_f32 v242, v32, v33, v242
v_max3_f32 v243, v40, v41, v243
v_max3_f32 v244, v48, v49, v244
v_mfma_f32_16x16x32_bf16 v[84:87], a[136:139], a[88:91], v[84:87]
v_max3_f32 v245, v56, v57, v245
v_max3_f32 v242, v34, v35, v242
v_max3_f32 v243, v42, v43, v243
v_mfma_f32_16x16x32_bf16 v[92:95], a[136:139], a[92:95], v[92:95]
v_max3_f32 v244, v50, v51, v244
v_max3_f32 v245, v58, v59, v245
v_max3_f32 v242, v36, v37, v242
v_mfma_f32_16x16x32_bf16 v[88:91], a[140:143], a[92:95], v[88:91]
v_max3_f32 v243, v44, v45, v243
v_max3_f32 v244, v52, v53, v244
v_max3_f32 v245, v60, v61, v245
v_mfma_f32_16x16x32_bf16 v[80:83], a[140:143], a[88:91], v[80:83]
v_max3_f32 v242, v38, v39, v242
v_max3_f32 v243, v46, v47, v243
v_max3_f32 v244, v54, v55, v244
v_max3_f32 v245, v62, v63, v245
v_mfma_f32_16x16x32_bf16 v[72:75], a[140:143], a[84:87], v[72:75]
v_fma_f32 v32, v32, s63, -v250
v_fma_f32 v33, v33, s63, -v250
v_fma_f32 v34, v34, s63, -v250
v_mfma_f32_16x16x32_bf16 v[64:67], a[140:143], a[80:83], v[64:67]
v_fma_f32 v35, v35, s63, -v250
v_fma_f32 v36, v36, s63, -v250
s_waitcnt lgkmcnt(1)
v_mfma_f32_16x16x32_bf16 v[96:99], a[96:99], v[128:131], 0
s_waitcnt vmcnt(16)
ds_read_b64 a[128:129], v224 offset:4096
v_fma_f32 v37, v37, s63, -v250
v_mfma_f32_16x16x32_bf16 v[104:107], a[96:99], v[136:139], 0
ds_read_b64 a[130:131], v225 offset:4096
ds_read_b64 a[132:133], v224 offset:6144
v_fma_f32 v38, v38, s63, -v250
v_mfma_f32_16x16x32_bf16 v[112:115], a[96:99], v[144:147], 0
ds_read_b64 a[134:135], v225 offset:6144
ds_read_b64 a[136:137], v226 offset:6144
v_fma_f32 v39, v39, s63, -v250
v_mfma_f32_16x16x32_bf16 v[120:123], a[96:99], v[152:155], 0
s_add_u32 m0, s53, 0
s_mov_b32 s58, 131072
buffer_load_dwordx4 v216, s[28:31], s58 offen lds
v_exp_f32 v32, v32
v_mfma_f32_16x16x32_bf16 v[124:127], a[100:103], v[152:155], 0
ds_read_b64 a[138:139], v227 offset:6144
v_exp_f32 v33, v33
v_mfma_f32_16x16x32_bf16 v[116:119], a[100:103], v[144:147], 0
ds_read_b64 a[140:141], v226 offset:4096
v_exp_f32 v34, v34
v_mfma_f32_16x16x32_bf16 v[108:111], a[100:103], v[136:139], 0
buffer_load_dwordx4 v217, s[28:31], s58 offen offset:1024 lds
v_mfma_f32_16x16x32_bf16 v[100:103], a[100:103], v[128:131], 0
ds_read_b64 a[142:143], v227 offset:4096
v_exp_f32 v35, v35
v_exp_f32 v36, v36
v_mfma_f32_16x16x32_bf16 v[100:103], a[104:107], v[160:163], v[100:103]
buffer_load_dwordx4 v218, s[28:31], s58 offen offset:2048 lds
v_mfma_f32_16x16x32_bf16 v[108:111], a[104:107], v[168:171], v[108:111]
v_exp_f32 v37, v37
v_exp_f32 v38, v38
v_mfma_f32_16x16x32_bf16 v[116:119], a[104:107], v[176:179], v[116:119]
buffer_load_dwordx4 v219, s[28:31], s58 offen offset:3072 lds
v_mfma_f32_16x16x32_bf16 v[124:127], a[104:107], v[184:187], v[124:127]
v_exp_f32 v39, v39
v_cvt_pk_bf16_f32 v196, v32, v33
v_cvt_pk_bf16_f32 v197, v34, v35
v_mfma_f32_16x16x32_bf16 v[120:123], a[108:111], v[184:187], v[120:123]
v_cvt_pk_bf16_f32 v198, v36, v37
v_cvt_pk_bf16_f32 v199, v38, v39
ds_write_b128 v235, v[196:199] offset:4096
v_mfma_f32_16x16x32_bf16 v[112:115], a[108:111], v[176:179], v[112:115]
v_mfma_f32_16x16x32_bf16 a[224:227], a[240:243], v[196:199], a[224:227]
v_fma_f32 v40, v40, s63, -v251
v_fma_f32 v41, v41, s63, -v251
v_fma_f32 v42, v42, s63, -v251
v_mfma_f32_16x16x32_bf16 v[104:107], a[108:111], v[168:171], v[104:107]
v_fma_f32 v43, v43, s63, -v251
v_fma_f32 v44, v44, s63, -v251
v_fma_f32 v45, v45, s63, -v251
v_mfma_f32_16x16x32_bf16 v[96:99], a[108:111], v[160:163], v[96:99]
v_fma_f32 v46, v46, s63, -v251
v_fma_f32 v47, v47, s63, -v251
s_waitcnt lgkmcnt(1)
v_mfma_f32_16x16x32_bf16 v[96:99], a[128:131], a[0:3], v[96:99]
s_waitcnt vmcnt(16)
ds_read_b64 a[96:97], v224 offset:8192
v_mfma_f32_16x16x32_bf16 v[104:107], a[128:131], a[4:7], v[104:107]
ds_read_b64 a[98:99], v225 offset:8192
ds_read_b64 a[100:101], v224 offset:10240
v_exp_f32 v40, v40
v_mfma_f32_16x16x32_bf16 v[112:115], a[128:131], a[8:11], v[112:115]
ds_read_b64 a[102:103], v225 offset:10240
ds_read_b64 a[104:105], v226 offset:10240
v_exp_f32 v41, v41
v_mfma_f32_16x16x32_bf16 v[120:123], a[128:131], a[12:15], v[120:123]
s_add_u32 m0, s53, 4096
s_mov_b32 s58, 196608
buffer_load_dwordx4 v216, s[28:31], s58 offen lds
v_mfma_f32_16x16x32_bf16 v[124:127], a[132:135], a[12:15], v[124:127]
ds_read_b64 a[106:107], v227 offset:10240
v_exp_f32 v42, v42
v_mfma_f32_16x16x32_bf16 v[116:119], a[132:135], a[8:11], v[116:119]
ds_read_b64 a[108:109], v226 offset:8192
v_exp_f32 v43, v43
v_mfma_f32_16x16x32_bf16 v[108:111], a[132:135], a[4:7], v[108:111]
buffer_load_dwordx4 v217, s[28:31], s58 offen offset:1024 lds
v_exp_f32 v44, v44
v_mfma_f32_16x16x32_bf16 v[100:103], a[132:135], a[0:3], v[100:103]
buffer_load_dwordx4 v218, s[28:31], s58 offen offset:2048 lds
v_mfma_f32_16x16x32_bf16 v[100:103], a[136:139], a[16:19], v[100:103]
ds_read_b64 a[110:111], v227 offset:8192
v_exp_f32 v45, v45
v_exp_f32 v46, v46
v_mfma_f32_16x16x32_bf16 v[108:111], a[136:139], a[20:23], v[108:111]
buffer_load_dwordx4 v219, s[28:31], s58 offen offset:3072 lds
v_mfma_f32_16x16x32_bf16 v[116:119], a[136:139], a[24:27], v[116:119]
v_exp_f32 v47, v47
v_cvt_pk_bf16_f32 v192, v40, v41
v_cvt_pk_bf16_f32 v193, v42, v43
v_mfma_f32_16x16x32_bf16 v[124:127], a[136:139], a[28:31], v[124:127]
v_cvt_pk_bf16_f32 v194, v44, v45
v_cvt_pk_bf16_f32 v195, v46, v47
v_mfma_f32_16x16x32_bf16 v[120:123], a[140:143], a[28:31], v[120:123]
ds_write_b128 v235, v[192:195] offset:5120
v_mfma_f32_16x16x32_bf16 a[228:231], a[240:243], v[192:195], a[228:231]
v_fma_f32 v48, v48, s63, -v252
v_fma_f32 v49, v49, s63, -v252
v_fma_f32 v50, v50, s63, -v252
v_fma_f32 v51, v51, s63, -v252
v_mfma_f32_16x16x32_bf16 v[112:115], a[140:143], a[24:27], v[112:115]
v_fma_f32 v52, v52, s63, -v252
v_fma_f32 v53, v53, s63, -v252
v_fma_f32 v54, v54, s63, -v252
v_fma_f32 v55, v55, s63, -v252
v_mfma_f32_16x16x32_bf16 v[104:107], a[140:143], a[20:23], v[104:107]
v_exp_f32 v48, v48
v_mfma_f32_16x16x32_bf16 v[96:99], a[140:143], a[16:19], v[96:99]
v_exp_f32 v49, v49
s_waitcnt lgkmcnt(1)
v_mfma_f32_16x16x32_bf16 v[96:99], a[96:99], a[32:35], v[96:99]
s_waitcnt vmcnt(16)
ds_read_b64 a[128:129], v224 offset:12288
v_exp_f32 v50, v50
v_mfma_f32_16x16x32_bf16 v[104:107], a[96:99], a[36:39], v[104:107]
ds_read_b64 a[130:131], v225 offset:12288
ds_read_b64 a[132:133], v224 offset:14336
v_mfma_f32_16x16x32_bf16 v[112:115], a[96:99], a[40:43], v[112:115]
ds_read_b64 a[134:135], v225 offset:14336
ds_read_b64 a[136:137], v226 offset:14336
v_exp_f32 v51, v51
v_mfma_f32_16x16x32_bf16 v[120:123], a[96:99], a[44:47], v[120:123]
s_add_u32 m0, s53, 8192
s_mov_b32 s58, 16384
buffer_load_dwordx4 v216, s[28:31], s58 offen lds
v_mfma_f32_16x16x32_bf16 v[124:127], a[100:103], a[44:47], v[124:127]
ds_read_b64 a[138:139], v227 offset:14336
v_exp_f32 v52, v52
v_mfma_f32_16x16x32_bf16 v[116:119], a[100:103], a[40:43], v[116:119]
ds_read_b64 a[140:141], v226 offset:12288
v_exp_f32 v53, v53
v_exp_f32 v54, v54
v_mfma_f32_16x16x32_bf16 v[108:111], a[100:103], a[36:39], v[108:111]
buffer_load_dwordx4 v217, s[28:31], s58 offen offset:1024 lds
v_mfma_f32_16x16x32_bf16 v[100:103], a[100:103], a[32:35], v[100:103]
ds_read_b64 a[142:143], v227 offset:12288
v_exp_f32 v55, v55
v_cvt_pk_bf16_f32 v196, v48, v49
v_mfma_f32_16x16x32_bf16 v[100:103], a[104:107], a[48:51], v[100:103]
buffer_load_dwordx4 v218, s[28:31], s58 offen offset:2048 lds
v_cvt_pk_bf16_f32 v197, v50, v51
v_mfma_f32_16x16x32_bf16 v[108:111], a[104:107], a[52:55], v[108:111]
buffer_load_dwordx4 v219, s[28:31], s58 offen offset:3072 lds
v_cvt_pk_bf16_f32 v198, v52, v53
v_mfma_f32_16x16x32_bf16 v[116:119], a[104:107], a[56:59], v[116:119]
v_cvt_pk_bf16_f32 v199, v54, v55
ds_write_b128 v235, v[196:199] offset:6144
v_mfma_f32_16x16x32_bf16 v[124:127], a[104:107], a[60:63], v[124:127]
v_mfma_f32_16x16x32_bf16 a[232:235], a[240:243], v[196:199], a[232:235]
v_fma_f32 v56, v56, s63, -v253
v_fma_f32 v57, v57, s63, -v253
v_fma_f32 v58, v58, s63, -v253
v_mfma_f32_16x16x32_bf16 v[120:123], a[108:111], a[60:63], v[120:123]
v_fma_f32 v59, v59, s63, -v253
v_fma_f32 v60, v60, s63, -v253
v_fma_f32 v61, v61, s63, -v253
v_fma_f32 v62, v62, s63, -v253
v_mfma_f32_16x16x32_bf16 v[112:115], a[108:111], a[56:59], v[112:115]
v_fma_f32 v63, v63, s63, -v253
v_exp_f32 v56, v56
v_mfma_f32_16x16x32_bf16 v[104:107], a[108:111], a[52:55], v[104:107]
v_exp_f32 v57, v57
v_mfma_f32_16x16x32_bf16 v[96:99], a[108:111], a[48:51], v[96:99]
v_exp_f32 v58, v58
s_waitcnt lgkmcnt(1)
v_mfma_f32_16x16x32_bf16 v[96:99], a[128:131], a[64:67], v[96:99]
s_waitcnt lgkmcnt(0)
s_barrier
v_exp_f32 v59, v59
v_mfma_f32_16x16x32_bf16 v[104:107], a[128:131], a[68:71], v[104:107]
s_waitcnt vmcnt(16)
ds_read_b64_tr_b16 a[96:97], v230 offset:16384
v_mfma_f32_16x16x32_bf16 v[112:115], a[128:131], a[72:75], v[112:115]
ds_read_b64_tr_b16 a[98:99], v230 offset:18432
ds_read_b128 a[112:115], v234 offset:0
v_exp_f32 v60, v60
v_mfma_f32_16x16x32_bf16 v[120:123], a[128:131], a[76:79], v[120:123]
s_add_u32 m0, s53, 12288
s_mov_b32 s58, 81920
buffer_load_dwordx4 v216, s[28:31], s58 offen lds
v_mfma_f32_16x16x32_bf16 v[124:127], a[132:135], a[76:79], v[124:127]
ds_read_b128 a[116:119], v234 offset:1024
ds_read_b128 a[120:123], v234 offset:2048
v_exp_f32 v61, v61
v_mfma_f32_16x16x32_bf16 v[116:119], a[132:135], a[72:75], v[116:119]
ds_read_b128 a[124:127], v234 offset:3072
ds_read_b64_tr_b16 a[100:101], v231 offset:16384
v_exp_f32 v62, v62
v_mfma_f32_16x16x32_bf16 v[108:111], a[132:135], a[68:71], v[108:111]
ds_read_b64_tr_b16 a[102:103], v231 offset:18432
ds_read_b64_tr_b16 a[104:105], v232 offset:16384
v_mfma_f32_16x16x32_bf16 v[100:103], a[132:135], a[64:67], v[100:103]
buffer_load_dwordx4 v217, s[28:31], s58 offen offset:1024 lds
v_exp_f32 v63, v63
v_mfma_f32_16x16x32_bf16 v[100:103], a[136:139], a[80:83], v[100:103]
ds_read_b64_tr_b16 a[106:107], v232 offset:18432
ds_read_b64_tr_b16 a[108:109], v233 offset:16384
v_cvt_pk_bf16_f32 v192, v56, v57
v_mfma_f32_16x16x32_bf16 v[108:111], a[136:139], a[84:87], v[108:111]
ds_read_b64_tr_b16 a[110:111], v233 offset:18432
v_cvt_pk_bf16_f32 v193, v58, v59
v_cvt_pk_bf16_f32 v194, v60, v61
v_mfma_f32_16x16x32_bf16 v[116:119], a[136:139], a[88:91], v[116:119]
buffer_load_dwordx4 v218, s[28:31], s58 offen offset:2048 lds
v_cvt_pk_bf16_f32 v195, v62, v63
v_mfma_f32_16x16x32_bf16 v[124:127], a[136:139], a[92:95], v[124:127]
buffer_load_dwordx4 v219, s[28:31], s58 offen offset:3072 lds
v_mfma_f32_16x16x32_bf16 v[120:123], a[140:143], a[92:95], v[120:123]
ds_write_b128 v235, v[192:195] offset:7168
v_mfma_f32_16x16x32_bf16 a[236:239], a[240:243], v[192:195], a[236:239]
v_max3_f32 v242, v64, v65, v242
v_max3_f32 v243, v72, v73, v243
v_max3_f32 v244, v80, v81, v244
v_max3_f32 v245, v88, v89, v245
v_max3_f32 v242, v66, v67, v242
v_mfma_f32_16x16x32_bf16 v[112:115], a[140:143], a[88:91], v[112:115]
v_max3_f32 v243, v74, v75, v243
v_max3_f32 v244, v82, v83, v244
v_max3_f32 v245, v90, v91, v245
v_mfma_f32_16x16x32_bf16 v[104:107], a[140:143], a[84:87], v[104:107]
v_max3_f32 v242, v68, v69, v242
v_max3_f32 v243, v76, v77, v243
v_max3_f32 v244, v84, v85, v244
v_mfma_f32_16x16x32_bf16 v[96:99], a[140:143], a[80:83], v[96:99]
v_max3_f32 v245, v92, v93, v245
v_max3_f32 v242, v70, v71, v242
s_waitcnt lgkmcnt(1)
v_mfma_f32_16x16x32_bf16 v[128:131], a[96:99], a[112:115], 0
s_waitcnt vmcnt(16)
ds_read_b64_tr_b16 a[128:129], v230 offset:20480
v_max3_f32 v243, v78, v79, v243
v_mfma_f32_16x16x32_bf16 v[136:139], a[96:99], a[116:119], 0
ds_read_b64_tr_b16 a[130:131], v230 offset:22528
ds_read_b128 a[144:147], v234 offset:16384
v_max3_f32 v244, v86, v87, v244
v_mfma_f32_16x16x32_bf16 v[144:147], a[96:99], a[120:123], 0
ds_read_b128 a[148:151], v234 offset:17408
ds_read_b128 a[152:155], v234 offset:18432
v_max3_f32 v245, v94, v95, v245
v_mfma_f32_16x16x32_bf16 v[152:155], a[96:99], a[124:127], 0
s_add_u32 m0, s53, 16384
s_mov_b32 s58, 180224
buffer_load_dwordx4 v216, s[28:31], s58 offen lds
v_fma_f32 v64, v64, s63, -v250
v_mfma_f32_16x16x32_bf16 v[156:159], a[100:103], a[124:127], 0
ds_read_b128 a[156:159], v234 offset:19456
ds_read_b64_tr_b16 a[132:133], v231 offset:20480
v_fma_f32 v65, v65, s63, -v250
v_mfma_f32_16x16x32_bf16 v[148:151], a[100:103], a[120:123], 0
ds_read_b64_tr_b16 a[134:135], v231 offset:22528
ds_read_b64_tr_b16 a[136:137], v232 offset:20480
v_fma_f32 v66, v66, s63, -v250
v_mfma_f32_16x16x32_bf16 v[140:143], a[100:103], a[116:119], 0
ds_read_b64_tr_b16 a[138:139], v232 offset:22528
v_fma_f32 v67, v67, s63, -v250
v_fma_f32 v68, v68, s63, -v250
v_fma_f32 v69, v69, s63, -v250
v_mfma_f32_16x16x32_bf16 v[132:135], a[100:103], a[112:115], 0
buffer_load_dwordx4 v217, s[28:31], s58 offen offset:1024 lds
v_fma_f32 v70, v70, s63, -v250
v_mfma_f32_16x16x32_bf16 v[160:163], a[104:107], a[112:115], 0
ds_read_b64_tr_b16 a[140:141], v233 offset:20480
ds_read_b64_tr_b16 a[142:143], v233 offset:22528
v_fma_f32 v71, v71, s63, -v250
v_mfma_f32_16x16x32_bf16 v[168:171], a[104:107], a[116:119], 0
buffer_load_dwordx4 v218, s[28:31], s58 offen offset:2048 lds
v_mfma_f32_16x16x32_bf16 v[176:179], a[104:107], a[120:123], 0
v_exp_f32 v64, v64
v_exp_f32 v65, v65
v_mfma_f32_16x16x32_bf16 v[184:187], a[104:107], a[124:127], 0
buffer_load_dwordx4 v219, s[28:31], s58 offen offset:3072 lds
v_mfma_f32_16x16x32_bf16 v[188:191], a[108:111], a[124:127], 0
v_exp_f32 v66, v66
v_exp_f32 v67, v67
v_mfma_f32_16x16x32_bf16 v[180:183], a[108:111], a[120:123], 0
v_exp_f32 v68, v68
v_mfma_f32_16x16x32_bf16 v[172:175], a[108:111], a[116:119], 0
v_exp_f32 v69, v69
v_exp_f32 v70, v70
v_mfma_f32_16x16x32_bf16 v[164:167], a[108:111], a[112:115], 0
v_exp_f32 v71, v71
v_cvt_pk_bf16_f32 v196, v64, v65
s_waitcnt lgkmcnt(0)
v_mfma_f32_16x16x32_bf16 v[128:131], a[128:131], a[144:147], v[128:131]
s_waitcnt vmcnt(16)
ds_read_b64_tr_b16 a[96:97], v230 offset:0
v_cvt_pk_bf16_f32 v197, v66, v67
v_mfma_f32_16x16x32_bf16 v[136:139], a[128:131], a[148:151], v[136:139]
ds_read_b64_tr_b16 a[98:99], v230 offset:2048
ds_read_b128 a[112:115], v234 offset:32768
v_cvt_pk_bf16_f32 v198, v68, v69
v_mfma_f32_16x16x32_bf16 v[144:147], a[128:131], a[152:155], v[144:147]
ds_read_b128 a[116:119], v234 offset:33792
ds_read_b128 a[120:123], v234 offset:34816
v_cvt_pk_bf16_f32 v199, v70, v71
v_mfma_f32_16x16x32_bf16 v[152:155], a[128:131], a[156:159], v[152:155]
s_add_u32 m0, s53, 20480
s_mov_b32 s58, 245760
buffer_load_dwordx4 v216, s[28:31], s58 offen lds
v_mfma_f32_16x16x32_bf16 v[156:159], a[132:135], a[156:159], v[156:159]
ds_read_b128 a[124:127], v234 offset:35840
ds_read_b64_tr_b16 a[100:101], v231 offset:0
ds_write_b128 v235, v[196:199] offset:8192
v_mfma_f32_16x16x32_bf16 v[148:151], a[132:135], a[152:155], v[148:151]
ds_read_b64_tr_b16 a[102:103], v231 offset:2048
ds_read_b64_tr_b16 a[104:105], v232 offset:0
v_mfma_f32_16x16x32_bf16 a[224:227], a[240:243], v[196:199], a[224:227]
v_fma_f32 v72, v72, s63, -v251
v_fma_f32 v73, v73, s63, -v251
v_fma_f32 v74, v74, s63, -v251
v_mfma_f32_16x16x32_bf16 v[140:143], a[132:135], a[148:151], v[140:143]
ds_read_b64_tr_b16 a[106:107], v232 offset:2048
v_fma_f32 v75, v75, s63, -v251
v_fma_f32 v76, v76, s63, -v251
v_mfma_f32_16x16x32_bf16 v[132:135], a[132:135], a[144:147], v[132:135]
buffer_load_dwordx4 v217, s[28:31], s58 offen offset:1024 lds
v_fma_f32 v77, v77, s63, -v251
v_fma_f32 v78, v78, s63, -v251
v_mfma_f32_16x16x32_bf16 v[160:163], a[136:139], a[144:147], v[160:163]
ds_read_b64_tr_b16 a[108:109], v233 offset:0
ds_read_b64_tr_b16 a[110:111], v233 offset:2048
v_fma_f32 v79, v79, s63, -v251
v_mfma_f32_16x16x32_bf16 v[168:171], a[136:139], a[148:151], v[168:171]
buffer_load_dwordx4 v218, s[28:31], s58 offen offset:2048 lds
v_mfma_f32_16x16x32_bf16 v[176:179], a[136:139], a[152:155], v[176:179]
v_exp_f32 v72, v72
v_exp_f32 v73, v73
v_mfma_f32_16x16x32_bf16 v[184:187], a[136:139], a[156:159], v[184:187]
buffer_load_dwordx4 v219, s[28:31], s58 offen offset:3072 lds
v_mfma_f32_16x16x32_bf16 v[188:191], a[140:143], a[156:159], v[188:191]
v_exp_f32 v74, v74
v_exp_f32 v75, v75
v_mfma_f32_16x16x32_bf16 v[180:183], a[140:143], a[152:155], v[180:183]
v_exp_f32 v76, v76
v_mfma_f32_16x16x32_bf16 v[172:175], a[140:143], a[148:151], v[172:175]
v_exp_f32 v77, v77
v_exp_f32 v78, v78
v_mfma_f32_16x16x32_bf16 v[164:167], a[140:143], a[144:147], v[164:167]
v_exp_f32 v79, v79
s_waitcnt lgkmcnt(0)
v_mfma_f32_16x16x32_bf16 v[128:131], a[96:99], a[112:115], v[128:131]
s_waitcnt vmcnt(16)
ds_read_b64_tr_b16 a[128:129], v230 offset:4096
v_cvt_pk_bf16_f32 v192, v72, v73
v_mfma_f32_16x16x32_bf16 v[136:139], a[96:99], a[116:119], v[136:139]
ds_read_b64_tr_b16 a[130:131], v230 offset:6144
ds_read_b128 a[144:147], v234 offset:49152
v_cvt_pk_bf16_f32 v193, v74, v75
v_mfma_f32_16x16x32_bf16 v[144:147], a[96:99], a[120:123], v[144:147]
ds_read_b128 a[148:151], v234 offset:50176
ds_read_b128 a[152:155], v234 offset:51200
v_cvt_pk_bf16_f32 v194, v76, v77
v_mfma_f32_16x16x32_bf16 v[152:155], a[96:99], a[124:127], v[152:155]
s_add_u32 m0, s53, 0
s_mov_b32 s58, 147456
buffer_load_dwordx4 v216, s[28:31], s58 offen lds
v_cvt_pk_bf16_f32 v195, v78, v79
v_mfma_f32_16x16x32_bf16 v[156:159], a[100:103], a[124:127], v[156:159]
ds_read_b128 a[156:159], v234 offset:52224
ds_read_b64_tr_b16 a[132:133], v231 offset:4096
ds_write_b128 v235, v[192:195] offset:9216
v_mfma_f32_16x16x32_bf16 v[148:151], a[100:103], a[120:123], v[148:151]
ds_read_b64_tr_b16 a[134:135], v231 offset:6144
ds_read_b64_tr_b16 a[136:137], v232 offset:4096
v_mfma_f32_16x16x32_bf16 a[228:231], a[240:243], v[192:195], a[228:231]
v_fma_f32 v80, v80, s63, -v252
v_fma_f32 v81, v81, s63, -v252
v_fma_f32 v82, v82, s63, -v252
v_mfma_f32_16x16x32_bf16 v[140:143], a[100:103], a[116:119], v[140:143]
ds_read_b64_tr_b16 a[138:139], v232 offset:6144
v_fma_f32 v83, v83, s63, -v252
v_fma_f32 v84, v84, s63, -v252
v_mfma_f32_16x16x32_bf16 v[132:135], a[100:103], a[112:115], v[132:135]
buffer_load_dwordx4 v217, s[28:31], s58 offen offset:1024 lds
v_fma_f32 v85, v85, s63, -v252
v_mfma_f32_16x16x32_bf16 v[160:163], a[104:107], a[112:115], v[160:163]
ds_read_b64_tr_b16 a[140:141], v233 offset:4096
ds_read_b64_tr_b16 a[142:143], v233 offset:6144
v_fma_f32 v86, v86, s63, -v252
v_mfma_f32_16x16x32_bf16 v[168:171], a[104:107], a[116:119], v[168:171]
buffer_load_dwordx4 v218, s[28:31], s58 offen offset:2048 lds
v_fma_f32 v87, v87, s63, -v252
v_mfma_f32_16x16x32_bf16 v[176:179], a[104:107], a[120:123], v[176:179]
v_exp_f32 v80, v80
v_mfma_f32_16x16x32_bf16 v[184:187], a[104:107], a[124:127], v[184:187]
v_exp_f32 v81, v81
v_exp_f32 v82, v82
v_mfma_f32_16x16x32_bf16 v[188:191], a[108:111], a[124:127], v[188:191]
v_exp_f32 v83, v83
v_mfma_f32_16x16x32_bf16 v[180:183], a[108:111], a[120:123], v[180:183]
v_exp_f32 v84, v84
v_exp_f32 v85, v85
v_mfma_f32_16x16x32_bf16 v[172:175], a[108:111], a[116:119], v[172:175]
v_exp_f32 v86, v86
v_mfma_f32_16x16x32_bf16 v[164:167], a[108:111], a[112:115], v[164:167]
v_exp_f32 v87, v87
v_cvt_pk_bf16_f32 v196, v80, v81
s_waitcnt lgkmcnt(0)
v_mfma_f32_16x16x32_bf16 v[128:131], a[128:131], a[144:147], v[128:131]
s_barrier
v_cvt_pk_bf16_f32 v197, v82, v83
v_mfma_f32_16x16x32_bf16 v[136:139], a[128:131], a[148:151], v[136:139]
s_waitcnt vmcnt(15)
ds_read_b64_tr_b16 a[96:97], v230 offset:8192
v_cvt_pk_bf16_f32 v198, v84, v85
v_cvt_pk_bf16_f32 v199, v86, v87
v_mfma_f32_16x16x32_bf16 v[144:147], a[128:131], a[152:155], v[144:147]
ds_read_b64_tr_b16 a[98:99], v230 offset:10240
ds_read_b128 a[112:115], v234 offset:4096
buffer_load_dwordx4 v219, s[28:31], s58 offen offset:3072 lds
v_mfma_f32_16x16x32_bf16 v[152:155], a[128:131], a[156:159], v[152:155]
s_add_u32 m0, s53, 4096
s_mov_b32 s58, 212992
ds_write_b128 v235, v[196:199] offset:10240
v_mfma_f32_16x16x32_bf16 v[156:159], a[132:135], a[156:159], v[156:159]
ds_read_b128 a[116:119], v234 offset:5120
ds_read_b128 a[120:123], v234 offset:6144
v_mfma_f32_16x16x32_bf16 a[232:235], a[240:243], v[196:199], a[232:235]
v_fma_f32 v88, v88, s63, -v253
v_fma_f32 v89, v89, s63, -v253
v_fma_f32 v90, v90, s63, -v253
v_mfma_f32_16x16x32_bf16 v[148:151], a[132:135], a[152:155], v[148:151]
ds_read_b128 a[124:127], v234 offset:7168
ds_read_b64_tr_b16 a[100:101], v231 offset:8192
v_fma_f32 v91, v91, s63, -v253
v_mfma_f32_16x16x32_bf16 v[140:143], a[132:135], a[148:151], v[140:143]
ds_read_b64_tr_b16 a[102:103], v231 offset:10240
ds_read_b64_tr_b16 a[104:105], v232 offset:8192
buffer_load_dwordx4 v216, s[28:31], s58 offen lds
v_fma_f32 v92, v92, s63, -v253
v_mfma_f32_16x16x32_bf16 v[132:135], a[132:135], a[144:147], v[132:135]
buffer_load_dwordx4 v217, s[28:31], s58 offen offset:1024 lds
v_fma_f32 v93, v93, s63, -v253
v_mfma_f32_16x16x32_bf16 v[160:163], a[136:139], a[144:147], v[160:163]
ds_read_b64_tr_b16 a[106:107], v232 offset:10240
ds_read_b64_tr_b16 a[108:109], v233 offset:8192
v_fma_f32 v94, v94, s63, -v253
v_mfma_f32_16x16x32_bf16 v[168:171], a[136:139], a[148:151], v[168:171]
ds_read_b64_tr_b16 a[110:111], v233 offset:10240
v_fma_f32 v95, v95, s63, -v253
v_mfma_f32_16x16x32_bf16 v[176:179], a[136:139], a[152:155], v[176:179]
buffer_load_dwordx4 v218, s[28:31], s58 offen offset:2048 lds
v_exp_f32 v88, v88
v_mfma_f32_16x16x32_bf16 v[184:187], a[136:139], a[156:159], v[184:187]
v_exp_f32 v89, v89
v_mfma_f32_16x16x32_bf16 v[188:191], a[140:143], a[156:159], v[188:191]
v_exp_f32 v90, v90
v_exp_f32 v91, v91
v_mfma_f32_16x16x32_bf16 v[180:183], a[140:143], a[152:155], v[180:183]
v_exp_f32 v92, v92
v_mfma_f32_16x16x32_bf16 v[172:175], a[140:143], a[148:151], v[172:175]
v_exp_f32 v93, v93
v_exp_f32 v94, v94
v_mfma_f32_16x16x32_bf16 v[164:167], a[140:143], a[144:147], v[164:167]
v_exp_f32 v95, v95
s_waitcnt lgkmcnt(0)
v_mfma_f32_16x16x32_bf16 v[128:131], a[96:99], a[112:115], v[128:131]
s_waitcnt vmcnt(15)
ds_read_b64_tr_b16 a[128:129], v230 offset:12288
v_cvt_pk_bf16_f32 v192, v88, v89
v_mfma_f32_16x16x32_bf16 v[136:139], a[96:99], a[116:119], v[136:139]
ds_read_b64_tr_b16 a[130:131], v230 offset:14336
ds_read_b128 a[144:147], v234 offset:20480
buffer_load_dwordx4 v219, s[28:31], s58 offen offset:3072 lds
v_cvt_pk_bf16_f32 v193, v90, v91
v_mfma_f32_16x16x32_bf16 v[144:147], a[96:99], a[120:123], v[144:147]
ds_read_b128 a[148:151], v234 offset:21504
ds_read_b128 a[152:155], v234 offset:22528
v_cvt_pk_bf16_f32 v194, v92, v93
v_mfma_f32_16x16x32_bf16 v[152:155], a[96:99], a[124:127], v[152:155]
s_add_u32 m0, s53, 8192
s_mov_b32 s58, 32768
v_cvt_pk_bf16_f32 v195, v94, v95
v_mfma_f32_16x16x32_bf16 v[156:159], a[100:103], a[124:127], v[156:159]
ds_read_b128 a[156:159], v234 offset:23552
ds_read_b64_tr_b16 a[132:133], v231 offset:12288
v_mfma_f32_16x16x32_bf16 v[148:151], a[100:103], a[120:123], v[148:151]
ds_read_b64_tr_b16 a[134:135], v231 offset:14336
ds_read_b64_tr_b16 a[136:137], v232 offset:12288
ds_write_b128 v235, v[192:195] offset:11264
v_mfma_f32_16x16x32_bf16 v[140:143], a[100:103], a[116:119], v[140:143]
ds_read_b64_tr_b16 a[138:139], v232 offset:14336
buffer_load_dwordx4 v216, s[28:31], s58 offen lds
v_mfma_f32_16x16x32_bf16 a[236:239], a[240:243], v[192:195], a[236:239]
v_max3_f32 v242, v96, v97, v242
v_max3_f32 v243, v104, v105, v243
v_max3_f32 v244, v112, v113, v244
v_mfma_f32_16x16x32_bf16 v[132:135], a[100:103], a[112:115], v[132:135]
ds_read_b64_tr_b16 a[140:141], v233 offset:12288
v_max3_f32 v245, v120, v121, v245
v_max3_f32 v242, v98, v99, v242
v_mfma_f32_16x16x32_bf16 v[160:163], a[104:107], a[112:115], v[160:163]
ds_read_b64_tr_b16 a[142:143], v233 offset:14336
v_max3_f32 v243, v106, v107, v243
v_max3_f32 v244, v114, v115, v244
v_mfma_f32_16x16x32_bf16 v[168:171], a[104:107], a[116:119], v[168:171]
buffer_load_dwordx4 v217, s[28:31], s58 offen offset:1024 lds
v_max3_f32 v245, v122, v123, v245
v_mfma_f32_16x16x32_bf16 v[176:179], a[104:107], a[120:123], v[176:179]
buffer_load_dwordx4 v218, s[28:31], s58 offen offset:2048 lds
v_max3_f32 v242, v100, v101, v242
v_mfma_f32_16x16x32_bf16 v[184:187], a[104:107], a[124:127], v[184:187]
v_max3_f32 v243, v108, v109, v243
v_max3_f32 v244, v116, v117, v244
v_max3_f32 v245, v124, v125, v245
v_mfma_f32_16x16x32_bf16 v[188:191], a[108:111], a[124:127], v[188:191]
v_max3_f32 v242, v102, v103, v242
v_max3_f32 v243, v110, v111, v243
v_max3_f32 v244, v118, v119, v244
v_mfma_f32_16x16x32_bf16 v[180:183], a[108:111], a[120:123], v[180:183]
buffer_load_dwordx4 v219, s[28:31], s58 offen offset:3072 lds
v_max3_f32 v245, v126, v127, v245
v_mfma_f32_16x16x32_bf16 v[172:175], a[108:111], a[116:119], v[172:175]
v_fma_f32 v96, v96, s63, -v250
v_fma_f32 v97, v97, s63, -v250
v_fma_f32 v98, v98, s63, -v250
v_mfma_f32_16x16x32_bf16 v[164:167], a[108:111], a[112:115], v[164:167]
v_fma_f32 v99, v99, s63, -v250
v_fma_f32 v100, v100, s63, -v250
s_waitcnt lgkmcnt(0)
v_mfma_f32_16x16x32_bf16 v[128:131], a[128:131], a[144:147], v[128:131]
s_waitcnt vmcnt(8)
v_fma_f32 v101, v101, s63, -v250
v_mfma_f32_16x16x32_bf16 v[136:139], a[128:131], a[148:151], v[136:139]
ds_read_b64_tr_b16 a[96:97], v230 offset:0
ds_read_b64_tr_b16 a[98:99], v230 offset:2048
v_fma_f32 v102, v102, s63, -v250
v_mfma_f32_16x16x32_bf16 v[144:147], a[128:131], a[152:155], v[144:147]
ds_read_b128 a[112:115], v234 offset:36864
ds_read_b128 a[116:119], v234 offset:37888
v_fma_f32 v103, v103, s63, -v250
v_mfma_f32_16x16x32_bf16 v[152:155], a[128:131], a[156:159], v[152:155]
s_add_u32 m0, s53, 12288
s_mov_b32 s58, 98304
buffer_load_dwordx4 v216, s[28:31], s58 offen lds
v_mfma_f32_16x16x32_bf16 v[156:159], a[132:135], a[156:159], v[156:159]
ds_read_b128 a[120:123], v234 offset:38912
ds_read_b128 a[124:127], v234 offset:39936
v_exp_f32 v96, v96
v_mfma_f32_16x16x32_bf16 v[148:151], a[132:135], a[152:155], v[148:151]
ds_read_b64_tr_b16 a[100:101], v231 offset:0
ds_read_b64_tr_b16 a[102:103], v231 offset:2048
v_mfma_f32_16x16x32_bf16 v[140:143], a[132:135], a[148:151], v[140:143]
ds_read_b64_tr_b16 a[104:105], v232 offset:0
ds_read_b64_tr_b16 a[106:107], v232 offset:2048
v_exp_f32 v97, v97
v_mfma_f32_16x16x32_bf16 v[132:135], a[132:135], a[144:147], v[132:135]
buffer_load_dwordx4 v217, s[28:31], s58 offen offset:1024 lds
v_mfma_f32_16x16x32_bf16 v[160:163], a[136:139], a[144:147], v[160:163]
ds_read_b64_tr_b16 a[108:109], v233 offset:0
ds_read_b64_tr_b16 a[110:111], v233 offset:2048
v_exp_f32 v98, v98
v_mfma_f32_16x16x32_bf16 v[168:171], a[136:139], a[148:151], v[168:171]
buffer_load_dwordx4 v218, s[28:31], s58 offen offset:2048 lds
v_exp_f32 v99, v99
v_mfma_f32_16x16x32_bf16 v[176:179], a[136:139], a[152:155], v[176:179]
buffer_load_dwordx4 v219, s[28:31], s58 offen offset:3072 lds
v_mfma_f32_16x16x32_bf16 v[184:187], a[136:139], a[156:159], v[184:187]
v_exp_f32 v100, v100
v_exp_f32 v101, v101
v_mfma_f32_16x16x32_bf16 v[188:191], a[140:143], a[156:159], v[188:191]
v_exp_f32 v102, v102
v_mfma_f32_16x16x32_bf16 v[180:183], a[140:143], a[152:155], v[180:183]
v_exp_f32 v103, v103
v_cvt_pk_bf16_f32 v196, v96, v97
v_cvt_pk_bf16_f32 v197, v98, v99
v_mfma_f32_16x16x32_bf16 v[172:175], a[140:143], a[148:151], v[172:175]
v_cvt_pk_bf16_f32 v198, v100, v101
v_cvt_pk_bf16_f32 v199, v102, v103
v_mfma_f32_16x16x32_bf16 v[164:167], a[140:143], a[144:147], v[164:167]
ds_write_b128 v235, v[196:199] offset:12288
v_mfma_f32_16x16x32_bf16 a[224:227], a[240:243], v[196:199], a[224:227]
v_fma_f32 v104, v104, s63, -v251
v_fma_f32 v105, v105, s63, -v251
v_fma_f32 v106, v106, s63, -v251
s_waitcnt lgkmcnt(1)
v_mfma_f32_16x16x32_bf16 v[128:131], a[96:99], a[112:115], v[128:131]
s_waitcnt vmcnt(8)
ds_read_b64_tr_b16 a[128:129], v230 offset:4096
v_fma_f32 v107, v107, s63, -v251
v_mfma_f32_16x16x32_bf16 v[136:139], a[96:99], a[116:119], v[136:139]
ds_read_b64_tr_b16 a[130:131], v230 offset:6144
ds_read_b128 a[144:147], v234 offset:53248
v_fma_f32 v108, v108, s63, -v251
v_mfma_f32_16x16x32_bf16 v[144:147], a[96:99], a[120:123], v[144:147]
ds_read_b128 a[148:151], v234 offset:54272
ds_read_b128 a[152:155], v234 offset:55296
v_fma_f32 v109, v109, s63, -v251
v_mfma_f32_16x16x32_bf16 v[152:155], a[96:99], a[124:127], v[152:155]
s_add_u32 m0, s53, 0
s_mov_b32 s58, 163840
buffer_load_dwordx4 v216, s[28:31], s58 offen lds
v_mfma_f32_16x16x32_bf16 v[156:159], a[100:103], a[124:127], v[156:159]
ds_read_b128 a[156:159], v234 offset:56320
ds_read_b64_tr_b16 a[132:133], v231 offset:4096
v_fma_f32 v110, v110, s63, -v251
v_mfma_f32_16x16x32_bf16 v[148:151], a[100:103], a[120:123], v[148:151]
ds_read_b64_tr_b16 a[134:135], v231 offset:6144
ds_read_b64_tr_b16 a[136:137], v232 offset:4096
v_fma_f32 v111, v111, s63, -v251
v_mfma_f32_16x16x32_bf16 v[140:143], a[100:103], a[116:119], v[140:143]
ds_read_b64_tr_b16 a[138:139], v232 offset:6144
v_exp_f32 v104, v104
v_mfma_f32_16x16x32_bf16 v[132:135], a[100:103], a[112:115], v[132:135]
buffer_load_dwordx4 v217, s[28:31], s58 offen offset:1024 lds
v_mfma_f32_16x16x32_bf16 v[160:163], a[104:107], a[112:115], v[160:163]
ds_read_b64_tr_b16 a[140:141], v233 offset:4096
ds_read_b64_tr_b16 a[142:143], v233 offset:6144
v_exp_f32 v105, v105
v_mfma_f32_16x16x32_bf16 v[168:171], a[104:107], a[116:119], v[168:171]
buffer_load_dwordx4 v218, s[28:31], s58 offen offset:2048 lds
v_exp_f32 v106, v106
v_mfma_f32_16x16x32_bf16 v[176:179], a[104:107], a[120:123], v[176:179]
buffer_load_dwordx4 v219, s[28:31], s58 offen offset:3072 lds
v_mfma_f32_16x16x32_bf16 v[184:187], a[104:107], a[124:127], v[184:187]
v_exp_f32 v107, v107
v_exp_f32 v108, v108
v_mfma_f32_16x16x32_bf16 v[188:191], a[108:111], a[124:127], v[188:191]
v_exp_f32 v109, v109
v_mfma_f32_16x16x32_bf16 v[180:183], a[108:111], a[120:123], v[180:183]
v_exp_f32 v110, v110
v_exp_f32 v111, v111
v_mfma_f32_16x16x32_bf16 v[172:175], a[108:111], a[116:119], v[172:175]
v_cvt_pk_bf16_f32 v192, v104, v105
v_cvt_pk_bf16_f32 v193, v106, v107
v_mfma_f32_16x16x32_bf16 v[164:167], a[108:111], a[112:115], v[164:167]
v_cvt_pk_bf16_f32 v194, v108, v109
v_cvt_pk_bf16_f32 v195, v110, v111
s_waitcnt lgkmcnt(0)
v_mfma_f32_16x16x32_bf16 v[128:131], a[128:131], a[144:147], v[128:131]
s_barrier
v_mfma_f32_16x16x32_bf16 v[136:139], a[128:131], a[148:151], v[136:139]
s_waitcnt vmcnt(8)
ds_read_b64_tr_b16 a[96:97], v230 offset:8192
ds_write_b128 v235, v[192:195] offset:13312
v_mfma_f32_16x16x32_bf16 v[144:147], a[128:131], a[152:155], v[144:147]
ds_read_b64_tr_b16 a[98:99], v230 offset:10240
ds_read_b128 a[112:115], v234 offset:8192
v_mfma_f32_16x16x32_bf16 a[228:231], a[240:243], v[192:195], a[228:231]
v_fma_f32 v112, v112, s63, -v252
v_fma_f32 v113, v113, s63, -v252
v_fma_f32 v114, v114, s63, -v252
v_mfma_f32_16x16x32_bf16 v[152:155], a[128:131], a[156:159], v[152:155]
s_add_u32 m0, s53, 4096
s_mov_b32 s58, 229376
buffer_load_dwordx4 v216, s[28:31], s58 offen lds
v_fma_f32 v115, v115, s63, -v252
v_mfma_f32_16x16x32_bf16 v[156:159], a[132:135], a[156:159], v[156:159]
ds_read_b128 a[116:119], v234 offset:9216
ds_read_b128 a[120:123], v234 offset:10240
v_fma_f32 v116, v116, s63, -v252
v_mfma_f32_16x16x32_bf16 v[148:151], a[132:135], a[152:155], v[148:151]
ds_read_b128 a[124:127], v234 offset:11264
ds_read_b64_tr_b16 a[100:101], v231 offset:8192
v_fma_f32 v117, v117, s63, -v252
v_mfma_f32_16x16x32_bf16 v[140:143], a[132:135], a[148:151], v[140:143]
ds_read_b64_tr_b16 a[102:103], v231 offset:10240
ds_read_b64_tr_b16 a[104:105], v232 offset:8192
v_fma_f32 v118, v118, s63, -v252
v_mfma_f32_16x16x32_bf16 v[132:135], a[132:135], a[144:147], v[132:135]
buffer_load_dwordx4 v217, s[28:31], s58 offen offset:1024 lds
v_fma_f32 v119, v119, s63, -v252
v_mfma_f32_16x16x32_bf16 v[160:163], a[136:139], a[144:147], v[160:163]
ds_read_b64_tr_b16 a[106:107], v232 offset:10240
ds_read_b64_tr_b16 a[108:109], v233 offset:8192
v_mfma_f32_16x16x32_bf16 v[168:171], a[136:139], a[148:151], v[168:171]
ds_read_b64_tr_b16 a[110:111], v233 offset:10240
v_exp_f32 v112, v112
v_mfma_f32_16x16x32_bf16 v[176:179], a[136:139], a[152:155], v[176:179]
buffer_load_dwordx4 v218, s[28:31], s58 offen offset:2048 lds
v_exp_f32 v113, v113
v_mfma_f32_16x16x32_bf16 v[184:187], a[136:139], a[156:159], v[184:187]
buffer_load_dwordx4 v219, s[28:31], s58 offen offset:3072 lds
v_mfma_f32_16x16x32_bf16 v[188:191], a[140:143], a[156:159], v[188:191]
v_exp_f32 v114, v114
v_exp_f32 v115, v115
v_mfma_f32_16x16x32_bf16 v[180:183], a[140:143], a[152:155], v[180:183]
v_exp_f32 v116, v116
v_mfma_f32_16x16x32_bf16 v[172:175], a[140:143], a[148:151], v[172:175]
v_exp_f32 v117, v117
v_exp_f32 v118, v118
v_mfma_f32_16x16x32_bf16 v[164:167], a[140:143], a[144:147], v[164:167]
v_exp_f32 v119, v119
s_waitcnt lgkmcnt(0)
v_mfma_f32_16x16x32_bf16 v[128:131], a[96:99], a[112:115], v[128:131]
s_waitcnt vmcnt(8)
ds_read_b64_tr_b16 a[128:129], v230 offset:12288
v_cvt_pk_bf16_f32 v196, v112, v113
v_mfma_f32_16x16x32_bf16 v[136:139], a[96:99], a[116:119], v[136:139]
ds_read_b64_tr_b16 a[130:131], v230 offset:14336
ds_read_b128 a[144:147], v234 offset:24576
v_cvt_pk_bf16_f32 v197, v114, v115
v_mfma_f32_16x16x32_bf16 v[144:147], a[96:99], a[120:123], v[144:147]
ds_read_b128 a[148:151], v234 offset:25600
ds_read_b128 a[152:155], v234 offset:26624
v_cvt_pk_bf16_f32 v198, v116, v117
v_mfma_f32_16x16x32_bf16 v[152:155], a[96:99], a[124:127], v[152:155]
s_add_u32 m0, s53, 8192
s_mov_b32 s58, 49152
buffer_load_dwordx4 v216, s[28:31], s58 offen lds
v_mfma_f32_16x16x32_bf16 v[156:159], a[100:103], a[124:127], v[156:159]
ds_read_b128 a[156:159], v234 offset:27648
ds_read_b64_tr_b16 a[132:133], v231 offset:12288
v_cvt_pk_bf16_f32 v199, v118, v119
v_mfma_f32_16x16x32_bf16 v[148:151], a[100:103], a[120:123], v[148:151]
ds_read_b64_tr_b16 a[134:135], v231 offset:14336
ds_read_b64_tr_b16 a[136:137], v232 offset:12288
v_mfma_f32_16x16x32_bf16 v[140:143], a[100:103], a[116:119], v[140:143]
ds_read_b64_tr_b16 a[138:139], v232 offset:14336
ds_write_b128 v235, v[196:199] offset:14336
v_mfma_f32_16x16x32_bf16 a[232:235], a[240:243], v[196:199], a[232:235]
v_fma_f32 v120, v120, s63, -v253
v_fma_f32 v121, v121, s63, -v253
v_fma_f32 v122, v122, s63, -v253
v_mfma_f32_16x16x32_bf16 v[132:135], a[100:103], a[112:115], v[132:135]
buffer_load_dwordx4 v217, s[28:31], s58 offen offset:1024 lds
v_fma_f32 v123, v123, s63, -v253
v_mfma_f32_16x16x32_bf16 v[160:163], a[104:107], a[112:115], v[160:163]
ds_read_b64_tr_b16 a[140:141], v233 offset:12288
ds_read_b64_tr_b16 a[142:143], v233 offset:14336
v_fma_f32 v124, v124, s63, -v253
v_mfma_f32_16x16x32_bf16 v[168:171], a[104:107], a[116:119], v[168:171]
buffer_load_dwordx4 v218, s[28:31], s58 offen offset:2048 lds
v_fma_f32 v125, v125, s63, -v253
v_mfma_f32_16x16x32_bf16 v[176:179], a[104:107], a[120:123], v[176:179]
buffer_load_dwordx4 v219, s[28:31], s58 offen offset:3072 lds
v_fma_f32 v126, v126, s63, -v253
v_mfma_f32_16x16x32_bf16 v[184:187], a[104:107], a[124:127], v[184:187]
v_fma_f32 v127, v127, s63, -v253
v_exp_f32 v120, v120
v_mfma_f32_16x16x32_bf16 v[188:191], a[108:111], a[124:127], v[188:191]
v_exp_f32 v121, v121
v_mfma_f32_16x16x32_bf16 v[180:183], a[108:111], a[120:123], v[180:183]
v_exp_f32 v122, v122
v_exp_f32 v123, v123
v_mfma_f32_16x16x32_bf16 v[172:175], a[108:111], a[116:119], v[172:175]
v_exp_f32 v124, v124
v_mfma_f32_16x16x32_bf16 v[164:167], a[108:111], a[112:115], v[164:167]
v_exp_f32 v125, v125
s_waitcnt lgkmcnt(0)
v_mfma_f32_16x16x32_bf16 v[128:131], a[128:131], a[144:147], v[128:131]
s_waitcnt vmcnt(8)
ds_read_b64_tr_b16 a[96:97], v230 offset:0
v_mfma_f32_16x16x32_bf16 v[136:139], a[128:131], a[148:151], v[136:139]
ds_read_b64_tr_b16 a[98:99], v230 offset:2048
ds_read_b128 a[112:115], v234 offset:40960
v_exp_f32 v126, v126
v_mfma_f32_16x16x32_bf16 v[144:147], a[128:131], a[152:155], v[144:147]
ds_read_b128 a[116:119], v234 offset:41984
ds_read_b128 a[120:123], v234 offset:43008
v_mfma_f32_16x16x32_bf16 v[152:155], a[128:131], a[156:159], v[152:155]
s_add_u32 m0, s53, 12288
s_mov_b32 s58, 114688
buffer_load_dwordx4 v216, s[28:31], s58 offen lds
v_exp_f32 v127, v127
v_mfma_f32_16x16x32_bf16 v[156:159], a[132:135], a[156:159], v[156:159]
ds_read_b128 a[124:127], v234 offset:44032
ds_read_b64_tr_b16 a[100:101], v231 offset:0
v_cvt_pk_bf16_f32 v192, v120, v121
v_mfma_f32_16x16x32_bf16 v[148:151], a[132:135], a[152:155], v[148:151]
ds_read_b64_tr_b16 a[102:103], v231 offset:2048
ds_read_b64_tr_b16 a[104:105], v232 offset:0
v_cvt_pk_bf16_f32 v193, v122, v123
v_mfma_f32_16x16x32_bf16 v[140:143], a[132:135], a[148:151], v[140:143]
ds_read_b64_tr_b16 a[106:107], v232 offset:2048
v_cvt_pk_bf16_f32 v194, v124, v125
v_cvt_pk_bf16_f32 v195, v126, v127
v_mfma_f32_16x16x32_bf16 v[132:135], a[132:135], a[144:147], v[132:135]
buffer_load_dwordx4 v217, s[28:31], s58 offen offset:1024 lds
v_mfma_f32_16x16x32_bf16 v[160:163], a[136:139], a[144:147], v[160:163]
ds_read_b64_tr_b16 a[108:109], v233 offset:0
ds_read_b64_tr_b16 a[110:111], v233 offset:2048
ds_write_b128 v235, v[192:195] offset:15360
v_mfma_f32_16x16x32_bf16 v[168:171], a[136:139], a[148:151], v[168:171]
buffer_load_dwordx4 v218, s[28:31], s58 offen offset:2048 lds
v_mfma_f32_16x16x32_bf16 a[236:239], a[240:243], v[192:195], a[236:239]
v_mov_b32 v200, v242
v_mov_b32 v201, v243
v_mov_b32 v202, v244
v_mfma_f32_16x16x32_bf16 v[176:179], a[136:139], a[152:155], v[176:179]
buffer_load_dwordx4 v219, s[28:31], s58 offen offset:3072 lds
v_mov_b32 v203, v245
v_mfma_f32_16x16x32_bf16 v[184:187], a[136:139], a[156:159], v[184:187]
v_permlane32_swap_b32 v200, v202
v_mfma_f32_16x16x32_bf16 v[188:191], a[140:143], a[156:159], v[188:191]
v_permlane32_swap_b32 v201, v203
v_max_f32 v200, v200, v202
v_max_f32 v201, v201, v203
v_mfma_f32_16x16x32_bf16 v[180:183], a[140:143], a[152:155], v[180:183]
s_nop 0
v_permlane16_swap_b32 v200, v201
v_max_f32 v200, v200, v201
v_mfma_f32_16x16x32_bf16 v[172:175], a[140:143], a[148:151], v[172:175]
ds_write_b32 v239, v200 offset:1024
ds_write_b32 v239, v200 offset:17408
v_mfma_f32_16x16x32_bf16 v[164:167], a[140:143], a[144:147], v[164:167]
ds_write_b32 v239, v200 offset:33792
s_waitcnt lgkmcnt(4)
v_mfma_f32_16x16x32_bf16 v[128:131], a[96:99], a[112:115], v[128:131]
s_waitcnt vmcnt(8)
ds_read_b64_tr_b16 a[128:129], v230 offset:4096
ds_write_b32 v239, v200 offset:50176
v_mfma_f32_16x16x32_bf16 v[136:139], a[96:99], a[116:119], v[136:139]
ds_read_b64_tr_b16 a[130:131], v230 offset:6144
ds_read_b128 a[144:147], v234 offset:57344
v_mfma_f32_16x16x32_bf16 v[144:147], a[96:99], a[120:123], v[144:147]
ds_read_b128 a[148:151], v234 offset:58368
ds_read_b128 a[152:155], v234 offset:59392
v_and_b32 v239, -16, v239
v_mfma_f32_16x16x32_bf16 v[152:155], a[96:99], a[124:127], v[152:155]
s_add_u32 m0, s53, 0
s_add_u32 s58, s4, 0
buffer_load_dwordx4 v220, s[36:39], s58 offen lds
v_mfma_f32_16x16x32_bf16 v[156:159], a[100:103], a[124:127], v[156:159]
ds_read_b128 a[156:159], v234 offset:60416
ds_read_b64_tr_b16 a[132:133], v231 offset:4096
v_mfma_f32_16x16x32_bf16 v[148:151], a[100:103], a[120:123], v[148:151]
ds_read_b64_tr_b16 a[134:135], v231 offset:6144
ds_read_b64_tr_b16 a[136:137], v232 offset:4096
v_accvgpr_read_b32 v246, a224
v_mfma_f32_16x16x32_bf16 v[140:143], a[100:103], a[116:119], v[140:143]
ds_read_b64_tr_b16 a[138:139], v232 offset:6144
v_accvgpr_read_b32 v247, a228
v_accvgpr_read_b32 v248, a232
v_mfma_f32_16x16x32_bf16 v[132:135], a[100:103], a[112:115], v[132:135]
buffer_load_dwordx4 v221, s[36:39], s58 offen offset:1024 lds
v_accvgpr_read_b32 v249, a236
v_mfma_f32_16x16x32_bf16 v[160:163], a[104:107], a[112:115], v[160:163]
ds_read_b64_tr_b16 a[140:141], v233 offset:4096
ds_read_b64_tr_b16 a[142:143], v233 offset:6144
v_mfma_f32_16x16x32_bf16 v[168:171], a[104:107], a[116:119], v[168:171]
buffer_load_dwordx4 v222, s[36:39], s58 offen offset:2048 lds
ds_write_b128 v239, v[246:249] offset:0
v_mfma_f32_16x16x32_bf16 v[176:179], a[104:107], a[120:123], v[176:179]
buffer_load_dwordx4 v223, s[36:39], s58 offen offset:3072 lds
v_mfma_f32_16x16x32_bf16 v[184:187], a[104:107], a[124:127], v[184:187]
ds_write_b128 v239, v[246:249] offset:16384
v_mfma_f32_16x16x32_bf16 v[188:191], a[108:111], a[124:127], v[188:191]
v_mfma_f32_16x16x32_bf16 v[180:183], a[108:111], a[120:123], v[180:183]
v_mfma_f32_16x16x32_bf16 v[172:175], a[108:111], a[116:119], v[172:175]
ds_write_b128 v239, v[246:249] offset:32768
v_mfma_f32_16x16x32_bf16 v[164:167], a[108:111], a[112:115], v[164:167]
s_waitcnt lgkmcnt(3)
v_mfma_f32_16x16x32_bf16 v[128:131], a[128:131], a[144:147], v[128:131]
ds_write_b128 v239, v[246:249] offset:49152
s_add_u32 m0, s53, 4096
s_add_u32 s58, s4, 28672
buffer_load_dwordx4 v220, s[36:39], s58 offen lds
s_waitcnt lgkmcnt(0)
s_barrier
buffer_load_dwordx4 v221, s[36:39], s58 offen offset:1024 lds
v_mfma_f32_16x16x32_bf16 v[136:139], a[128:131], a[148:151], v[136:139]
s_waitcnt vmcnt(10)
ds_read_b64_tr_b16 a[96:97], v230 offset:8192
ds_read_b128 v[192:195], v240 offset:1024
ds_read_b128 v[196:199], v240 offset:1280
ds_read_b128 v[200:203], v240 offset:1536
ds_read_b128 v[204:207], v240 offset:1792
v_mfma_f32_16x16x32_bf16 v[144:147], a[128:131], a[152:155], v[144:147]
ds_read_b64_tr_b16 a[98:99], v230 offset:10240
ds_read_b128 a[112:115], v234 offset:12288
v_mfma_f32_16x16x32_bf16 v[152:155], a[128:131], a[156:159], v[152:155]
buffer_load_dwordx4 v222, s[36:39], s58 offen offset:2048 lds
v_mfma_f32_16x16x32_bf16 v[156:159], a[132:135], a[156:159], v[156:159]
ds_read_b128 a[116:119], v234 offset:13312
ds_read_b128 a[120:123], v234 offset:14336
v_mfma_f32_16x16x32_bf16 v[148:151], a[132:135], a[152:155], v[148:151]
ds_read_b128 a[124:127], v234 offset:15360
ds_read_b64_tr_b16 a[100:101], v231 offset:8192
v_mfma_f32_16x16x32_bf16 v[140:143], a[132:135], a[148:151], v[140:143]
ds_read_b64_tr_b16 a[102:103], v231 offset:10240
ds_read_b64_tr_b16 a[104:105], v232 offset:8192
v_mfma_f32_16x16x32_bf16 v[132:135], a[132:135], a[144:147], v[132:135]
buffer_load_dwordx4 v223, s[36:39], s58 offen offset:3072 lds
v_mfma_f32_16x16x32_bf16 v[160:163], a[136:139], a[144:147], v[160:163]
ds_read_b64_tr_b16 a[106:107], v232 offset:10240
ds_read_b64_tr_b16 a[108:109], v233 offset:8192
s_waitcnt lgkmcnt(10)
v_mfma_f32_16x16x32_bf16 v[168:171], a[136:139], a[148:151], v[168:171]
ds_read_b64_tr_b16 a[110:111], v233 offset:10240
v_max3_f32 v242, v192, v196, v200
v_max3_f32 v243, v193, v197, v201
v_mfma_f32_16x16x32_bf16 v[176:179], a[136:139], a[152:155], v[176:179]
v_max3_f32 v244, v194, v198, v202
v_max3_f32 v245, v195, v199, v203
v_max_f32 v242, v242, v204
v_mfma_f32_16x16x32_bf16 v[184:187], a[136:139], a[156:159], v[184:187]
v_max_f32 v243, v243, v205
v_max_f32 v244, v244, v206
v_max_f32 v245, v245, v207
v_mfma_f32_16x16x32_bf16 v[188:191], a[140:143], a[156:159], v[188:191]
ds_read_b128 v[192:195], v240 offset:0
ds_read_b128 v[196:199], v240 offset:256
ds_read_b128 v[200:203], v240 offset:512
ds_read_b128 v[204:207], v240 offset:768
v_fma_f32 v250, v242, s63, -v250
v_mfma_f32_16x16x32_bf16 v[180:183], a[140:143], a[152:155], v[180:183]
v_fma_f32 v251, v243, s63, -v251
v_fma_f32 v252, v244, s63, -v252
v_fma_f32 v253, v245, s63, -v253
v_mfma_f32_16x16x32_bf16 v[172:175], a[140:143], a[148:151], v[172:175]
v_max3_f32 v250, v250, v251, v252
v_max_f32 v250, v250, v253
v_cmp_lt_f32 vcc, 0x41400000, v250
v_mfma_f32_16x16x32_bf16 v[164:167], a[140:143], a[144:147], v[164:167]
s_waitcnt lgkmcnt(4)
v_mfma_f32_16x16x32_bf16 v[128:131], a[96:99], a[112:115], v[128:131]
s_waitcnt vmcnt(8)
ds_read_b64_tr_b16 a[128:129], v230 offset:12288
s_cbranch_vccnz L_fb2
v_mfma_f32_16x16x32_bf16 v[136:139], a[96:99], a[116:119], v[136:139]
ds_read_b64_tr_b16 a[130:131], v230 offset:14336
ds_read_b128 a[144:147], v234 offset:28672
v_mfma_f32_16x16x32_bf16 v[144:147], a[96:99], a[120:123], v[144:147]
ds_read_b128 a[148:151], v234 offset:29696
ds_read_b128 a[152:155], v234 offset:30720
v_mfma_f32_16x16x32_bf16 v[152:155], a[96:99], a[124:127], v[152:155]
s_add_u32 m0, s53, 8192
s_add_u32 s58, s5, 0
buffer_load_dwordx4 v220, s[36:39], s58 offen lds
s_waitcnt lgkmcnt(5)
v_mfma_f32_16x16x32_bf16 v[156:159], a[100:103], a[124:127], v[156:159]
ds_read_b128 a[156:159], v234 offset:31744
ds_read_b64_tr_b16 a[132:133], v231 offset:12288
v_add_f32 v192, v192, v196
v_mfma_f32_16x16x32_bf16 v[148:151], a[100:103], a[120:123], v[148:151]
ds_read_b64_tr_b16 a[134:135], v231 offset:14336
ds_read_b64_tr_b16 a[136:137], v232 offset:12288
v_add_f32 v193, v193, v197
v_mfma_f32_16x16x32_bf16 v[140:143], a[100:103], a[116:119], v[140:143]
ds_read_b64_tr_b16 a[138:139], v232 offset:14336
v_add_f32 v194, v194, v198
v_add_f32 v195, v195, v199
v_mfma_f32_16x16x32_bf16 v[132:135], a[100:103], a[112:115], v[132:135]
buffer_load_dwordx4 v221, s[36:39], s58 offen offset:1024 lds
v_add_f32 v200, v200, v204
v_mfma_f32_16x16x32_bf16 v[160:163], a[104:107], a[112:115], v[160:163]
ds_read_b64_tr_b16 a[140:141], v233 offset:12288
ds_read_b64_tr_b16 a[142:143], v233 offset:14336
v_add_f32 v201, v201, v205
v_mfma_f32_16x16x32_bf16 v[168:171], a[104:107], a[116:119], v[168:171]
buffer_load_dwordx4 v222, s[36:39], s58 offen offset:2048 lds
v_add_f32 v202, v202, v206
v_add_f32 v203, v203, v207
v_mfma_f32_16x16x32_bf16 v[176:179], a[104:107], a[120:123], v[176:179]
buffer_load_dwordx4 v223, s[36:39], s58 offen offset:3072 lds
v_add_f32 v192, v192, v200
v_mfma_f32_16x16x32_bf16 v[184:187], a[104:107], a[124:127], v[184:187]
v_add_f32 v193, v193, v201
v_add_f32 v194, v194, v202
v_add_f32 v195, v195, v203
v_mfma_f32_16x16x32_bf16 v[188:191], a[108:111], a[124:127], v[188:191]
v_rcp_f32 v246, v192
v_mfma_f32_16x16x32_bf16 v[180:183], a[108:111], a[120:123], v[180:183]
v_rcp_f32 v247, v193
v_rcp_f32 v248, v194
v_mfma_f32_16x16x32_bf16 v[172:175], a[108:111], a[116:119], v[172:175]
v_rcp_f32 v249, v195
v_mfma_f32_16x16x32_bf16 v[164:167], a[108:111], a[112:115], v[164:167]
s_waitcnt lgkmcnt(0)
v_mfma_f32_16x16x32_bf16 v[128:131], a[128:131], a[144:147], v[128:131]
ds_read_b64_tr_b16 a[96:97], v230 offset:16384
ds_read_b64_tr_b16 a[98:99], v230 offset:18432
v_mfma_f32_16x16x32_bf16 v[136:139], a[128:131], a[148:151], v[136:139]
ds_read_b128 a[160:163], v234 offset:45056
ds_read_b128 a[164:167], v234 offset:46080
v_mfma_f32_16x16x32_bf16 v[144:147], a[128:131], a[152:155], v[144:147]
ds_read_b128 a[168:171], v234 offset:47104
ds_read_b128 a[172:175], v234 offset:48128
v_mfma_f32_16x16x32_bf16 v[152:155], a[128:131], a[156:159], v[152:155]
s_add_u32 m0, s53, 12288
s_add_u32 s58, s5, 28672
buffer_load_dwordx4 v220, s[36:39], s58 offen lds
v_mfma_f32_16x16x32_bf16 v[156:159], a[132:135], a[156:159], v[156:159]
ds_read_b64_tr_b16 a[100:101], v231 offset:16384
ds_read_b64_tr_b16 a[102:103], v231 offset:18432
v_mfma_f32_16x16x32_bf16 v[148:151], a[132:135], a[152:155], v[148:151]
ds_read_b64_tr_b16 a[104:105], v230 offset:20480
ds_read_b64_tr_b16 a[106:107], v230 offset:22528
v_mfma_f32_16x16x32_bf16 v[140:143], a[132:135], a[148:151], v[140:143]
ds_read_b128 a[176:179], v234 offset:61440
ds_read_b128 a[180:183], v234 offset:62464
v_mfma_f32_16x16x32_bf16 v[132:135], a[132:135], a[144:147], v[132:135]
buffer_load_dwordx4 v221, s[36:39], s58 offen offset:1024 lds
v_mfma_f32_16x16x32_bf16 v[160:163], a[136:139], a[144:147], v[160:163]
ds_read_b128 a[184:187], v234 offset:63488
ds_read_b128 a[188:191], v234 offset:64512
v_mfma_f32_16x16x32_bf16 v[168:171], a[136:139], a[148:151], v[168:171]
ds_read_b64_tr_b16 a[108:109], v231 offset:20480
ds_read_b64_tr_b16 a[110:111], v231 offset:22528
v_mfma_f32_16x16x32_bf16 v[176:179], a[136:139], a[152:155], v[176:179]
buffer_load_dwordx4 v222, s[36:39], s58 offen offset:2048 lds
v_mfma_f32_16x16x32_bf16 v[184:187], a[136:139], a[156:159], v[184:187]
v_mfma_f32_16x16x32_bf16 v[188:191], a[140:143], a[156:159], v[188:191]
buffer_load_dwordx4 v223, s[36:39], s58 offen offset:3072 lds
v_mfma_f32_16x16x32_bf16 v[180:183], a[140:143], a[152:155], v[180:183]
v_mfma_f32_16x16x32_bf16 v[172:175], a[140:143], a[148:151], v[172:175]
v_mfma_f32_16x16x32_bf16 v[164:167], a[140:143], a[144:147], v[164:167]
s_waitcnt lgkmcnt(0)
v_mfma_f32_16x16x32_bf16 v[128:131], a[96:99], a[160:163], v[128:131]
ds_read_b64_tr_b16 a[128:129], v232 offset:16384
ds_read_b64_tr_b16 a[130:131], v232 offset:18432
v_mfma_f32_16x16x32_bf16 v[136:139], a[96:99], a[164:167], v[136:139]
ds_read_b64_tr_b16 a[132:133], v233 offset:16384
ds_read_b64_tr_b16 a[134:135], v233 offset:18432
v_mfma_f32_16x16x32_bf16 v[144:147], a[96:99], a[168:171], v[144:147]
ds_read_b64_tr_b16 a[136:137], v232 offset:20480
v_mfma_f32_16x16x32_bf16 v[152:155], a[96:99], a[172:175], v[152:155]
v_mfma_f32_16x16x32_bf16 v[156:159], a[100:103], a[172:175], v[156:159]
ds_read_b64_tr_b16 a[138:139], v232 offset:22528
v_mfma_f32_16x16x32_bf16 v[148:151], a[100:103], a[168:171], v[148:151]
ds_read_b64_tr_b16 a[140:141], v233 offset:20480
v_mfma_f32_16x16x32_bf16 v[140:143], a[100:103], a[164:167], v[140:143]
v_mfma_f32_16x16x32_bf16 v[132:135], a[100:103], a[160:163], v[132:135]
ds_read_b64_tr_b16 a[142:143], v233 offset:22528
v_mfma_f32_16x16x32_bf16 v[128:131], a[104:107], a[176:179], v[128:131]
v_mfma_f32_16x16x32_bf16 v[136:139], a[104:107], a[180:183], v[136:139]
v_mfma_f32_16x16x32_bf16 v[144:147], a[104:107], a[184:187], v[144:147]
v_mfma_f32_16x16x32_bf16 v[152:155], a[104:107], a[188:191], v[152:155]
v_mfma_f32_16x16x32_bf16 v[156:159], a[108:111], a[188:191], v[156:159]
v_mfma_f32_16x16x32_bf16 v[148:151], a[108:111], a[184:187], v[148:151]
v_mfma_f32_16x16x32_bf16 v[140:143], a[108:111], a[180:183], v[140:143]
v_mfma_f32_16x16x32_bf16 v[132:135], a[108:111], a[176:179], v[132:135]
s_waitcnt lgkmcnt(0)
v_mfma_f32_16x16x32_bf16 v[160:163], a[128:131], a[160:163], v[160:163]
s_waitcnt vmcnt(12)
ds_read_b64_tr_b16 a[96:97], v230 offset:0
v_mfma_f32_16x16x32_bf16 v[168:171], a[128:131], a[164:167], v[168:171]
ds_read_b64_tr_b16 a[98:99], v230 offset:2048
ds_read_b64_tr_b16 a[100:101], v231 offset:0
v_mfma_f32_16x16x32_bf16 v[176:179], a[128:131], a[168:171], v[176:179]
ds_read_b64_tr_b16 a[102:103], v231 offset:2048
ds_read_b64_tr_b16 a[104:105], v232 offset:0
v_mul_f32 v128, v128, v246
v_mul_f32 v129, v129, v246
v_mul_f32 v130, v130, v246
v_mfma_f32_16x16x32_bf16 v[184:187], a[128:131], a[172:175], v[184:187]
s_add_u32 m0, s53, 16384
s_add_u32 s58, s6, 0
buffer_load_dwordx4 v220, s[36:39], s58 offen lds
v_mul_f32 v131, v131, v246
v_mul_f32 v132, v132, v246
v_mul_f32 v133, v133, v246
v_mul_f32 v134, v134, v246
v_mfma_f32_16x16x32_bf16 v[188:191], a[132:135], a[172:175], v[188:191]
ds_read_b64_tr_b16 a[106:107], v232 offset:2048
v_mul_f32 v135, v135, v246
v_cvt_pk_bf16_f32 v128, v128, v129
v_cvt_pk_bf16_f32 v129, v130, v131
v_cvt_pk_bf16_f32 v130, v132, v133
v_cvt_pk_bf16_f32 v131, v134, v135
v_mfma_f32_16x16x32_bf16 v[180:183], a[132:135], a[168:171], v[180:183]
ds_read_b64_tr_b16 a[108:109], v233 offset:0
ds_write_b128 v235, v[128:131] offset:0
v_mul_f32 v136, v136, v247
v_mul_f32 v137, v137, v247
v_mul_f32 v138, v138, v247
v_mfma_f32_16x16x32_bf16 v[172:175], a[132:135], a[164:167], v[172:175]
buffer_load_dwordx4 v221, s[36:39], s58 offen offset:1024 lds
v_mul_f32 v139, v139, v247
v_mul_f32 v140, v140, v247
v_mul_f32 v141, v141, v247
v_mul_f32 v142, v142, v247
v_mfma_f32_16x16x32_bf16 v[164:167], a[132:135], a[160:163], v[164:167]
buffer_load_dwordx4 v222, s[36:39], s58 offen offset:2048 lds
v_mul_f32 v143, v143, v247
v_cvt_pk_bf16_f32 v136, v136, v137
v_cvt_pk_bf16_f32 v137, v138, v139
v_cvt_pk_bf16_f32 v138, v140, v141
v_mfma_f32_16x16x32_bf16 v[160:163], a[136:139], a[176:179], v[160:163]
ds_read_b64_tr_b16 a[110:111], v233 offset:2048
v_cvt_pk_bf16_f32 v139, v142, v143
ds_write_b128 v235, v[136:139] offset:1024
v_mul_f32 v144, v144, v248
v_mul_f32 v145, v145, v248
v_mul_f32 v146, v146, v248
v_mfma_f32_16x16x32_bf16 v[168:171], a[136:139], a[180:183], v[168:171]
buffer_load_dwordx4 v223, s[36:39], s58 offen offset:3072 lds
v_mul_f32 v147, v147, v248
v_mul_f32 v148, v148, v248
v_mul_f32 v149, v149, v248
v_mul_f32 v150, v150, v248
v_mfma_f32_16x16x32_bf16 v[176:179], a[136:139], a[184:187], v[176:179]
s_add_u32 m0, s53, 20480
s_add_u32 s58, s6, 28672
v_mul_f32 v151, v151, v248
v_cvt_pk_bf16_f32 v144, v144, v145
v_cvt_pk_bf16_f32 v145, v146, v147
v_cvt_pk_bf16_f32 v146, v148, v149
v_mfma_f32_16x16x32_bf16 v[184:187], a[136:139], a[188:191], v[184:187]
buffer_load_dwordx4 v220, s[36:39], s58 offen lds
v_cvt_pk_bf16_f32 v147, v150, v151
ds_write_b128 v235, v[144:147] offset:2048
v_mul_f32 v152, v152, v249
v_mfma_f32_16x16x32_bf16 v[188:191], a[140:143], a[188:191], v[188:191]
buffer_load_dwordx4 v221, s[36:39], s58 offen offset:1024 lds
v_mul_f32 v153, v153, v249
v_mul_f32 v154, v154, v249
v_mul_f32 v155, v155, v249
v_mul_f32 v156, v156, v249
v_mul_f32 v157, v157, v249
v_mfma_f32_16x16x32_bf16 v[180:183], a[140:143], a[184:187], v[180:183]
buffer_load_dwordx4 v222, s[36:39], s58 offen offset:2048 lds
v_mul_f32 v158, v158, v249
v_mul_f32 v159, v159, v249
v_cvt_pk_bf16_f32 v152, v152, v153
v_cvt_pk_bf16_f32 v153, v154, v155
v_cvt_pk_bf16_f32 v154, v156, v157
v_mfma_f32_16x16x32_bf16 v[172:175], a[140:143], a[180:183], v[172:175]
buffer_load_dwordx4 v223, s[36:39], s58 offen offset:3072 lds
v_cvt_pk_bf16_f32 v155, v158, v159
ds_write_b128 v235, v[152:155] offset:3072
v_mfma_f32_16x16x32_bf16 v[164:167], a[140:143], a[176:179], v[164:167]
s_waitcnt lgkmcnt(3)
v_mfma_f32_16x16x32_bf16 v[0:3], a[96:99], v[128:131], 0
s_waitcnt vmcnt(16)
ds_read_b64_tr_b16 a[128:129], v230 offset:4096
v_mfma_f32_16x16x32_bf16 v[8:11], a[96:99], v[136:139], 0
ds_read_b64_tr_b16 a[130:131], v230 offset:6144
ds_read_b64_tr_b16 a[132:133], v231 offset:4096
v_mfma_f32_16x16x32_bf16 v[16:19], a[96:99], v[144:147], 0
ds_read_b64_tr_b16 a[134:135], v231 offset:6144
ds_read_b64_tr_b16 a[136:137], v232 offset:4096
v_mul_f32 v160, v160, v246
v_mul_f32 v161, v161, v246
v_mul_f32 v162, v162, v246
v_mfma_f32_16x16x32_bf16 v[24:27], a[96:99], v[152:155], 0
s_add_u32 m0, s53, 0
s_add_u32 s58, s7, 0
buffer_load_dwordx4 v220, s[36:39], s58 offen lds
v_mul_f32 v163, v163, v246
v_mul_f32 v164, v164, v246
v_mul_f32 v165, v165, v246
v_mul_f32 v166, v166, v246
v_mfma_f32_16x16x32_bf16 v[28:31], a[100:103], v[152:155], 0
ds_read_b64_tr_b16 a[138:139], v232 offset:6144
v_mul_f32 v167, v167, v246
v_cvt_pk_bf16_f32 v160, v160, v161
v_cvt_pk_bf16_f32 v161, v162, v163
v_cvt_pk_bf16_f32 v162, v164, v165
v_cvt_pk_bf16_f32 v163, v166, v167
v_mfma_f32_16x16x32_bf16 v[20:23], a[100:103], v[144:147], 0
ds_read_b64_tr_b16 a[140:141], v233 offset:4096
ds_write_b128 v235, v[160:163] offset:4096
v_mul_f32 v168, v168, v247
v_mul_f32 v169, v169, v247
v_mul_f32 v170, v170, v247
v_mfma_f32_16x16x32_bf16 v[12:15], a[100:103], v[136:139], 0
buffer_load_dwordx4 v221, s[36:39], s58 offen offset:1024 lds
v_mul_f32 v171, v171, v247
v_mul_f32 v172, v172, v247
v_mul_f32 v173, v173, v247
v_mul_f32 v174, v174, v247
v_mfma_f32_16x16x32_bf16 v[4:7], a[100:103], v[128:131], 0
buffer_load_dwordx4 v222, s[36:39], s58 offen offset:2048 lds
v_mul_f32 v175, v175, v247
v_cvt_pk_bf16_f32 v168, v168, v169
v_cvt_pk_bf16_f32 v169, v170, v171
v_cvt_pk_bf16_f32 v170, v172, v173
v_mfma_f32_16x16x32_bf16 v[32:35], a[104:107], v[128:131], 0
ds_read_b64_tr_b16 a[142:143], v233 offset:6144
v_cvt_pk_bf16_f32 v171, v174, v175
ds_write_b128 v235, v[168:171] offset:5120
v_mul_f32 v176, v176, v248
v_mul_f32 v177, v177, v248
v_mul_f32 v178, v178, v248
v_mfma_f32_16x16x32_bf16 v[40:43], a[104:107], v[136:139], 0
buffer_load_dwordx4 v223, s[36:39], s58 offen offset:3072 lds
v_mul_f32 v179, v179, v248
v_mul_f32 v180, v180, v248
v_mul_f32 v181, v181, v248
v_mul_f32 v182, v182, v248
v_mfma_f32_16x16x32_bf16 v[48:51], a[104:107], v[144:147], 0
v_mul_f32 v183, v183, v248
v_cvt_pk_bf16_f32 v176, v176, v177
v_cvt_pk_bf16_f32 v177, v178, v179
v_cvt_pk_bf16_f32 v178, v180, v181
v_cvt_pk_bf16_f32 v179, v182, v183
v_mfma_f32_16x16x32_bf16 v[56:59], a[104:107], v[152:155], 0
ds_write_b128 v235, v[176:179] offset:6144
v_mul_f32 v184, v184, v249
v_mul_f32 v185, v185, v249
v_mul_f32 v186, v186, v249
v_mul_f32 v187, v187, v249
v_mfma_f32_16x16x32_bf16 v[60:63], a[108:111], v[152:155], 0
v_mul_f32 v188, v188, v249
v_mul_f32 v189, v189, v249
v_mul_f32 v190, v190, v249
v_mul_f32 v191, v191, v249
v_mfma_f32_16x16x32_bf16 v[52:55], a[108:111], v[144:147], 0
v_cvt_pk_bf16_f32 v184, v184, v185
v_cvt_pk_bf16_f32 v185, v186, v187
v_cvt_pk_bf16_f32 v186, v188, v189
v_mfma_f32_16x16x32_bf16 v[44:47], a[108:111], v[136:139], 0
v_cvt_pk_bf16_f32 v187, v190, v191
ds_write_b128 v235, v[184:187] offset:7168
v_mfma_f32_16x16x32_bf16 v[36:39], a[108:111], v[128:131], 0
s_waitcnt lgkmcnt(3)
v_mfma_f32_16x16x32_bf16 v[0:3], a[128:131], v[160:163], v[0:3]
s_waitcnt vmcnt(16)
ds_read_b64_tr_b16 a[96:97], v230 offset:8192
v_mfma_f32_16x16x32_bf16 v[8:11], a[128:131], v[168:171], v[8:11]
ds_read_b64_tr_b16 a[98:99], v230 offset:10240
s_add_u32 m0, s53, 4096
v_mfma_f32_16x16x32_bf16 v[16:19], a[128:131], v[176:179], v[16:19]
s_add_u32 s58, s7, 28672
buffer_load_dwordx4 v220, s[36:39], s58 offen lds
v_mfma_f32_16x16x32_bf16 v[24:27], a[128:131], v[184:187], v[24:27]
ds_read_b64_tr_b16 a[100:101], v231 offset:8192
s_waitcnt lgkmcnt(3)
s_barrier
ds_read_b128 a[0:3], v236 offset:0
ds_read_b128 a[4:7], v236 offset:1024
ds_read_b128 a[8:11], v236 offset:2048
ds_read_b128 a[12:15], v236 offset:3072
v_mfma_f32_16x16x32_bf16 v[28:31], a[132:135], v[184:187], v[28:31]
ds_read_b64_tr_b16 a[102:103], v231 offset:10240
buffer_load_dwordx4 v221, s[36:39], s58 offen offset:1024 lds
v_mfma_f32_16x16x32_bf16 v[20:23], a[132:135], v[176:179], v[20:23]
ds_read_b64_tr_b16 a[104:105], v232 offset:8192
v_lshrrev_b32 v219, 4, v234
v_mfma_f32_16x16x32_bf16 v[12:15], a[132:135], v[168:171], v[12:15]
ds_read_b64_tr_b16 a[106:107], v232 offset:10240
v_lshlrev_b32 v208, 8, v219
s_lshl_b32 s59, s52, 10
v_mfma_f32_16x16x32_bf16 v[4:7], a[132:135], v[160:163], v[4:7]
buffer_load_dwordx4 v222, s[36:39], s58 offen offset:2048 lds
v_mfma_f32_16x16x32_bf16 v[32:35], a[136:139], v[160:163], v[32:35]
ds_read_b64_tr_b16 a[108:109], v233 offset:8192
ds_read_b64_tr_b16 a[110:111], v233 offset:10240
v_mfma_f32_16x16x32_bf16 v[40:43], a[136:139], v[168:171], v[40:43]
buffer_load_dwordx4 v223, s[36:39], s58 offen offset:3072 lds
v_mfma_f32_16x16x32_bf16 v[48:51], a[136:139], v[176:179], v[48:51]
s_lshl_b32 s60, s67, 2
s_add_u32 s59, s59, s60
v_add_u32 v208, s59, v208
v_mfma_f32_16x16x32_bf16 v[56:59], a[136:139], v[184:187], v[56:59]
v_cmp_gt_u32 vcc, 4, v219
v_mov_b32 v224, 0x40000000
v_mfma_f32_16x16x32_bf16 v[60:63], a[140:143], v[184:187], v[60:63]
v_mov_b32 v209, 1
v_cndmask_b32 v208, v224, v208, vcc
v_mfma_f32_16x16x32_bf16 v[52:55], a[140:143], v[176:179], v[52:55]
v_and_b32 v219, 15, v219
s_max_u32 s59, s52, 1
s_sub_u32 s59, s59, 1
v_mfma_f32_16x16x32_bf16 v[44:47], a[140:143], v[168:171], v[44:47]
s_lshl_b32 s59, s59, 6
s_lshl_b32 s60, s67, 8
v_mfma_f32_16x16x32_bf16 v[36:39], a[140:143], v[160:163], v[36:39]
s_add_u32 s59, s59, s60
s_waitcnt lgkmcnt(8)
v_mfma_f32_16x16x32_bf16 v[0:3], a[96:99], a[0:3], v[0:3]
s_waitcnt vmcnt(16)
ds_read_b64_tr_b16 a[128:129], v230 offset:12288
s_waitcnt lgkmcnt(8)
v_mfma_f32_16x16x32_bf16 v[8:11], a[96:99], a[4:7], v[8:11]
ds_read_b64_tr_b16 a[130:131], v230 offset:14336
ds_read_b128 a[16:19], v236 offset:4096
v_lshl_add_u32 v210, v219, 2, s59
s_waitcnt lgkmcnt(9)
v_mfma_f32_16x16x32_bf16 v[16:19], a[96:99], a[8:11], v[16:19]
ds_read_b128 a[20:23], v236 offset:5120
ds_read_b128 a[24:27], v236 offset:6144
s_waitcnt lgkmcnt(10)
v_mfma_f32_16x16x32_bf16 v[24:27], a[96:99], a[12:15], v[24:27]
ds_read_b128 a[28:31], v236 offset:7168
s_waitcnt lgkmcnt(10)
v_mfma_f32_16x16x32_bf16 v[28:31], a[100:103], a[12:15], v[28:31]
ds_read_b64_tr_b16 a[132:133], v231 offset:12288
ds_read_b64_tr_b16 a[134:135], v231 offset:14336
v_mfma_f32_16x16x32_bf16 v[20:23], a[100:103], a[8:11], v[20:23]
ds_read_b64_tr_b16 a[136:137], v232 offset:12288
v_mul_u32_u24 v216, 896, v219
v_lshrrev_b32 v224, 8, v234
v_mfma_f32_16x16x32_bf16 v[12:15], a[100:103], a[4:7], v[12:15]
ds_read_b64_tr_b16 a[138:139], v232 offset:14336
v_lshl_add_u32 v216, v224, 3, v216
v_mfma_f32_16x16x32_bf16 v[4:7], a[100:103], a[0:3], v[4:7]
ds_read_b64_tr_b16 a[140:141], v233 offset:12288
v_mov_b32 v217, 0
s_waitcnt lgkmcnt(13)
v_mfma_f32_16x16x32_bf16 v[32:35], a[104:107], a[0:3], v[32:35]
ds_read_b64_tr_b16 a[142:143], v233 offset:14336
v_mov_b32 v218, 1
v_add_u32 v212, 0, v234
v_mfma_f32_16x16x32_bf16 v[40:43], a[104:107], a[4:7], v[40:43]
v_add_u32 v213, 4096, v234
v_add_u32 v214, 8192, v234
v_mfma_f32_16x16x32_bf16 v[48:51], a[104:107], a[8:11], v[48:51]
v_add_u32 v215, 12288, v234
v_bfe_u32 v219, v234, 6, 2
v_mfma_f32_16x16x32_bf16 v[56:59], a[104:107], a[12:15], v[56:59]
v_cmp_eq_u32 vcc, v219, v224
v_bfe_u32 v219, v234, 4, 1
s_waitcnt lgkmcnt(12)
v_mfma_f32_16x16x32_bf16 v[60:63], a[108:111], a[12:15], v[60:63]
s_add_u32 m0, s53, 8192
s_add_u32 s58, s4, 0
buffer_load_dwordx4 v220, s[40:43], s58 offen lds
v_lshlrev_b32 v219, 4, v219
v_mfma_f32_16x16x32_bf16 v[52:55], a[108:111], a[8:11], v[52:55]
buffer_load_dwordx4 v221, s[40:43], s58 offen offset:1024 lds
v_mfma_f32_16x16x32_bf16 v[44:47], a[108:111], a[4:7], v[44:47]
v_mov_b32 v224, 0x3f80
v_lshlrev_b32 v219, v219, v224
v_mfma_f32_16x16x32_bf16 v[36:39], a[108:111], a[0:3], v[36:39]
v_cndmask_b32 v219, 0, v219, vcc
s_waitcnt lgkmcnt(0)
v_mfma_f32_16x16x32_bf16 v[0:3], a[128:131], a[16:19], v[0:3]
s_waitcnt vmcnt(14)
ds_read_b64_tr_b16 a[96:97], v230 offset:16384
v_mfma_f32_16x16x32_bf16 v[8:11], a[128:131], a[20:23], v[8:11]
ds_read_b64_tr_b16 a[98:99], v230 offset:18432
ds_read_b128 a[32:35], v237 offset:0
v_bfe_u32 v224, v234, 5, 1
v_mfma_f32_16x16x32_bf16 v[16:19], a[128:131], a[24:27], v[16:19]
ds_read_b128 a[36:39], v237 offset:1024
ds_read_b128 a[40:43], v237 offset:2048
v_mfma_f32_16x16x32_bf16 v[24:27], a[128:131], a[28:31], v[24:27]
buffer_load_dwordx4 v222, s[40:43], s58 offen offset:2048 lds
v_mfma_f32_16x16x32_bf16 v[28:31], a[132:135], a[28:31], v[28:31]
ds_read_b128 a[44:47], v237 offset:3072
ds_read_b64_tr_b16 a[100:101], v231 offset:16384
v_mfma_f32_16x16x32_bf16 v[20:23], a[132:135], a[24:27], v[20:23]
ds_read_b64_tr_b16 a[102:103], v231 offset:18432
ds_read_b64_tr_b16 a[104:105], v232 offset:16384
v_cmp_eq_u32 vcc, 0, v224
v_mfma_f32_16x16x32_bf16 v[12:15], a[132:135], a[20:23], v[12:15]
ds_read_b64_tr_b16 a[106:107], v232 offset:18432
v_accvgpr_write_b32 a226, 0
v_mfma_f32_16x16x32_bf16 v[4:7], a[132:135], a[16:19], v[4:7]
buffer_load_dwordx4 v223, s[40:43], s58 offen offset:3072 lds
v_mfma_f32_16x16x32_bf16 v[32:35], a[136:139], a[16:19], v[32:35]
ds_read_b64_tr_b16 a[108:109], v233 offset:16384
ds_read_b64_tr_b16 a[110:111], v233 offset:18432
v_mfma_f32_16x16x32_bf16 v[40:43], a[136:139], a[20:23], v[40:43]
s_add_u32 m0, s53, 12288
s_add_u32 s58, s4, 28672
v_accvgpr_write_b32 a227, 0
v_mfma_f32_16x16x32_bf16 v[48:51], a[136:139], a[24:27], v[48:51]
buffer_load_dwordx4 v220, s[40:43], s58 offen lds
v_mfma_f32_16x16x32_bf16 v[56:59], a[136:139], a[28:31], v[56:59]
v_cndmask_b32 v224, 0, v219, vcc
v_sub_u32 v219, v219, v224
v_mfma_f32_16x16x32_bf16 v[60:63], a[140:143], a[28:31], v[60:63]
buffer_load_dwordx4 v221, s[40:43], s58 offen offset:1024 lds
v_accvgpr_write_b32 a228, 0
v_mfma_f32_16x16x32_bf16 v[52:55], a[140:143], a[24:27], v[52:55]
buffer_load_dwordx4 v222, s[40:43], s58 offen offset:2048 lds
v_mfma_f32_16x16x32_bf16 v[44:47], a[140:143], a[20:23], v[44:47]
v_accvgpr_write_b32 a229, 0
v_accvgpr_write_b32 a224, v224
v_mfma_f32_16x16x32_bf16 v[36:39], a[140:143], a[16:19], v[36:39]
v_accvgpr_write_b32 a225, v219
s_waitcnt lgkmcnt(0)
v_mfma_f32_16x16x32_bf16 v[0:3], a[96:99], a[32:35], v[0:3]
s_waitcnt vmcnt(15)
ds_read_b64_tr_b16 a[128:129], v230 offset:20480
v_accvgpr_write_b32 a230, v224
v_mfma_f32_16x16x32_bf16 v[8:11], a[96:99], a[36:39], v[8:11]
ds_read_b64_tr_b16 a[130:131], v230 offset:22528
ds_read_b128 a[48:51], v237 offset:4096
v_mfma_f32_16x16x32_bf16 v[16:19], a[96:99], a[40:43], v[16:19]
ds_read_b128 a[52:55], v237 offset:5120
ds_read_b128 a[56:59], v237 offset:6144
v_mfma_f32_16x16x32_bf16 v[24:27], a[96:99], a[44:47], v[24:27]
buffer_load_dwordx4 v223, s[40:43], s58 offen offset:3072 lds
v_accvgpr_write_b32 a231, v219
v_mfma_f32_16x16x32_bf16 v[28:31], a[100:103], a[44:47], v[28:31]
ds_read_b128 a[60:63], v237 offset:7168
ds_read_b64_tr_b16 a[132:133], v231 offset:20480
v_mfma_f32_16x16x32_bf16 v[20:23], a[100:103], a[40:43], v[20:23]
ds_read_b64_tr_b16 a[134:135], v231 offset:22528
ds_read_b64_tr_b16 a[136:137], v232 offset:20480
v_mfma_f32_16x16x32_bf16 v[12:15], a[100:103], a[36:39], v[12:15]
ds_read_b64_tr_b16 a[138:139], v232 offset:22528
s_add_u32 m0, s53, 16384
v_mfma_f32_16x16x32_bf16 v[4:7], a[100:103], a[32:35], v[4:7]
s_add_u32 s58, s5, 0
ds_read_b64_tr_b16 a[140:141], v233 offset:20480
s_lshl_b32 s59, s66, 4
v_mfma_f32_16x16x32_bf16 v[32:35], a[104:107], a[32:35], v[32:35]
ds_read_b64_tr_b16 a[142:143], v233 offset:22528
v_mfma_f32_16x16x32_bf16 v[40:43], a[104:107], a[36:39], v[40:43]
buffer_load_dwordx4 v220, s[40:43], s58 offen lds
v_mfma_f32_16x16x32_bf16 v[48:51], a[104:107], a[40:43], v[48:51]
s_add_u32 s20, s16, s59
s_addc_u32 s21, s17, 0
s_mov_b32 s22, 4
v_mfma_f32_16x16x32_bf16 v[56:59], a[104:107], a[44:47], v[56:59]
buffer_load_dwordx4 v221, s[40:43], s58 offen offset:1024 lds
v_mfma_f32_16x16x32_bf16 v[60:63], a[108:111], a[44:47], v[60:63]
s_mov_b32 s23, 0x20000
s_mul_i32 s59, s66, 917504
v_mfma_f32_16x16x32_bf16 v[52:55], a[108:111], a[40:43], v[52:55]
buffer_load_dwordx4 v222, s[40:43], s58 offen offset:2048 lds
v_mfma_f32_16x16x32_bf16 v[44:47], a[108:111], a[36:39], v[44:47]
s_add_u32 s24, s18, s59
s_addc_u32 s25, s19, 0
s_mov_b32 s26, 917504
v_mfma_f32_16x16x32_bf16 v[36:39], a[108:111], a[32:35], v[36:39]
s_mov_b32 s27, 0x20000
s_waitcnt lgkmcnt(0)
v_mfma_f32_16x16x32_bf16 v[0:3], a[128:131], a[48:51], v[0:3]
s_waitcnt vmcnt(15)
ds_read_b64_tr_b16 a[96:97], v230 offset:0
s_mov_b32 s59, 0
v_mfma_f32_16x16x32_bf16 v[8:11], a[128:131], a[52:55], v[8:11]
ds_read_b64_tr_b16 a[98:99], v230 offset:2048
ds_read_b128 a[64:67], v238 offset:0
v_mfma_f32_16x16x32_bf16 v[16:19], a[128:131], a[56:59], v[16:19]
ds_read_b128 a[68:71], v238 offset:1024
ds_read_b128 a[72:75], v238 offset:2048
v_mfma_f32_16x16x32_bf16 v[24:27], a[128:131], a[60:63], v[24:27]
buffer_load_dwordx4 v223, s[40:43], s58 offen offset:3072 lds
v_mfma_f32_16x16x32_bf16 v[28:31], a[132:135], a[60:63], v[28:31]
ds_read_b128 a[76:79], v238 offset:3072
ds_read_b64_tr_b16 a[100:101], v231 offset:0
v_mfma_f32_16x16x32_bf16 v[20:23], a[132:135], a[56:59], v[20:23]
ds_read_b64_tr_b16 a[102:103], v231 offset:2048
ds_read_b64_tr_b16 a[104:105], v232 offset:0
v_mfma_f32_16x16x32_bf16 v[12:15], a[132:135], a[52:55], v[12:15]
ds_read_b64_tr_b16 a[106:107], v232 offset:2048
s_add_u32 m0, s53, 20480
s_add_u32 s28, s14, s59
s_addc_u32 s29, s15, 0
v_mfma_f32_16x16x32_bf16 v[4:7], a[132:135], a[48:51], v[4:7]
s_add_u32 s58, s5, 28672
ds_read_b64_tr_b16 a[108:109], v233 offset:0
v_mfma_f32_16x16x32_bf16 v[32:35], a[136:139], a[48:51], v[32:35]
ds_read_b64_tr_b16 a[110:111], v233 offset:2048
s_mov_b32 s30, 57344
v_mfma_f32_16x16x32_bf16 v[40:43], a[136:139], a[52:55], v[40:43]
buffer_load_dwordx4 v220, s[40:43], s58 offen lds
s_mov_b32 s31, 0x20000
v_mfma_f32_16x16x32_bf16 v[48:51], a[136:139], a[56:59], v[48:51]
buffer_load_dwordx4 v221, s[40:43], s58 offen offset:1024 lds
v_mfma_f32_16x16x32_bf16 v[56:59], a[136:139], a[60:63], v[56:59]
s_mov_b32 s63, 0xffff0000
s_lshl_b32 s55, s67, 2
v_mfma_f32_16x16x32_bf16 v[60:63], a[140:143], a[60:63], v[60:63]
buffer_load_dwordx4 v222, s[40:43], s58 offen offset:2048 lds
s_add_u32 s55, s55, s52
v_mfma_f32_16x16x32_bf16 v[52:55], a[140:143], a[56:59], v[52:55]
buffer_load_dwordx4 v223, s[40:43], s58 offen offset:3072 lds
v_mfma_f32_16x16x32_bf16 v[44:47], a[140:143], a[52:55], v[44:47]
s_lshr_b32 s56, s55, 4
s_and_b32 s59, s55, 2
v_mfma_f32_16x16x32_bf16 v[36:39], a[140:143], a[48:51], v[36:39]
s_lshl_b32 s59, s59, 1
s_add_u32 s56, s56, s59
s_waitcnt lgkmcnt(0)
v_mfma_f32_16x16x32_bf16 v[0:3], a[96:99], a[64:67], v[0:3]
s_waitcnt vmcnt(16)
ds_read_b64_tr_b16 a[128:129], v230 offset:4096
v_mfma_f32_16x16x32_bf16 v[8:11], a[96:99], a[68:71], v[8:11]
ds_read_b64_tr_b16 a[130:131], v230 offset:6144
ds_read_b128 a[80:83], v238 offset:4096
v_mfma_f32_16x16x32_bf16 v[16:19], a[96:99], a[72:75], v[16:19]
ds_read_b128 a[84:87], v238 offset:5120
ds_read_b128 a[88:91], v238 offset:6144
s_add_u32 s56, s56, s64
v_mfma_f32_16x16x32_bf16 v[24:27], a[96:99], a[76:79], v[24:27]
s_add_u32 m0, s53, 0
s_add_u32 s58, s6, 0
buffer_load_dwordx4 v220, s[40:43], s58 offen lds
v_mfma_f32_16x16x32_bf16 v[28:31], a[100:103], a[76:79], v[28:31]
ds_read_b128 a[92:95], v238 offset:7168
ds_read_b64_tr_b16 a[132:133], v231 offset:4096
s_and_b32 s56, s56, 7
v_mfma_f32_16x16x32_bf16 v[20:23], a[100:103], a[72:75], v[20:23]
ds_read_b64_tr_b16 a[134:135], v231 offset:6144
ds_read_b64_tr_b16 a[136:137], v232 offset:4096
v_mfma_f32_16x16x32_bf16 v[12:15], a[100:103], a[68:71], v[12:15]
ds_read_b64_tr_b16 a[138:139], v232 offset:6144
s_bfe_u32 s59, s55, 0x20002
v_mfma_f32_16x16x32_bf16 v[4:7], a[100:103], a[64:67], v[4:7]
buffer_load_dwordx4 v221, s[40:43], s58 offen offset:1024 lds
s_and_b32 s60, s55, 1
v_mfma_f32_16x16x32_bf16 v[32:35], a[104:107], a[64:67], v[32:35]
ds_read_b64_tr_b16 a[140:141], v233 offset:4096
ds_read_b64_tr_b16 a[142:143], v233 offset:6144
v_mfma_f32_16x16x32_bf16 v[40:43], a[104:107], a[68:71], v[40:43]
buffer_load_dwordx4 v222, s[40:43], s58 offen offset:2048 lds
s_lshl_b32 s57, s56, 1
v_mfma_f32_16x16x32_bf16 v[48:51], a[104:107], a[72:75], v[48:51]
buffer_load_dwordx4 v223, s[40:43], s58 offen offset:3072 lds
v_mfma_f32_16x16x32_bf16 v[56:59], a[104:107], a[76:79], v[56:59]
s_add_u32 s57, s57, s60
s_lshl_b32 s9, s57, 6
v_mfma_f32_16x16x32_bf16 v[60:63], a[108:111], a[76:79], v[60:63]
s_lshl_b32 s57, s57, 2
s_add_u32 s57, s57, s59
s_lshl_b32 s57, s57, 14
v_mfma_f32_16x16x32_bf16 v[52:55], a[108:111], a[72:75], v[52:55]
s_mul_i32 s60, s59, 14336
s_add_u32 s9, s9, s60
v_mfma_f32_16x16x32_bf16 v[44:47], a[108:111], a[68:71], v[44:47]
s_cmp_eq_u32 s56, 7
s_cselect_b32 s56, 1, 0
v_mfma_f32_16x16x32_bf16 v[36:39], a[108:111], a[64:67], v[36:39]
s_cmp_ge_u32 s59, 4
s_cselect_b32 s56, 1, s56
s_waitcnt lgkmcnt(0)
v_mfma_f32_16x16x32_bf16 v[0:3], a[128:131], a[80:83], v[0:3]
s_waitcnt vmcnt(16)
ds_read_b64_tr_b16 a[96:97], v230 offset:8192
v_mfma_f32_16x16x32_bf16 v[8:11], a[128:131], a[84:87], v[8:11]
ds_read_b64_tr_b16 a[98:99], v230 offset:10240
ds_read_b64_tr_b16 a[100:101], v231 offset:8192
v_mfma_f32_16x16x32_bf16 v[16:19], a[128:131], a[88:91], v[16:19]
ds_read_b64_tr_b16 a[102:103], v231 offset:10240
ds_read_b64_tr_b16 a[104:105], v232 offset:8192
v_mfma_f32_16x16x32_bf16 v[24:27], a[128:131], a[92:95], v[24:27]
s_add_u32 m0, s53, 4096
s_add_u32 s58, s6, 28672
buffer_load_dwordx4 v220, s[40:43], s58 offen lds
v_mfma_f32_16x16x32_bf16 v[28:31], a[132:135], a[92:95], v[28:31]
ds_read_b64_tr_b16 a[106:107], v232 offset:10240
v_mfma_f32_16x16x32_bf16 v[20:23], a[132:135], a[88:91], v[20:23]
ds_read_b64_tr_b16 a[108:109], v233 offset:8192
v_mfma_f32_16x16x32_bf16 v[12:15], a[132:135], a[84:87], v[12:15]
buffer_load_dwordx4 v221, s[40:43], s58 offen offset:1024 lds
v_mfma_f32_16x16x32_bf16 v[4:7], a[132:135], a[80:83], v[4:7]
ds_read_b64_tr_b16 a[110:111], v233 offset:10240
v_mfma_f32_16x16x32_bf16 v[32:35], a[136:139], a[80:83], v[32:35]
buffer_load_dwordx4 v222, s[40:43], s58 offen offset:2048 lds
v_mfma_f32_16x16x32_bf16 v[40:43], a[136:139], a[84:87], v[40:43]
v_mfma_f32_16x16x32_bf16 v[48:51], a[136:139], a[88:91], v[48:51]
buffer_load_dwordx4 v223, s[40:43], s58 offen offset:3072 lds
v_mfma_f32_16x16x32_bf16 v[56:59], a[136:139], a[92:95], v[56:59]
v_mfma_f32_16x16x32_bf16 v[60:63], a[140:143], a[92:95], v[60:63]
v_mfma_f32_16x16x32_bf16 v[52:55], a[140:143], a[88:91], v[52:55]
v_mfma_f32_16x16x32_bf16 v[44:47], a[140:143], a[84:87], v[44:47]
v_mfma_f32_16x16x32_bf16 v[36:39], a[140:143], a[80:83], v[36:39]
s_waitcnt lgkmcnt(0)
v_mfma_f32_16x16x32_bf16 v[64:67], a[96:99], v[128:131], 0
s_waitcnt vmcnt(16)
ds_read_b64_tr_b16 a[128:129], v230 offset:12288
v_mfma_f32_16x16x32_bf16 v[72:75], a[96:99], v[136:139], 0
ds_read_b64_tr_b16 a[130:131], v230 offset:14336
ds_read_b64_tr_b16 a[132:133], v231 offset:12288
v_mfma_f32_16x16x32_bf16 v[80:83], a[96:99], v[144:147], 0
ds_read_b64_tr_b16 a[134:135], v231 offset:14336
ds_read_b64_tr_b16 a[136:137], v232 offset:12288
v_mfma_f32_16x16x32_bf16 v[88:91], a[96:99], v[152:155], 0
s_add_u32 m0, s53, 8192
s_add_u32 s58, s7, 0
buffer_load_dwordx4 v220, s[40:43], s58 offen lds
v_mfma_f32_16x16x32_bf16 v[92:95], a[100:103], v[152:155], 0
ds_read_b64_tr_b16 a[138:139], v232 offset:14336
v_cvt_pk_bf16_f32 v192, v0, v1
v_mfma_f32_16x16x32_bf16 v[84:87], a[100:103], v[144:147], 0
ds_read_b64_tr_b16 a[140:141], v233 offset:12288
v_cvt_pk_bf16_f32 v193, v2, v3
v_cvt_pk_bf16_f32 v194, v4, v5
v_mfma_f32_16x16x32_bf16 v[76:79], a[100:103], v[136:139], 0
buffer_load_dwordx4 v221, s[40:43], s58 offen offset:1024 lds
v_cvt_pk_bf16_f32 v195, v6, v7
v_mfma_f32_16x16x32_bf16 v[68:71], a[100:103], v[128:131], 0
buffer_load_dwordx4 v222, s[40:43], s58 offen offset:2048 lds
v_mfma_f32_16x16x32_bf16 v[96:99], a[104:107], v[128:131], 0
ds_read_b64_tr_b16 a[142:143], v233 offset:14336
s_mov_b32 s69, 0
buffer_store_dwordx4 v[192:195], v234, s[44:47], s69 offen sc1
v_cvt_pk_bf16_f32 v196, v8, v9
v_mfma_f32_16x16x32_bf16 v[104:107], a[104:107], v[136:139], 0
buffer_load_dwordx4 v223, s[40:43], s58 offen offset:3072 lds
v_cvt_pk_bf16_f32 v197, v10, v11
v_mfma_f32_16x16x32_bf16 v[112:115], a[104:107], v[144:147], 0
v_cvt_pk_bf16_f32 v198, v12, v13
v_cvt_pk_bf16_f32 v199, v14, v15
v_mfma_f32_16x16x32_bf16 v[120:123], a[104:107], v[152:155], 0
s_mov_b32 s69, 16384
buffer_store_dwordx4 v[196:199], v234, s[44:47], s69 offen sc1
v_cvt_pk_bf16_f32 v200, v16, v17
v_cvt_pk_bf16_f32 v201, v18, v19
v_mfma_f32_16x16x32_bf16 v[124:127], a[108:111], v[152:155], 0
v_cvt_pk_bf16_f32 v202, v20, v21
v_cvt_pk_bf16_f32 v203, v22, v23
v_mfma_f32_16x16x32_bf16 v[116:119], a[108:111], v[144:147], 0
s_mov_b32 s69, 32768
buffer_store_dwordx4 v[200:203], v234, s[44:47], s69 offen sc1
v_cvt_pk_bf16_f32 v204, v24, v25
v_cvt_pk_bf16_f32 v205, v26, v27
v_mfma_f32_16x16x32_bf16 v[108:111], a[108:111], v[136:139], 0
v_cvt_pk_bf16_f32 v206, v28, v29
v_cvt_pk_bf16_f32 v207, v30, v31
v_mfma_f32_16x16x32_bf16 v[100:103], a[108:111], v[128:131], 0
s_mov_b32 s69, 49152
buffer_store_dwordx4 v[204:207], v234, s[44:47], s69 offen sc1
s_waitcnt lgkmcnt(0)
v_mfma_f32_16x16x32_bf16 v[64:67], a[128:131], v[160:163], v[64:67]
s_waitcnt vmcnt(20)
ds_read_b64_tr_b16 a[96:97], v230 offset:16384
v_cvt_pk_bf16_f32 v192, v32, v33
v_mfma_f32_16x16x32_bf16 v[72:75], a[128:131], v[168:171], v[72:75]
ds_read_b64_tr_b16 a[98:99], v230 offset:18432
ds_read_b64_tr_b16 a[100:101], v231 offset:16384
v_cvt_pk_bf16_f32 v193, v34, v35
v_mfma_f32_16x16x32_bf16 v[80:83], a[128:131], v[176:179], v[80:83]
ds_read_b64_tr_b16 a[102:103], v231 offset:18432
ds_read_b64_tr_b16 a[104:105], v232 offset:16384
v_cvt_pk_bf16_f32 v194, v36, v37
v_mfma_f32_16x16x32_bf16 v[88:91], a[128:131], v[184:187], v[88:91]
s_add_u32 m0, s53, 12288
s_add_u32 s58, s7, 28672
buffer_load_dwordx4 v220, s[40:43], s58 offen lds
v_mfma_f32_16x16x32_bf16 v[92:95], a[132:135], v[184:187], v[92:95]
ds_read_b64_tr_b16 a[106:107], v232 offset:18432
v_cvt_pk_bf16_f32 v195, v38, v39
v_mfma_f32_16x16x32_bf16 v[84:87], a[132:135], v[176:179], v[84:87]
ds_read_b64_tr_b16 a[108:109], v233 offset:16384
s_mov_b32 s69, 65536
buffer_store_dwordx4 v[192:195], v234, s[44:47], s69 offen sc1
v_cvt_pk_bf16_f32 v196, v40, v41
v_mfma_f32_16x16x32_bf16 v[76:79], a[132:135], v[168:171], v[76:79]
buffer_load_dwordx4 v221, s[40:43], s58 offen offset:1024 lds
v_cvt_pk_bf16_f32 v197, v42, v43
v_mfma_f32_16x16x32_bf16 v[68:71], a[132:135], v[160:163], v[68:71]
ds_read_b64_tr_b16 a[110:111], v233 offset:18432
v_cvt_pk_bf16_f32 v198, v44, v45
v_cvt_pk_bf16_f32 v199, v46, v47
v_mfma_f32_16x16x32_bf16 v[96:99], a[136:139], v[160:163], v[96:99]
s_mov_b32 s69, 81920
buffer_store_dwordx4 v[196:199], v234, s[44:47], s69 offen sc1
v_mfma_f32_16x16x32_bf16 v[104:107], a[136:139], v[168:171], v[104:107]
v_cvt_pk_bf16_f32 v200, v48, v49
v_cvt_pk_bf16_f32 v201, v50, v51
v_cvt_pk_bf16_f32 v202, v52, v53
v_mfma_f32_16x16x32_bf16 v[112:115], a[136:139], v[176:179], v[112:115]
v_cvt_pk_bf16_f32 v203, v54, v55
v_mfma_f32_16x16x32_bf16 v[120:123], a[136:139], v[184:187], v[120:123]
s_mov_b32 s69, 98304
buffer_store_dwordx4 v[200:203], v234, s[44:47], s69 offen sc1
v_mfma_f32_16x16x32_bf16 v[124:127], a[140:143], v[184:187], v[124:127]
v_cvt_pk_bf16_f32 v204, v56, v57
v_cvt_pk_bf16_f32 v205, v58, v59
v_mfma_f32_16x16x32_bf16 v[116:119], a[140:143], v[176:179], v[116:119]
v_cvt_pk_bf16_f32 v206, v60, v61
v_cvt_pk_bf16_f32 v207, v62, v63
v_mfma_f32_16x16x32_bf16 v[108:111], a[140:143], v[168:171], v[108:111]
s_mov_b32 s69, 114688
buffer_store_dwordx4 v[204:207], v234, s[44:47], s69 offen sc1
v_mfma_f32_16x16x32_bf16 v[100:103], a[140:143], v[160:163], v[100:103]
s_waitcnt lgkmcnt(0)
v_mfma_f32_16x16x32_bf16 v[64:67], a[96:99], a[0:3], v[64:67]
s_waitcnt vmcnt(22)
ds_read_b64_tr_b16 a[128:129], v230 offset:20480
v_mfma_f32_16x16x32_bf16 v[72:75], a[96:99], a[4:7], v[72:75]
ds_read_b64_tr_b16 a[130:131], v230 offset:22528
ds_read_b64_tr_b16 a[132:133], v231 offset:20480
v_mfma_f32_16x16x32_bf16 v[80:83], a[96:99], a[8:11], v[80:83]
ds_read_b64_tr_b16 a[134:135], v231 offset:22528
ds_read_b64_tr_b16 a[136:137], v232 offset:20480
v_mfma_f32_16x16x32_bf16 v[88:91], a[96:99], a[12:15], v[88:91]
buffer_load_dwordx4 v222, s[40:43], s58 offen offset:2048 lds
v_mfma_f32_16x16x32_bf16 v[92:95], a[100:103], a[12:15], v[92:95]
ds_read_b64_tr_b16 a[138:139], v232 offset:22528
v_mfma_f32_16x16x32_bf16 v[84:87], a[100:103], a[8:11], v[84:87]
ds_read_b64_tr_b16 a[140:141], v233 offset:20480
v_mfma_f32_16x16x32_bf16 v[76:79], a[100:103], a[4:7], v[76:79]
v_mfma_f32_16x16x32_bf16 v[68:71], a[100:103], a[0:3], v[68:71]
buffer_load_dwordx4 v223, s[40:43], s58 offen offset:3072 lds
v_mfma_f32_16x16x32_bf16 v[96:99], a[104:107], a[0:3], v[96:99]
ds_read_b64_tr_b16 a[142:143], v233 offset:22528
v_mfma_f32_16x16x32_bf16 v[104:107], a[104:107], a[4:7], v[104:107]
v_mfma_f32_16x16x32_bf16 v[112:115], a[104:107], a[8:11], v[112:115]
v_mfma_f32_16x16x32_bf16 v[120:123], a[104:107], a[12:15], v[120:123]
v_mfma_f32_16x16x32_bf16 v[124:127], a[108:111], a[12:15], v[124:127]
v_mfma_f32_16x16x32_bf16 v[116:119], a[108:111], a[8:11], v[116:119]
v_mfma_f32_16x16x32_bf16 v[108:111], a[108:111], a[4:7], v[108:111]
v_mfma_f32_16x16x32_bf16 v[100:103], a[108:111], a[0:3], v[100:103]
s_waitcnt lgkmcnt(0)
v_mfma_f32_16x16x32_bf16 v[64:67], a[128:131], a[16:19], v[64:67]
s_waitcnt vmcnt(16)
ds_read_b64_tr_b16 a[96:97], v230 offset:0
v_mfma_f32_16x16x32_bf16 v[72:75], a[128:131], a[20:23], v[72:75]
ds_read_b64_tr_b16 a[98:99], v230 offset:2048
ds_read_b64_tr_b16 a[100:101], v231 offset:0
v_mfma_f32_16x16x32_bf16 v[80:83], a[128:131], a[24:27], v[80:83]
ds_read_b64_tr_b16 a[102:103], v231 offset:2048
ds_read_b64_tr_b16 a[104:105], v230 offset:4096
v_mfma_f32_16x16x32_bf16 v[88:91], a[128:131], a[28:31], v[88:91]
v_mfma_f32_16x16x32_bf16 v[92:95], a[132:135], a[28:31], v[92:95]
ds_read_b64_tr_b16 a[106:107], v230 offset:6144
v_mfma_f32_16x16x32_bf16 v[84:87], a[132:135], a[24:27], v[84:87]
ds_read_b64_tr_b16 a[108:109], v231 offset:4096
v_mfma_f32_16x16x32_bf16 v[76:79], a[132:135], a[20:23], v[76:79]
v_mfma_f32_16x16x32_bf16 v[68:71], a[132:135], a[16:19], v[68:71]
ds_read_b64_tr_b16 a[110:111], v231 offset:6144
v_mfma_f32_16x16x32_bf16 v[96:99], a[136:139], a[16:19], v[96:99]
v_mfma_f32_16x16x32_bf16 v[104:107], a[136:139], a[20:23], v[104:107]
v_mfma_f32_16x16x32_bf16 v[112:115], a[136:139], a[24:27], v[112:115]
v_mfma_f32_16x16x32_bf16 v[120:123], a[136:139], a[28:31], v[120:123]
v_mfma_f32_16x16x32_bf16 v[124:127], a[140:143], a[28:31], v[124:127]
v_mfma_f32_16x16x32_bf16 v[116:119], a[140:143], a[24:27], v[116:119]
v_mfma_f32_16x16x32_bf16 v[108:111], a[140:143], a[20:23], v[108:111]
v_mfma_f32_16x16x32_bf16 v[100:103], a[140:143], a[16:19], v[100:103]
s_waitcnt lgkmcnt(0)
v_mfma_f32_16x16x32_bf16 v[64:67], a[96:99], a[32:35], v[64:67]
s_waitcnt vmcnt(0)
v_mfma_f32_16x16x32_bf16 v[72:75], a[96:99], a[36:39], v[72:75]
ds_read_b64_tr_b16 a[128:129], v230 offset:8192
ds_read_b64_tr_b16 a[130:131], v230 offset:10240
v_mfma_f32_16x16x32_bf16 v[80:83], a[96:99], a[40:43], v[80:83]
ds_read_b64_tr_b16 a[132:133], v231 offset:8192
ds_read_b64_tr_b16 a[134:135], v231 offset:10240
v_mfma_f32_16x16x32_bf16 v[88:91], a[96:99], a[44:47], v[88:91]
ds_read_b64_tr_b16 a[136:137], v230 offset:12288
v_mfma_f32_16x16x32_bf16 v[92:95], a[100:103], a[44:47], v[92:95]
ds_read_b64_tr_b16 a[138:139], v230 offset:14336
v_mfma_f32_16x16x32_bf16 v[84:87], a[100:103], a[40:43], v[84:87]
ds_read_b64_tr_b16 a[140:141], v231 offset:12288
v_mfma_f32_16x16x32_bf16 v[76:79], a[100:103], a[36:39], v[76:79]
v_mfma_f32_16x16x32_bf16 v[68:71], a[100:103], a[32:35], v[68:71]
ds_read_b64_tr_b16 a[142:143], v231 offset:14336
v_mfma_f32_16x16x32_bf16 v[64:67], a[104:107], a[48:51], v[64:67]
v_mfma_f32_16x16x32_bf16 v[72:75], a[104:107], a[52:55], v[72:75]
v_mfma_f32_16x16x32_bf16 v[80:83], a[104:107], a[56:59], v[80:83]
v_mfma_f32_16x16x32_bf16 v[88:91], a[104:107], a[60:63], v[88:91]
v_mfma_f32_16x16x32_bf16 v[92:95], a[108:111], a[60:63], v[92:95]
v_mfma_f32_16x16x32_bf16 v[84:87], a[108:111], a[56:59], v[84:87]
v_mfma_f32_16x16x32_bf16 v[76:79], a[108:111], a[52:55], v[76:79]
v_mfma_f32_16x16x32_bf16 v[68:71], a[108:111], a[48:51], v[68:71]
s_waitcnt lgkmcnt(0)
v_mfma_f32_16x16x32_bf16 v[64:67], a[128:131], a[64:67], v[64:67]
ds_read_b64_tr_b16 a[96:97], v232 offset:0
ds_read_b64_tr_b16 a[98:99], v232 offset:2048
v_mfma_f32_16x16x32_bf16 v[72:75], a[128:131], a[68:71], v[72:75]
ds_read_b64_tr_b16 a[100:101], v233 offset:0
ds_read_b64_tr_b16 a[102:103], v233 offset:2048
v_mfma_f32_16x16x32_bf16 v[80:83], a[128:131], a[72:75], v[80:83]
ds_read_b64_tr_b16 a[104:105], v232 offset:4096
v_mfma_f32_16x16x32_bf16 v[88:91], a[128:131], a[76:79], v[88:91]
v_mfma_f32_16x16x32_bf16 v[92:95], a[132:135], a[76:79], v[92:95]
ds_read_b64_tr_b16 a[106:107], v232 offset:6144
v_mfma_f32_16x16x32_bf16 v[84:87], a[132:135], a[72:75], v[84:87]
ds_read_b64_tr_b16 a[108:109], v233 offset:4096
v_mfma_f32_16x16x32_bf16 v[76:79], a[132:135], a[68:71], v[76:79]
v_mfma_f32_16x16x32_bf16 v[68:71], a[132:135], a[64:67], v[68:71]
ds_read_b64_tr_b16 a[110:111], v233 offset:6144
v_mfma_f32_16x16x32_bf16 v[64:67], a[136:139], a[80:83], v[64:67]
buffer_store_dword v209, v208, s[72:75], 0 offen offset:0 sc1
v_mfma_f32_16x16x32_bf16 v[72:75], a[136:139], a[84:87], v[72:75]
v_mfma_f32_16x16x32_bf16 v[80:83], a[136:139], a[88:91], v[80:83]
v_mfma_f32_16x16x32_bf16 v[88:91], a[136:139], a[92:95], v[88:91]
v_mfma_f32_16x16x32_bf16 v[92:95], a[140:143], a[92:95], v[92:95]
v_mfma_f32_16x16x32_bf16 v[84:87], a[140:143], a[88:91], v[84:87]
v_mfma_f32_16x16x32_bf16 v[76:79], a[140:143], a[84:87], v[76:79]
v_mfma_f32_16x16x32_bf16 v[68:71], a[140:143], a[80:83], v[68:71]
s_waitcnt lgkmcnt(0)
v_mfma_f32_16x16x32_bf16 v[96:99], a[96:99], a[32:35], v[96:99]
ds_read_b64_tr_b16 a[128:129], v232 offset:8192
ds_read_b64_tr_b16 a[130:131], v232 offset:10240
v_mfma_f32_16x16x32_bf16 v[104:107], a[96:99], a[36:39], v[104:107]
ds_read_b64_tr_b16 a[132:133], v233 offset:8192
ds_read_b64_tr_b16 a[134:135], v233 offset:10240
v_mfma_f32_16x16x32_bf16 v[112:115], a[96:99], a[40:43], v[112:115]
ds_read_b64_tr_b16 a[136:137], v232 offset:12288
v_mfma_f32_16x16x32_bf16 v[120:123], a[96:99], a[44:47], v[120:123]
v_mfma_f32_16x16x32_bf16 v[124:127], a[100:103], a[44:47], v[124:127]
ds_read_b64_tr_b16 a[138:139], v232 offset:14336
v_cvt_pk_bf16_f32 v192, v64, v65
v_cvt_pk_bf16_f32 v193, v66, v67
v_mfma_f32_16x16x32_bf16 v[116:119], a[100:103], a[40:43], v[116:119]
ds_read_b64_tr_b16 a[140:141], v233 offset:12288
v_cvt_pk_bf16_f32 v194, v68, v69
v_cvt_pk_bf16_f32 v195, v70, v71
v_mfma_f32_16x16x32_bf16 v[108:111], a[100:103], a[36:39], v[108:111]
s_mov_b32 s69, 0
buffer_store_dwordx4 v[192:195], v234, s[48:51], s69 offen sc1
v_cvt_pk_bf16_f32 v196, v72, v73
v_cvt_pk_bf16_f32 v197, v74, v75
v_mfma_f32_16x16x32_bf16 v[100:103], a[100:103], a[32:35], v[100:103]
ds_read_b64_tr_b16 a[142:143], v233 offset:14336
v_cvt_pk_bf16_f32 v198, v76, v77
v_cvt_pk_bf16_f32 v199, v78, v79
v_mfma_f32_16x16x32_bf16 v[96:99], a[104:107], a[48:51], v[96:99]
s_mov_b32 s69, 16384
buffer_store_dwordx4 v[196:199], v234, s[48:51], s69 offen sc1
v_cvt_pk_bf16_f32 v200, v80, v81
v_mfma_f32_16x16x32_bf16 v[104:107], a[104:107], a[52:55], v[104:107]
v_cvt_pk_bf16_f32 v201, v82, v83
v_cvt_pk_bf16_f32 v202, v84, v85
v_cvt_pk_bf16_f32 v203, v86, v87
v_mfma_f32_16x16x32_bf16 v[112:115], a[104:107], a[56:59], v[112:115]
s_mov_b32 s69, 32768
buffer_store_dwordx4 v[200:203], v234, s[48:51], s69 offen sc1
v_cvt_pk_bf16_f32 v204, v88, v89
v_mfma_f32_16x16x32_bf16 v[120:123], a[104:107], a[60:63], v[120:123]
v_cvt_pk_bf16_f32 v205, v90, v91
v_cvt_pk_bf16_f32 v206, v92, v93
v_mfma_f32_16x16x32_bf16 v[124:127], a[108:111], a[60:63], v[124:127]
v_cvt_pk_bf16_f32 v207, v94, v95
v_mfma_f32_16x16x32_bf16 v[116:119], a[108:111], a[56:59], v[116:119]
s_mov_b32 s69, 49152
buffer_store_dwordx4 v[204:207], v234, s[48:51], s69 offen sc1
v_mfma_f32_16x16x32_bf16 v[108:111], a[108:111], a[52:55], v[108:111]
v_mfma_f32_16x16x32_bf16 v[100:103], a[108:111], a[48:51], v[100:103]
s_waitcnt lgkmcnt(0)
v_mfma_f32_16x16x32_bf16 v[96:99], a[128:131], a[64:67], v[96:99]
v_mfma_f32_16x16x32_bf16 v[104:107], a[128:131], a[68:71], v[104:107]
v_mfma_f32_16x16x32_bf16 v[112:115], a[128:131], a[72:75], v[112:115]
v_mfma_f32_16x16x32_bf16 v[120:123], a[128:131], a[76:79], v[120:123]
v_mfma_f32_16x16x32_bf16 v[124:127], a[132:135], a[76:79], v[124:127]
v_mfma_f32_16x16x32_bf16 v[116:119], a[132:135], a[72:75], v[116:119]
v_mfma_f32_16x16x32_bf16 v[108:111], a[132:135], a[68:71], v[108:111]
v_mfma_f32_16x16x32_bf16 v[100:103], a[132:135], a[64:67], v[100:103]
v_mfma_f32_16x16x32_bf16 v[96:99], a[136:139], a[80:83], v[96:99]
v_mfma_f32_16x16x32_bf16 v[104:107], a[136:139], a[84:87], v[104:107]
v_mfma_f32_16x16x32_bf16 v[112:115], a[136:139], a[88:91], v[112:115]
v_mfma_f32_16x16x32_bf16 v[120:123], a[136:139], a[92:95], v[120:123]
buffer_load_dword v211, v210, s[72:75], 0 offen sc1
v_mfma_f32_16x16x32_bf16 v[124:127], a[140:143], a[92:95], v[124:127]
v_mfma_f32_16x16x32_bf16 v[116:119], a[140:143], a[88:91], v[116:119]
v_mfma_f32_16x16x32_bf16 v[108:111], a[140:143], a[84:87], v[108:111]
v_mfma_f32_16x16x32_bf16 v[100:103], a[140:143], a[80:83], v[100:103]
v_cvt_pk_bf16_f32 v192, v96, v97
v_cvt_pk_bf16_f32 v193, v98, v99
s_nop 5
v_cvt_pk_bf16_f32 v194, v100, v101
v_cvt_pk_bf16_f32 v195, v102, v103
s_mov_b32 s69, 65536
buffer_store_dwordx4 v[192:195], v234, s[48:51], s69 offen sc1
v_cvt_pk_bf16_f32 v196, v104, v105
v_cvt_pk_bf16_f32 v197, v106, v107
v_cvt_pk_bf16_f32 v198, v108, v109
v_cvt_pk_bf16_f32 v199, v110, v111
s_mov_b32 s69, 81920
buffer_store_dwordx4 v[196:199], v234, s[48:51], s69 offen sc1
v_cvt_pk_bf16_f32 v200, v112, v113
v_cvt_pk_bf16_f32 v201, v114, v115
v_cvt_pk_bf16_f32 v202, v116, v117
v_cvt_pk_bf16_f32 v203, v118, v119
s_mov_b32 s69, 98304
buffer_store_dwordx4 v[200:203], v234, s[48:51], s69 offen sc1
v_cvt_pk_bf16_f32 v204, v120, v121
v_cvt_pk_bf16_f32 v205, v122, v123
v_cvt_pk_bf16_f32 v206, v124, v125
v_cvt_pk_bf16_f32 v207, v126, v127
s_mov_b32 s69, 114688
buffer_store_dwordx4 v[204:207], v234, s[48:51], s69 offen sc1
s_cmp_eq_u32 s56, 1
s_cbranch_scc1 L_rb2
s_waitcnt vmcnt(4)
v_cmp_eq_u32 vcc, 1, v211
s_nop 1
s_cmp_eq_u64 vcc, -1
s_cbranch_scc0 L_rb2
buffer_load_dwordx4 v[128:131], v212, s[24:27], s57 offen sc1
buffer_load_dwordx4 v[132:135], v212, s[24:27], s57 offen offset:1024 sc1
buffer_load_dwordx4 v[136:139], v212, s[24:27], s57 offen offset:2048 sc1
buffer_load_dwordx4 v[140:143], v212, s[24:27], s57 offen offset:3072 sc1
buffer_load_dwordx4 v[144:147], v213, s[24:27], s57 offen sc1
buffer_load_dwordx4 v[148:151], v213, s[24:27], s57 offen offset:1024 sc1
s_waitcnt vmcnt(10)
buffer_store_dword v209, v208, s[72:75], 0 offen offset:64 sc1
s_waitcnt vmcnt(7)
buffer_store_dword v209, v208, s[72:75], 0 offen offset:128 sc1
s_barrier
s_cmp_eq_u32 s52, 0
s_cselect_b32 s22, 4, 0
s_mov_b64 exec, 1
buffer_atomic_add v218, v217, s[20:23], 0 offen sc0
s_mov_b64 exec, -1
s_mov_b32 s22, 4
buffer_load_dwordx4 v[152:155], v213, s[24:27], s57 offen offset:2048 sc1
buffer_load_dwordx4 v[156:159], v213, s[24:27], s57 offen offset:3072 sc1
buffer_load_dwordx4 v[160:163], v214, s[24:27], s57 offen sc1
buffer_load_dwordx4 v[164:167], v214, s[24:27], s57 offen offset:1024 sc1
buffer_load_dwordx4 v[168:171], v214, s[24:27], s57 offen offset:2048 sc1
buffer_load_dwordx4 v[172:175], v214, s[24:27], s57 offen offset:3072 sc1
buffer_load_dwordx4 v[176:179], v215, s[24:27], s57 offen sc1
buffer_load_dwordx4 v[180:183], v215, s[24:27], s57 offen offset:1024 sc1
buffer_load_dwordx4 v[184:187], v215, s[24:27], s57 offen offset:2048 sc1
buffer_load_dwordx4 v[188:191], v215, s[24:27], s57 offen offset:3072 sc1
s_branch L_rsum2
L_rb2:
s_waitcnt vmcnt(4)
buffer_store_dword v209, v208, s[72:75], 0 offen offset:64 sc1
s_waitcnt vmcnt(1)
buffer_store_dword v209, v208, s[72:75], 0 offen offset:128 sc1
s_barrier
s_cmp_eq_u32 s52, 0
s_cselect_b32 s22, 4, 0
s_mov_b64 exec, 1
buffer_atomic_add v218, v217, s[20:23], 0 offen sc0
s_mov_b64 exec, -1
s_mov_b32 s22, 4
s_cmp_eq_u32 s56, 1
s_cbranch_scc1 L_rfin2
s_mov_b32 s62, 200
buffer_load_dword v24, v210, s[72:75], 0 offen sc1
L_rl2:
s_waitcnt vmcnt(0)
v_cmp_eq_u32 vcc, 1, v24
s_nop 1
s_cmp_eq_u64 vcc, -1
s_cbranch_scc1 L_rgo2
buffer_load_dword v24, v210, s[72:75], 0 offen sc1
s_sub_u32 s62, s62, 1
s_cmp_lg_u32 s62, 0
s_cbranch_scc1 L_rl2
s_lshl_b32 s59, 0x10000, s67
v_mov_b32 v219, s59
s_mov_b64 exec, 1
buffer_atomic_or v219, v217, s[20:23], 0 offen sc0
s_mov_b64 exec, -1
s_waitcnt vmcnt(0)
v_readfirstlane_b32 s59, v219
s_nop 1
s_and_b32 s59, s59, 0xff
s_cmp_eq_u32 s59, 16
s_cbranch_scc0 L_rfin2
L_rgo2:
buffer_load_dwordx4 v[128:131], v212, s[24:27], s57 offen sc1
buffer_load_dwordx4 v[132:135], v212, s[24:27], s57 offen offset:1024 sc1
buffer_load_dwordx4 v[136:139], v212, s[24:27], s57 offen offset:2048 sc1
buffer_load_dwordx4 v[140:143], v212, s[24:27], s57 offen offset:3072 sc1
buffer_load_dwordx4 v[144:147], v213, s[24:27], s57 offen sc1
buffer_load_dwordx4 v[148:151], v213, s[24:27], s57 offen offset:1024 sc1
buffer_load_dwordx4 v[152:155], v213, s[24:27], s57 offen offset:2048 sc1
buffer_load_dwordx4 v[156:159], v213, s[24:27], s57 offen offset:3072 sc1
buffer_load_dwordx4 v[160:163], v214, s[24:27], s57 offen sc1
buffer_load_dwordx4 v[164:167], v214, s[24:27], s57 offen offset:1024 sc1
buffer_load_dwordx4 v[168:171], v214, s[24:27], s57 offen offset:2048 sc1
buffer_load_dwordx4 v[172:175], v214, s[24:27], s57 offen offset:3072 sc1
buffer_load_dwordx4 v[176:179], v215, s[24:27], s57 offen sc1
buffer_load_dwordx4 v[180:183], v215, s[24:27], s57 offen offset:1024 sc1
buffer_load_dwordx4 v[184:187], v215, s[24:27], s57 offen offset:2048 sc1
buffer_load_dwordx4 v[188:191], v215, s[24:27], s57 offen offset:3072 sc1
L_rsum2:
s_waitcnt vmcnt(15)
v_mfma_f32_16x16x32_bf16 v[0:3], a[224:227], v[128:131], 0
v_mfma_f32_16x16x32_bf16 v[4:7], a[228:231], v[128:131], 0
s_waitcnt vmcnt(14)
v_mfma_f32_16x16x32_bf16 v[0:3], a[224:227], v[132:135], v[0:3]
v_mfma_f32_16x16x32_bf16 v[4:7], a[228:231], v[132:135], v[4:7]
s_waitcnt vmcnt(13)
v_mfma_f32_16x16x32_bf16 v[0:3], a[224:227], v[136:139], v[0:3]
v_mfma_f32_16x16x32_bf16 v[4:7], a[228:231], v[136:139], v[4:7]
s_waitcnt vmcnt(12)
v_mfma_f32_16x16x32_bf16 v[0:3], a[224:227], v[140:143], v[0:3]
v_mfma_f32_16x16x32_bf16 v[4:7], a[228:231], v[140:143], v[4:7]
s_waitcnt vmcnt(11)
v_mfma_f32_16x16x32_bf16 v[0:3], a[224:227], v[144:147], v[0:3]
v_mfma_f32_16x16x32_bf16 v[4:7], a[228:231], v[144:147], v[4:7]
s_waitcnt vmcnt(10)
v_mfma_f32_16x16x32_bf16 v[0:3], a[224:227], v[148:151], v[0:3]
v_mfma_f32_16x16x32_bf16 v[4:7], a[228:231], v[148:151], v[4:7]
s_waitcnt vmcnt(9)
v_mfma_f32_16x16x32_bf16 v[0:3], a[224:227], v[152:155], v[0:3]
v_mfma_f32_16x16x32_bf16 v[4:7], a[228:231], v[152:155], v[4:7]
s_waitcnt vmcnt(8)
v_mfma_f32_16x16x32_bf16 v[0:3], a[224:227], v[156:159], v[0:3]
v_mfma_f32_16x16x32_bf16 v[4:7], a[228:231], v[156:159], v[4:7]
s_waitcnt vmcnt(7)
v_mfma_f32_16x16x32_bf16 v[0:3], a[224:227], v[160:163], v[0:3]
v_mfma_f32_16x16x32_bf16 v[4:7], a[228:231], v[160:163], v[4:7]
s_waitcnt vmcnt(6)
v_mfma_f32_16x16x32_bf16 v[0:3], a[224:227], v[164:167], v[0:3]
v_mfma_f32_16x16x32_bf16 v[4:7], a[228:231], v[164:167], v[4:7]
s_waitcnt vmcnt(5)
v_mfma_f32_16x16x32_bf16 v[0:3], a[224:227], v[168:171], v[0:3]
v_mfma_f32_16x16x32_bf16 v[4:7], a[228:231], v[168:171], v[4:7]
s_waitcnt vmcnt(4)
v_mfma_f32_16x16x32_bf16 v[0:3], a[224:227], v[172:175], v[0:3]
v_mfma_f32_16x16x32_bf16 v[4:7], a[228:231], v[172:175], v[4:7]
s_waitcnt vmcnt(3)
v_mfma_f32_16x16x32_bf16 v[0:3], a[224:227], v[176:179], v[0:3]
v_mfma_f32_16x16x32_bf16 v[4:7], a[228:231], v[176:179], v[4:7]
s_waitcnt vmcnt(2)
v_mfma_f32_16x16x32_bf16 v[0:3], a[224:227], v[180:183], v[0:3]
v_mfma_f32_16x16x32_bf16 v[4:7], a[228:231], v[180:183], v[4:7]
s_waitcnt vmcnt(1)
v_mfma_f32_16x16x32_bf16 v[0:3], a[224:227], v[184:187], v[0:3]
v_mfma_f32_16x16x32_bf16 v[4:7], a[228:231], v[184:187], v[4:7]
s_waitcnt vmcnt(0)
v_mfma_f32_16x16x32_bf16 v[0:3], a[224:227], v[188:191], v[0:3]
v_mfma_f32_16x16x32_bf16 v[4:7], a[228:231], v[188:191], v[4:7]
s_nop 6
v_cvt_pk_bf16_f32 v16, v0, v1
v_cvt_pk_bf16_f32 v17, v2, v3
v_cvt_pk_bf16_f32 v18, v4, v5
v_cvt_pk_bf16_f32 v19, v6, v7
buffer_store_dwordx2 v[16:17], v216, s[28:31], s9 offen
buffer_store_dwordx2 v[18:19], v216, s[28:31], s9 offen offset:32
L_rfin2:
s_cmp_lg_u32 s52, 0
s_cbranch_scc1 L_rd2
s_waitcnt vmcnt(0)
v_readfirstlane_b32 s59, v218
s_nop 1
s_and_b32 s60, s59, 0xff
s_cmp_lg_u32 s60, 15
s_cbranch_scc1 L_rd2
s_lshr_b32 s60, s59, 16
s_cmp_eq_u32 s60, 0
s_cbranch_scc1 L_rd2
s_ff1_i32_b32 s61, s60
s_bfe_u32 s62, s59, 0x20008
s_lshl_b32 s55, s61, 2
s_add_u32 s55, s55, s62
s_add_u32 s59, s59, 0x100
s_cmp_eq_u32 s62, 3
s_cbranch_scc0 L_rk2
s_and_b32 s59, s59, 0xffff00ff
s_add_u32 s61, s61, 16
s_bitset0_b32 s59, s61
L_rk2:
v_mov_b32 v218, s59
s_lshr_b32 s56, s55, 4
s_and_b32 s59, s55, 2
s_lshl_b32 s59, s59, 1
s_add_u32 s56, s56, s59
s_add_u32 s56, s56, s64
s_and_b32 s56, s56, 7
s_bfe_u32 s59, s55, 0x20002
s_and_b32 s60, s55, 1
s_lshl_b32 s57, s56, 1
s_add_u32 s57, s57, s60
s_lshl_b32 s9, s57, 6
s_lshl_b32 s57, s57, 2
s_add_u32 s57, s57, s59
s_lshl_b32 s57, s57, 14
s_mul_i32 s60, s59, 14336
s_add_u32 s9, s9, s60
s_cmp_eq_u32 s56, 7
s_cselect_b32 s56, 1, 0
s_cmp_ge_u32 s59, 4
s_cselect_b32 s56, 1, s56
s_cmp_eq_u32 s56, 1
s_cbranch_scc1 L_rfin2
s_branch L_rgo2
L_rd2:
s_endpgm
L_fb2:
s_waitcnt vmcnt(0) lgkmcnt(0)
s_nop 15
s_barrier
v_accvgpr_write_b32 a244, v242
v_accvgpr_write_b32 a245, v243
v_accvgpr_write_b32 a246, v244
v_accvgpr_write_b32 a247, v245
v_accvgpr_read_b32 v0, a248
s_mov_b32 s71, 0
s_nop 3
s_branch L_top
.p2align 6
L_v3:
v_accvgpr_write_b32 a248, v0
s_cmp_eq_u32 s71, 0
s_cbranch_scc1 L_ni3
v_mov_b32 v6, 0xff800000
v_accvgpr_write_b32 a244, v6
v_accvgpr_write_b32 a245, v6
v_accvgpr_write_b32 a246, v6
v_accvgpr_write_b32 a247, v6
L_ni3:
s_lshl_b32 s59, s64, 7
s_add_u32 s77, s59, 0
s_sub_u32 s69, s77, 896
s_min_u32 s77, s77, s69
s_add_u32 s78, s59, 512
s_sub_u32 s69, s78, 896
s_min_u32 s78, s78, s69
s_add_u32 s79, s59, 640
s_sub_u32 s69, s79, 896
s_min_u32 s79, s79, s69
s_add_u32 s80, s59, 768
s_sub_u32 s69, s80, 896
s_min_u32 s80, s80, s69
s_add_u32 s81, s59, 256
s_sub_u32 s69, s81, 896
s_min_u32 s81, s81, s69
s_add_u32 s82, s59, 384
s_sub_u32 s69, s82, 896
s_min_u32 s82, s82, s69
s_add_u32 s14, s14, s60
s_addc_u32 s15, s15, 0
s_lshl_b32 s66, s64, 1
s_add_u32 s66, s66, 1
s_lshl_b32 s60, s66, 12
s_add_u32 s60, s60, 33554432
s_add_u32 s72, s18, s60
s_addc_u32 s73, s19, 0
s_mov_b32 s74, 4096
s_mov_b32 s75, 0x20000
s_lshl_b32 s60, s67, 8
v_lshlrev_b32 v7, 2, v1
v_mov_b32 v8, 0
s_mov_b32 s74, s71
buffer_store_dword v8, v7, s[72:75], s60 offen sc1
s_mov_b32 s74, 4096
s_lshl_b32 s60, s64, 3
s_add_u32 s60, s60, s65
s_lshl_b32 s60, s60, 18
s_add_u32 s62, s60, s61
s_add_u32 s28, s8, s62
s_addc_u32 s29, s9, 0
s_sub_u32 s30, 262144, s61
s_mov_b32 s31, 0x20000
s_lshl_b32 s62, s52, 16
s_add_u32 s62, s62, s60
s_add_u32 s24, s6, s62
s_addc_u32 s25, s7, 0
s_mov_b32 s26, 65536
s_mov_b32 s27, 0x20000
s_add_u32 s54, s52, s64
s_and_b32 s54, s54, 7
s_lshl_b32 s62, s54, 7
s_mul_i32 s60, s67, 229376
s_add_u32 s60, s60, s62
s_add_u32 s36, s12, s60
s_addc_u32 s37, s13, 0
s_sub_u32 s38, 229376, s62
s_mov_b32 s39, 0x20000
s_mul_i32 s60, s66, 896
s_add_u32 s60, s60, s67
s_lshl_b32 s60, s60, 10
s_lshl_b32 s62, s54, 17
s_add_u32 s60, s60, s62
s_add_u32 s44, s18, s60
s_addc_u32 s45, s19, 0
s_mov_b32 s46, 131072
s_mov_b32 s47, 0x20000
s_cmp_lt_u32 s54, 7
s_cselect_b32 s38, s38, 0
s_cselect_b32 s46, s46, 0
s_add_u32 s54, s52, s64
s_add_u32 s54, s54, 4
s_and_b32 s54, s54, 7
s_lshl_b32 s62, s54, 7
s_mul_i32 s60, s67, 229376
s_add_u32 s60, s60, s62
s_add_u32 s40, s12, s60
s_addc_u32 s41, s13, 0
s_sub_u32 s42, 229376, s62
s_mov_b32 s43, 0x20000
s_mul_i32 s60, s66, 896
s_add_u32 s60, s60, s67
s_lshl_b32 s60, s60, 10
s_lshl_b32 s62, s54, 17
s_add_u32 s60, s60, s62
s_add_u32 s48, s18, s60
s_addc_u32 s49, s19, 0
s_mov_b32 s50, 131072
s_mov_b32 s51, 0x20000
s_cmp_lt_u32 s54, 7
s_cselect_b32 s42, s42, 0
s_cselect_b32 s50, s50, 0
s_add_u32 s60, s52, 0
s_and_b32 s60, s60, 3
s_lshl_b32 s54, s60, 7
s_mul_i32 s4, s60, 57344
s_lshl_b32 s60, s60, 14
v_lshl_add_u32 v235, v1, 4, s60
s_add_u32 s60, s52, 1
s_and_b32 s60, s60, 3
s_lshl_b32 s55, s60, 7
s_mul_i32 s5, s60, 57344
s_lshl_b32 s60, s60, 14
v_lshl_add_u32 v236, v1, 4, s60
s_add_u32 s60, s52, 2
s_and_b32 s60, s60, 3
s_lshl_b32 s56, s60, 7
s_mul_i32 s6, s60, 57344
s_lshl_b32 s60, s60, 14
v_lshl_add_u32 v237, v1, 4, s60
s_add_u32 s60, s52, 3
s_and_b32 s60, s60, 3
s_lshl_b32 s57, s60, 7
s_mul_i32 s7, s60, 57344
s_lshl_b32 s60, s60, 14
v_lshl_add_u32 v238, v1, 4, s60
s_mov_b32 s63, 0x3db8aa3b
v_and_b32 v11, 15, v1
v_lshrrev_b32 v6, 1, v11
v_xor_b32 v7, v6, v5
v_lshlrev_b32 v7, 4, v7
v_lshl_add_u32 v228, v11, 7, v7
v_xor_b32 v229, 64, v228
v_bfe_u32 v7, v1, 3, 2
v_lshlrev_b32 v7, 5, v7
v_and_b32 v8, 3, v1
v_lshl_add_u32 v7, v8, 3, v7
v_bfe_u32 v8, v1, 2, 2
v_lshl_add_u32 v7, v8, 7, v7
v_lshl_add_u32 v7, v5, 10, v7
v_add_u32 v230, s53, v7
v_xor_b32 v231, 32, v230
v_xor_b32 v232, 64, v230
v_xor_b32 v233, 96, v230
v_lshlrev_b32 v254, 9, v5
v_lshrrev_b32 v7, 1, v5
v_xor_b32 v7, v7, v6
v_lshlrev_b32 v7, 4, v7
v_lshl_add_u32 v7, v11, 7, v7
v_and_b32 v8, 1, v5
v_lshl_add_u32 v7, v8, 3, v7
v_add_u32 v224, s53, v7
v_xor_b32 v225, 32, v224
v_xor_b32 v226, 64, v224
v_xor_b32 v227, 96, v224
v_lshlrev_b32 v6, 9, v3
v_add_u32 v212, v6, v9
v_add_u32 v213, v6, v10
v_add_u32 v214, 6144, v212
v_add_u32 v215, 9216, v213
v_add_u32 v213, 3072, v213
v_lshlrev_b32 v12, 1, v5
v_xor_b32 v12, v4, v12
v_lshlrev_b32 v12, 4, v12
v_add_u32 v216, v6, v12
v_add_u32 v217, 3072, v216
v_add_u32 v218, 6144, v216
v_add_u32 v219, 9216, v216
v_mul_u32_u24 v6, 896, v3
v_add_u32 v220, v6, v12
v_add_u32 v221, 6144, v220
v_add_u32 v222, 12288, v220
v_add_u32 v223, 18432, v220
v_lshlrev_b32 v234, 4, v1
v_add_u32 v241, s53, v234
v_lshlrev_b32 v6, 7, v1
v_accvgpr_write_b32 a250, v6
v_and_b32 v6, 31, v1
v_lshlrev_b32 v6, 9, v6
v_lshrrev_b32 v7, 5, v1
v_lshl_add_u32 v6, v7, 16, v6
v_accvgpr_write_b32 a251, v6
v_mul_u32_u24 v6, 896, v1
v_accvgpr_write_b32 a252, v6
v_lshlrev_b32 v6, 4, v11
v_lshl_add_u32 v240, v2, 14, v6
v_lshl_add_u32 v6, v5, 2, v6
v_lshl_add_u32 v239, v2, 8, v6
s_waitcnt vmcnt(9)
s_barrier
s_add_u32 m0, s68, 24576
s_nop 0
buffer_load_dwordx4 v250, s[20:23], s77 offen lds
buffer_load_dwordx4 v251, s[20:23], s77 offen offset:1024 lds
s_add_u32 m0, s53, 8192
s_lshl_b32 s58, s77, 12
buffer_load_dwordx4 v208, s[32:35], s58 offen lds
s_waitcnt vmcnt(8)
ds_read_b64_tr_b16 a[96:97], v230 offset:0
ds_read_b64_tr_b16 a[98:99], v230 offset:512
ds_read_b128 a[112:115], v228 offset:8192
ds_read_b128 a[116:119], v228 offset:10240
ds_read_b128 a[120:123], v228 offset:12288
ds_read_b64_tr_b16 a[100:101], v231 offset:0
ds_read_b64_tr_b16 a[102:103], v231 offset:512
ds_read_b64_tr_b16 a[104:105], v232 offset:0
ds_read_b64_tr_b16 a[106:107], v232 offset:512
ds_read_b64_tr_b16 a[108:109], v233 offset:0
ds_read_b64_tr_b16 a[110:111], v233 offset:512
s_waitcnt lgkmcnt(8)
v_mfma_f32_16x16x32_bf16 v[128:131], a[96:99], a[112:115], 0
buffer_load_dwordx4 v209, s[32:35], s58 offen offset:1024 lds
buffer_load_dwordx4 v210, s[32:35], s58 offen offset:2048 lds
buffer_load_dwordx4 v211, s[32:35], s58 offen offset:3072 lds
s_add_u32 m0, s53, 12288
s_lshl_b32 s58, s77, 12
s_add_u32 s58, s58, 262144
buffer_load_dwordx4 v208, s[32:35], s58 offen lds
s_waitcnt vmcnt(8)
s_waitcnt lgkmcnt(7)
v_mfma_f32_16x16x32_bf16 v[136:139], a[96:99], a[116:119], 0
ds_read_b64_tr_b16 a[128:129], v230 offset:4096
ds_read_b64_tr_b16 a[130:131], v230 offset:4608
s_waitcnt lgkmcnt(8)
v_mfma_f32_16x16x32_bf16 v[144:147], a[96:99], a[120:123], 0
ds_read_b128 a[144:147], v229 offset:8192
s_waitcnt lgkmcnt(7)
v_mfma_f32_16x16x32_bf16 v[148:151], a[100:103], a[120:123], 0
buffer_load_dwordx4 v209, s[32:35], s58 offen offset:1024 lds
v_mfma_f32_16x16x32_bf16 v[140:143], a[100:103], a[116:119], 0
ds_read_b128 a[148:151], v229 offset:10240
ds_read_b128 a[152:155], v229 offset:12288
v_mfma_f32_16x16x32_bf16 v[132:135], a[100:103], a[112:115], 0
ds_read_b64_tr_b16 a[132:133], v231 offset:4096
ds_read_b64_tr_b16 a[134:135], v231 offset:4608
s_waitcnt lgkmcnt(9)
v_mfma_f32_16x16x32_bf16 v[160:163], a[104:107], a[112:115], 0
ds_read_b64_tr_b16 a[136:137], v232 offset:4096
ds_read_b64_tr_b16 a[138:139], v232 offset:4608
v_mfma_f32_16x16x32_bf16 v[168:171], a[104:107], a[116:119], 0
buffer_load_dwordx4 v210, s[32:35], s58 offen offset:2048 lds
v_mfma_f32_16x16x32_bf16 v[176:179], a[104:107], a[120:123], 0
ds_read_b64_tr_b16 a[140:141], v233 offset:4096
ds_read_b64_tr_b16 a[142:143], v233 offset:4608
s_waitcnt lgkmcnt(11)
v_mfma_f32_16x16x32_bf16 v[180:183], a[108:111], a[120:123], 0
buffer_load_dwordx4 v211, s[32:35], s58 offen offset:3072 lds
v_mfma_f32_16x16x32_bf16 v[172:175], a[108:111], a[116:119], 0
s_add_u32 m0, s68, 40960
v_mfma_f32_16x16x32_bf16 v[164:167], a[108:111], a[112:115], 0
s_waitcnt lgkmcnt(6)
v_mfma_f32_16x16x32_bf16 v[128:131], a[128:131], a[144:147], v[128:131]
s_waitcnt vmcnt(8)
s_barrier
buffer_load_dwordx4 v250, s[20:23], s78 offen lds
v_mfma_f32_16x16x32_bf16 v[136:139], a[128:131], a[148:151], v[136:139]
buffer_load_dwordx4 v251, s[20:23], s78 offen offset:1024 lds
s_add_u32 m0, s68, 0
s_nop 0
buffer_load_dwordx4 v250, s[20:23], s79 offen lds
buffer_load_dwordx4 v251, s[20:23], s79 offen offset:1024 lds
s_waitcnt vmcnt(8)
v_mfma_f32_16x16x32_bf16 v[144:147], a[128:131], a[152:155], v[144:147]
ds_read_b64_tr_b16 a[96:97], v230 offset:8192
s_waitcnt lgkmcnt(1)
v_mfma_f32_16x16x32_bf16 v[148:151], a[132:135], a[152:155], v[148:151]
s_add_u32 m0, s68, 16384
s_nop 0
buffer_load_dwordx4 v250, s[20:23], s80 offen lds
v_mfma_f32_16x16x32_bf16 v[140:143], a[132:135], a[148:151], v[140:143]
ds_read_b64_tr_b16 a[98:99], v230 offset:8704
ds_read_b128 a[112:115], v228 offset:24576
v_mfma_f32_16x16x32_bf16 v[132:135], a[132:135], a[144:147], v[132:135]
ds_read_b128 a[116:119], v228 offset:26624
ds_read_b128 a[120:123], v228 offset:28672
v_mfma_f32_16x16x32_bf16 v[160:163], a[136:139], a[144:147], v[160:163]
ds_read_b64_tr_b16 a[100:101], v231 offset:8192
ds_read_b64_tr_b16 a[102:103], v231 offset:8704
v_mfma_f32_16x16x32_bf16 v[168:171], a[136:139], a[148:151], v[168:171]
ds_read_b64_tr_b16 a[104:105], v232 offset:8192
ds_read_b64_tr_b16 a[106:107], v232 offset:8704
v_mfma_f32_16x16x32_bf16 v[176:179], a[136:139], a[152:155], v[176:179]
ds_read_b64_tr_b16 a[108:109], v233 offset:8192
ds_read_b64_tr_b16 a[110:111], v233 offset:8704
v_mfma_f32_16x16x32_bf16 v[180:183], a[140:143], a[152:155], v[180:183]
buffer_load_dwordx4 v251, s[20:23], s80 offen offset:1024 lds
v_mfma_f32_16x16x32_bf16 v[172:175], a[140:143], a[148:151], v[172:175]
s_add_u32 m0, s53, 16384
s_lshl_b32 s58, s78, 12
v_mfma_f32_16x16x32_bf16 v[164:167], a[140:143], a[144:147], v[164:167]
s_waitcnt lgkmcnt(6)
v_mfma_f32_16x16x32_bf16 v[128:131], a[96:99], a[112:115], v[128:131]
buffer_load_dwordx4 v208, s[32:35], s58 offen lds
buffer_load_dwordx4 v209, s[32:35], s58 offen offset:1024 lds
s_waitcnt vmcnt(8)
v_mfma_f32_16x16x32_bf16 v[136:139], a[96:99], a[116:119], v[136:139]
ds_read_b64_tr_b16 a[128:129], v230 offset:12288
ds_read_b64_tr_b16 a[130:131], v230 offset:12800
v_mfma_f32_16x16x32_bf16 v[144:147], a[96:99], a[120:123], v[144:147]
ds_read_b128 a[144:147], v229 offset:24576
s_waitcnt lgkmcnt(3)
v_mfma_f32_16x16x32_bf16 v[148:151], a[100:103], a[120:123], v[148:151]
buffer_load_dwordx4 v210, s[32:35], s58 offen offset:2048 lds
v_mfma_f32_16x16x32_bf16 v[140:143], a[100:103], a[116:119], v[140:143]
ds_read_b128 a[148:151], v229 offset:26624
ds_read_b128 a[152:155], v229 offset:28672
v_mfma_f32_16x16x32_bf16 v[132:135], a[100:103], a[112:115], v[132:135]
ds_read_b64_tr_b16 a[132:133], v231 offset:12288
ds_read_b64_tr_b16 a[134:135], v231 offset:12800
v_mfma_f32_16x16x32_bf16 v[160:163], a[104:107], a[112:115], v[160:163]
ds_read_b64_tr_b16 a[136:137], v232 offset:12288
ds_read_b64_tr_b16 a[138:139], v232 offset:12800
v_mfma_f32_16x16x32_bf16 v[168:171], a[104:107], a[116:119], v[168:171]
buffer_load_dwordx4 v211, s[32:35], s58 offen offset:3072 lds
v_mfma_f32_16x16x32_bf16 v[176:179], a[104:107], a[120:123], v[176:179]
ds_read_b64_tr_b16 a[140:141], v233 offset:12288
ds_read_b64_tr_b16 a[142:143], v233 offset:12800
v_mfma_f32_16x16x32_bf16 v[180:183], a[108:111], a[120:123], v[180:183]
s_add_u32 m0, s53, 20480
s_lshl_b32 s58, s78, 12
v_mfma_f32_16x16x32_bf16 v[172:175], a[108:111], a[116:119], v[172:175]
s_add_u32 s58, s58, 262144
v_mfma_f32_16x16x32_bf16 v[164:167], a[108:111], a[112:115], v[164:167]
s_waitcnt lgkmcnt(6)
v_mfma_f32_16x16x32_bf16 v[128:131], a[128:131], a[144:147], v[128:131]
buffer_load_dwordx4 v208, s[32:35], s58 offen lds
buffer_load_dwordx4 v209, s[32:35], s58 offen offset:1024 lds
buffer_load_dwordx4 v210, s[32:35], s58 offen offset:2048 lds
buffer_load_dwordx4 v211, s[32:35], s58 offen offset:3072 lds
s_waitcnt vmcnt(8)
s_barrier
v_mfma_f32_16x16x32_bf16 v[136:139], a[128:131], a[148:151], v[136:139]
s_add_u32 m0, s53, 0
s_lshl_b32 s58, s79, 12
buffer_load_dwordx4 v208, s[32:35], s58 offen lds
buffer_load_dwordx4 v209, s[32:35], s58 offen offset:1024 lds
buffer_load_dwordx4 v210, s[32:35], s58 offen offset:2048 lds
buffer_load_dwordx4 v211, s[32:35], s58 offen offset:3072 lds
s_waitcnt vmcnt(8)
v_mfma_f32_16x16x32_bf16 v[144:147], a[128:131], a[152:155], v[144:147]
ds_read_b64_tr_b16 a[96:97], v230 offset:16384
s_waitcnt lgkmcnt(1)
v_mfma_f32_16x16x32_bf16 v[148:151], a[132:135], a[152:155], v[148:151]
s_add_u32 m0, s53, 4096
s_lshl_b32 s58, s79, 12
v_mfma_f32_16x16x32_bf16 v[140:143], a[132:135], a[148:151], v[140:143]
ds_read_b64_tr_b16 a[98:99], v230 offset:16896
ds_read_b128 a[112:115], v228 offset:40960
v_mfma_f32_16x16x32_bf16 v[132:135], a[132:135], a[144:147], v[132:135]
ds_read_b128 a[116:119], v228 offset:43008
ds_read_b128 a[120:123], v228 offset:45056
v_mfma_f32_16x16x32_bf16 v[160:163], a[136:139], a[144:147], v[160:163]
ds_read_b64_tr_b16 a[100:101], v231 offset:16384
ds_read_b64_tr_b16 a[102:103], v231 offset:16896
v_mfma_f32_16x16x32_bf16 v[168:171], a[136:139], a[148:151], v[168:171]
ds_read_b64_tr_b16 a[104:105], v232 offset:16384
ds_read_b64_tr_b16 a[106:107], v232 offset:16896
v_mfma_f32_16x16x32_bf16 v[176:179], a[136:139], a[152:155], v[176:179]
ds_read_b64_tr_b16 a[108:109], v233 offset:16384
ds_read_b64_tr_b16 a[110:111], v233 offset:16896
v_mfma_f32_16x16x32_bf16 v[180:183], a[140:143], a[152:155], v[180:183]
s_add_u32 s58, s58, 262144
buffer_load_dwordx4 v208, s[32:35], s58 offen lds
v_mfma_f32_16x16x32_bf16 v[172:175], a[140:143], a[148:151], v[172:175]
v_mfma_f32_16x16x32_bf16 v[164:167], a[140:143], a[144:147], v[164:167]
s_waitcnt lgkmcnt(6)
v_mfma_f32_16x16x32_bf16 v[128:131], a[96:99], a[112:115], v[128:131]
buffer_load_dwordx4 v209, s[32:35], s58 offen offset:1024 lds
buffer_load_dwordx4 v210, s[32:35], s58 offen offset:2048 lds
buffer_load_dwordx4 v211, s[32:35], s58 offen offset:3072 lds
s_waitcnt vmcnt(8)
v_mfma_f32_16x16x32_bf16 v[136:139], a[96:99], a[116:119], v[136:139]
ds_read_b64_tr_b16 a[128:129], v230 offset:20480
ds_read_b64_tr_b16 a[130:131], v230 offset:20992
v_mfma_f32_16x16x32_bf16 v[144:147], a[96:99], a[120:123], v[144:147]
ds_read_b128 a[144:147], v229 offset:40960
s_waitcnt lgkmcnt(3)
v_mfma_f32_16x16x32_bf16 v[148:151], a[100:103], a[120:123], v[148:151]
s_add_u32 m0, s53, 8192
s_lshl_b32 s58, s80, 12
v_mfma_f32_16x16x32_bf16 v[140:143], a[100:103], a[116:119], v[140:143]
ds_read_b128 a[148:151], v229 offset:43008
ds_read_b128 a[152:155], v229 offset:45056
v_mfma_f32_16x16x32_bf16 v[132:135], a[100:103], a[112:115], v[132:135]
ds_read_b64_tr_b16 a[132:133], v231 offset:20480
ds_read_b64_tr_b16 a[134:135], v231 offset:20992
v_mfma_f32_16x16x32_bf16 v[160:163], a[104:107], a[112:115], v[160:163]
ds_read_b64_tr_b16 a[136:137], v232 offset:20480
ds_read_b64_tr_b16 a[138:139], v232 offset:20992
buffer_load_dwordx4 v208, s[32:35], s58 offen lds
v_mfma_f32_16x16x32_bf16 v[168:171], a[104:107], a[116:119], v[168:171]
ds_read_b64_tr_b16 a[140:141], v233 offset:20480
ds_read_b64_tr_b16 a[142:143], v233 offset:20992
v_mfma_f32_16x16x32_bf16 v[176:179], a[104:107], a[120:123], v[176:179]
buffer_load_dwordx4 v209, s[32:35], s58 offen offset:1024 lds
v_mfma_f32_16x16x32_bf16 v[180:183], a[108:111], a[120:123], v[180:183]
v_mfma_f32_16x16x32_bf16 v[172:175], a[108:111], a[116:119], v[172:175]
buffer_load_dwordx4 v210, s[32:35], s58 offen offset:2048 lds
v_mfma_f32_16x16x32_bf16 v[164:167], a[108:111], a[112:115], v[164:167]
s_waitcnt lgkmcnt(6)
v_mfma_f32_16x16x32_bf16 v[128:131], a[128:131], a[144:147], v[128:131]
buffer_load_dwordx4 v211, s[32:35], s58 offen offset:3072 lds
s_waitcnt vmcnt(8)
v_mfma_f32_16x16x32_bf16 v[136:139], a[128:131], a[148:151], v[136:139]
ds_read_b64_tr_b16 a[96:97], v230 offset:0
ds_read_b64_tr_b16 a[98:99], v230 offset:512
v_mfma_f32_16x16x32_bf16 v[144:147], a[128:131], a[152:155], v[144:147]
ds_read_b128 a[112:115], v228 offset:0
s_waitcnt lgkmcnt(3)
v_mfma_f32_16x16x32_bf16 v[148:151], a[132:135], a[152:155], v[148:151]
s_add_u32 m0, s68, 32768
s_nop 0
buffer_load_dwordx4 v250, s[20:23], s81 offen lds
v_mfma_f32_16x16x32_bf16 v[140:143], a[132:135], a[148:151], v[140:143]
ds_read_b128 a[116:119], v228 offset:2048
ds_read_b128 a[120:123], v228 offset:4096
v_mfma_f32_16x16x32_bf16 v[132:135], a[132:135], a[144:147], v[132:135]
ds_read_b64_tr_b16 a[100:101], v231 offset:0
ds_read_b64_tr_b16 a[102:103], v231 offset:512
v_mfma_f32_16x16x32_bf16 v[160:163], a[136:139], a[144:147], v[160:163]
ds_read_b64_tr_b16 a[104:105], v232 offset:0
ds_read_b64_tr_b16 a[106:107], v232 offset:512
v_mfma_f32_16x16x32_bf16 v[168:171], a[136:139], a[148:151], v[168:171]
buffer_load_dwordx4 v251, s[20:23], s81 offen offset:1024 lds
v_mfma_f32_16x16x32_bf16 v[176:179], a[136:139], a[152:155], v[176:179]
ds_read_b64_tr_b16 a[108:109], v233 offset:0
ds_read_b64_tr_b16 a[110:111], v233 offset:512
v_mfma_f32_16x16x32_bf16 v[180:183], a[140:143], a[152:155], v[180:183]
s_add_u32 m0, s53, 12288
s_lshl_b32 s58, s80, 12
v_mfma_f32_16x16x32_bf16 v[172:175], a[140:143], a[148:151], v[172:175]
s_add_u32 s58, s58, 262144
v_mfma_f32_16x16x32_bf16 v[164:167], a[140:143], a[144:147], v[164:167]
s_waitcnt lgkmcnt(6)
v_mfma_f32_16x16x32_bf16 v[128:131], a[96:99], a[112:115], v[128:131]
buffer_load_dwordx4 v208, s[32:35], s58 offen lds
buffer_load_dwordx4 v209, s[32:35], s58 offen offset:1024 lds
s_waitcnt vmcnt(8)
v_mfma_f32_16x16x32_bf16 v[136:139], a[96:99], a[116:119], v[136:139]
ds_read_b64_tr_b16 a[128:129], v230 offset:4096
ds_read_b64_tr_b16 a[130:131], v230 offset:4608
v_mfma_f32_16x16x32_bf16 v[144:147], a[96:99], a[120:123], v[144:147]
ds_read_b128 a[144:147], v229 offset:0
s_waitcnt lgkmcnt(3)
v_mfma_f32_16x16x32_bf16 v[148:151], a[100:103], a[120:123], v[148:151]
buffer_load_dwordx4 v210, s[32:35], s58 offen offset:2048 lds
v_mfma_f32_16x16x32_bf16 v[140:143], a[100:103], a[116:119], v[140:143]
ds_read_b128 a[148:151], v229 offset:2048
ds_read_b128 a[152:155], v229 offset:4096
v_mfma_f32_16x16x32_bf16 v[132:135], a[100:103], a[112:115], v[132:135]
ds_read_b64_tr_b16 a[132:133], v231 offset:4096
ds_read_b64_tr_b16 a[134:135], v231 offset:4608
v_mfma_f32_16x16x32_bf16 v[160:163], a[104:107], a[112:115], v[160:163]
ds_read_b64_tr_b16 a[136:137], v232 offset:4096
ds_read_b64_tr_b16 a[138:139], v232 offset:4608
v_mfma_f32_16x16x32_bf16 v[168:171], a[104:107], a[116:119], v[168:171]
buffer_load_dwordx4 v211, s[32:35], s58 offen offset:3072 lds
v_mfma_f32_16x16x32_bf16 v[176:179], a[104:107], a[120:123], v[176:179]
ds_read_b64_tr_b16 a[140:141], v233 offset:4096
ds_read_b64_tr_b16 a[142:143], v233 offset:4608
v_mfma_f32_16x16x32_bf16 v[180:183], a[108:111], a[120:123], v[180:183]
s_add_u32 m0, s53, 16384
s_add_u32 s58, s54, 32768
v_mfma_f32_16x16x32_bf16 v[172:175], a[108:111], a[116:119], v[172:175]
buffer_load_dwordx4 v212, s[24:27], s58 offen lds
v_mfma_f32_16x16x32_bf16 v[164:167], a[108:111], a[112:115], v[164:167]
s_waitcnt lgkmcnt(6)
v_mfma_f32_16x16x32_bf16 v[128:131], a[128:131], a[144:147], v[128:131]
buffer_load_dwordx4 v213, s[24:27], s58 offen offset:1024 lds
s_waitcnt vmcnt(8)
v_mfma_f32_16x16x32_bf16 v[136:139], a[128:131], a[148:151], v[136:139]
ds_read_b64_tr_b16 a[96:97], v230 offset:8192
ds_read_b64_tr_b16 a[98:99], v230 offset:8704
v_mfma_f32_16x16x32_bf16 v[144:147], a[128:131], a[152:155], v[144:147]
ds_read_b128 a[112:115], v228 offset:16384
s_waitcnt lgkmcnt(3)
v_mfma_f32_16x16x32_bf16 v[148:151], a[132:135], a[152:155], v[148:151]
buffer_load_dwordx4 v214, s[24:27], s58 offen offset:2048 lds
v_mfma_f32_16x16x32_bf16 v[140:143], a[132:135], a[148:151], v[140:143]
ds_read_b128 a[116:119], v228 offset:18432
ds_read_b128 a[120:123], v228 offset:20480
v_mfma_f32_16x16x32_bf16 v[132:135], a[132:135], a[144:147], v[132:135]
ds_read_b64_tr_b16 a[100:101], v231 offset:8192
ds_read_b64_tr_b16 a[102:103], v231 offset:8704
v_mfma_f32_16x16x32_bf16 v[160:163], a[136:139], a[144:147], v[160:163]
ds_read_b64_tr_b16 a[104:105], v232 offset:8192
ds_read_b64_tr_b16 a[106:107], v232 offset:8704
v_mfma_f32_16x16x32_bf16 v[168:171], a[136:139], a[148:151], v[168:171]
buffer_load_dwordx4 v215, s[24:27], s58 offen offset:3072 lds
v_mfma_f32_16x16x32_bf16 v[176:179], a[136:139], a[152:155], v[176:179]
ds_read_b64_tr_b16 a[108:109], v233 offset:8192
ds_read_b64_tr_b16 a[110:111], v233 offset:8704
v_mfma_f32_16x16x32_bf16 v[180:183], a[140:143], a[152:155], v[180:183]
s_add_u32 m0, s53, 20480
s_add_u32 s58, s55, 0
v_mfma_f32_16x16x32_bf16 v[172:175], a[140:143], a[148:151], v[172:175]
buffer_load_dwordx4 v212, s[24:27], s58 offen lds
v_mfma_f32_16x16x32_bf16 v[164:167], a[140:143], a[144:147], v[164:167]
s_waitcnt lgkmcnt(6)
v_mfma_f32_16x16x32_bf16 v[128:131], a[96:99], a[112:115], v[128:131]
buffer_load_dwordx4 v213, s[24:27], s58 offen offset:1024 lds
buffer_load_dwordx4 v214, s[24:27], s58 offen offset:2048 lds
buffer_load_dwordx4 v215, s[24:27], s58 offen offset:3072 lds
s_waitcnt vmcnt(8)
v_mfma_f32_16x16x32_bf16 v[136:139], a[96:99], a[116:119], v[136:139]
ds_read_b64_tr_b16 a[128:129], v230 offset:12288
ds_read_b64_tr_b16 a[130:131], v230 offset:12800
v_mfma_f32_16x16x32_bf16 v[144:147], a[96:99], a[120:123], v[144:147]
ds_read_b128 a[144:147], v229 offset:16384
s_waitcnt lgkmcnt(3)
v_mfma_f32_16x16x32_bf16 v[148:151], a[100:103], a[120:123], v[148:151]
s_add_u32 m0, s68, 49152
s_nop 0
buffer_load_dwordx4 v250, s[20:23], s82 offen lds
v_mfma_f32_16x16x32_bf16 v[140:143], a[100:103], a[116:119], v[140:143]
ds_read_b128 a[148:151], v229 offset:18432
ds_read_b128 a[152:155], v229 offset:20480
v_mfma_f32_16x16x32_bf16 v[132:135], a[100:103], a[112:115], v[132:135]
ds_read_b64_tr_b16 a[132:133], v231 offset:12288
ds_read_b64_tr_b16 a[134:135], v231 offset:12800
v_mfma_f32_16x16x32_bf16 v[160:163], a[104:107], a[112:115], v[160:163]
ds_read_b64_tr_b16 a[136:137], v232 offset:12288
ds_read_b64_tr_b16 a[138:139], v232 offset:12800
v_mfma_f32_16x16x32_bf16 v[168:171], a[104:107], a[116:119], v[168:171]
buffer_load_dwordx4 v251, s[20:23], s82 offen offset:1024 lds
v_mfma_f32_16x16x32_bf16 v[176:179], a[104:107], a[120:123], v[176:179]
ds_read_b64_tr_b16 a[140:141], v233 offset:12288
ds_read_b64_tr_b16 a[142:143], v233 offset:12800
v_mfma_f32_16x16x32_bf16 v[180:183], a[108:111], a[120:123], v[180:183]
s_add_u32 m0, s53, 0
s_lshl_b32 s58, s81, 12
v_mfma_f32_16x16x32_bf16 v[172:175], a[108:111], a[116:119], v[172:175]
buffer_load_dwordx4 v208, s[32:35], s58 offen lds
v_mfma_f32_16x16x32_bf16 v[164:167], a[108:111], a[112:115], v[164:167]
s_waitcnt lgkmcnt(6)
v_mfma_f32_16x16x32_bf16 v[128:131], a[128:131], a[144:147], v[128:131]
buffer_load_dwordx4 v209, s[32:35], s58 offen offset:1024 lds
buffer_load_dwordx4 v210, s[32:35], s58 offen offset:2048 lds
buffer_load_dwordx4 v211, s[32:35], s58 offen offset:3072 lds
s_add_u32 m0, s53, 4096
s_lshl_b32 s58, s81, 12
s_add_u32 s58, s58, 262144
buffer_load_dwordx4 v208, s[32:35], s58 offen lds
buffer_load_dwordx4 v209, s[32:35], s58 offen offset:1024 lds
buffer_load_dwordx4 v210, s[32:35], s58 offen offset:2048 lds
buffer_load_dwordx4 v211, s[32:35], s58 offen offset:3072 lds
s_waitcnt vmcnt(8)
s_barrier
v_mfma_f32_16x16x32_bf16 v[136:139], a[128:131], a[148:151], v[136:139]
s_add_u32 m0, s53, 8192
s_lshl_b32 s58, s82, 12
buffer_load_dwordx4 v208, s[32:35], s58 offen lds
buffer_load_dwordx4 v209, s[32:35], s58 offen offset:1024 lds
buffer_load_dwordx4 v210, s[32:35], s58 offen offset:2048 lds
buffer_load_dwordx4 v211, s[32:35], s58 offen offset:3072 lds
s_waitcnt vmcnt(8)
v_mfma_f32_16x16x32_bf16 v[144:147], a[128:131], a[152:155], v[144:147]
ds_read_b64_tr_b16 a[96:97], v230 offset:0
s_waitcnt lgkmcnt(1)
v_mfma_f32_16x16x32_bf16 v[148:151], a[132:135], a[152:155], v[148:151]
s_add_u32 m0, s53, 12288
s_lshl_b32 s58, s82, 12
v_mfma_f32_16x16x32_bf16 v[140:143], a[132:135], a[148:151], v[140:143]
ds_read_b64_tr_b16 a[98:99], v230 offset:512
ds_read_b128 a[112:115], v228 offset:32768
v_mfma_f32_16x16x32_bf16 v[132:135], a[132:135], a[144:147], v[132:135]
ds_read_b128 a[116:119], v228 offset:34816
ds_read_b128 a[120:123], v228 offset:36864
v_mfma_f32_16x16x32_bf16 v[160:163], a[136:139], a[144:147], v[160:163]
ds_read_b64_tr_b16 a[100:101], v231 offset:0
ds_read_b64_tr_b16 a[102:103], v231 offset:512
v_mfma_f32_16x16x32_bf16 v[168:171], a[136:139], a[148:151], v[168:171]
ds_read_b64_tr_b16 a[104:105], v232 offset:0
ds_read_b64_tr_b16 a[106:107], v232 offset:512
v_mfma_f32_16x16x32_bf16 v[176:179], a[136:139], a[152:155], v[176:179]
ds_read_b64_tr_b16 a[108:109], v233 offset:0
ds_read_b64_tr_b16 a[110:111], v233 offset:512
v_mfma_f32_16x16x32_bf16 v[180:183], a[140:143], a[152:155], v[180:183]
s_add_u32 s58, s58, 262144
buffer_load_dwordx4 v208, s[32:35], s58 offen lds
v_mfma_f32_16x16x32_bf16 v[172:175], a[140:143], a[148:151], v[172:175]
v_mfma_f32_16x16x32_bf16 v[164:167], a[140:143], a[144:147], v[164:167]
s_waitcnt lgkmcnt(6)
v_mfma_f32_16x16x32_bf16 v[128:131], a[96:99], a[112:115], v[128:131]
buffer_load_dwordx4 v209, s[32:35], s58 offen offset:1024 lds
buffer_load_dwordx4 v210, s[32:35], s58 offen offset:2048 lds
buffer_load_dwordx4 v211, s[32:35], s58 offen offset:3072 lds
s_waitcnt vmcnt(8)
v_mfma_f32_16x16x32_bf16 v[136:139], a[96:99], a[116:119], v[136:139]
ds_read_b64_tr_b16 a[128:129], v230 offset:4096
ds_read_b64_tr_b16 a[130:131], v230 offset:4608
v_mfma_f32_16x16x32_bf16 v[144:147], a[96:99], a[120:123], v[144:147]
ds_read_b128 a[144:147], v229 offset:32768
s_waitcnt lgkmcnt(3)
v_mfma_f32_16x16x32_bf16 v[148:151], a[100:103], a[120:123], v[148:151]
s_add_u32 m0, s53, 0
s_add_u32 s58, s54, 0
v_mfma_f32_16x16x32_bf16 v[140:143], a[100:103], a[116:119], v[140:143]
ds_read_b128 a[148:151], v229 offset:34816
ds_read_b128 a[152:155], v229 offset:36864
v_mfma_f32_16x16x32_bf16 v[132:135], a[100:103], a[112:115], v[132:135]
ds_read_b64_tr_b16 a[132:133], v231 offset:4096
ds_read_b64_tr_b16 a[134:135], v231 offset:4608
v_mfma_f32_16x16x32_bf16 v[160:163], a[104:107], a[112:115], v[160:163]
ds_read_b64_tr_b16 a[136:137], v232 offset:4096
ds_read_b64_tr_b16 a[138:139], v232 offset:4608
buffer_load_dwordx4 v212, s[24:27], s58 offen lds
v_mfma_f32_16x16x32_bf16 v[168:171], a[104:107], a[116:119], v[168:171]
ds_read_b64_tr_b16 a[140:141], v233 offset:4096
ds_read_b64_tr_b16 a[142:143], v233 offset:4608
v_mfma_f32_16x16x32_bf16 v[176:179], a[104:107], a[120:123], v[176:179]
buffer_load_dwordx4 v213, s[24:27], s58 offen offset:1024 lds
v_mfma_f32_16x16x32_bf16 v[180:183], a[108:111], a[120:123], v[180:183]
v_mfma_f32_16x16x32_bf16 v[172:175], a[108:111], a[116:119], v[172:175]
buffer_load_dwordx4 v214, s[24:27], s58 offen offset:2048 lds
v_mfma_f32_16x16x32_bf16 v[164:167], a[108:111], a[112:115], v[164:167]
s_waitcnt lgkmcnt(6)
v_mfma_f32_16x16x32_bf16 v[128:131], a[128:131], a[144:147], v[128:131]
buffer_load_dwordx4 v215, s[24:27], s58 offen offset:3072 lds
s_waitcnt vmcnt(4)
v_mfma_f32_16x16x32_bf16 v[136:139], a[128:131], a[148:151], v[136:139]
ds_read_b64_tr_b16 a[96:97], v230 offset:8192
ds_read_b64_tr_b16 a[98:99], v230 offset:8704
v_mfma_f32_16x16x32_bf16 v[144:147], a[128:131], a[152:155], v[144:147]
ds_read_b128 a[160:163], v228 offset:49152
s_waitcnt lgkmcnt(3)
v_mfma_f32_16x16x32_bf16 v[148:151], a[132:135], a[152:155], v[148:151]
ds_read_b128 a[164:167], v228 offset:51200
ds_read_b128 a[168:171], v228 offset:53248
v_mfma_f32_16x16x32_bf16 v[140:143], a[132:135], a[148:151], v[140:143]
ds_read_b64_tr_b16 a[100:101], v231 offset:8192
ds_read_b64_tr_b16 a[102:103], v231 offset:8704
v_mfma_f32_16x16x32_bf16 v[132:135], a[132:135], a[144:147], v[132:135]
ds_read_b64_tr_b16 a[104:105], v230 offset:12288
ds_read_b64_tr_b16 a[106:107], v230 offset:12800
v_mfma_f32_16x16x32_bf16 v[160:163], a[136:139], a[144:147], v[160:163]
ds_read_b128 a[176:179], v229 offset:49152
ds_read_b128 a[180:183], v229 offset:51200
v_mfma_f32_16x16x32_bf16 v[168:171], a[136:139], a[148:151], v[168:171]
ds_read_b128 a[184:187], v229 offset:53248
ds_read_b64_tr_b16 a[108:109], v231 offset:12288
v_mfma_f32_16x16x32_bf16 v[176:179], a[136:139], a[152:155], v[176:179]
ds_read_b64_tr_b16 a[110:111], v231 offset:12800
s_add_u32 m0, s53, 4096
v_mfma_f32_16x16x32_bf16 v[180:183], a[140:143], a[152:155], v[180:183]
s_add_u32 s58, s54, 16384
buffer_load_dwordx4 v212, s[24:27], s58 offen lds
v_mfma_f32_16x16x32_bf16 v[172:175], a[140:143], a[148:151], v[172:175]
v_mfma_f32_16x16x32_bf16 v[164:167], a[140:143], a[144:147], v[164:167]
s_waitcnt lgkmcnt(9)
v_mfma_f32_16x16x32_bf16 v[128:131], a[96:99], a[160:163], v[128:131]
buffer_load_dwordx4 v213, s[24:27], s58 offen offset:1024 lds
buffer_load_dwordx4 v214, s[24:27], s58 offen offset:2048 lds
buffer_load_dwordx4 v215, s[24:27], s58 offen offset:3072 lds
v_mfma_f32_16x16x32_bf16 v[136:139], a[96:99], a[164:167], v[136:139]
ds_read_b64_tr_b16 a[128:129], v232 offset:8192
ds_read_b64_tr_b16 a[130:131], v232 offset:8704
v_mfma_f32_16x16x32_bf16 v[144:147], a[96:99], a[168:171], v[144:147]
ds_read_b64_tr_b16 a[132:133], v233 offset:8192
s_waitcnt lgkmcnt(3)
v_mfma_f32_16x16x32_bf16 v[148:151], a[100:103], a[168:171], v[148:151]
ds_read_b64_tr_b16 a[134:135], v233 offset:8704
ds_read_b64_tr_b16 a[136:137], v232 offset:12288
v_mfma_f32_16x16x32_bf16 v[140:143], a[100:103], a[164:167], v[140:143]
ds_read_b64_tr_b16 a[138:139], v232 offset:12800
ds_read_b64_tr_b16 a[140:141], v233 offset:12288
v_mfma_f32_16x16x32_bf16 v[132:135], a[100:103], a[160:163], v[132:135]
ds_read_b64_tr_b16 a[142:143], v233 offset:12800
v_mfma_f32_16x16x32_bf16 v[128:131], a[104:107], a[176:179], v[128:131]
v_mfma_f32_16x16x32_bf16 v[136:139], a[104:107], a[180:183], v[136:139]
v_mfma_f32_16x16x32_bf16 v[144:147], a[104:107], a[184:187], v[144:147]
v_mfma_f32_16x16x32_bf16 v[148:151], a[108:111], a[184:187], v[148:151]
v_mfma_f32_16x16x32_bf16 v[140:143], a[108:111], a[180:183], v[140:143]
v_mfma_f32_16x16x32_bf16 v[132:135], a[108:111], a[176:179], v[132:135]
s_waitcnt lgkmcnt(0)
v_mfma_f32_16x16x32_bf16 v[160:163], a[128:131], a[160:163], v[160:163]
s_add_u32 m0, s53, 8192
s_add_u32 s58, s57, 16384
buffer_load_dwordx4 v212, s[24:27], s58 offen lds
buffer_load_dwordx4 v213, s[24:27], s58 offen offset:1024 lds
buffer_load_dwordx4 v214, s[24:27], s58 offen offset:2048 lds
buffer_load_dwordx4 v215, s[24:27], s58 offen offset:3072 lds
s_waitcnt vmcnt(8)
v_mfma_f32_16x16x32_bf16 v[168:171], a[128:131], a[164:167], v[168:171]
ds_read_b64 a[96:97], v224 offset:0
ds_read_b64 a[98:99], v225 offset:0
v_mfma_f32_16x16x32_bf16 v[176:179], a[128:131], a[168:171], v[176:179]
ds_read_b64 a[100:101], v224 offset:2048
ds_read_b64 a[102:103], v225 offset:2048
v_cvt_pk_bf16_f32 v128, v128, v129
v_mfma_f32_16x16x32_bf16 v[180:183], a[132:135], a[168:171], v[180:183]
s_add_u32 m0, s53, 12288
s_add_u32 s58, s55, 32768
v_cvt_pk_bf16_f32 v129, v130, v131
v_cvt_pk_bf16_f32 v130, v132, v133
v_mfma_f32_16x16x32_bf16 v[172:175], a[132:135], a[164:167], v[172:175]
ds_read_b64 a[104:105], v226 offset:2048
ds_read_b64 a[106:107], v227 offset:2048
v_cvt_pk_bf16_f32 v131, v134, v135
v_mfma_f32_16x16x32_bf16 v[164:167], a[132:135], a[160:163], v[164:167]
ds_read_b64 a[108:109], v226 offset:0
ds_read_b64 a[110:111], v227 offset:0
buffer_load_dwordx4 v212, s[24:27], s58 offen lds
ds_write_b128 v235, v[128:131] offset:8192
v_cvt_pk_bf16_f32 v136, v136, v137
v_mfma_f32_16x16x32_bf16 v[160:163], a[136:139], a[176:179], v[160:163]
buffer_load_dwordx4 v213, s[24:27], s58 offen offset:1024 lds
v_cvt_pk_bf16_f32 v137, v138, v139
v_cvt_pk_bf16_f32 v138, v140, v141
v_mfma_f32_16x16x32_bf16 v[168:171], a[136:139], a[180:183], v[168:171]
buffer_load_dwordx4 v214, s[24:27], s58 offen offset:2048 lds
v_cvt_pk_bf16_f32 v139, v142, v143
ds_write_b128 v235, v[136:139] offset:9216
v_mfma_f32_16x16x32_bf16 v[176:179], a[136:139], a[184:187], v[176:179]
buffer_load_dwordx4 v215, s[24:27], s58 offen offset:3072 lds
v_cvt_pk_bf16_f32 v144, v144, v145
v_cvt_pk_bf16_f32 v145, v146, v147
v_mfma_f32_16x16x32_bf16 v[180:183], a[140:143], a[184:187], v[180:183]
v_cvt_pk_bf16_f32 v146, v148, v149
v_cvt_pk_bf16_f32 v147, v150, v151
ds_write_b128 v235, v[144:147] offset:10240
v_mfma_f32_16x16x32_bf16 v[172:175], a[140:143], a[180:183], v[172:175]
v_mfma_f32_16x16x32_bf16 v[164:167], a[140:143], a[176:179], v[164:167]
s_waitcnt lgkmcnt(3)
v_mfma_f32_16x16x32_bf16 v[0:3], a[96:99], v[128:131], 0
s_waitcnt vmcnt(8)
v_mfma_f32_16x16x32_bf16 v[8:11], a[96:99], v[136:139], 0
ds_read_b64 a[128:129], v224 offset:4096
ds_read_b64 a[130:131], v225 offset:4096
v_mfma_f32_16x16x32_bf16 v[16:19], a[96:99], v[144:147], 0
ds_read_b64 a[132:133], v224 offset:6144
ds_read_b64 a[134:135], v225 offset:6144
v_cvt_pk_bf16_f32 v160, v160, v161
v_cvt_pk_bf16_f32 v161, v162, v163
v_cvt_pk_bf16_f32 v162, v164, v165
v_cvt_pk_bf16_f32 v163, v166, v167
ds_write_b128 v235, v[160:163] offset:12288
v_cvt_pk_bf16_f32 v168, v168, v169
v_mfma_f32_16x16x32_bf16 v[20:23], a[100:103], v[144:147], 0
s_add_u32 m0, s53, 0
s_add_u32 s58, s56, 0
buffer_load_dwordx4 v212, s[24:27], s58 offen lds
v_cvt_pk_bf16_f32 v169, v170, v171
v_cvt_pk_bf16_f32 v170, v172, v173
v_cvt_pk_bf16_f32 v171, v174, v175
ds_write_b128 v235, v[168:171] offset:13312
v_cvt_pk_bf16_f32 v176, v176, v177
v_cvt_pk_bf16_f32 v177, v178, v179
v_cvt_pk_bf16_f32 v178, v180, v181
v_mfma_f32_16x16x32_bf16 v[12:15], a[100:103], v[136:139], 0
ds_read_b64 a[136:137], v226 offset:6144
ds_read_b64 a[138:139], v227 offset:6144
v_cvt_pk_bf16_f32 v179, v182, v183
v_mfma_f32_16x16x32_bf16 v[4:7], a[100:103], v[128:131], 0
ds_read_b64 a[140:141], v226 offset:4096
ds_read_b64 a[142:143], v227 offset:4096
v_mfma_f32_16x16x32_bf16 v[4:7], a[104:107], v[160:163], v[4:7]
buffer_load_dwordx4 v213, s[24:27], s58 offen offset:1024 lds
ds_write_b128 v235, v[176:179] offset:14336
v_mfma_f32_16x16x32_bf16 v[12:15], a[104:107], v[168:171], v[12:15]
buffer_load_dwordx4 v214, s[24:27], s58 offen offset:2048 lds
v_mfma_f32_16x16x32_bf16 v[20:23], a[104:107], v[176:179], v[20:23]
s_waitcnt lgkmcnt(0)
s_barrier
v_mfma_f32_16x16x32_bf16 v[16:19], a[108:111], v[176:179], v[16:19]
v_mfma_f32_16x16x32_bf16 v[8:11], a[108:111], v[168:171], v[8:11]
v_sub_u32 v230, v230, v254
v_sub_u32 v231, v231, v254
v_sub_u32 v232, v232, v254
v_sub_u32 v233, v233, v254
v_mfma_f32_16x16x32_bf16 v[0:3], a[108:111], v[160:163], v[0:3]
v_mfma_f32_16x16x32_bf16 v[32:35], a[128:131], v[128:131], 0
ds_read_b64 a[96:97], v224 offset:16384
ds_read_b64 a[98:99], v225 offset:16384
v_mfma_f32_16x16x32_bf16 v[40:43], a[128:131], v[136:139], 0
ds_read_b64 a[100:101], v224 offset:18432
ds_read_b64 a[102:103], v225 offset:18432
v_mfma_f32_16x16x32_bf16 v[48:51], a[128:131], v[144:147], 0
ds_read_b64 a[104:105], v226 offset:18432
v_mfma_f32_16x16x32_bf16 v[52:55], a[132:135], v[144:147], 0
ds_read_b64 a[106:107], v227 offset:18432
v_mfma_f32_16x16x32_bf16 v[44:47], a[132:135], v[136:139], 0
ds_read_b64 a[108:109], v226 offset:16384
v_mfma_f32_16x16x32_bf16 v[36:39], a[132:135], v[128:131], 0
ds_read_b64 a[110:111], v227 offset:16384
v_mfma_f32_16x16x32_bf16 v[36:39], a[136:139], v[160:163], v[36:39]
v_mfma_f32_16x16x32_bf16 v[44:47], a[136:139], v[168:171], v[44:47]
v_mfma_f32_16x16x32_bf16 v[52:55], a[136:139], v[176:179], v[52:55]
v_mfma_f32_16x16x32_bf16 v[48:51], a[140:143], v[176:179], v[48:51]
v_mfma_f32_16x16x32_bf16 v[40:43], a[140:143], v[168:171], v[40:43]
v_mfma_f32_16x16x32_bf16 v[32:35], a[140:143], v[160:163], v[32:35]
s_waitcnt lgkmcnt(0)
v_mfma_f32_16x16x32_bf16 v[64:67], a[96:99], v[128:131], 0
ds_read_b64 a[128:129], v224 offset:20480
ds_read_b64 a[130:131], v225 offset:20480
v_mfma_f32_16x16x32_bf16 v[72:75], a[96:99], v[136:139], 0
ds_read_b128 a[0:3], v236 offset:8192
ds_read_b128 a[4:7], v236 offset:9216
v_mfma_f32_16x16x32_bf16 v[80:83], a[96:99], v[144:147], 0
ds_read_b128 a[8:11], v236 offset:10240
ds_read_b64 a[132:133], v224 offset:22528
v_mfma_f32_16x16x32_bf16 v[84:87], a[100:103], v[144:147], 0
ds_read_b64 a[134:135], v225 offset:22528
ds_read_b64 a[136:137], v226 offset:22528
v_mfma_f32_16x16x32_bf16 v[76:79], a[100:103], v[136:139], 0
ds_read_b64 a[138:139], v227 offset:22528
ds_read_b128 a[16:19], v236 offset:12288
v_mfma_f32_16x16x32_bf16 v[68:71], a[100:103], v[128:131], 0
ds_read_b128 a[20:23], v236 offset:13312
ds_read_b128 a[24:27], v236 offset:14336
v_mfma_f32_16x16x32_bf16 v[68:71], a[104:107], v[160:163], v[68:71]
ds_read_b64 a[140:141], v226 offset:20480
buffer_load_dwordx4 v215, s[24:27], s58 offen offset:3072 lds
v_mfma_f32_16x16x32_bf16 v[76:79], a[104:107], v[168:171], v[76:79]
s_add_u32 m0, s53, 4096
s_add_u32 s58, s57, 0
v_mfma_f32_16x16x32_bf16 v[84:87], a[104:107], v[176:179], v[84:87]
ds_read_b64 a[142:143], v227 offset:20480
v_mfma_f32_16x16x32_bf16 v[80:83], a[108:111], v[176:179], v[80:83]
v_mfma_f32_16x16x32_bf16 v[72:75], a[108:111], v[168:171], v[72:75]
buffer_load_dwordx4 v212, s[24:27], s58 offen lds
v_mfma_f32_16x16x32_bf16 v[64:67], a[108:111], v[160:163], v[64:67]
s_waitcnt lgkmcnt(9)
v_mfma_f32_16x16x32_bf16 v[0:3], a[128:131], a[0:3], v[0:3]
buffer_load_dwordx4 v213, s[24:27], s58 offen offset:1024 lds
buffer_load_dwordx4 v214, s[24:27], s58 offen offset:2048 lds
buffer_load_dwordx4 v215, s[24:27], s58 offen offset:3072 lds
s_add_u32 m0, s53, 16384
s_add_u32 s58, s55, 16384
buffer_load_dwordx4 v212, s[24:27], s58 offen lds
buffer_load_dwordx4 v213, s[24:27], s58 offen offset:1024 lds
buffer_load_dwordx4 v214, s[24:27], s58 offen offset:2048 lds
buffer_load_dwordx4 v215, s[24:27], s58 offen offset:3072 lds
s_waitcnt vmcnt(8)
v_mfma_f32_16x16x32_bf16 v[8:11], a[128:131], a[4:7], v[8:11]
ds_read_b64 a[96:97], v224 offset:0
ds_read_b64 a[98:99], v225 offset:0
v_mfma_f32_16x16x32_bf16 v[16:19], a[128:131], a[8:11], v[16:19]
ds_read_b128 a[32:35], v237 offset:8192
s_waitcnt lgkmcnt(3)
v_mfma_f32_16x16x32_bf16 v[20:23], a[132:135], a[8:11], v[20:23]
ds_read_b128 a[36:39], v237 offset:9216
ds_read_b128 a[40:43], v237 offset:10240
v_mfma_f32_16x16x32_bf16 v[12:15], a[132:135], a[4:7], v[12:15]
ds_read_b64 a[100:101], v224 offset:2048
ds_read_b64 a[102:103], v225 offset:2048
v_mfma_f32_16x16x32_bf16 v[4:7], a[132:135], a[0:3], v[4:7]
ds_read_b64 a[104:105], v226 offset:2048
ds_read_b64 a[106:107], v227 offset:2048
v_mfma_f32_16x16x32_bf16 v[4:7], a[136:139], a[16:19], v[4:7]
ds_read_b128 a[48:51], v237 offset:12288
ds_read_b128 a[52:55], v237 offset:13312
v_mfma_f32_16x16x32_bf16 v[12:15], a[136:139], a[20:23], v[12:15]
ds_read_b128 a[56:59], v237 offset:14336
ds_read_b64 a[108:109], v226 offset:0
v_mfma_f32_16x16x32_bf16 v[20:23], a[136:139], a[24:27], v[20:23]
ds_read_b64 a[110:111], v227 offset:0
s_add_u32 m0, s53, 20480
v_mfma_f32_16x16x32_bf16 v[16:19], a[140:143], a[24:27], v[16:19]
s_add_u32 s58, s56, 16384
buffer_load_dwordx4 v212, s[24:27], s58 offen lds
v_mfma_f32_16x16x32_bf16 v[8:11], a[140:143], a[20:23], v[8:11]
v_mfma_f32_16x16x32_bf16 v[0:3], a[140:143], a[16:19], v[0:3]
s_waitcnt lgkmcnt(9)
v_mfma_f32_16x16x32_bf16 v[0:3], a[96:99], a[32:35], v[0:3]
buffer_load_dwordx4 v213, s[24:27], s58 offen offset:1024 lds
buffer_load_dwordx4 v214, s[24:27], s58 offen offset:2048 lds
buffer_load_dwordx4 v215, s[24:27], s58 offen offset:3072 lds
s_waitcnt vmcnt(8)
v_mfma_f32_16x16x32_bf16 v[8:11], a[96:99], a[36:39], v[8:11]
ds_read_b64 a[128:129], v224 offset:4096
ds_read_b64 a[130:131], v225 offset:4096
v_mfma_f32_16x16x32_bf16 v[16:19], a[96:99], a[40:43], v[16:19]
ds_read_b128 a[64:67], v238 offset:8192
s_waitcnt lgkmcnt(3)
v_mfma_f32_16x16x32_bf16 v[20:23], a[100:103], a[40:43], v[20:23]
ds_read_b128 a[68:71], v238 offset:9216
ds_read_b128 a[72:75], v238 offset:10240
v_mfma_f32_16x16x32_bf16 v[12:15], a[100:103], a[36:39], v[12:15]
ds_read_b64 a[132:133], v224 offset:6144
ds_read_b64 a[134:135], v225 offset:6144
v_mfma_f32_16x16x32_bf16 v[4:7], a[100:103], a[32:35], v[4:7]
ds_read_b64 a[136:137], v226 offset:6144
ds_read_b64 a[138:139], v227 offset:6144
v_mfma_f32_16x16x32_bf16 v[4:7], a[104:107], a[48:51], v[4:7]
ds_read_b128 a[80:83], v238 offset:12288
ds_read_b128 a[84:87], v238 offset:13312
v_mfma_f32_16x16x32_bf16 v[12:15], a[104:107], a[52:55], v[12:15]
ds_read_b128 a[88:91], v238 offset:14336
ds_read_b64 a[140:141], v226 offset:4096
v_mfma_f32_16x16x32_bf16 v[20:23], a[104:107], a[56:59], v[20:23]
ds_read_b64 a[142:143], v227 offset:4096
s_add_u32 m0, s53, 0
v_mfma_f32_16x16x32_bf16 v[16:19], a[108:111], a[56:59], v[16:19]
s_add_u32 s58, s56, 49152
buffer_load_dwordx4 v212, s[24:27], s58 offen lds
v_mfma_f32_16x16x32_bf16 v[8:11], a[108:111], a[52:55], v[8:11]
v_mfma_f32_16x16x32_bf16 v[0:3], a[108:111], a[48:51], v[0:3]
s_waitcnt lgkmcnt(9)
v_mfma_f32_16x16x32_bf16 v[0:3], a[128:131], a[64:67], v[0:3]
buffer_load_dwordx4 v213, s[24:27], s58 offen offset:1024 lds
buffer_load_dwordx4 v214, s[24:27], s58 offen offset:2048 lds
buffer_load_dwordx4 v215, s[24:27], s58 offen offset:3072 lds
s_waitcnt vmcnt(8)
v_mfma_f32_16x16x32_bf16 v[8:11], a[128:131], a[68:71], v[8:11]
ds_read_b64 a[96:97], v224 offset:16384
ds_read_b64 a[98:99], v225 offset:16384
v_mfma_f32_16x16x32_bf16 v[16:19], a[128:131], a[72:75], v[16:19]
ds_read_b64 a[100:101], v224 offset:18432
s_waitcnt lgkmcnt(3)
v_mfma_f32_16x16x32_bf16 v[20:23], a[132:135], a[72:75], v[20:23]
s_add_u32 m0, s53, 4096
s_add_u32 s58, s57, 49152
v_mfma_f32_16x16x32_bf16 v[12:15], a[132:135], a[68:71], v[12:15]
ds_read_b64 a[102:103], v225 offset:18432
ds_read_b64 a[104:105], v226 offset:18432
v_mfma_f32_16x16x32_bf16 v[4:7], a[132:135], a[64:67], v[4:7]
ds_read_b64 a[106:107], v227 offset:18432
ds_read_b64 a[108:109], v226 offset:16384
v_mfma_f32_16x16x32_bf16 v[4:7], a[136:139], a[80:83], v[4:7]
ds_read_b64 a[110:111], v227 offset:16384
v_mfma_f32_16x16x32_bf16 v[12:15], a[136:139], a[84:87], v[12:15]
buffer_load_dwordx4 v212, s[24:27], s58 offen lds
v_mfma_f32_16x16x32_bf16 v[20:23], a[136:139], a[88:91], v[20:23]
v_mfma_f32_16x16x32_bf16 v[16:19], a[140:143], a[88:91], v[16:19]
buffer_load_dwordx4 v213, s[24:27], s58 offen offset:1024 lds
v_mfma_f32_16x16x32_bf16 v[8:11], a[140:143], a[84:87], v[8:11]
v_mfma_f32_16x16x32_bf16 v[0:3], a[140:143], a[80:83], v[0:3]
s_waitcnt lgkmcnt(6)
v_mfma_f32_16x16x32_bf16 v[32:35], a[96:99], a[0:3], v[32:35]
buffer_load_dwordx4 v214, s[24:27], s58 offen offset:2048 lds
buffer_load_dwordx4 v215, s[24:27], s58 offen offset:3072 lds
s_waitcnt vmcnt(8)
v_mfma_f32_16x16x32_bf16 v[40:43], a[96:99], a[4:7], v[40:43]
ds_read_b64 a[128:129], v224 offset:20480
ds_read_b64 a[130:131], v225 offset:20480
v_mfma_f32_16x16x32_bf16 v[48:51], a[96:99], a[8:11], v[48:51]
ds_read_b64 a[132:133], v224 offset:22528
s_waitcnt lgkmcnt(3)
v_mfma_f32_16x16x32_bf16 v[52:55], a[100:103], a[8:11], v[52:55]
s_add_u32 m0, s53, 16384
s_add_u32 s58, s56, 32768
buffer_load_dwordx4 v212, s[24:27], s58 offen lds
v_mfma_f32_16x16x32_bf16 v[44:47], a[100:103], a[4:7], v[44:47]
ds_read_b64 a[134:135], v225 offset:22528
ds_read_b64 a[136:137], v226 offset:22528
v_max_f32 v242, v0, v1
v_max_f32 v243, v8, v9
v_mfma_f32_16x16x32_bf16 v[36:39], a[100:103], a[0:3], v[36:39]
ds_read_b64 a[138:139], v227 offset:22528
ds_read_b64 a[140:141], v226 offset:20480
v_max_f32 v244, v16, v17
v_max3_f32 v242, v2, v3, v242
v_mfma_f32_16x16x32_bf16 v[36:39], a[104:107], a[16:19], v[36:39]
ds_read_b64 a[142:143], v227 offset:20480
v_max3_f32 v243, v10, v11, v243
v_max3_f32 v244, v18, v19, v244
v_max3_f32 v242, v4, v5, v242
v_mfma_f32_16x16x32_bf16 v[44:47], a[104:107], a[20:23], v[44:47]
buffer_load_dwordx4 v213, s[24:27], s58 offen offset:1024 lds
v_max3_f32 v243, v12, v13, v243
v_max3_f32 v244, v20, v21, v244
v_mfma_f32_16x16x32_bf16 v[52:55], a[104:107], a[24:27], v[52:55]
buffer_load_dwordx4 v214, s[24:27], s58 offen offset:2048 lds
v_max3_f32 v242, v6, v7, v242
v_max3_f32 v243, v14, v15, v243
v_mfma_f32_16x16x32_bf16 v[48:51], a[108:111], a[24:27], v[48:51]
v_max3_f32 v244, v22, v23, v244
v_mov_b32 v200, v242
v_mov_b32 v201, v243
v_mov_b32 v202, v244
v_mfma_f32_16x16x32_bf16 v[40:43], a[108:111], a[20:23], v[40:43]
v_mov_b32 v203, v244
v_permlane32_swap_b32 v200, v202
s_nop 0
v_permlane32_swap_b32 v201, v203
v_mfma_f32_16x16x32_bf16 v[32:35], a[108:111], a[16:19], v[32:35]
v_max_f32 v200, v200, v202
v_max_f32 v201, v201, v203
s_waitcnt lgkmcnt(0)
v_mfma_f32_16x16x32_bf16 v[32:35], a[128:131], a[32:35], v[32:35]
ds_read_b64 a[96:97], v224 offset:8192
ds_read_b64 a[98:99], v225 offset:8192
v_permlane16_swap_b32 v200, v201
v_mfma_f32_16x16x32_bf16 v[40:43], a[128:131], a[36:39], v[40:43]
ds_read_b64 a[100:101], v224 offset:10240
ds_read_b64 a[102:103], v225 offset:10240
v_max_f32 v200, v200, v201
ds_write_b32 v239, v200 offset:0
v_mfma_f32_16x16x32_bf16 v[48:51], a[128:131], a[40:43], v[48:51]
ds_read_b64 a[104:105], v226 offset:10240
ds_write_b32 v239, v200 offset:16384
ds_write_b32 v239, v200 offset:32768
ds_write_b32 v239, v200 offset:49152
v_mfma_f32_16x16x32_bf16 v[52:55], a[132:135], a[40:43], v[52:55]
ds_read_b64 a[106:107], v227 offset:10240
v_mov_b32 v246, 0x3f803f80
v_accvgpr_write_b32 a240, v246
v_accvgpr_write_b32 a241, v246
v_mfma_f32_16x16x32_bf16 v[44:47], a[132:135], a[36:39], v[44:47]
ds_read_b64 a[108:109], v226 offset:8192
v_accvgpr_write_b32 a242, v246
v_accvgpr_write_b32 a243, v246
v_mfma_f32_16x16x32_bf16 v[36:39], a[132:135], a[32:35], v[36:39]
ds_read_b64 a[110:111], v227 offset:8192
v_mfma_f32_16x16x32_bf16 v[36:39], a[136:139], a[48:51], v[36:39]
v_mfma_f32_16x16x32_bf16 v[44:47], a[136:139], a[52:55], v[44:47]
v_mfma_f32_16x16x32_bf16 v[52:55], a[136:139], a[56:59], v[52:55]
s_waitcnt lgkmcnt(3)
s_barrier
ds_read_b128 v[192:195], v240 offset:0
ds_read_b128 v[196:199], v240 offset:256
ds_read_b128 v[200:203], v240 offset:512
ds_read_b128 v[204:207], v240 offset:768
v_mfma_f32_16x16x32_bf16 v[48:51], a[140:143], a[56:59], v[48:51]
v_mfma_f32_16x16x32_bf16 v[40:43], a[140:143], a[52:55], v[40:43]
v_mfma_f32_16x16x32_bf16 v[32:35], a[140:143], a[48:51], v[32:35]
s_waitcnt lgkmcnt(4)
v_mfma_f32_16x16x32_bf16 v[32:35], a[96:99], a[64:67], v[32:35]
ds_read_b64 a[128:129], v224 offset:12288
ds_read_b64 a[130:131], v225 offset:12288
v_mfma_f32_16x16x32_bf16 v[40:43], a[96:99], a[68:71], v[40:43]
ds_read_b64 a[132:133], v224 offset:14336
ds_read_b64 a[134:135], v225 offset:14336
v_mfma_f32_16x16x32_bf16 v[48:51], a[96:99], a[72:75], v[48:51]
ds_read_b64 a[136:137], v226 offset:14336
v_mfma_f32_16x16x32_bf16 v[52:55], a[100:103], a[72:75], v[52:55]
ds_read_b64 a[138:139], v227 offset:14336
s_waitcnt lgkmcnt(6)
v_max3_f32 v250, v192, v196, v200
v_max3_f32 v251, v193, v197, v201
v_max3_f32 v252, v194, v198, v202
v_accvgpr_read_b32 v192, a244
v_accvgpr_read_b32 v193, a245
v_accvgpr_read_b32 v194, a246
v_max3_f32 v250, v250, v204, v192
v_max3_f32 v251, v251, v205, v193
v_max3_f32 v252, v252, v206, v194
v_mul_f32 v250, s63, v250
v_mul_f32 v251, s63, v251
v_mfma_f32_16x16x32_bf16 v[44:47], a[100:103], a[68:71], v[44:47]
ds_read_b64 a[140:141], v226 offset:12288
buffer_load_dwordx4 v215, s[24:27], s58 offen offset:3072 lds
v_mul_f32 v252, s63, v252
v_mfma_f32_16x16x32_bf16 v[36:39], a[100:103], a[64:67], v[36:39]
ds_read_b64 a[142:143], v227 offset:12288
s_add_u32 m0, s53, 20480
v_fma_f32 v0, v0, s63, -v250
v_fma_f32 v1, v1, s63, -v250
v_mfma_f32_16x16x32_bf16 v[36:39], a[104:107], a[80:83], v[36:39]
s_add_u32 s58, s57, 32768
v_fma_f32 v2, v2, s63, -v250
v_fma_f32 v3, v3, s63, -v250
v_mfma_f32_16x16x32_bf16 v[44:47], a[104:107], a[84:87], v[44:47]
buffer_load_dwordx4 v212, s[24:27], s58 offen lds
v_fma_f32 v4, v4, s63, -v250
v_mfma_f32_16x16x32_bf16 v[52:55], a[104:107], a[88:91], v[52:55]
v_fma_f32 v5, v5, s63, -v250
v_fma_f32 v6, v6, s63, -v250
v_fma_f32 v7, v7, s63, -v250
v_mfma_f32_16x16x32_bf16 v[48:51], a[108:111], a[88:91], v[48:51]
buffer_load_dwordx4 v213, s[24:27], s58 offen offset:1024 lds
v_exp_f32 v0, v0
v_mfma_f32_16x16x32_bf16 v[40:43], a[108:111], a[84:87], v[40:43]
v_exp_f32 v1, v1
v_mfma_f32_16x16x32_bf16 v[32:35], a[108:111], a[80:83], v[32:35]
v_exp_f32 v2, v2
v_exp_f32 v3, v3
s_waitcnt lgkmcnt(0)
v_mfma_f32_16x16x32_bf16 v[64:67], a[128:131], a[0:3], v[64:67]
buffer_load_dwordx4 v214, s[24:27], s58 offen offset:2048 lds
buffer_load_dwordx4 v215, s[24:27], s58 offen offset:3072 lds
s_add_u32 m0, s53, 8192
s_add_u32 s58, s54, 49152
buffer_load_dwordx4 v212, s[24:27], s58 offen lds
buffer_load_dwordx4 v213, s[24:27], s58 offen offset:1024 lds
buffer_load_dwordx4 v214, s[24:27], s58 offen offset:2048 lds
buffer_load_dwordx4 v215, s[24:27], s58 offen offset:3072 lds
s_waitcnt vmcnt(8)
v_mfma_f32_16x16x32_bf16 v[72:75], a[128:131], a[4:7], v[72:75]
ds_read_b64 a[96:97], v224 offset:16384
ds_read_b64 a[98:99], v225 offset:16384
v_exp_f32 v4, v4
v_mfma_f32_16x16x32_bf16 v[80:83], a[128:131], a[8:11], v[80:83]
ds_read_b64 a[100:101], v224 offset:18432
ds_read_b64 a[102:103], v225 offset:18432
v_exp_f32 v5, v5
v_mfma_f32_16x16x32_bf16 v[84:87], a[132:135], a[8:11], v[84:87]
s_add_u32 m0, s53, 12288
s_add_u32 s58, s55, 49152
buffer_load_dwordx4 v212, s[24:27], s58 offen lds
v_mfma_f32_16x16x32_bf16 v[76:79], a[132:135], a[4:7], v[76:79]
ds_read_b64 a[104:105], v226 offset:18432
ds_read_b64 a[106:107], v227 offset:18432
v_exp_f32 v6, v6
v_mfma_f32_16x16x32_bf16 v[68:71], a[132:135], a[0:3], v[68:71]
ds_read_b64 a[108:109], v226 offset:16384
ds_read_b64 a[110:111], v227 offset:16384
v_exp_f32 v7, v7
v_mfma_f32_16x16x32_bf16 v[68:71], a[136:139], a[16:19], v[68:71]
buffer_load_dwordx4 v213, s[24:27], s58 offen offset:1024 lds
v_cvt_pk_bf16_f32 v196, v0, v1
v_mfma_f32_16x16x32_bf16 v[76:79], a[136:139], a[20:23], v[76:79]
buffer_load_dwordx4 v214, s[24:27], s58 offen offset:2048 lds
v_cvt_pk_bf16_f32 v197, v2, v3
v_cvt_pk_bf16_f32 v198, v4, v5
v_mfma_f32_16x16x32_bf16 v[84:87], a[136:139], a[24:27], v[84:87]
buffer_load_dwordx4 v215, s[24:27], s58 offen offset:3072 lds
v_cvt_pk_bf16_f32 v199, v6, v7
v_mfma_f32_16x16x32_bf16 v[80:83], a[140:143], a[24:27], v[80:83]
ds_write_b128 v235, v[196:199] offset:0
v_mfma_f32_16x16x32_bf16 a[224:227], a[240:243], v[196:199], 0
v_fma_f32 v8, v8, s63, -v251
v_fma_f32 v9, v9, s63, -v251
v_fma_f32 v10, v10, s63, -v251
v_mfma_f32_16x16x32_bf16 v[72:75], a[140:143], a[20:23], v[72:75]
v_fma_f32 v11, v11, s63, -v251
v_fma_f32 v12, v12, s63, -v251
v_fma_f32 v13, v13, s63, -v251
v_fma_f32 v14, v14, s63, -v251
v_mfma_f32_16x16x32_bf16 v[64:67], a[140:143], a[16:19], v[64:67]
v_fma_f32 v15, v15, s63, -v251
s_waitcnt lgkmcnt(1)
v_mfma_f32_16x16x32_bf16 v[64:67], a[96:99], a[32:35], v[64:67]
s_waitcnt vmcnt(8)
ds_read_b64 a[128:129], v224 offset:20480
v_exp_f32 v8, v8
v_mfma_f32_16x16x32_bf16 v[72:75], a[96:99], a[36:39], v[72:75]
ds_read_b64 a[130:131], v225 offset:20480
ds_read_b64 a[132:133], v224 offset:22528
v_exp_f32 v9, v9
v_mfma_f32_16x16x32_bf16 v[80:83], a[96:99], a[40:43], v[80:83]
ds_read_b64 a[134:135], v225 offset:22528
ds_read_b64 a[136:137], v226 offset:22528
v_mfma_f32_16x16x32_bf16 v[84:87], a[100:103], a[40:43], v[84:87]
s_add_u32 m0, s53, 16384
s_mov_b32 s58, 131072
buffer_load_dwordx4 v216, s[28:31], s58 offen lds
v_exp_f32 v10, v10
v_mfma_f32_16x16x32_bf16 v[76:79], a[100:103], a[36:39], v[76:79]
ds_read_b64 a[138:139], v227 offset:22528
ds_read_b64 a[140:141], v226 offset:20480
v_exp_f32 v11, v11
v_mfma_f32_16x16x32_bf16 v[68:71], a[100:103], a[32:35], v[68:71]
ds_read_b64 a[142:143], v227 offset:20480
v_exp_f32 v12, v12
v_mfma_f32_16x16x32_bf16 v[68:71], a[104:107], a[48:51], v[68:71]
buffer_load_dwordx4 v217, s[28:31], s58 offen offset:1024 lds
v_exp_f32 v13, v13
v_mfma_f32_16x16x32_bf16 v[76:79], a[104:107], a[52:55], v[76:79]
buffer_load_dwordx4 v218, s[28:31], s58 offen offset:2048 lds
v_mfma_f32_16x16x32_bf16 v[84:87], a[104:107], a[56:59], v[84:87]
v_exp_f32 v14, v14
v_exp_f32 v15, v15
v_mfma_f32_16x16x32_bf16 v[80:83], a[108:111], a[56:59], v[80:83]
buffer_load_dwordx4 v219, s[28:31], s58 offen offset:3072 lds
v_cvt_pk_bf16_f32 v192, v8, v9
v_cvt_pk_bf16_f32 v193, v10, v11
v_mfma_f32_16x16x32_bf16 v[72:75], a[108:111], a[52:55], v[72:75]
v_cvt_pk_bf16_f32 v194, v12, v13
v_cvt_pk_bf16_f32 v195, v14, v15
v_mfma_f32_16x16x32_bf16 v[64:67], a[108:111], a[48:51], v[64:67]
ds_write_b128 v235, v[192:195] offset:1024
v_mfma_f32_16x16x32_bf16 a[228:231], a[240:243], v[192:195], 0
v_fma_f32 v16, v16, s63, -v252
v_fma_f32 v17, v17, s63, -v252
v_fma_f32 v18, v18, s63, -v252
v_fma_f32 v19, v19, s63, -v252
s_waitcnt lgkmcnt(1)
v_mfma_f32_16x16x32_bf16 v[64:67], a[128:131], a[64:67], v[64:67]
s_waitcnt vmcnt(8)
ds_read_b64 a[96:97], v224 offset:8192
v_fma_f32 v20, v20, s63, -v252
v_mfma_f32_16x16x32_bf16 v[72:75], a[128:131], a[68:71], v[72:75]
ds_read_b64 a[98:99], v225 offset:8192
ds_read_b64 a[100:101], v224 offset:10240
v_fma_f32 v21, v21, s63, -v252
v_mfma_f32_16x16x32_bf16 v[80:83], a[128:131], a[72:75], v[80:83]
ds_read_b64 a[102:103], v225 offset:10240
ds_read_b64 a[104:105], v226 offset:10240
v_fma_f32 v22, v22, s63, -v252
v_fma_f32 v23, v23, s63, -v252
v_mfma_f32_16x16x32_bf16 v[84:87], a[132:135], a[72:75], v[84:87]
s_add_u32 m0, s53, 20480
s_mov_b32 s58, 196608
buffer_load_dwordx4 v216, s[28:31], s58 offen lds
v_mfma_f32_16x16x32_bf16 v[76:79], a[132:135], a[68:71], v[76:79]
ds_read_b64 a[106:107], v227 offset:10240
ds_read_b64 a[108:109], v226 offset:8192
v_exp_f32 v16, v16
v_mfma_f32_16x16x32_bf16 v[68:71], a[132:135], a[64:67], v[68:71]
ds_read_b64 a[110:111], v227 offset:8192
v_exp_f32 v17, v17
v_mfma_f32_16x16x32_bf16 v[68:71], a[136:139], a[80:83], v[68:71]
buffer_load_dwordx4 v217, s[28:31], s58 offen offset:1024 lds
v_exp_f32 v18, v18
v_mfma_f32_16x16x32_bf16 v[76:79], a[136:139], a[84:87], v[76:79]
buffer_load_dwordx4 v218, s[28:31], s58 offen offset:2048 lds
v_mfma_f32_16x16x32_bf16 v[84:87], a[136:139], a[88:91], v[84:87]
v_exp_f32 v19, v19
v_exp_f32 v20, v20
v_mfma_f32_16x16x32_bf16 v[80:83], a[140:143], a[88:91], v[80:83]
buffer_load_dwordx4 v219, s[28:31], s58 offen offset:3072 lds
v_exp_f32 v21, v21
v_mfma_f32_16x16x32_bf16 v[72:75], a[140:143], a[84:87], v[72:75]
v_exp_f32 v22, v22
v_exp_f32 v23, v23
v_mfma_f32_16x16x32_bf16 v[64:67], a[140:143], a[80:83], v[64:67]
v_cvt_pk_bf16_f32 v196, v16, v17
v_cvt_pk_bf16_f32 v197, v18, v19
s_waitcnt lgkmcnt(0)
v_mfma_f32_16x16x32_bf16 v[96:99], a[96:99], v[128:131], 0
s_waitcnt vmcnt(8)
ds_read_b64 a[128:129], v224 offset:12288
v_cvt_pk_bf16_f32 v198, v20, v21
v_mfma_f32_16x16x32_bf16 v[104:107], a[96:99], v[136:139], 0
ds_read_b64 a[130:131], v225 offset:12288
ds_read_b64 a[132:133], v224 offset:14336
v_cvt_pk_bf16_f32 v199, v22, v23
v_mfma_f32_16x16x32_bf16 v[112:115], a[96:99], v[144:147], 0
ds_read_b64 a[134:135], v225 offset:14336
ds_read_b64 a[136:137], v226 offset:14336
ds_write_b128 v235, v[196:199] offset:2048
v_mfma_f32_16x16x32_bf16 v[116:119], a[100:103], v[144:147], 0
s_add_u32 m0, s53, 8192
s_mov_b32 s58, 0
buffer_load_dwordx4 v216, s[28:31], s58 offen lds
v_mfma_f32_16x16x32_bf16 a[232:235], a[240:243], v[196:199], 0
v_max3_f32 v242, v32, v33, v242
v_max3_f32 v243, v40, v41, v243
v_max3_f32 v244, v48, v49, v244
v_mfma_f32_16x16x32_bf16 v[108:111], a[100:103], v[136:139], 0
ds_read_b64 a[138:139], v227 offset:14336
ds_read_b64 a[140:141], v226 offset:12288
v_max3_f32 v242, v34, v35, v242
v_max3_f32 v243, v42, v43, v243
v_mfma_f32_16x16x32_bf16 v[100:103], a[100:103], v[128:131], 0
ds_read_b64 a[142:143], v227 offset:12288
v_max3_f32 v244, v50, v51, v244
v_max3_f32 v242, v36, v37, v242
v_mfma_f32_16x16x32_bf16 v[100:103], a[104:107], v[160:163], v[100:103]
buffer_load_dwordx4 v217, s[28:31], s58 offen offset:1024 lds
v_max3_f32 v243, v44, v45, v243
v_mfma_f32_16x16x32_bf16 v[108:111], a[104:107], v[168:171], v[108:111]
buffer_load_dwordx4 v218, s[28:31], s58 offen offset:2048 lds
v_max3_f32 v244, v52, v53, v244
v_max3_f32 v242, v38, v39, v242
v_mfma_f32_16x16x32_bf16 v[116:119], a[104:107], v[176:179], v[116:119]
v_max3_f32 v243, v46, v47, v243
v_max3_f32 v244, v54, v55, v244
v_fma_f32 v32, v32, s63, -v250
v_mfma_f32_16x16x32_bf16 v[112:115], a[108:111], v[176:179], v[112:115]
v_fma_f32 v33, v33, s63, -v250
v_fma_f32 v34, v34, s63, -v250
v_fma_f32 v35, v35, s63, -v250
v_mfma_f32_16x16x32_bf16 v[104:107], a[108:111], v[168:171], v[104:107]
v_fma_f32 v36, v36, s63, -v250
v_fma_f32 v37, v37, s63, -v250
v_fma_f32 v38, v38, s63, -v250
v_fma_f32 v39, v39, s63, -v250
v_mfma_f32_16x16x32_bf16 v[96:99], a[108:111], v[160:163], v[96:99]
v_exp_f32 v32, v32
s_waitcnt lgkmcnt(0)
v_mfma_f32_16x16x32_bf16 v[96:99], a[128:131], a[0:3], v[96:99]
ds_read_b64 a[96:97], v224 offset:0
ds_read_b64 a[98:99], v225 offset:0
v_mfma_f32_16x16x32_bf16 v[104:107], a[128:131], a[4:7], v[104:107]
ds_read_b64 a[100:101], v224 offset:2048
ds_read_b64 a[102:103], v225 offset:2048
v_exp_f32 v33, v33
v_mfma_f32_16x16x32_bf16 v[112:115], a[128:131], a[8:11], v[112:115]
ds_read_b64 a[104:105], v226 offset:2048
v_exp_f32 v34, v34
v_mfma_f32_16x16x32_bf16 v[116:119], a[132:135], a[8:11], v[116:119]
ds_read_b64 a[106:107], v227 offset:2048
v_exp_f32 v35, v35
v_mfma_f32_16x16x32_bf16 v[108:111], a[132:135], a[4:7], v[108:111]
ds_read_b64 a[108:109], v226 offset:0
v_exp_f32 v36, v36
v_exp_f32 v37, v37
v_mfma_f32_16x16x32_bf16 v[100:103], a[132:135], a[0:3], v[100:103]
ds_read_b64 a[110:111], v227 offset:0
v_exp_f32 v38, v38
v_mfma_f32_16x16x32_bf16 v[100:103], a[136:139], a[16:19], v[100:103]
v_exp_f32 v39, v39
v_cvt_pk_bf16_f32 v192, v32, v33
v_mfma_f32_16x16x32_bf16 v[108:111], a[136:139], a[20:23], v[108:111]
v_cvt_pk_bf16_f32 v193, v34, v35
v_cvt_pk_bf16_f32 v194, v36, v37
v_cvt_pk_bf16_f32 v195, v38, v39
v_mfma_f32_16x16x32_bf16 v[116:119], a[136:139], a[24:27], v[116:119]
ds_write_b128 v235, v[192:195] offset:4096
v_mfma_f32_16x16x32_bf16 a[224:227], a[240:243], v[192:195], a[224:227]
v_fma_f32 v40, v40, s63, -v251
v_fma_f32 v41, v41, s63, -v251
v_fma_f32 v42, v42, s63, -v251
v_fma_f32 v43, v43, s63, -v251
v_mfma_f32_16x16x32_bf16 v[112:115], a[140:143], a[24:27], v[112:115]
v_fma_f32 v44, v44, s63, -v251
v_fma_f32 v45, v45, s63, -v251
v_fma_f32 v46, v46, s63, -v251
v_mfma_f32_16x16x32_bf16 v[104:107], a[140:143], a[20:23], v[104:107]
v_fma_f32 v47, v47, s63, -v251
v_exp_f32 v40, v40
v_mfma_f32_16x16x32_bf16 v[96:99], a[140:143], a[16:19], v[96:99]
v_exp_f32 v41, v41
s_waitcnt lgkmcnt(1)
v_mfma_f32_16x16x32_bf16 v[96:99], a[96:99], a[32:35], v[96:99]
ds_read_b64 a[128:129], v224 offset:4096
ds_read_b64 a[130:131], v225 offset:4096
v_exp_f32 v42, v42
v_mfma_f32_16x16x32_bf16 v[104:107], a[96:99], a[36:39], v[104:107]
ds_read_b64 a[132:133], v224 offset:6144
ds_read_b64 a[134:135], v225 offset:6144
buffer_load_dwordx4 v219, s[28:31], s58 offen offset:3072 lds
v_mfma_f32_16x16x32_bf16 v[112:115], a[96:99], a[40:43], v[112:115]
ds_read_b64 a[136:137], v226 offset:6144
s_add_u32 m0, s53, 12288
v_exp_f32 v43, v43
v_mfma_f32_16x16x32_bf16 v[116:119], a[100:103], a[40:43], v[116:119]
s_mov_b32 s58, 65536
ds_read_b64 a[138:139], v227 offset:6144
v_exp_f32 v44, v44
v_mfma_f32_16x16x32_bf16 v[108:111], a[100:103], a[36:39], v[108:111]
ds_read_b64 a[140:141], v226 offset:4096
v_exp_f32 v45, v45
v_mfma_f32_16x16x32_bf16 v[100:103], a[100:103], a[32:35], v[100:103]
ds_read_b64 a[142:143], v227 offset:4096
v_exp_f32 v46, v46
v_mfma_f32_16x16x32_bf16 v[100:103], a[104:107], a[48:51], v[100:103]
buffer_load_dwordx4 v216, s[28:31], s58 offen lds
v_exp_f32 v47, v47
v_mfma_f32_16x16x32_bf16 v[108:111], a[104:107], a[52:55], v[108:111]
buffer_load_dwordx4 v217, s[28:31], s58 offen offset:1024 lds
v_cvt_pk_bf16_f32 v196, v40, v41
v_mfma_f32_16x16x32_bf16 v[116:119], a[104:107], a[56:59], v[116:119]
v_cvt_pk_bf16_f32 v197, v42, v43
v_cvt_pk_bf16_f32 v198, v44, v45
v_cvt_pk_bf16_f32 v199, v46, v47
v_mfma_f32_16x16x32_bf16 v[112:115], a[108:111], a[56:59], v[112:115]
buffer_load_dwordx4 v218, s[28:31], s58 offen offset:2048 lds
ds_write_b128 v235, v[196:199] offset:5120
v_mfma_f32_16x16x32_bf16 v[104:107], a[108:111], a[52:55], v[104:107]
v_mfma_f32_16x16x32_bf16 a[228:231], a[240:243], v[196:199], a[228:231]
v_fma_f32 v48, v48, s63, -v252
v_fma_f32 v49, v49, s63, -v252
v_fma_f32 v50, v50, s63, -v252
v_mfma_f32_16x16x32_bf16 v[96:99], a[108:111], a[48:51], v[96:99]
v_fma_f32 v51, v51, s63, -v252
v_fma_f32 v52, v52, s63, -v252
s_waitcnt lgkmcnt(1)
v_mfma_f32_16x16x32_bf16 v[96:99], a[128:131], a[64:67], v[96:99]
s_waitcnt lgkmcnt(0)
s_barrier
buffer_load_dwordx4 v219, s[28:31], s58 offen offset:3072 lds
v_fma_f32 v53, v53, s63, -v252
v_mfma_f32_16x16x32_bf16 v[104:107], a[128:131], a[68:71], v[104:107]
s_add_u32 m0, s53, 0
s_mov_b32 s58, 32768
buffer_load_dwordx4 v216, s[28:31], s58 offen lds
buffer_load_dwordx4 v217, s[28:31], s58 offen offset:1024 lds
buffer_load_dwordx4 v218, s[28:31], s58 offen offset:2048 lds
buffer_load_dwordx4 v219, s[28:31], s58 offen offset:3072 lds
s_waitcnt vmcnt(8)
v_fma_f32 v54, v54, s63, -v252
v_fma_f32 v55, v55, s63, -v252
v_mfma_f32_16x16x32_bf16 v[112:115], a[128:131], a[72:75], v[112:115]
ds_read_b64_tr_b16 a[96:97], v230 offset:8192
ds_read_b64_tr_b16 a[98:99], v230 offset:10240
v_mfma_f32_16x16x32_bf16 v[116:119], a[132:135], a[72:75], v[116:119]
s_add_u32 m0, s53, 4096
s_mov_b32 s58, 98304
buffer_load_dwordx4 v216, s[28:31], s58 offen lds
v_exp_f32 v48, v48
v_mfma_f32_16x16x32_bf16 v[108:111], a[132:135], a[68:71], v[108:111]
ds_read_b128 a[112:115], v234 offset:0
ds_read_b128 a[116:119], v234 offset:1024
v_exp_f32 v49, v49
v_mfma_f32_16x16x32_bf16 v[100:103], a[132:135], a[64:67], v[100:103]
ds_read_b128 a[120:123], v234 offset:2048
ds_read_b64_tr_b16 a[100:101], v231 offset:8192
v_mfma_f32_16x16x32_bf16 v[100:103], a[136:139], a[80:83], v[100:103]
ds_read_b64_tr_b16 a[102:103], v231 offset:10240
ds_read_b64_tr_b16 a[104:105], v232 offset:8192
v_exp_f32 v50, v50
v_mfma_f32_16x16x32_bf16 v[108:111], a[136:139], a[84:87], v[108:111]
ds_read_b64_tr_b16 a[106:107], v232 offset:10240
ds_read_b64_tr_b16 a[108:109], v233 offset:8192
v_mfma_f32_16x16x32_bf16 v[116:119], a[136:139], a[88:91], v[116:119]
ds_read_b64_tr_b16 a[110:111], v233 offset:10240
buffer_load_dwordx4 v217, s[28:31], s58 offen offset:1024 lds
v_exp_f32 v51, v51
v_mfma_f32_16x16x32_bf16 v[112:115], a[140:143], a[88:91], v[112:115]
buffer_load_dwordx4 v218, s[28:31], s58 offen offset:2048 lds
v_exp_f32 v52, v52
v_mfma_f32_16x16x32_bf16 v[104:107], a[140:143], a[84:87], v[104:107]
buffer_load_dwordx4 v219, s[28:31], s58 offen offset:3072 lds
v_mfma_f32_16x16x32_bf16 v[96:99], a[140:143], a[80:83], v[96:99]
v_exp_f32 v53, v53
v_exp_f32 v54, v54
s_waitcnt lgkmcnt(6)
v_mfma_f32_16x16x32_bf16 v[128:131], a[96:99], a[112:115], 0
s_waitcnt vmcnt(8)
v_mfma_f32_16x16x32_bf16 v[136:139], a[96:99], a[116:119], 0
ds_read_b64_tr_b16 a[128:129], v230 offset:12288
ds_read_b64_tr_b16 a[130:131], v230 offset:14336
v_exp_f32 v55, v55
v_mfma_f32_16x16x32_bf16 v[144:147], a[96:99], a[120:123], 0
ds_read_b128 a[144:147], v234 offset:16384
v_cvt_pk_bf16_f32 v192, v48, v49
v_cvt_pk_bf16_f32 v193, v50, v51
s_waitcnt lgkmcnt(3)
v_mfma_f32_16x16x32_bf16 v[148:151], a[100:103], a[120:123], 0
s_add_u32 m0, s53, 8192
s_mov_b32 s58, 16384
buffer_load_dwordx4 v216, s[28:31], s58 offen lds
v_cvt_pk_bf16_f32 v194, v52, v53
v_mfma_f32_16x16x32_bf16 v[140:143], a[100:103], a[116:119], 0
ds_read_b128 a[148:151], v234 offset:17408
ds_read_b128 a[152:155], v234 offset:18432
v_cvt_pk_bf16_f32 v195, v54, v55
v_mfma_f32_16x16x32_bf16 v[132:135], a[100:103], a[112:115], 0
ds_read_b64_tr_b16 a[132:133], v231 offset:12288
ds_read_b64_tr_b16 a[134:135], v231 offset:14336
ds_write_b128 v235, v[192:195] offset:6144
v_mfma_f32_16x16x32_bf16 v[160:163], a[104:107], a[112:115], 0
ds_read_b64_tr_b16 a[136:137], v232 offset:12288
ds_read_b64_tr_b16 a[138:139], v232 offset:14336
v_mfma_f32_16x16x32_bf16 a[232:235], a[240:243], v[192:195], a[232:235]
v_max3_f32 v242, v64, v65, v242
v_max3_f32 v243, v72, v73, v243
v_max3_f32 v244, v80, v81, v244
v_mfma_f32_16x16x32_bf16 v[168:171], a[104:107], a[116:119], 0
buffer_load_dwordx4 v217, s[28:31], s58 offen offset:1024 lds
v_max3_f32 v242, v66, v67, v242
v_mfma_f32_16x16x32_bf16 v[176:179], a[104:107], a[120:123], 0
ds_read_b64_tr_b16 a[140:141], v233 offset:12288
ds_read_b64_tr_b16 a[142:143], v233 offset:14336
v_max3_f32 v243, v74, v75, v243
v_max3_f32 v244, v82, v83, v244
v_mfma_f32_16x16x32_bf16 v[180:183], a[108:111], a[120:123], 0
buffer_load_dwordx4 v218, s[28:31], s58 offen offset:2048 lds
v_max3_f32 v242, v68, v69, v242
v_mfma_f32_16x16x32_bf16 v[172:175], a[108:111], a[116:119], 0
v_max3_f32 v243, v76, v77, v243
v_max3_f32 v244, v84, v85, v244
v_max3_f32 v242, v70, v71, v242
v_mfma_f32_16x16x32_bf16 v[164:167], a[108:111], a[112:115], 0
v_max3_f32 v243, v78, v79, v243
v_max3_f32 v244, v86, v87, v244
s_waitcnt lgkmcnt(7)
v_mfma_f32_16x16x32_bf16 v[128:131], a[128:131], a[144:147], v[128:131]
ds_read_b64_tr_b16 a[96:97], v230 offset:16384
ds_read_b64_tr_b16 a[98:99], v230 offset:18432
v_fma_f32 v64, v64, s63, -v250
v_fma_f32 v65, v65, s63, -v250
v_mfma_f32_16x16x32_bf16 v[136:139], a[128:131], a[148:151], v[136:139]
ds_read_b128 a[112:115], v234 offset:32768
ds_read_b128 a[116:119], v234 offset:33792
v_fma_f32 v66, v66, s63, -v250
v_mfma_f32_16x16x32_bf16 v[144:147], a[128:131], a[152:155], v[144:147]
ds_read_b128 a[120:123], v234 offset:34816
v_fma_f32 v67, v67, s63, -v250
s_waitcnt lgkmcnt(5)
v_mfma_f32_16x16x32_bf16 v[148:151], a[132:135], a[152:155], v[148:151]
ds_read_b64_tr_b16 a[100:101], v231 offset:16384
ds_read_b64_tr_b16 a[102:103], v231 offset:18432
v_fma_f32 v68, v68, s63, -v250
v_fma_f32 v69, v69, s63, -v250
v_mfma_f32_16x16x32_bf16 v[140:143], a[132:135], a[148:151], v[140:143]
ds_read_b64_tr_b16 a[104:105], v232 offset:16384
ds_read_b64_tr_b16 a[106:107], v232 offset:18432
v_fma_f32 v70, v70, s63, -v250
v_mfma_f32_16x16x32_bf16 v[132:135], a[132:135], a[144:147], v[132:135]
ds_read_b64_tr_b16 a[108:109], v233 offset:16384
v_fma_f32 v71, v71, s63, -v250
v_mfma_f32_16x16x32_bf16 v[160:163], a[136:139], a[144:147], v[160:163]
ds_read_b64_tr_b16 a[110:111], v233 offset:18432
v_exp_f32 v64, v64
v_exp_f32 v65, v65
v_mfma_f32_16x16x32_bf16 v[168:171], a[136:139], a[148:151], v[168:171]
buffer_load_dwordx4 v219, s[28:31], s58 offen offset:3072 lds
v_mfma_f32_16x16x32_bf16 v[176:179], a[136:139], a[152:155], v[176:179]
s_add_u32 m0, s53, 12288
s_mov_b32 s58, 81920
v_exp_f32 v66, v66
v_mfma_f32_16x16x32_bf16 v[180:183], a[140:143], a[152:155], v[180:183]
buffer_load_dwordx4 v216, s[28:31], s58 offen lds
v_exp_f32 v67, v67
v_mfma_f32_16x16x32_bf16 v[172:175], a[140:143], a[148:151], v[172:175]
v_exp_f32 v68, v68
v_mfma_f32_16x16x32_bf16 v[164:167], a[140:143], a[144:147], v[164:167]
v_exp_f32 v69, v69
v_exp_f32 v70, v70
s_waitcnt lgkmcnt(0)
v_mfma_f32_16x16x32_bf16 v[128:131], a[96:99], a[112:115], v[128:131]
ds_read_b64_tr_b16 a[128:129], v230 offset:20480
ds_read_b64_tr_b16 a[130:131], v230 offset:22528
v_mfma_f32_16x16x32_bf16 v[136:139], a[96:99], a[116:119], v[136:139]
ds_read_b128 a[144:147], v234 offset:49152
ds_read_b128 a[148:151], v234 offset:50176
v_exp_f32 v71, v71
v_mfma_f32_16x16x32_bf16 v[144:147], a[96:99], a[120:123], v[144:147]
ds_read_b128 a[152:155], v234 offset:51200
ds_read_b64_tr_b16 a[132:133], v231 offset:20480
buffer_load_dwordx4 v217, s[28:31], s58 offen offset:1024 lds
v_cvt_pk_bf16_f32 v196, v64, v65
v_cvt_pk_bf16_f32 v197, v66, v67
v_mfma_f32_16x16x32_bf16 v[148:151], a[100:103], a[120:123], v[148:151]
buffer_load_dwordx4 v218, s[28:31], s58 offen offset:2048 lds
v_cvt_pk_bf16_f32 v198, v68, v69
v_mfma_f32_16x16x32_bf16 v[140:143], a[100:103], a[116:119], v[140:143]
ds_read_b64_tr_b16 a[134:135], v231 offset:22528
ds_read_b64_tr_b16 a[136:137], v232 offset:20480
v_cvt_pk_bf16_f32 v199, v70, v71
v_mfma_f32_16x16x32_bf16 v[132:135], a[100:103], a[112:115], v[132:135]
ds_read_b64_tr_b16 a[138:139], v232 offset:22528
ds_read_b64_tr_b16 a[140:141], v233 offset:20480
ds_write_b128 v235, v[196:199] offset:8192
v_mfma_f32_16x16x32_bf16 v[160:163], a[104:107], a[112:115], v[160:163]
ds_read_b64_tr_b16 a[142:143], v233 offset:22528
v_mfma_f32_16x16x32_bf16 a[224:227], a[240:243], v[196:199], a[224:227]
v_fma_f32 v72, v72, s63, -v251
v_fma_f32 v73, v73, s63, -v251
v_fma_f32 v74, v74, s63, -v251
v_mfma_f32_16x16x32_bf16 v[168:171], a[104:107], a[116:119], v[168:171]
v_fma_f32 v75, v75, s63, -v251
v_fma_f32 v76, v76, s63, -v251
v_fma_f32 v77, v77, s63, -v251
v_mfma_f32_16x16x32_bf16 v[176:179], a[104:107], a[120:123], v[176:179]
v_fma_f32 v78, v78, s63, -v251
v_fma_f32 v79, v79, s63, -v251
v_exp_f32 v72, v72
v_mfma_f32_16x16x32_bf16 v[180:183], a[108:111], a[120:123], v[180:183]
v_exp_f32 v73, v73
v_mfma_f32_16x16x32_bf16 v[172:175], a[108:111], a[116:119], v[172:175]
v_exp_f32 v74, v74
v_exp_f32 v75, v75
v_mfma_f32_16x16x32_bf16 v[164:167], a[108:111], a[112:115], v[164:167]
v_exp_f32 v76, v76
s_waitcnt lgkmcnt(0)
v_mfma_f32_16x16x32_bf16 v[128:131], a[128:131], a[144:147], v[128:131]
s_barrier
buffer_load_dwordx4 v219, s[28:31], s58 offen offset:3072 lds
v_exp_f32 v77, v77
v_mfma_f32_16x16x32_bf16 v[136:139], a[128:131], a[148:151], v[136:139]
s_add_u32 m0, s53, 16384
s_mov_b32 s58, 147456
buffer_load_dwordx4 v216, s[28:31], s58 offen lds
buffer_load_dwordx4 v217, s[28:31], s58 offen offset:1024 lds
buffer_load_dwordx4 v218, s[28:31], s58 offen offset:2048 lds
buffer_load_dwordx4 v219, s[28:31], s58 offen offset:3072 lds
s_waitcnt vmcnt(8)
v_mfma_f32_16x16x32_bf16 v[144:147], a[128:131], a[152:155], v[144:147]
ds_read_b64_tr_b16 a[96:97], v230 offset:8192
ds_read_b64_tr_b16 a[98:99], v230 offset:10240
v_exp_f32 v78, v78
v_mfma_f32_16x16x32_bf16 v[148:151], a[132:135], a[152:155], v[148:151]
s_add_u32 m0, s53, 20480
s_mov_b32 s58, 212992
buffer_load_dwordx4 v216, s[28:31], s58 offen lds
v_exp_f32 v79, v79
v_mfma_f32_16x16x32_bf16 v[140:143], a[132:135], a[148:151], v[140:143]
ds_read_b128 a[112:115], v234 offset:4096
ds_read_b128 a[116:119], v234 offset:5120
v_cvt_pk_bf16_f32 v192, v72, v73
v_mfma_f32_16x16x32_bf16 v[132:135], a[132:135], a[144:147], v[132:135]
ds_read_b128 a[120:123], v234 offset:6144
ds_read_b64_tr_b16 a[100:101], v231 offset:8192
v_cvt_pk_bf16_f32 v193, v74, v75
v_cvt_pk_bf16_f32 v194, v76, v77
v_mfma_f32_16x16x32_bf16 v[160:163], a[136:139], a[144:147], v[160:163]
ds_read_b64_tr_b16 a[102:103], v231 offset:10240
ds_read_b64_tr_b16 a[104:105], v232 offset:8192
v_cvt_pk_bf16_f32 v195, v78, v79
v_mfma_f32_16x16x32_bf16 v[168:171], a[136:139], a[148:151], v[168:171]
ds_read_b64_tr_b16 a[106:107], v232 offset:10240
ds_read_b64_tr_b16 a[108:109], v233 offset:8192
v_mfma_f32_16x16x32_bf16 v[176:179], a[136:139], a[152:155], v[176:179]
ds_read_b64_tr_b16 a[110:111], v233 offset:10240
buffer_load_dwordx4 v217, s[28:31], s58 offen offset:1024 lds
ds_write_b128 v235, v[192:195] offset:9216
v_mfma_f32_16x16x32_bf16 a[228:231], a[240:243], v[192:195], a[228:231]
v_fma_f32 v80, v80, s63, -v252
v_fma_f32 v81, v81, s63, -v252
v_fma_f32 v82, v82, s63, -v252
v_mfma_f32_16x16x32_bf16 v[180:183], a[140:143], a[152:155], v[180:183]
buffer_load_dwordx4 v218, s[28:31], s58 offen offset:2048 lds
v_fma_f32 v83, v83, s63, -v252
v_mfma_f32_16x16x32_bf16 v[172:175], a[140:143], a[148:151], v[172:175]
buffer_load_dwordx4 v219, s[28:31], s58 offen offset:3072 lds
v_fma_f32 v84, v84, s63, -v252
v_mfma_f32_16x16x32_bf16 v[164:167], a[140:143], a[144:147], v[164:167]
v_fma_f32 v85, v85, s63, -v252
v_fma_f32 v86, v86, s63, -v252
v_fma_f32 v87, v87, s63, -v252
s_waitcnt lgkmcnt(1)
v_mfma_f32_16x16x32_bf16 v[128:131], a[96:99], a[112:115], v[128:131]
s_waitcnt vmcnt(8)
ds_read_b64_tr_b16 a[128:129], v230 offset:12288
v_mfma_f32_16x16x32_bf16 v[136:139], a[96:99], a[116:119], v[136:139]
ds_read_b64_tr_b16 a[130:131], v230 offset:14336
ds_read_b128 a[144:147], v234 offset:20480
v_exp_f32 v80, v80
v_mfma_f32_16x16x32_bf16 v[144:147], a[96:99], a[120:123], v[144:147]
ds_read_b128 a[148:151], v234 offset:21504
ds_read_b128 a[152:155], v234 offset:22528
v_exp_f32 v81, v81
v_mfma_f32_16x16x32_bf16 v[148:151], a[100:103], a[120:123], v[148:151]
s_add_u32 m0, s53, 8192
s_mov_b32 s58, 163840
buffer_load_dwordx4 v216, s[28:31], s58 offen lds
v_mfma_f32_16x16x32_bf16 v[140:143], a[100:103], a[116:119], v[140:143]
ds_read_b64_tr_b16 a[132:133], v231 offset:12288
ds_read_b64_tr_b16 a[134:135], v231 offset:14336
v_exp_f32 v82, v82
v_mfma_f32_16x16x32_bf16 v[132:135], a[100:103], a[112:115], v[132:135]
ds_read_b64_tr_b16 a[136:137], v232 offset:12288
ds_read_b64_tr_b16 a[138:139], v232 offset:14336
v_exp_f32 v83, v83
v_mfma_f32_16x16x32_bf16 v[160:163], a[104:107], a[112:115], v[160:163]
ds_read_b64_tr_b16 a[140:141], v233 offset:12288
ds_read_b64_tr_b16 a[142:143], v233 offset:14336
v_mfma_f32_16x16x32_bf16 v[168:171], a[104:107], a[116:119], v[168:171]
buffer_load_dwordx4 v217, s[28:31], s58 offen offset:1024 lds
v_exp_f32 v84, v84
v_mfma_f32_16x16x32_bf16 v[176:179], a[104:107], a[120:123], v[176:179]
buffer_load_dwordx4 v218, s[28:31], s58 offen offset:2048 lds
v_exp_f32 v85, v85
v_mfma_f32_16x16x32_bf16 v[180:183], a[108:111], a[120:123], v[180:183]
buffer_load_dwordx4 v219, s[28:31], s58 offen offset:3072 lds
v_mfma_f32_16x16x32_bf16 v[172:175], a[108:111], a[116:119], v[172:175]
v_exp_f32 v86, v86
v_exp_f32 v87, v87
v_cvt_pk_bf16_f32 v196, v80, v81
v_mfma_f32_16x16x32_bf16 v[164:167], a[108:111], a[112:115], v[164:167]
v_cvt_pk_bf16_f32 v197, v82, v83
v_cvt_pk_bf16_f32 v198, v84, v85
s_waitcnt lgkmcnt(0)
v_mfma_f32_16x16x32_bf16 v[128:131], a[128:131], a[144:147], v[128:131]
s_waitcnt vmcnt(8)
ds_read_b64_tr_b16 a[96:97], v230 offset:16384
v_cvt_pk_bf16_f32 v199, v86, v87
v_mfma_f32_16x16x32_bf16 v[136:139], a[128:131], a[148:151], v[136:139]
ds_read_b64_tr_b16 a[98:99], v230 offset:18432
ds_read_b128 a[112:115], v234 offset:36864
ds_write_b128 v235, v[196:199] offset:10240
v_mfma_f32_16x16x32_bf16 v[144:147], a[128:131], a[152:155], v[144:147]
ds_read_b128 a[116:119], v234 offset:37888
ds_read_b128 a[120:123], v234 offset:38912
v_mfma_f32_16x16x32_bf16 a[232:235], a[240:243], v[196:199], a[232:235]
v_max3_f32 v242, v96, v97, v242
v_max3_f32 v243, v104, v105, v243
v_max3_f32 v244, v112, v113, v244
v_mfma_f32_16x16x32_bf16 v[148:151], a[132:135], a[152:155], v[148:151]
s_add_u32 m0, s53, 12288
s_mov_b32 s58, 229376
buffer_load_dwordx4 v216, s[28:31], s58 offen lds
v_max3_f32 v242, v98, v99, v242
v_max3_f32 v243, v106, v107, v243
v_mfma_f32_16x16x32_bf16 v[140:143], a[132:135], a[148:151], v[140:143]
ds_read_b64_tr_b16 a[100:101], v231 offset:16384
ds_read_b64_tr_b16 a[102:103], v231 offset:18432
v_max3_f32 v244, v114, v115, v244
v_mfma_f32_16x16x32_bf16 v[132:135], a[132:135], a[144:147], v[132:135]
ds_read_b64_tr_b16 a[104:105], v232 offset:16384
ds_read_b64_tr_b16 a[106:107], v232 offset:18432
v_max3_f32 v242, v100, v101, v242
v_mfma_f32_16x16x32_bf16 v[160:163], a[136:139], a[144:147], v[160:163]
ds_read_b64_tr_b16 a[108:109], v233 offset:16384
ds_read_b64_tr_b16 a[110:111], v233 offset:18432
v_max3_f32 v243, v108, v109, v243
v_max3_f32 v244, v116, v117, v244
v_mfma_f32_16x16x32_bf16 v[168:171], a[136:139], a[148:151], v[168:171]
buffer_load_dwordx4 v217, s[28:31], s58 offen offset:1024 lds
v_max3_f32 v242, v102, v103, v242
v_mfma_f32_16x16x32_bf16 v[176:179], a[136:139], a[152:155], v[176:179]
buffer_load_dwordx4 v218, s[28:31], s58 offen offset:2048 lds
v_max3_f32 v243, v110, v111, v243
v_max3_f32 v244, v118, v119, v244
v_mfma_f32_16x16x32_bf16 v[180:183], a[140:143], a[152:155], v[180:183]
buffer_load_dwordx4 v219, s[28:31], s58 offen offset:3072 lds
v_fma_f32 v96, v96, s63, -v250
v_mfma_f32_16x16x32_bf16 v[172:175], a[140:143], a[148:151], v[172:175]
v_fma_f32 v97, v97, s63, -v250
v_fma_f32 v98, v98, s63, -v250
v_fma_f32 v99, v99, s63, -v250
v_mfma_f32_16x16x32_bf16 v[164:167], a[140:143], a[144:147], v[164:167]
v_fma_f32 v100, v100, s63, -v250
v_fma_f32 v101, v101, s63, -v250
v_fma_f32 v102, v102, s63, -v250
s_waitcnt lgkmcnt(0)
v_mfma_f32_16x16x32_bf16 v[128:131], a[96:99], a[112:115], v[128:131]
s_waitcnt vmcnt(8)
ds_read_b64_tr_b16 a[128:129], v230 offset:20480
v_fma_f32 v103, v103, s63, -v250
v_mfma_f32_16x16x32_bf16 v[136:139], a[96:99], a[116:119], v[136:139]
ds_read_b64_tr_b16 a[130:131], v230 offset:22528
ds_read_b128 a[144:147], v234 offset:53248
v_exp_f32 v96, v96
v_mfma_f32_16x16x32_bf16 v[144:147], a[96:99], a[120:123], v[144:147]
ds_read_b128 a[148:151], v234 offset:54272
ds_read_b128 a[152:155], v234 offset:55296
v_mfma_f32_16x16x32_bf16 v[148:151], a[100:103], a[120:123], v[148:151]
s_add_u32 m0, s53, 16384
s_add_u32 s58, s4, 0
buffer_load_dwordx4 v220, s[36:39], s58 offen lds
v_exp_f32 v97, v97
v_mfma_f32_16x16x32_bf16 v[140:143], a[100:103], a[116:119], v[140:143]
ds_read_b64_tr_b16 a[132:133], v231 offset:20480
ds_read_b64_tr_b16 a[134:135], v231 offset:22528
v_exp_f32 v98, v98
v_mfma_f32_16x16x32_bf16 v[132:135], a[100:103], a[112:115], v[132:135]
ds_read_b64_tr_b16 a[136:137], v232 offset:20480
ds_read_b64_tr_b16 a[138:139], v232 offset:22528
v_mfma_f32_16x16x32_bf16 v[160:163], a[104:107], a[112:115], v[160:163]
ds_read_b64_tr_b16 a[140:141], v233 offset:20480
ds_read_b64_tr_b16 a[142:143], v233 offset:22528
v_exp_f32 v99, v99
v_mfma_f32_16x16x32_bf16 v[168:171], a[104:107], a[116:119], v[168:171]
buffer_load_dwordx4 v221, s[36:39], s58 offen offset:1024 lds
v_exp_f32 v100, v100
v_mfma_f32_16x16x32_bf16 v[176:179], a[104:107], a[120:123], v[176:179]
buffer_load_dwordx4 v222, s[36:39], s58 offen offset:2048 lds
v_exp_f32 v101, v101
v_mfma_f32_16x16x32_bf16 v[180:183], a[108:111], a[120:123], v[180:183]
v_exp_f32 v102, v102
v_exp_f32 v103, v103
v_mfma_f32_16x16x32_bf16 v[172:175], a[108:111], a[116:119], v[172:175]
v_cvt_pk_bf16_f32 v192, v96, v97
v_cvt_pk_bf16_f32 v193, v98, v99
v_cvt_pk_bf16_f32 v194, v100, v101
v_mfma_f32_16x16x32_bf16 v[164:167], a[108:111], a[112:115], v[164:167]
v_cvt_pk_bf16_f32 v195, v102, v103
s_waitcnt lgkmcnt(0)
v_mfma_f32_16x16x32_bf16 v[128:131], a[128:131], a[144:147], v[128:131]
s_barrier
ds_write_b128 v235, v[192:195] offset:12288
v_mfma_f32_16x16x32_bf16 a[224:227], a[240:243], v[192:195], a[224:227]
v_fma_f32 v104, v104, s63, -v251
v_fma_f32 v105, v105, s63, -v251
v_fma_f32 v106, v106, s63, -v251
v_mfma_f32_16x16x32_bf16 v[136:139], a[128:131], a[148:151], v[136:139]
ds_read_b64_tr_b16 a[96:97], v230 offset:0
ds_read_b64_tr_b16 a[98:99], v230 offset:2048
v_fma_f32 v107, v107, s63, -v251
v_mfma_f32_16x16x32_bf16 v[144:147], a[128:131], a[152:155], v[144:147]
ds_read_b128 a[112:115], v234 offset:8192
ds_read_b128 a[116:119], v234 offset:9216
v_fma_f32 v108, v108, s63, -v251
v_fma_f32 v109, v109, s63, -v251
v_mfma_f32_16x16x32_bf16 v[148:151], a[132:135], a[152:155], v[148:151]
ds_read_b128 a[120:123], v234 offset:10240
ds_read_b64_tr_b16 a[100:101], v231 offset:0
v_fma_f32 v110, v110, s63, -v251
v_mfma_f32_16x16x32_bf16 v[140:143], a[132:135], a[148:151], v[140:143]
ds_read_b64_tr_b16 a[102:103], v231 offset:2048
ds_read_b64_tr_b16 a[104:105], v232 offset:0
v_fma_f32 v111, v111, s63, -v251
v_mfma_f32_16x16x32_bf16 v[132:135], a[132:135], a[144:147], v[132:135]
ds_read_b64_tr_b16 a[106:107], v232 offset:2048
ds_read_b64_tr_b16 a[108:109], v233 offset:0
v_exp_f32 v104, v104
v_mfma_f32_16x16x32_bf16 v[160:163], a[136:139], a[144:147], v[160:163]
ds_read_b64_tr_b16 a[110:111], v233 offset:2048
v_exp_f32 v105, v105
v_mfma_f32_16x16x32_bf16 v[168:171], a[136:139], a[148:151], v[168:171]
v_exp_f32 v106, v106
v_exp_f32 v107, v107
v_mfma_f32_16x16x32_bf16 v[176:179], a[136:139], a[152:155], v[176:179]
v_exp_f32 v108, v108
v_mfma_f32_16x16x32_bf16 v[180:183], a[140:143], a[152:155], v[180:183]
v_exp_f32 v109, v109
v_exp_f32 v110, v110
v_mfma_f32_16x16x32_bf16 v[172:175], a[140:143], a[148:151], v[172:175]
v_exp_f32 v111, v111
v_cvt_pk_bf16_f32 v196, v104, v105
v_cvt_pk_bf16_f32 v197, v106, v107
v_mfma_f32_16x16x32_bf16 v[164:167], a[140:143], a[144:147], v[164:167]
v_cvt_pk_bf16_f32 v198, v108, v109
v_cvt_pk_bf16_f32 v199, v110, v111
s_waitcnt lgkmcnt(0)
v_mfma_f32_16x16x32_bf16 v[128:131], a[96:99], a[112:115], v[128:131]
ds_read_b64_tr_b16 a[128:129], v230 offset:4096
ds_read_b64_tr_b16 a[130:131], v230 offset:6144
buffer_load_dwordx4 v223, s[36:39], s58 offen offset:3072 lds
ds_write_b128 v235, v[196:199] offset:13312
v_mfma_f32_16x16x32_bf16 v[136:139], a[96:99], a[116:119], v[136:139]
ds_read_b128 a[144:147], v234 offset:24576
ds_read_b128 a[148:151], v234 offset:25600
v_mfma_f32_16x16x32_bf16 a[228:231], a[240:243], v[196:199], a[228:231]
v_fma_f32 v112, v112, s63, -v252
v_fma_f32 v113, v113, s63, -v252
v_fma_f32 v114, v114, s63, -v252
v_mfma_f32_16x16x32_bf16 v[144:147], a[96:99], a[120:123], v[144:147]
ds_read_b128 a[152:155], v234 offset:26624
ds_read_b64_tr_b16 a[132:133], v231 offset:4096
v_fma_f32 v115, v115, s63, -v252
v_mfma_f32_16x16x32_bf16 v[148:151], a[100:103], a[120:123], v[148:151]
s_add_u32 m0, s53, 20480
s_add_u32 s58, s4, 28672
v_fma_f32 v116, v116, s63, -v252
v_mfma_f32_16x16x32_bf16 v[140:143], a[100:103], a[116:119], v[140:143]
ds_read_b64_tr_b16 a[134:135], v231 offset:6144
ds_read_b64_tr_b16 a[136:137], v232 offset:4096
buffer_load_dwordx4 v220, s[36:39], s58 offen lds
v_fma_f32 v117, v117, s63, -v252
v_fma_f32 v118, v118, s63, -v252
v_mfma_f32_16x16x32_bf16 v[132:135], a[100:103], a[112:115], v[132:135]
ds_read_b64_tr_b16 a[138:139], v232 offset:6144
ds_read_b64_tr_b16 a[140:141], v233 offset:4096
v_fma_f32 v119, v119, s63, -v252
v_mfma_f32_16x16x32_bf16 v[160:163], a[104:107], a[112:115], v[160:163]
ds_read_b64_tr_b16 a[142:143], v233 offset:6144
v_exp_f32 v112, v112
v_mfma_f32_16x16x32_bf16 v[168:171], a[104:107], a[116:119], v[168:171]
buffer_load_dwordx4 v221, s[36:39], s58 offen offset:1024 lds
v_exp_f32 v113, v113
v_mfma_f32_16x16x32_bf16 v[176:179], a[104:107], a[120:123], v[176:179]
buffer_load_dwordx4 v222, s[36:39], s58 offen offset:2048 lds
v_mfma_f32_16x16x32_bf16 v[180:183], a[108:111], a[120:123], v[180:183]
v_exp_f32 v114, v114
v_exp_f32 v115, v115
v_mfma_f32_16x16x32_bf16 v[172:175], a[108:111], a[116:119], v[172:175]
v_exp_f32 v116, v116
v_exp_f32 v117, v117
v_mfma_f32_16x16x32_bf16 v[164:167], a[108:111], a[112:115], v[164:167]
v_exp_f32 v118, v118
s_waitcnt lgkmcnt(0)
v_mfma_f32_16x16x32_bf16 v[128:131], a[128:131], a[144:147], v[128:131]
s_waitcnt vmcnt(11)
ds_read_b64_tr_b16 a[96:97], v230 offset:8192
v_mfma_f32_16x16x32_bf16 v[136:139], a[128:131], a[148:151], v[136:139]
ds_read_b64_tr_b16 a[98:99], v230 offset:10240
ds_read_b128 a[112:115], v234 offset:40960
buffer_load_dwordx4 v223, s[36:39], s58 offen offset:3072 lds
v_exp_f32 v119, v119
v_mfma_f32_16x16x32_bf16 v[144:147], a[128:131], a[152:155], v[144:147]
ds_read_b128 a[116:119], v234 offset:41984
ds_read_b128 a[120:123], v234 offset:43008
v_cvt_pk_bf16_f32 v192, v112, v113
v_cvt_pk_bf16_f32 v193, v114, v115
v_mfma_f32_16x16x32_bf16 v[148:151], a[132:135], a[152:155], v[148:151]
s_add_u32 m0, s53, 0
s_mov_b32 s58, 49152
v_cvt_pk_bf16_f32 v194, v116, v117
v_mfma_f32_16x16x32_bf16 v[140:143], a[132:135], a[148:151], v[140:143]
ds_read_b64_tr_b16 a[100:101], v231 offset:8192
ds_read_b64_tr_b16 a[102:103], v231 offset:10240
v_cvt_pk_bf16_f32 v195, v118, v119
v_mfma_f32_16x16x32_bf16 v[132:135], a[132:135], a[144:147], v[132:135]
ds_read_b64_tr_b16 a[104:105], v232 offset:8192
ds_read_b64_tr_b16 a[106:107], v232 offset:10240
ds_write_b128 v235, v[192:195] offset:14336
v_mfma_f32_16x16x32_bf16 v[160:163], a[136:139], a[144:147], v[160:163]
ds_read_b64_tr_b16 a[108:109], v233 offset:8192
ds_read_b64_tr_b16 a[110:111], v233 offset:10240
buffer_load_dwordx4 v216, s[28:31], s58 offen lds
v_mfma_f32_16x16x32_bf16 a[232:235], a[240:243], v[192:195], a[232:235]
v_mov_b32 v200, v242
v_mov_b32 v201, v243
v_mov_b32 v202, v244
v_mfma_f32_16x16x32_bf16 v[168:171], a[136:139], a[148:151], v[168:171]
buffer_load_dwordx4 v217, s[28:31], s58 offen offset:1024 lds
v_mov_b32 v203, v244
v_mfma_f32_16x16x32_bf16 v[176:179], a[136:139], a[152:155], v[176:179]
buffer_load_dwordx4 v218, s[28:31], s58 offen offset:2048 lds
v_permlane32_swap_b32 v200, v202
v_mfma_f32_16x16x32_bf16 v[180:183], a[140:143], a[152:155], v[180:183]
v_permlane32_swap_b32 v201, v203
v_max_f32 v200, v200, v202
v_max_f32 v201, v201, v203
v_mfma_f32_16x16x32_bf16 v[172:175], a[140:143], a[148:151], v[172:175]
buffer_load_dwordx4 v219, s[28:31], s58 offen offset:3072 lds
v_mfma_f32_16x16x32_bf16 v[164:167], a[140:143], a[144:147], v[164:167]
s_add_u32 m0, s53, 4096
v_permlane16_swap_b32 v200, v201
s_waitcnt lgkmcnt(0)
v_mfma_f32_16x16x32_bf16 v[128:131], a[96:99], a[112:115], v[128:131]
s_waitcnt vmcnt(12)
ds_read_b64_tr_b16 a[128:129], v230 offset:12288
v_max_f32 v200, v200, v201
v_mfma_f32_16x16x32_bf16 v[136:139], a[96:99], a[116:119], v[136:139]
ds_read_b64_tr_b16 a[130:131], v230 offset:14336
ds_read_b128 a[144:147], v234 offset:57344
ds_write_b32 v239, v200 offset:1024
v_mfma_f32_16x16x32_bf16 v[144:147], a[96:99], a[120:123], v[144:147]
ds_read_b128 a[148:151], v234 offset:58368
ds_read_b128 a[152:155], v234 offset:59392
ds_write_b32 v239, v200 offset:17408
ds_write_b32 v239, v200 offset:33792
v_mfma_f32_16x16x32_bf16 v[148:151], a[100:103], a[120:123], v[148:151]
s_mov_b32 s58, 114688
ds_read_b64_tr_b16 a[132:133], v231 offset:12288
buffer_load_dwordx4 v216, s[28:31], s58 offen lds
ds_write_b32 v239, v200 offset:50176
v_mfma_f32_16x16x32_bf16 v[140:143], a[100:103], a[116:119], v[140:143]
ds_read_b64_tr_b16 a[134:135], v231 offset:14336
ds_read_b64_tr_b16 a[136:137], v232 offset:12288
v_and_b32 v239, -16, v239
v_mfma_f32_16x16x32_bf16 v[132:135], a[100:103], a[112:115], v[132:135]
ds_read_b64_tr_b16 a[138:139], v232 offset:14336
ds_read_b64_tr_b16 a[140:141], v233 offset:12288
v_mfma_f32_16x16x32_bf16 v[160:163], a[104:107], a[112:115], v[160:163]
ds_read_b64_tr_b16 a[142:143], v233 offset:14336
v_accvgpr_read_b32 v246, a224
v_accvgpr_read_b32 v247, a228
v_accvgpr_read_b32 v248, a232
v_mfma_f32_16x16x32_bf16 v[168:171], a[104:107], a[116:119], v[168:171]
buffer_load_dwordx4 v217, s[28:31], s58 offen offset:1024 lds
ds_write_b128 v239, v[246:249] offset:0
v_mfma_f32_16x16x32_bf16 v[176:179], a[104:107], a[120:123], v[176:179]
v_mfma_f32_16x16x32_bf16 v[180:183], a[108:111], a[120:123], v[180:183]
v_mfma_f32_16x16x32_bf16 v[172:175], a[108:111], a[116:119], v[172:175]
ds_write_b128 v239, v[246:249] offset:16384
v_mfma_f32_16x16x32_bf16 v[164:167], a[108:111], a[112:115], v[164:167]
s_waitcnt lgkmcnt(2)
v_mfma_f32_16x16x32_bf16 v[128:131], a[128:131], a[144:147], v[128:131]
ds_write_b128 v239, v[246:249] offset:32768
ds_write_b128 v239, v[246:249] offset:49152
s_waitcnt lgkmcnt(0)
s_barrier
v_mfma_f32_16x16x32_bf16 v[136:139], a[128:131], a[148:151], v[136:139]
buffer_load_dwordx4 v218, s[28:31], s58 offen offset:2048 lds
buffer_load_dwordx4 v219, s[28:31], s58 offen offset:3072 lds
s_add_u32 m0, s53, 8192
s_mov_b32 s58, 180224
buffer_load_dwordx4 v216, s[28:31], s58 offen lds
buffer_load_dwordx4 v217, s[28:31], s58 offen offset:1024 lds
buffer_load_dwordx4 v218, s[28:31], s58 offen offset:2048 lds
buffer_load_dwordx4 v219, s[28:31], s58 offen offset:3072 lds
s_waitcnt vmcnt(8)
ds_read_b128 v[192:195], v240 offset:1024
ds_read_b128 v[196:199], v240 offset:1280
ds_read_b128 v[200:203], v240 offset:1536
ds_read_b128 v[204:207], v240 offset:1792
v_mfma_f32_16x16x32_bf16 v[144:147], a[128:131], a[152:155], v[144:147]
ds_read_b64_tr_b16 a[96:97], v230 offset:0
ds_read_b64_tr_b16 a[98:99], v230 offset:2048
v_mfma_f32_16x16x32_bf16 v[148:151], a[132:135], a[152:155], v[148:151]
s_add_u32 m0, s53, 12288
s_mov_b32 s58, 245760
buffer_load_dwordx4 v216, s[28:31], s58 offen lds
v_mfma_f32_16x16x32_bf16 v[140:143], a[132:135], a[148:151], v[140:143]
ds_read_b128 a[112:115], v234 offset:12288
ds_read_b128 a[116:119], v234 offset:13312
v_mfma_f32_16x16x32_bf16 v[132:135], a[132:135], a[144:147], v[132:135]
ds_read_b128 a[120:123], v234 offset:14336
ds_read_b64_tr_b16 a[100:101], v231 offset:0
v_mfma_f32_16x16x32_bf16 v[160:163], a[136:139], a[144:147], v[160:163]
ds_read_b64_tr_b16 a[102:103], v231 offset:2048
ds_read_b64_tr_b16 a[104:105], v232 offset:0
v_mfma_f32_16x16x32_bf16 v[168:171], a[136:139], a[148:151], v[168:171]
ds_read_b64_tr_b16 a[106:107], v232 offset:2048
ds_read_b64_tr_b16 a[108:109], v233 offset:0
v_mfma_f32_16x16x32_bf16 v[176:179], a[136:139], a[152:155], v[176:179]
ds_read_b64_tr_b16 a[110:111], v233 offset:2048
s_waitcnt lgkmcnt(11)
v_max3_f32 v242, v192, v196, v200
v_mfma_f32_16x16x32_bf16 v[180:183], a[140:143], a[152:155], v[180:183]
buffer_load_dwordx4 v217, s[28:31], s58 offen offset:1024 lds
v_max3_f32 v243, v193, v197, v201
v_mfma_f32_16x16x32_bf16 v[172:175], a[140:143], a[148:151], v[172:175]
buffer_load_dwordx4 v218, s[28:31], s58 offen offset:2048 lds
v_max3_f32 v244, v194, v198, v202
v_mfma_f32_16x16x32_bf16 v[164:167], a[140:143], a[144:147], v[164:167]
v_max_f32 v242, v242, v204
v_max_f32 v243, v243, v205
s_waitcnt lgkmcnt(6)
v_mfma_f32_16x16x32_bf16 v[128:131], a[96:99], a[112:115], v[128:131]
buffer_load_dwordx4 v219, s[28:31], s58 offen offset:3072 lds
s_waitcnt vmcnt(8)
v_max_f32 v244, v244, v206
v_mfma_f32_16x16x32_bf16 v[136:139], a[96:99], a[116:119], v[136:139]
ds_read_b64_tr_b16 a[128:129], v230 offset:4096
ds_read_b64_tr_b16 a[130:131], v230 offset:6144
ds_read_b128 v[192:195], v240 offset:0
ds_read_b128 v[196:199], v240 offset:256
ds_read_b128 v[200:203], v240 offset:512
ds_read_b128 v[204:207], v240 offset:768
v_mfma_f32_16x16x32_bf16 v[144:147], a[96:99], a[120:123], v[144:147]
ds_read_b128 a[144:147], v234 offset:28672
v_fma_f32 v250, v242, s63, -v250
s_waitcnt lgkmcnt(7)
v_mfma_f32_16x16x32_bf16 v[148:151], a[100:103], a[120:123], v[148:151]
s_add_u32 m0, s53, 0
s_add_u32 s58, s5, 0
buffer_load_dwordx4 v220, s[36:39], s58 offen lds
v_fma_f32 v251, v243, s63, -v251
v_mfma_f32_16x16x32_bf16 v[140:143], a[100:103], a[116:119], v[140:143]
ds_read_b128 a[148:151], v234 offset:29696
ds_read_b128 a[152:155], v234 offset:30720
v_fma_f32 v252, v244, s63, -v252
v_mfma_f32_16x16x32_bf16 v[132:135], a[100:103], a[112:115], v[132:135]
ds_read_b64_tr_b16 a[132:133], v231 offset:4096
ds_read_b64_tr_b16 a[134:135], v231 offset:6144
v_max3_f32 v250, v250, v251, v252
v_cmp_lt_f32 vcc, 0x41400000, v250
v_mfma_f32_16x16x32_bf16 v[160:163], a[104:107], a[112:115], v[160:163]
ds_read_b64_tr_b16 a[136:137], v232 offset:4096
ds_read_b64_tr_b16 a[138:139], v232 offset:6144
v_mfma_f32_16x16x32_bf16 v[168:171], a[104:107], a[116:119], v[168:171]
buffer_load_dwordx4 v221, s[36:39], s58 offen offset:1024 lds
s_cbranch_vccnz L_fb3
v_mfma_f32_16x16x32_bf16 v[176:179], a[104:107], a[120:123], v[176:179]
ds_read_b64_tr_b16 a[140:141], v233 offset:4096
ds_read_b64_tr_b16 a[142:143], v233 offset:6144
v_mfma_f32_16x16x32_bf16 v[180:183], a[108:111], a[120:123], v[180:183]
buffer_load_dwordx4 v222, s[36:39], s58 offen offset:2048 lds
v_mfma_f32_16x16x32_bf16 v[172:175], a[108:111], a[116:119], v[172:175]
s_waitcnt lgkmcnt(9)
v_add_f32 v192, v192, v196
v_add_f32 v193, v193, v197
v_mfma_f32_16x16x32_bf16 v[164:167], a[108:111], a[112:115], v[164:167]
v_add_f32 v194, v194, v198
v_add_f32 v200, v200, v204
s_waitcnt lgkmcnt(6)
v_mfma_f32_16x16x32_bf16 v[128:131], a[128:131], a[144:147], v[128:131]
buffer_load_dwordx4 v223, s[36:39], s58 offen offset:3072 lds
s_waitcnt vmcnt(4)
v_add_f32 v201, v201, v205
v_add_f32 v202, v202, v206
v_mfma_f32_16x16x32_bf16 v[136:139], a[128:131], a[148:151], v[136:139]
ds_read_b64_tr_b16 a[96:97], v230 offset:8192
ds_read_b64_tr_b16 a[98:99], v230 offset:10240
v_add_f32 v192, v192, v200
v_mfma_f32_16x16x32_bf16 v[144:147], a[128:131], a[152:155], v[144:147]
ds_read_b128 a[160:163], v234 offset:45056
v_add_f32 v193, v193, v201
s_waitcnt lgkmcnt(3)
v_mfma_f32_16x16x32_bf16 v[148:151], a[132:135], a[152:155], v[148:151]
ds_read_b128 a[164:167], v234 offset:46080
ds_read_b128 a[168:171], v234 offset:47104
v_add_f32 v194, v194, v202
v_mfma_f32_16x16x32_bf16 v[140:143], a[132:135], a[148:151], v[140:143]
ds_read_b64_tr_b16 a[100:101], v231 offset:8192
ds_read_b64_tr_b16 a[102:103], v231 offset:10240
v_rcp_f32 v246, v192
v_mfma_f32_16x16x32_bf16 v[132:135], a[132:135], a[144:147], v[132:135]
ds_read_b64_tr_b16 a[104:105], v230 offset:12288
ds_read_b64_tr_b16 a[106:107], v230 offset:14336
v_rcp_f32 v247, v193
v_mfma_f32_16x16x32_bf16 v[160:163], a[136:139], a[144:147], v[160:163]
ds_read_b128 a[176:179], v234 offset:61440
ds_read_b128 a[180:183], v234 offset:62464
v_mfma_f32_16x16x32_bf16 v[168:171], a[136:139], a[148:151], v[168:171]
ds_read_b128 a[184:187], v234 offset:63488
ds_read_b64_tr_b16 a[108:109], v231 offset:12288
v_rcp_f32 v248, v194
v_mfma_f32_16x16x32_bf16 v[176:179], a[136:139], a[152:155], v[176:179]
ds_read_b64_tr_b16 a[110:111], v231 offset:14336
s_add_u32 m0, s53, 4096
v_mfma_f32_16x16x32_bf16 v[180:183], a[140:143], a[152:155], v[180:183]
s_add_u32 s58, s5, 28672
buffer_load_dwordx4 v220, s[36:39], s58 offen lds
v_mfma_f32_16x16x32_bf16 v[172:175], a[140:143], a[148:151], v[172:175]
v_mfma_f32_16x16x32_bf16 v[164:167], a[140:143], a[144:147], v[164:167]
s_waitcnt lgkmcnt(9)
v_mfma_f32_16x16x32_bf16 v[128:131], a[96:99], a[160:163], v[128:131]
buffer_load_dwordx4 v221, s[36:39], s58 offen offset:1024 lds
buffer_load_dwordx4 v222, s[36:39], s58 offen offset:2048 lds
buffer_load_dwordx4 v223, s[36:39], s58 offen offset:3072 lds
v_mfma_f32_16x16x32_bf16 v[136:139], a[96:99], a[164:167], v[136:139]
ds_read_b64_tr_b16 a[128:129], v232 offset:8192
ds_read_b64_tr_b16 a[130:131], v232 offset:10240
v_mfma_f32_16x16x32_bf16 v[144:147], a[96:99], a[168:171], v[144:147]
ds_read_b64_tr_b16 a[132:133], v233 offset:8192
s_waitcnt lgkmcnt(3)
v_mfma_f32_16x16x32_bf16 v[148:151], a[100:103], a[168:171], v[148:151]
ds_read_b64_tr_b16 a[134:135], v233 offset:10240
ds_read_b64_tr_b16 a[136:137], v232 offset:12288
v_mfma_f32_16x16x32_bf16 v[140:143], a[100:103], a[164:167], v[140:143]
ds_read_b64_tr_b16 a[138:139], v232 offset:14336
ds_read_b64_tr_b16 a[140:141], v233 offset:12288
v_mfma_f32_16x16x32_bf16 v[132:135], a[100:103], a[160:163], v[132:135]
ds_read_b64_tr_b16 a[142:143], v233 offset:14336
v_mfma_f32_16x16x32_bf16 v[128:131], a[104:107], a[176:179], v[128:131]
v_mfma_f32_16x16x32_bf16 v[136:139], a[104:107], a[180:183], v[136:139]
v_mfma_f32_16x16x32_bf16 v[144:147], a[104:107], a[184:187], v[144:147]
v_mfma_f32_16x16x32_bf16 v[148:151], a[108:111], a[184:187], v[148:151]
v_mfma_f32_16x16x32_bf16 v[140:143], a[108:111], a[180:183], v[140:143]
v_mfma_f32_16x16x32_bf16 v[132:135], a[108:111], a[176:179], v[132:135]
s_waitcnt lgkmcnt(0)
v_mfma_f32_16x16x32_bf16 v[160:163], a[128:131], a[160:163], v[160:163]
ds_read_b64_tr_b16 a[96:97], v230 offset:16384
ds_read_b64_tr_b16 a[98:99], v230 offset:18432
v_mfma_f32_16x16x32_bf16 v[168:171], a[128:131], a[164:167], v[168:171]
ds_read_b64_tr_b16 a[100:101], v231 offset:16384
ds_read_b64_tr_b16 a[102:103], v231 offset:18432
v_mfma_f32_16x16x32_bf16 v[176:179], a[128:131], a[168:171], v[176:179]
ds_read_b64_tr_b16 a[104:105], v232 offset:16384
s_add_u32 m0, s53, 8192
v_mul_f32 v128, v128, v246
v_mul_f32 v129, v129, v246
v_mul_f32 v130, v130, v246
v_mul_f32 v131, v131, v246
v_mfma_f32_16x16x32_bf16 v[180:183], a[132:135], a[168:171], v[180:183]
s_add_u32 s58, s6, 0
buffer_load_dwordx4 v220, s[36:39], s58 offen lds
v_mul_f32 v132, v132, v246
v_mul_f32 v133, v133, v246
v_mul_f32 v134, v134, v246
v_mul_f32 v135, v135, v246
v_mfma_f32_16x16x32_bf16 v[172:175], a[132:135], a[164:167], v[172:175]
ds_read_b64_tr_b16 a[106:107], v232 offset:18432
ds_read_b64_tr_b16 a[108:109], v233 offset:16384
v_cvt_pk_bf16_f32 v128, v128, v129
v_cvt_pk_bf16_f32 v129, v130, v131
v_cvt_pk_bf16_f32 v130, v132, v133
v_cvt_pk_bf16_f32 v131, v134, v135
v_mfma_f32_16x16x32_bf16 v[164:167], a[132:135], a[160:163], v[164:167]
ds_read_b64_tr_b16 a[110:111], v233 offset:18432
ds_write_b128 v235, v[128:131] offset:0
v_mul_f32 v136, v136, v247
v_mul_f32 v137, v137, v247
v_mul_f32 v138, v138, v247
v_mul_f32 v139, v139, v247
v_mul_f32 v140, v140, v247
v_mfma_f32_16x16x32_bf16 v[160:163], a[136:139], a[176:179], v[160:163]
buffer_load_dwordx4 v221, s[36:39], s58 offen offset:1024 lds
v_mul_f32 v141, v141, v247
v_mul_f32 v142, v142, v247
v_mul_f32 v143, v143, v247
v_cvt_pk_bf16_f32 v136, v136, v137
v_cvt_pk_bf16_f32 v137, v138, v139
v_mfma_f32_16x16x32_bf16 v[168:171], a[136:139], a[180:183], v[168:171]
buffer_load_dwordx4 v222, s[36:39], s58 offen offset:2048 lds
v_cvt_pk_bf16_f32 v138, v140, v141
v_cvt_pk_bf16_f32 v139, v142, v143
ds_write_b128 v235, v[136:139] offset:1024
v_mfma_f32_16x16x32_bf16 v[176:179], a[136:139], a[184:187], v[176:179]
buffer_load_dwordx4 v223, s[36:39], s58 offen offset:3072 lds
v_mul_f32 v144, v144, v248
v_mul_f32 v145, v145, v248
v_mul_f32 v146, v146, v248
v_mul_f32 v147, v147, v248
v_mul_f32 v148, v148, v248
v_mul_f32 v149, v149, v248
v_mfma_f32_16x16x32_bf16 v[180:183], a[140:143], a[184:187], v[180:183]
s_add_u32 m0, s53, 12288
s_add_u32 s58, s6, 28672
v_mul_f32 v150, v150, v248
v_mul_f32 v151, v151, v248
v_cvt_pk_bf16_f32 v144, v144, v145
v_cvt_pk_bf16_f32 v145, v146, v147
v_cvt_pk_bf16_f32 v146, v148, v149
v_mfma_f32_16x16x32_bf16 v[172:175], a[140:143], a[180:183], v[172:175]
buffer_load_dwordx4 v220, s[36:39], s58 offen lds
v_cvt_pk_bf16_f32 v147, v150, v151
ds_write_b128 v235, v[144:147] offset:2048
v_mfma_f32_16x16x32_bf16 v[164:167], a[140:143], a[176:179], v[164:167]
s_waitcnt lgkmcnt(3)
v_mfma_f32_16x16x32_bf16 v[0:3], a[96:99], v[128:131], 0
ds_read_b64_tr_b16 a[128:129], v230 offset:20480
ds_read_b64_tr_b16 a[130:131], v230 offset:22528
v_mfma_f32_16x16x32_bf16 v[8:11], a[96:99], v[136:139], 0
ds_read_b64_tr_b16 a[132:133], v231 offset:20480
ds_read_b64_tr_b16 a[134:135], v231 offset:22528
v_mfma_f32_16x16x32_bf16 v[16:19], a[96:99], v[144:147], 0
ds_read_b64_tr_b16 a[136:137], v232 offset:20480
v_mul_f32 v160, v160, v246
v_mul_f32 v161, v161, v246
v_mul_f32 v162, v162, v246
v_mul_f32 v163, v163, v246
v_mul_f32 v164, v164, v246
v_mfma_f32_16x16x32_bf16 v[20:23], a[100:103], v[144:147], 0
buffer_load_dwordx4 v221, s[36:39], s58 offen offset:1024 lds
v_mul_f32 v165, v165, v246
v_mul_f32 v166, v166, v246
v_mul_f32 v167, v167, v246
v_cvt_pk_bf16_f32 v160, v160, v161
v_mfma_f32_16x16x32_bf16 v[12:15], a[100:103], v[136:139], 0
ds_read_b64_tr_b16 a[138:139], v232 offset:22528
ds_read_b64_tr_b16 a[140:141], v233 offset:20480
v_cvt_pk_bf16_f32 v161, v162, v163
v_cvt_pk_bf16_f32 v162, v164, v165
v_cvt_pk_bf16_f32 v163, v166, v167
ds_write_b128 v235, v[160:163] offset:4096
v_mfma_f32_16x16x32_bf16 v[4:7], a[100:103], v[128:131], 0
ds_read_b64_tr_b16 a[142:143], v233 offset:22528
v_mul_f32 v168, v168, v247
v_mul_f32 v169, v169, v247
v_mul_f32 v170, v170, v247
v_mul_f32 v171, v171, v247
v_mul_f32 v172, v172, v247
v_mfma_f32_16x16x32_bf16 v[32:35], a[104:107], v[128:131], 0
buffer_load_dwordx4 v222, s[36:39], s58 offen offset:2048 lds
v_mul_f32 v173, v173, v247
v_mul_f32 v174, v174, v247
v_mul_f32 v175, v175, v247
v_cvt_pk_bf16_f32 v168, v168, v169
v_cvt_pk_bf16_f32 v169, v170, v171
v_mfma_f32_16x16x32_bf16 v[40:43], a[104:107], v[136:139], 0
buffer_load_dwordx4 v223, s[36:39], s58 offen offset:3072 lds
v_cvt_pk_bf16_f32 v170, v172, v173
v_cvt_pk_bf16_f32 v171, v174, v175
ds_write_b128 v235, v[168:171] offset:5120
v_mfma_f32_16x16x32_bf16 v[48:51], a[104:107], v[144:147], 0
s_add_u32 m0, s53, 16384
s_add_u32 s58, s7, 0
v_mul_f32 v176, v176, v248
v_mul_f32 v177, v177, v248
v_mul_f32 v178, v178, v248
v_mul_f32 v179, v179, v248
v_mul_f32 v180, v180, v248
v_mul_f32 v181, v181, v248
v_mfma_f32_16x16x32_bf16 v[52:55], a[108:111], v[144:147], 0
buffer_load_dwordx4 v220, s[36:39], s58 offen lds
v_mul_f32 v182, v182, v248
v_mul_f32 v183, v183, v248
v_cvt_pk_bf16_f32 v176, v176, v177
v_cvt_pk_bf16_f32 v177, v178, v179
v_cvt_pk_bf16_f32 v178, v180, v181
v_mfma_f32_16x16x32_bf16 v[44:47], a[108:111], v[136:139], 0
buffer_load_dwordx4 v221, s[36:39], s58 offen offset:1024 lds
v_cvt_pk_bf16_f32 v179, v182, v183
v_mfma_f32_16x16x32_bf16 v[36:39], a[108:111], v[128:131], 0
s_waitcnt lgkmcnt(1)
v_mfma_f32_16x16x32_bf16 v[0:3], a[128:131], v[160:163], v[0:3]
s_waitcnt vmcnt(14)
ds_read_b64_tr_b16 a[96:97], v230 offset:0
v_mfma_f32_16x16x32_bf16 v[8:11], a[128:131], v[168:171], v[8:11]
ds_read_b64_tr_b16 a[98:99], v230 offset:2048
ds_write_b128 v235, v[176:179] offset:6144
v_mfma_f32_16x16x32_bf16 v[16:19], a[128:131], v[176:179], v[16:19]
ds_read_b64_tr_b16 a[100:101], v231 offset:0
v_mfma_f32_16x16x32_bf16 v[20:23], a[132:135], v[176:179], v[20:23]
buffer_load_dwordx4 v222, s[36:39], s58 offen offset:2048 lds
v_mfma_f32_16x16x32_bf16 v[12:15], a[132:135], v[168:171], v[12:15]
ds_read_b64_tr_b16 a[102:103], v231 offset:2048
ds_read_b64_tr_b16 a[104:105], v232 offset:0
v_mfma_f32_16x16x32_bf16 v[4:7], a[132:135], v[160:163], v[4:7]
ds_read_b64_tr_b16 a[106:107], v232 offset:2048
ds_read_b64_tr_b16 a[108:109], v233 offset:0
s_waitcnt lgkmcnt(5)
s_barrier
ds_read_b128 a[0:3], v236 offset:0
ds_read_b128 a[4:7], v236 offset:1024
ds_read_b128 a[8:11], v236 offset:2048
v_mfma_f32_16x16x32_bf16 v[32:35], a[136:139], v[160:163], v[32:35]
ds_read_b64_tr_b16 a[110:111], v233 offset:2048
buffer_load_dwordx4 v223, s[36:39], s58 offen offset:3072 lds
v_mfma_f32_16x16x32_bf16 v[40:43], a[136:139], v[168:171], v[40:43]
s_add_u32 m0, s53, 20480
s_add_u32 s58, s7, 28672
v_lshrrev_b32 v219, 4, v234
v_mfma_f32_16x16x32_bf16 v[48:51], a[136:139], v[176:179], v[48:51]
buffer_load_dwordx4 v220, s[36:39], s58 offen lds
v_lshlrev_b32 v208, 8, v219
v_mfma_f32_16x16x32_bf16 v[52:55], a[140:143], v[176:179], v[52:55]
buffer_load_dwordx4 v221, s[36:39], s58 offen offset:1024 lds
v_mfma_f32_16x16x32_bf16 v[44:47], a[140:143], v[168:171], v[44:47]
s_lshl_b32 s59, s52, 10
s_lshl_b32 s60, s67, 2
s_add_u32 s59, s59, s60
v_mfma_f32_16x16x32_bf16 v[36:39], a[140:143], v[160:163], v[36:39]
v_add_u32 v208, s59, v208
s_waitcnt lgkmcnt(3)
v_mfma_f32_16x16x32_bf16 v[0:3], a[96:99], a[0:3], v[0:3]
s_waitcnt vmcnt(14)
ds_read_b64_tr_b16 a[128:129], v230 offset:4096
v_cmp_gt_u32 vcc, 4, v219
s_waitcnt lgkmcnt(3)
v_mfma_f32_16x16x32_bf16 v[8:11], a[96:99], a[4:7], v[8:11]
ds_read_b64_tr_b16 a[130:131], v230 offset:6144
ds_read_b128 a[16:19], v236 offset:4096
s_waitcnt lgkmcnt(4)
v_mfma_f32_16x16x32_bf16 v[16:19], a[96:99], a[8:11], v[16:19]
ds_read_b128 a[20:23], v236 offset:5120
v_mov_b32 v224, 0x40000000
v_mfma_f32_16x16x32_bf16 v[20:23], a[100:103], a[8:11], v[20:23]
buffer_load_dwordx4 v222, s[36:39], s58 offen offset:2048 lds
v_mfma_f32_16x16x32_bf16 v[12:15], a[100:103], a[4:7], v[12:15]
ds_read_b128 a[24:27], v236 offset:6144
ds_read_b64_tr_b16 a[132:133], v231 offset:4096
v_mov_b32 v209, 1
v_mfma_f32_16x16x32_bf16 v[4:7], a[100:103], a[0:3], v[4:7]
ds_read_b64_tr_b16 a[134:135], v231 offset:6144
ds_read_b64_tr_b16 a[136:137], v232 offset:4096
v_mfma_f32_16x16x32_bf16 v[32:35], a[104:107], a[0:3], v[32:35]
ds_read_b64_tr_b16 a[138:139], v232 offset:6144
ds_read_b64_tr_b16 a[140:141], v233 offset:4096
v_cndmask_b32 v208, v224, v208, vcc
v_mfma_f32_16x16x32_bf16 v[40:43], a[104:107], a[4:7], v[40:43]
buffer_load_dwordx4 v223, s[36:39], s58 offen offset:3072 lds
v_and_b32 v219, 15, v219
v_mfma_f32_16x16x32_bf16 v[48:51], a[104:107], a[8:11], v[48:51]
ds_read_b64_tr_b16 a[142:143], v233 offset:6144
s_max_u32 s59, s52, 1
s_waitcnt lgkmcnt(11)
v_mfma_f32_16x16x32_bf16 v[52:55], a[108:111], a[8:11], v[52:55]
s_add_u32 m0, s53, 0
s_add_u32 s58, s4, 0
s_sub_u32 s59, s59, 1
v_mfma_f32_16x16x32_bf16 v[44:47], a[108:111], a[4:7], v[44:47]
buffer_load_dwordx4 v220, s[40:43], s58 offen lds
v_mfma_f32_16x16x32_bf16 v[36:39], a[108:111], a[0:3], v[36:39]
s_lshl_b32 s59, s59, 6
s_lshl_b32 s60, s67, 8
s_waitcnt lgkmcnt(6)
v_mfma_f32_16x16x32_bf16 v[0:3], a[128:131], a[16:19], v[0:3]
s_waitcnt vmcnt(13)
ds_read_b64_tr_b16 a[96:97], v230 offset:8192
s_add_u32 s59, s59, s60
v_mfma_f32_16x16x32_bf16 v[8:11], a[128:131], a[20:23], v[8:11]
ds_read_b64_tr_b16 a[98:99], v230 offset:10240
ds_read_b128 a[32:35], v237 offset:0
v_mfma_f32_16x16x32_bf16 v[16:19], a[128:131], a[24:27], v[16:19]
ds_read_b128 a[36:39], v237 offset:1024
v_lshl_add_u32 v210, v219, 2, s59
s_waitcnt lgkmcnt(4)
v_mfma_f32_16x16x32_bf16 v[20:23], a[132:135], a[24:27], v[20:23]
buffer_load_dwordx4 v221, s[40:43], s58 offen offset:1024 lds
v_mfma_f32_16x16x32_bf16 v[12:15], a[132:135], a[20:23], v[12:15]
ds_read_b128 a[40:43], v237 offset:2048
ds_read_b64_tr_b16 a[100:101], v231 offset:8192
v_mul_u32_u24 v216, 896, v219
v_mfma_f32_16x16x32_bf16 v[4:7], a[132:135], a[16:19], v[4:7]
ds_read_b64_tr_b16 a[102:103], v231 offset:10240
ds_read_b64_tr_b16 a[104:105], v232 offset:8192
v_lshrrev_b32 v224, 8, v234
v_mfma_f32_16x16x32_bf16 v[32:35], a[136:139], a[16:19], v[32:35]
ds_read_b64_tr_b16 a[106:107], v232 offset:10240
ds_read_b64_tr_b16 a[108:109], v233 offset:8192
v_mfma_f32_16x16x32_bf16 v[40:43], a[136:139], a[20:23], v[40:43]
buffer_load_dwordx4 v222, s[40:43], s58 offen offset:2048 lds
v_lshl_add_u32 v216, v224, 3, v216
v_mfma_f32_16x16x32_bf16 v[48:51], a[136:139], a[24:27], v[48:51]
ds_read_b64_tr_b16 a[110:111], v233 offset:10240
v_mov_b32 v217, 0
v_mov_b32 v218, 1
v_mfma_f32_16x16x32_bf16 v[52:55], a[140:143], a[24:27], v[52:55]
buffer_load_dwordx4 v223, s[40:43], s58 offen offset:3072 lds
v_mfma_f32_16x16x32_bf16 v[44:47], a[140:143], a[20:23], v[44:47]
s_add_u32 m0, s53, 4096
s_add_u32 s58, s4, 28672
v_add_u32 v212, 0, v234
v_mfma_f32_16x16x32_bf16 v[36:39], a[140:143], a[16:19], v[36:39]
v_add_u32 v213, 4096, v234
v_add_u32 v214, 8192, v234
s_waitcnt lgkmcnt(6)
v_mfma_f32_16x16x32_bf16 v[0:3], a[96:99], a[32:35], v[0:3]
s_waitcnt vmcnt(12)
ds_read_b64_tr_b16 a[128:129], v230 offset:12288
v_mfma_f32_16x16x32_bf16 v[8:11], a[96:99], a[36:39], v[8:11]
ds_read_b64_tr_b16 a[130:131], v230 offset:14336
ds_read_b128 a[48:51], v237 offset:4096
v_add_u32 v215, 12288, v234
v_mfma_f32_16x16x32_bf16 v[16:19], a[96:99], a[40:43], v[16:19]
ds_read_b128 a[52:55], v237 offset:5120
v_bfe_u32 v219, v234, 6, 2
s_waitcnt lgkmcnt(4)
v_mfma_f32_16x16x32_bf16 v[20:23], a[100:103], a[40:43], v[20:23]
buffer_load_dwordx4 v220, s[40:43], s58 offen lds
v_mfma_f32_16x16x32_bf16 v[12:15], a[100:103], a[36:39], v[12:15]
ds_read_b128 a[56:59], v237 offset:6144
ds_read_b64_tr_b16 a[132:133], v231 offset:12288
v_cmp_eq_u32 vcc, v219, v224
v_mfma_f32_16x16x32_bf16 v[4:7], a[100:103], a[32:35], v[4:7]
ds_read_b64_tr_b16 a[134:135], v231 offset:14336
ds_read_b64_tr_b16 a[136:137], v232 offset:12288
v_bfe_u32 v219, v234, 4, 1
v_mfma_f32_16x16x32_bf16 v[32:35], a[104:107], a[32:35], v[32:35]
ds_read_b64_tr_b16 a[138:139], v232 offset:14336
ds_read_b64_tr_b16 a[140:141], v233 offset:12288
v_mfma_f32_16x16x32_bf16 v[40:43], a[104:107], a[36:39], v[40:43]
buffer_load_dwordx4 v221, s[40:43], s58 offen offset:1024 lds
v_lshlrev_b32 v219, 4, v219
v_mfma_f32_16x16x32_bf16 v[48:51], a[104:107], a[40:43], v[48:51]
ds_read_b64_tr_b16 a[142:143], v233 offset:14336
v_mov_b32 v224, 0x3f80
v_lshlrev_b32 v219, v219, v224
v_mfma_f32_16x16x32_bf16 v[52:55], a[108:111], a[40:43], v[52:55]
buffer_load_dwordx4 v222, s[40:43], s58 offen offset:2048 lds
v_cndmask_b32 v219, 0, v219, vcc
v_mfma_f32_16x16x32_bf16 v[44:47], a[108:111], a[36:39], v[44:47]
buffer_load_dwordx4 v223, s[40:43], s58 offen offset:3072 lds
v_mfma_f32_16x16x32_bf16 v[36:39], a[108:111], a[32:35], v[36:39]
s_add_u32 m0, s53, 8192
v_bfe_u32 v224, v234, 5, 1
s_waitcnt lgkmcnt(6)
v_mfma_f32_16x16x32_bf16 v[0:3], a[128:131], a[48:51], v[0:3]
s_waitcnt vmcnt(12)
ds_read_b64_tr_b16 a[96:97], v230 offset:16384
v_cmp_eq_u32 vcc, 0, v224
v_mfma_f32_16x16x32_bf16 v[8:11], a[128:131], a[52:55], v[8:11]
ds_read_b64_tr_b16 a[98:99], v230 offset:18432
ds_read_b128 a[64:67], v238 offset:0
v_accvgpr_write_b32 a226, 0
v_mfma_f32_16x16x32_bf16 v[16:19], a[128:131], a[56:59], v[16:19]
ds_read_b128 a[68:71], v238 offset:1024
v_accvgpr_write_b32 a227, 0
s_waitcnt lgkmcnt(4)
v_mfma_f32_16x16x32_bf16 v[20:23], a[132:135], a[56:59], v[20:23]
s_add_u32 s58, s5, 0
ds_read_b128 a[72:75], v238 offset:2048
v_mfma_f32_16x16x32_bf16 v[12:15], a[132:135], a[52:55], v[12:15]
ds_read_b64_tr_b16 a[100:101], v231 offset:16384
ds_read_b64_tr_b16 a[102:103], v231 offset:18432
buffer_load_dwordx4 v220, s[40:43], s58 offen lds
v_cndmask_b32 v224, 0, v219, vcc
v_mfma_f32_16x16x32_bf16 v[4:7], a[132:135], a[48:51], v[4:7]
ds_read_b64_tr_b16 a[104:105], v232 offset:16384
ds_read_b64_tr_b16 a[106:107], v232 offset:18432
v_sub_u32 v219, v219, v224
v_mfma_f32_16x16x32_bf16 v[32:35], a[136:139], a[48:51], v[32:35]
ds_read_b64_tr_b16 a[108:109], v233 offset:16384
ds_read_b64_tr_b16 a[110:111], v233 offset:18432
v_accvgpr_write_b32 a228, 0
v_mfma_f32_16x16x32_bf16 v[40:43], a[136:139], a[52:55], v[40:43]
buffer_load_dwordx4 v221, s[40:43], s58 offen offset:1024 lds
v_accvgpr_write_b32 a229, 0
v_mfma_f32_16x16x32_bf16 v[48:51], a[136:139], a[56:59], v[48:51]
buffer_load_dwordx4 v222, s[40:43], s58 offen offset:2048 lds
v_mfma_f32_16x16x32_bf16 v[52:55], a[140:143], a[56:59], v[52:55]
v_accvgpr_write_b32 a224, v224
v_accvgpr_write_b32 a225, v219
v_accvgpr_write_b32 a230, v224
v_mfma_f32_16x16x32_bf16 v[44:47], a[140:143], a[52:55], v[44:47]
buffer_load_dwordx4 v223, s[40:43], s58 offen offset:3072 lds
v_accvgpr_write_b32 a231, v219
v_mfma_f32_16x16x32_bf16 v[36:39], a[140:143], a[48:51], v[36:39]
s_add_u32 m0, s53, 12288
s_lshl_b32 s59, s66, 4
s_waitcnt lgkmcnt(0)
v_mfma_f32_16x16x32_bf16 v[0:3], a[96:99], a[64:67], v[0:3]
s_waitcnt vmcnt(12)
ds_read_b64_tr_b16 a[128:129], v230 offset:20480
v_mfma_f32_16x16x32_bf16 v[8:11], a[96:99], a[68:71], v[8:11]
ds_read_b64_tr_b16 a[130:131], v230 offset:22528
ds_read_b128 a[80:83], v238 offset:4096
s_add_u32 s20, s16, s59
s_addc_u32 s21, s17, 0
v_mfma_f32_16x16x32_bf16 v[16:19], a[96:99], a[72:75], v[16:19]
ds_read_b128 a[84:87], v238 offset:5120
ds_read_b128 a[88:91], v238 offset:6144
s_mov_b32 s22, 4
v_mfma_f32_16x16x32_bf16 v[20:23], a[100:103], a[72:75], v[20:23]
s_add_u32 s58, s5, 28672
ds_read_b64_tr_b16 a[132:133], v231 offset:20480
buffer_load_dwordx4 v220, s[40:43], s58 offen lds
s_mov_b32 s23, 0x20000
v_mfma_f32_16x16x32_bf16 v[12:15], a[100:103], a[68:71], v[12:15]
ds_read_b64_tr_b16 a[134:135], v231 offset:22528
ds_read_b64_tr_b16 a[136:137], v232 offset:20480
v_mfma_f32_16x16x32_bf16 v[4:7], a[100:103], a[64:67], v[4:7]
ds_read_b64_tr_b16 a[138:139], v232 offset:22528
ds_read_b64_tr_b16 a[140:141], v233 offset:20480
s_mul_i32 s59, s66, 917504
v_mfma_f32_16x16x32_bf16 v[32:35], a[104:107], a[64:67], v[32:35]
ds_read_b64_tr_b16 a[142:143], v233 offset:22528
s_add_u32 s24, s18, s59
s_addc_u32 s25, s19, 0
v_mfma_f32_16x16x32_bf16 v[40:43], a[104:107], a[68:71], v[40:43]
buffer_load_dwordx4 v221, s[40:43], s58 offen offset:1024 lds
s_mov_b32 s26, 917504
v_mfma_f32_16x16x32_bf16 v[48:51], a[104:107], a[72:75], v[48:51]
buffer_load_dwordx4 v222, s[40:43], s58 offen offset:2048 lds
s_mov_b32 s27, 0x20000
v_mfma_f32_16x16x32_bf16 v[52:55], a[108:111], a[72:75], v[52:55]
buffer_load_dwordx4 v223, s[40:43], s58 offen offset:3072 lds
s_mov_b32 s59, 0
v_mfma_f32_16x16x32_bf16 v[44:47], a[108:111], a[68:71], v[44:47]
s_add_u32 m0, s53, 16384
s_add_u32 s58, s6, 0
v_mfma_f32_16x16x32_bf16 v[36:39], a[108:111], a[64:67], v[36:39]
s_add_u32 s28, s14, s59
s_addc_u32 s29, s15, 0
s_mov_b32 s30, 43008
s_waitcnt lgkmcnt(0)
v_mfma_f32_16x16x32_bf16 v[0:3], a[128:131], a[80:83], v[0:3]
s_waitcnt vmcnt(12)
ds_read_b64_tr_b16 a[96:97], v230 offset:0
s_mov_b32 s31, 0x20000
v_mfma_f32_16x16x32_bf16 v[8:11], a[128:131], a[84:87], v[8:11]
ds_read_b64_tr_b16 a[98:99], v230 offset:2048
ds_read_b64_tr_b16 a[100:101], v231 offset:0
s_mov_b32 s63, 0xffff0000
v_mfma_f32_16x16x32_bf16 v[16:19], a[128:131], a[88:91], v[16:19]
ds_read_b64_tr_b16 a[102:103], v231 offset:2048
ds_read_b64_tr_b16 a[104:105], v232 offset:0
buffer_load_dwordx4 v220, s[40:43], s58 offen lds
s_lshl_b32 s55, s67, 2
v_mfma_f32_16x16x32_bf16 v[20:23], a[132:135], a[88:91], v[20:23]
buffer_load_dwordx4 v221, s[40:43], s58 offen offset:1024 lds
s_add_u32 s55, s55, s52
v_mfma_f32_16x16x32_bf16 v[12:15], a[132:135], a[84:87], v[12:15]
ds_read_b64_tr_b16 a[106:107], v232 offset:2048
ds_read_b64_tr_b16 a[108:109], v233 offset:0
s_lshr_b32 s56, s55, 4
v_mfma_f32_16x16x32_bf16 v[4:7], a[132:135], a[80:83], v[4:7]
ds_read_b64_tr_b16 a[110:111], v233 offset:2048
s_and_b32 s59, s55, 2
s_lshl_b32 s59, s59, 1
v_mfma_f32_16x16x32_bf16 v[32:35], a[136:139], a[80:83], v[32:35]
buffer_load_dwordx4 v222, s[40:43], s58 offen offset:2048 lds
s_add_u32 s56, s56, s59
s_add_u32 s56, s56, s64
v_mfma_f32_16x16x32_bf16 v[40:43], a[136:139], a[84:87], v[40:43]
buffer_load_dwordx4 v223, s[40:43], s58 offen offset:3072 lds
s_and_b32 s56, s56, 7
v_mfma_f32_16x16x32_bf16 v[48:51], a[136:139], a[88:91], v[48:51]
s_add_u32 m0, s53, 20480
s_add_u32 s58, s6, 28672
s_bfe_u32 s59, s55, 0x20002
v_mfma_f32_16x16x32_bf16 v[52:55], a[140:143], a[88:91], v[52:55]
buffer_load_dwordx4 v220, s[40:43], s58 offen lds
s_and_b32 s60, s55, 1
v_mfma_f32_16x16x32_bf16 v[44:47], a[140:143], a[84:87], v[44:47]
buffer_load_dwordx4 v221, s[40:43], s58 offen offset:1024 lds
s_lshl_b32 s57, s56, 1
v_mfma_f32_16x16x32_bf16 v[36:39], a[140:143], a[80:83], v[36:39]
s_add_u32 s57, s57, s60
s_lshl_b32 s9, s57, 6
s_waitcnt lgkmcnt(0)
v_mfma_f32_16x16x32_bf16 v[64:67], a[96:99], v[128:131], 0
s_waitcnt vmcnt(14)
ds_read_b64_tr_b16 a[128:129], v230 offset:4096
s_lshl_b32 s57, s57, 2
v_mfma_f32_16x16x32_bf16 v[72:75], a[96:99], v[136:139], 0
ds_read_b64_tr_b16 a[130:131], v230 offset:6144
ds_read_b64_tr_b16 a[132:133], v231 offset:4096
s_add_u32 s57, s57, s59
s_lshl_b32 s57, s57, 14
v_mfma_f32_16x16x32_bf16 v[80:83], a[96:99], v[144:147], 0
ds_read_b64_tr_b16 a[134:135], v231 offset:6144
ds_read_b64_tr_b16 a[136:137], v232 offset:4096
s_mul_i32 s60, s59, 14336
v_mfma_f32_16x16x32_bf16 v[84:87], a[100:103], v[144:147], 0
buffer_load_dwordx4 v222, s[40:43], s58 offen offset:2048 lds
s_add_u32 s9, s9, s60
v_mfma_f32_16x16x32_bf16 v[76:79], a[100:103], v[136:139], 0
ds_read_b64_tr_b16 a[138:139], v232 offset:6144
ds_read_b64_tr_b16 a[140:141], v233 offset:4096
v_mfma_f32_16x16x32_bf16 v[68:71], a[100:103], v[128:131], 0
ds_read_b64_tr_b16 a[142:143], v233 offset:6144
s_cmp_eq_u32 s56, 7
s_cselect_b32 s56, 1, 0
s_cmp_ge_u32 s59, 3
s_cselect_b32 s56, 1, s56
v_mfma_f32_16x16x32_bf16 v[96:99], a[104:107], v[128:131], 0
buffer_load_dwordx4 v223, s[40:43], s58 offen offset:3072 lds
v_cvt_pk_bf16_f32 v192, v0, v1
v_mfma_f32_16x16x32_bf16 v[104:107], a[104:107], v[136:139], 0
s_add_u32 m0, s53, 0
s_add_u32 s58, s7, 0
v_cvt_pk_bf16_f32 v193, v2, v3
v_mfma_f32_16x16x32_bf16 v[112:115], a[104:107], v[144:147], 0
buffer_load_dwordx4 v220, s[40:43], s58 offen lds
v_cvt_pk_bf16_f32 v194, v4, v5
v_cvt_pk_bf16_f32 v195, v6, v7
v_mfma_f32_16x16x32_bf16 v[116:119], a[108:111], v[144:147], 0
buffer_load_dwordx4 v221, s[40:43], s58 offen offset:1024 lds
v_mfma_f32_16x16x32_bf16 v[108:111], a[108:111], v[136:139], 0
s_mov_b32 s69, 0
buffer_store_dwordx4 v[192:195], v234, s[44:47], s69 offen sc1
v_cvt_pk_bf16_f32 v196, v8, v9
v_cvt_pk_bf16_f32 v197, v10, v11
v_mfma_f32_16x16x32_bf16 v[100:103], a[108:111], v[128:131], 0
v_cvt_pk_bf16_f32 v198, v12, v13
v_cvt_pk_bf16_f32 v199, v14, v15
s_waitcnt lgkmcnt(0)
v_mfma_f32_16x16x32_bf16 v[64:67], a[128:131], v[160:163], v[64:67]
s_waitcnt vmcnt(15)
ds_read_b64_tr_b16 a[96:97], v230 offset:8192
s_mov_b32 s69, 16384
buffer_store_dwordx4 v[196:199], v234, s[44:47], s69 offen sc1
v_mfma_f32_16x16x32_bf16 v[72:75], a[128:131], v[168:171], v[72:75]
ds_read_b64_tr_b16 a[98:99], v230 offset:10240
ds_read_b64_tr_b16 a[100:101], v231 offset:8192
v_cvt_pk_bf16_f32 v200, v16, v17
v_mfma_f32_16x16x32_bf16 v[80:83], a[128:131], v[176:179], v[80:83]
ds_read_b64_tr_b16 a[102:103], v231 offset:10240
ds_read_b64_tr_b16 a[104:105], v232 offset:8192
v_cvt_pk_bf16_f32 v201, v18, v19
v_cvt_pk_bf16_f32 v202, v20, v21
v_mfma_f32_16x16x32_bf16 v[84:87], a[132:135], v[176:179], v[84:87]
buffer_load_dwordx4 v222, s[40:43], s58 offen offset:2048 lds
v_cvt_pk_bf16_f32 v203, v22, v23
v_mfma_f32_16x16x32_bf16 v[76:79], a[132:135], v[168:171], v[76:79]
ds_read_b64_tr_b16 a[106:107], v232 offset:10240
ds_read_b64_tr_b16 a[108:109], v233 offset:8192
s_mov_b32 s69, 32768
buffer_store_dwordx4 v[200:203], v234, s[44:47], s69 offen sc1
v_mfma_f32_16x16x32_bf16 v[68:71], a[132:135], v[160:163], v[68:71]
ds_read_b64_tr_b16 a[110:111], v233 offset:10240
v_cvt_pk_bf16_f32 v204, v32, v33
v_cvt_pk_bf16_f32 v205, v34, v35
v_mfma_f32_16x16x32_bf16 v[96:99], a[136:139], v[160:163], v[96:99]
v_cvt_pk_bf16_f32 v206, v36, v37
v_cvt_pk_bf16_f32 v207, v38, v39
s_mov_b32 s69, 65536
buffer_store_dwordx4 v[204:207], v234, s[44:47], s69 offen sc1
v_mfma_f32_16x16x32_bf16 v[104:107], a[136:139], v[168:171], v[104:107]
v_cvt_pk_bf16_f32 v192, v40, v41
v_cvt_pk_bf16_f32 v193, v42, v43
v_cvt_pk_bf16_f32 v194, v44, v45
v_mfma_f32_16x16x32_bf16 v[112:115], a[136:139], v[176:179], v[112:115]
v_cvt_pk_bf16_f32 v195, v46, v47
s_mov_b32 s69, 81920
buffer_store_dwordx4 v[192:195], v234, s[44:47], s69 offen sc1
v_mfma_f32_16x16x32_bf16 v[116:119], a[140:143], v[176:179], v[116:119]
v_cvt_pk_bf16_f32 v196, v48, v49
v_cvt_pk_bf16_f32 v197, v50, v51
v_mfma_f32_16x16x32_bf16 v[108:111], a[140:143], v[168:171], v[108:111]
v_cvt_pk_bf16_f32 v198, v52, v53
v_cvt_pk_bf16_f32 v199, v54, v55
v_mfma_f32_16x16x32_bf16 v[100:103], a[140:143], v[160:163], v[100:103]
s_mov_b32 s69, 98304
buffer_store_dwordx4 v[196:199], v234, s[44:47], s69 offen sc1
s_waitcnt lgkmcnt(0)
v_mfma_f32_16x16x32_bf16 v[64:67], a[96:99], a[0:3], v[64:67]
s_waitcnt vmcnt(17)
ds_read_b64_tr_b16 a[128:129], v230 offset:12288
v_mfma_f32_16x16x32_bf16 v[72:75], a[96:99], a[4:7], v[72:75]
ds_read_b64_tr_b16 a[130:131], v230 offset:14336
ds_read_b64_tr_b16 a[132:133], v231 offset:12288
v_mfma_f32_16x16x32_bf16 v[80:83], a[96:99], a[8:11], v[80:83]
ds_read_b64_tr_b16 a[134:135], v231 offset:14336
ds_read_b64_tr_b16 a[136:137], v232 offset:12288
v_mfma_f32_16x16x32_bf16 v[84:87], a[100:103], a[8:11], v[84:87]
ds_read_b64_tr_b16 a[138:139], v232 offset:14336
v_mfma_f32_16x16x32_bf16 v[76:79], a[100:103], a[4:7], v[76:79]
ds_read_b64_tr_b16 a[140:141], v233 offset:12288
buffer_load_dwordx4 v223, s[40:43], s58 offen offset:3072 lds
v_mfma_f32_16x16x32_bf16 v[68:71], a[100:103], a[0:3], v[68:71]
ds_read_b64_tr_b16 a[142:143], v233 offset:14336
s_add_u32 m0, s53, 4096
v_mfma_f32_16x16x32_bf16 v[96:99], a[104:107], a[0:3], v[96:99]
s_add_u32 s58, s7, 28672
v_mfma_f32_16x16x32_bf16 v[104:107], a[104:107], a[4:7], v[104:107]
buffer_load_dwordx4 v220, s[40:43], s58 offen lds
v_mfma_f32_16x16x32_bf16 v[112:115], a[104:107], a[8:11], v[112:115]
v_mfma_f32_16x16x32_bf16 v[116:119], a[108:111], a[8:11], v[116:119]
v_mfma_f32_16x16x32_bf16 v[108:111], a[108:111], a[4:7], v[108:111]
buffer_load_dwordx4 v221, s[40:43], s58 offen offset:1024 lds
v_mfma_f32_16x16x32_bf16 v[100:103], a[108:111], a[0:3], v[100:103]
s_waitcnt lgkmcnt(0)
v_mfma_f32_16x16x32_bf16 v[64:67], a[128:131], a[16:19], v[64:67]
s_waitcnt vmcnt(12)
ds_read_b64_tr_b16 a[96:97], v230 offset:16384
v_mfma_f32_16x16x32_bf16 v[72:75], a[128:131], a[20:23], v[72:75]
ds_read_b64_tr_b16 a[98:99], v230 offset:18432
ds_read_b64_tr_b16 a[100:101], v231 offset:16384
v_mfma_f32_16x16x32_bf16 v[80:83], a[128:131], a[24:27], v[80:83]
ds_read_b64_tr_b16 a[102:103], v231 offset:18432
ds_read_b64_tr_b16 a[104:105], v230 offset:20480
v_mfma_f32_16x16x32_bf16 v[84:87], a[132:135], a[24:27], v[84:87]
buffer_load_dwordx4 v222, s[40:43], s58 offen offset:2048 lds
v_mfma_f32_16x16x32_bf16 v[76:79], a[132:135], a[20:23], v[76:79]
ds_read_b64_tr_b16 a[106:107], v230 offset:22528
ds_read_b64_tr_b16 a[108:109], v231 offset:20480
v_mfma_f32_16x16x32_bf16 v[68:71], a[132:135], a[16:19], v[68:71]
ds_read_b64_tr_b16 a[110:111], v231 offset:22528
v_mfma_f32_16x16x32_bf16 v[96:99], a[136:139], a[16:19], v[96:99]
buffer_load_dwordx4 v223, s[40:43], s58 offen offset:3072 lds
v_mfma_f32_16x16x32_bf16 v[104:107], a[136:139], a[20:23], v[104:107]
v_mfma_f32_16x16x32_bf16 v[112:115], a[136:139], a[24:27], v[112:115]
v_mfma_f32_16x16x32_bf16 v[116:119], a[140:143], a[24:27], v[116:119]
v_mfma_f32_16x16x32_bf16 v[108:111], a[140:143], a[20:23], v[108:111]
v_mfma_f32_16x16x32_bf16 v[100:103], a[140:143], a[16:19], v[100:103]
s_waitcnt lgkmcnt(0)
v_mfma_f32_16x16x32_bf16 v[64:67], a[96:99], a[32:35], v[64:67]
s_waitcnt vmcnt(0)
v_mfma_f32_16x16x32_bf16 v[72:75], a[96:99], a[36:39], v[72:75]
ds_read_b64_tr_b16 a[128:129], v230 offset:0
ds_read_b64_tr_b16 a[130:131], v230 offset:2048
v_mfma_f32_16x16x32_bf16 v[80:83], a[96:99], a[40:43], v[80:83]
ds_read_b64_tr_b16 a[132:133], v231 offset:0
ds_read_b64_tr_b16 a[134:135], v231 offset:2048
v_mfma_f32_16x16x32_bf16 v[84:87], a[100:103], a[40:43], v[84:87]
ds_read_b64_tr_b16 a[136:137], v230 offset:4096
ds_read_b64_tr_b16 a[138:139], v230 offset:6144
v_mfma_f32_16x16x32_bf16 v[76:79], a[100:103], a[36:39], v[76:79]
ds_read_b64_tr_b16 a[140:141], v231 offset:4096
v_mfma_f32_16x16x32_bf16 v[68:71], a[100:103], a[32:35], v[68:71]
ds_read_b64_tr_b16 a[142:143], v231 offset:6144
v_mfma_f32_16x16x32_bf16 v[64:67], a[104:107], a[48:51], v[64:67]
v_mfma_f32_16x16x32_bf16 v[72:75], a[104:107], a[52:55], v[72:75]
v_mfma_f32_16x16x32_bf16 v[80:83], a[104:107], a[56:59], v[80:83]
v_mfma_f32_16x16x32_bf16 v[84:87], a[108:111], a[56:59], v[84:87]
v_mfma_f32_16x16x32_bf16 v[76:79], a[108:111], a[52:55], v[76:79]
v_mfma_f32_16x16x32_bf16 v[68:71], a[108:111], a[48:51], v[68:71]
s_waitcnt lgkmcnt(0)
v_mfma_f32_16x16x32_bf16 v[64:67], a[128:131], a[64:67], v[64:67]
ds_read_b64_tr_b16 a[96:97], v232 offset:16384
ds_read_b64_tr_b16 a[98:99], v232 offset:18432
v_mfma_f32_16x16x32_bf16 v[72:75], a[128:131], a[68:71], v[72:75]
ds_read_b64_tr_b16 a[100:101], v233 offset:16384
ds_read_b64_tr_b16 a[102:103], v233 offset:18432
v_mfma_f32_16x16x32_bf16 v[80:83], a[128:131], a[72:75], v[80:83]
ds_read_b64_tr_b16 a[104:105], v232 offset:20480
v_mfma_f32_16x16x32_bf16 v[84:87], a[132:135], a[72:75], v[84:87]
ds_read_b64_tr_b16 a[106:107], v232 offset:22528
v_mfma_f32_16x16x32_bf16 v[76:79], a[132:135], a[68:71], v[76:79]
ds_read_b64_tr_b16 a[108:109], v233 offset:20480
v_mfma_f32_16x16x32_bf16 v[68:71], a[132:135], a[64:67], v[68:71]
ds_read_b64_tr_b16 a[110:111], v233 offset:22528
v_mfma_f32_16x16x32_bf16 v[64:67], a[136:139], a[80:83], v[64:67]
buffer_store_dword v209, v208, s[72:75], 0 offen offset:0 sc1
v_mfma_f32_16x16x32_bf16 v[72:75], a[136:139], a[84:87], v[72:75]
v_mfma_f32_16x16x32_bf16 v[80:83], a[136:139], a[88:91], v[80:83]
v_mfma_f32_16x16x32_bf16 v[84:87], a[140:143], a[88:91], v[84:87]
v_mfma_f32_16x16x32_bf16 v[76:79], a[140:143], a[84:87], v[76:79]
v_mfma_f32_16x16x32_bf16 v[68:71], a[140:143], a[80:83], v[68:71]
s_waitcnt lgkmcnt(0)
v_mfma_f32_16x16x32_bf16 v[96:99], a[96:99], a[32:35], v[96:99]
ds_read_b64_tr_b16 a[128:129], v232 offset:0
ds_read_b64_tr_b16 a[130:131], v232 offset:2048
v_mfma_f32_16x16x32_bf16 v[104:107], a[96:99], a[36:39], v[104:107]
ds_read_b64_tr_b16 a[132:133], v233 offset:0
ds_read_b64_tr_b16 a[134:135], v233 offset:2048
v_mfma_f32_16x16x32_bf16 v[112:115], a[96:99], a[40:43], v[112:115]
ds_read_b64_tr_b16 a[136:137], v232 offset:4096
v_mfma_f32_16x16x32_bf16 v[116:119], a[100:103], a[40:43], v[116:119]
ds_read_b64_tr_b16 a[138:139], v232 offset:6144
v_mfma_f32_16x16x32_bf16 v[108:111], a[100:103], a[36:39], v[108:111]
ds_read_b64_tr_b16 a[140:141], v233 offset:4096
v_cvt_pk_bf16_f32 v192, v64, v65
v_cvt_pk_bf16_f32 v193, v66, v67
v_mfma_f32_16x16x32_bf16 v[100:103], a[100:103], a[32:35], v[100:103]
ds_read_b64_tr_b16 a[142:143], v233 offset:6144
v_cvt_pk_bf16_f32 v194, v68, v69
v_cvt_pk_bf16_f32 v195, v70, v71
v_mfma_f32_16x16x32_bf16 v[96:99], a[104:107], a[48:51], v[96:99]
s_mov_b32 s69, 0
buffer_store_dwordx4 v[192:195], v234, s[48:51], s69 offen sc1
v_cvt_pk_bf16_f32 v196, v72, v73
v_cvt_pk_bf16_f32 v197, v74, v75
v_cvt_pk_bf16_f32 v198, v76, v77
v_mfma_f32_16x16x32_bf16 v[104:107], a[104:107], a[52:55], v[104:107]
v_cvt_pk_bf16_f32 v199, v78, v79
s_mov_b32 s69, 16384
buffer_store_dwordx4 v[196:199], v234, s[48:51], s69 offen sc1
v_mfma_f32_16x16x32_bf16 v[112:115], a[104:107], a[56:59], v[112:115]
v_cvt_pk_bf16_f32 v200, v80, v81
v_cvt_pk_bf16_f32 v201, v82, v83
v_cvt_pk_bf16_f32 v202, v84, v85
v_mfma_f32_16x16x32_bf16 v[116:119], a[108:111], a[56:59], v[116:119]
v_cvt_pk_bf16_f32 v203, v86, v87
v_mfma_f32_16x16x32_bf16 v[108:111], a[108:111], a[52:55], v[108:111]
s_mov_b32 s69, 32768
buffer_store_dwordx4 v[200:203], v234, s[48:51], s69 offen sc1
v_mfma_f32_16x16x32_bf16 v[100:103], a[108:111], a[48:51], v[100:103]
s_waitcnt lgkmcnt(0)
v_mfma_f32_16x16x32_bf16 v[96:99], a[128:131], a[64:67], v[96:99]
v_mfma_f32_16x16x32_bf16 v[104:107], a[128:131], a[68:71], v[104:107]
v_mfma_f32_16x16x32_bf16 v[112:115], a[128:131], a[72:75], v[112:115]
v_mfma_f32_16x16x32_bf16 v[116:119], a[132:135], a[72:75], v[116:119]
v_mfma_f32_16x16x32_bf16 v[108:111], a[132:135], a[68:71], v[108:111]
v_mfma_f32_16x16x32_bf16 v[100:103], a[132:135], a[64:67], v[100:103]
v_mfma_f32_16x16x32_bf16 v[96:99], a[136:139], a[80:83], v[96:99]
v_mfma_f32_16x16x32_bf16 v[104:107], a[136:139], a[84:87], v[104:107]
buffer_load_dword v211, v210, s[72:75], 0 offen sc1
v_mfma_f32_16x16x32_bf16 v[112:115], a[136:139], a[88:91], v[112:115]
v_mfma_f32_16x16x32_bf16 v[116:119], a[140:143], a[88:91], v[116:119]
v_mfma_f32_16x16x32_bf16 v[108:111], a[140:143], a[84:87], v[108:111]
v_mfma_f32_16x16x32_bf16 v[100:103], a[140:143], a[80:83], v[100:103]
s_nop 1
v_cvt_pk_bf16_f32 v192, v96, v97
v_cvt_pk_bf16_f32 v193, v98, v99
s_nop 3
v_cvt_pk_bf16_f32 v194, v100, v101
v_cvt_pk_bf16_f32 v195, v102, v103
s_mov_b32 s69, 65536
buffer_store_dwordx4 v[192:195], v234, s[48:51], s69 offen sc1
v_cvt_pk_bf16_f32 v196, v104, v105
v_cvt_pk_bf16_f32 v197, v106, v107
v_cvt_pk_bf16_f32 v198, v108, v109
v_cvt_pk_bf16_f32 v199, v110, v111
s_mov_b32 s69, 81920
buffer_store_dwordx4 v[196:199], v234, s[48:51], s69 offen sc1
v_cvt_pk_bf16_f32 v200, v112, v113
v_cvt_pk_bf16_f32 v201, v114, v115
v_cvt_pk_bf16_f32 v202, v116, v117
v_cvt_pk_bf16_f32 v203, v118, v119
s_mov_b32 s69, 98304
buffer_store_dwordx4 v[200:203], v234, s[48:51], s69 offen sc1
s_cmp_eq_u32 s56, 1
s_cbranch_scc1 L_rb3
s_waitcnt vmcnt(3)
v_cmp_eq_u32 vcc, 1, v211
s_nop 1
s_cmp_eq_u64 vcc, -1
s_cbranch_scc0 L_rb3
buffer_load_dwordx4 v[128:131], v212, s[24:27], s57 offen sc1
buffer_load_dwordx4 v[132:135], v212, s[24:27], s57 offen offset:1024 sc1
buffer_load_dwordx4 v[136:139], v212, s[24:27], s57 offen offset:2048 sc1
buffer_load_dwordx4 v[140:143], v212, s[24:27], s57 offen offset:3072 sc1
buffer_load_dwordx4 v[144:147], v213, s[24:27], s57 offen sc1
buffer_load_dwordx4 v[148:151], v213, s[24:27], s57 offen offset:1024 sc1
s_waitcnt vmcnt(9)
buffer_store_dword v209, v208, s[72:75], 0 offen offset:64 sc1
s_waitcnt vmcnt(7)
buffer_store_dword v209, v208, s[72:75], 0 offen offset:128 sc1
s_barrier
s_cmp_eq_u32 s52, 0
s_cselect_b32 s22, 4, 0
s_mov_b64 exec, 1
buffer_atomic_add v218, v217, s[20:23], 0 offen sc0
s_mov_b64 exec, -1
s_mov_b32 s22, 4
buffer_load_dwordx4 v[152:155], v213, s[24:27], s57 offen offset:2048 sc1
buffer_load_dwordx4 v[156:159], v213, s[24:27], s57 offen offset:3072 sc1
buffer_load_dwordx4 v[160:163], v214, s[24:27], s57 offen sc1
buffer_load_dwordx4 v[164:167], v214, s[24:27], s57 offen offset:1024 sc1
buffer_load_dwordx4 v[168:171], v214, s[24:27], s57 offen offset:2048 sc1
buffer_load_dwordx4 v[172:175], v214, s[24:27], s57 offen offset:3072 sc1
buffer_load_dwordx4 v[176:179], v215, s[24:27], s57 offen sc1
buffer_load_dwordx4 v[180:183], v215, s[24:27], s57 offen offset:1024 sc1
buffer_load_dwordx4 v[184:187], v215, s[24:27], s57 offen offset:2048 sc1
buffer_load_dwordx4 v[188:191], v215, s[24:27], s57 offen offset:3072 sc1
s_branch L_rsum3
L_rb3:
s_waitcnt vmcnt(3)
buffer_store_dword v209, v208, s[72:75], 0 offen offset:64 sc1
s_waitcnt vmcnt(1)
buffer_store_dword v209, v208, s[72:75], 0 offen offset:128 sc1
s_barrier
s_cmp_eq_u32 s52, 0
s_cselect_b32 s22, 4, 0
s_mov_b64 exec, 1
buffer_atomic_add v218, v217, s[20:23], 0 offen sc0
s_mov_b64 exec, -1
s_mov_b32 s22, 4
s_cmp_eq_u32 s56, 1
s_cbranch_scc1 L_rfin3
s_mov_b32 s62, 200
buffer_load_dword v24, v210, s[72:75], 0 offen sc1
L_rl3:
s_waitcnt vmcnt(0)
v_cmp_eq_u32 vcc, 1, v24
s_nop 1
s_cmp_eq_u64 vcc, -1
s_cbranch_scc1 L_rgo3
buffer_load_dword v24, v210, s[72:75], 0 offen sc1
s_sub_u32 s62, s62, 1
s_cmp_lg_u32 s62, 0
s_cbranch_scc1 L_rl3
s_lshl_b32 s59, 0x10000, s67
v_mov_b32 v219, s59
s_mov_b64 exec, 1
buffer_atomic_or v219, v217, s[20:23], 0 offen sc0
s_mov_b64 exec, -1
s_waitcnt vmcnt(0)
v_readfirstlane_b32 s59, v219
s_nop 1
s_and_b32 s59, s59, 0xff
s_cmp_eq_u32 s59, 16
s_cbranch_scc0 L_rfin3
L_rgo3:
buffer_load_dwordx4 v[128:131], v212, s[24:27], s57 offen sc1
buffer_load_dwordx4 v[132:135], v212, s[24:27], s57 offen offset:1024 sc1
buffer_load_dwordx4 v[136:139], v212, s[24:27], s57 offen offset:2048 sc1
buffer_load_dwordx4 v[140:143], v212, s[24:27], s57 offen offset:3072 sc1
buffer_load_dwordx4 v[144:147], v213, s[24:27], s57 offen sc1
buffer_load_dwordx4 v[148:151], v213, s[24:27], s57 offen offset:1024 sc1
buffer_load_dwordx4 v[152:155], v213, s[24:27], s57 offen offset:2048 sc1
buffer_load_dwordx4 v[156:159], v213, s[24:27], s57 offen offset:3072 sc1
buffer_load_dwordx4 v[160:163], v214, s[24:27], s57 offen sc1
buffer_load_dwordx4 v[164:167], v214, s[24:27], s57 offen offset:1024 sc1
buffer_load_dwordx4 v[168:171], v214, s[24:27], s57 offen offset:2048 sc1
buffer_load_dwordx4 v[172:175], v214, s[24:27], s57 offen offset:3072 sc1
buffer_load_dwordx4 v[176:179], v215, s[24:27], s57 offen sc1
buffer_load_dwordx4 v[180:183], v215, s[24:27], s57 offen offset:1024 sc1
buffer_load_dwordx4 v[184:187], v215, s[24:27], s57 offen offset:2048 sc1
buffer_load_dwordx4 v[188:191], v215, s[24:27], s57 offen offset:3072 sc1
L_rsum3:
s_waitcnt vmcnt(15)
v_mfma_f32_16x16x32_bf16 v[0:3], a[224:227], v[128:131], 0
v_mfma_f32_16x16x32_bf16 v[4:7], a[228:231], v[128:131], 0
s_waitcnt vmcnt(14)
v_mfma_f32_16x16x32_bf16 v[0:3], a[224:227], v[132:135], v[0:3]
v_mfma_f32_16x16x32_bf16 v[4:7], a[228:231], v[132:135], v[4:7]
s_waitcnt vmcnt(13)
v_mfma_f32_16x16x32_bf16 v[0:3], a[224:227], v[136:139], v[0:3]
v_mfma_f32_16x16x32_bf16 v[4:7], a[228:231], v[136:139], v[4:7]
s_waitcnt vmcnt(12)
v_mfma_f32_16x16x32_bf16 v[0:3], a[224:227], v[140:143], v[0:3]
v_mfma_f32_16x16x32_bf16 v[4:7], a[228:231], v[140:143], v[4:7]
s_waitcnt vmcnt(11)
v_mfma_f32_16x16x32_bf16 v[0:3], a[224:227], v[144:147], v[0:3]
v_mfma_f32_16x16x32_bf16 v[4:7], a[228:231], v[144:147], v[4:7]
s_waitcnt vmcnt(10)
v_mfma_f32_16x16x32_bf16 v[0:3], a[224:227], v[148:151], v[0:3]
v_mfma_f32_16x16x32_bf16 v[4:7], a[228:231], v[148:151], v[4:7]
s_waitcnt vmcnt(9)
v_mfma_f32_16x16x32_bf16 v[0:3], a[224:227], v[152:155], v[0:3]
v_mfma_f32_16x16x32_bf16 v[4:7], a[228:231], v[152:155], v[4:7]
s_waitcnt vmcnt(8)
v_mfma_f32_16x16x32_bf16 v[0:3], a[224:227], v[156:159], v[0:3]
v_mfma_f32_16x16x32_bf16 v[4:7], a[228:231], v[156:159], v[4:7]
s_waitcnt vmcnt(7)
v_mfma_f32_16x16x32_bf16 v[0:3], a[224:227], v[160:163], v[0:3]
v_mfma_f32_16x16x32_bf16 v[4:7], a[228:231], v[160:163], v[4:7]
s_waitcnt vmcnt(6)
v_mfma_f32_16x16x32_bf16 v[0:3], a[224:227], v[164:167], v[0:3]
v_mfma_f32_16x16x32_bf16 v[4:7], a[228:231], v[164:167], v[4:7]
s_waitcnt vmcnt(5)
v_mfma_f32_16x16x32_bf16 v[0:3], a[224:227], v[168:171], v[0:3]
v_mfma_f32_16x16x32_bf16 v[4:7], a[228:231], v[168:171], v[4:7]
s_waitcnt vmcnt(4)
v_mfma_f32_16x16x32_bf16 v[0:3], a[224:227], v[172:175], v[0:3]
v_mfma_f32_16x16x32_bf16 v[4:7], a[228:231], v[172:175], v[4:7]
s_waitcnt vmcnt(3)
v_mfma_f32_16x16x32_bf16 v[0:3], a[224:227], v[176:179], v[0:3]
v_mfma_f32_16x16x32_bf16 v[4:7], a[228:231], v[176:179], v[4:7]
s_waitcnt vmcnt(2)
v_mfma_f32_16x16x32_bf16 v[0:3], a[224:227], v[180:183], v[0:3]
v_mfma_f32_16x16x32_bf16 v[4:7], a[228:231], v[180:183], v[4:7]
s_waitcnt vmcnt(1)
v_mfma_f32_16x16x32_bf16 v[0:3], a[224:227], v[184:187], v[0:3]
v_mfma_f32_16x16x32_bf16 v[4:7], a[228:231], v[184:187], v[4:7]
s_waitcnt vmcnt(0)
v_mfma_f32_16x16x32_bf16 v[0:3], a[224:227], v[188:191], v[0:3]
v_mfma_f32_16x16x32_bf16 v[4:7], a[228:231], v[188:191], v[4:7]
s_nop 6
v_cvt_pk_bf16_f32 v16, v0, v1
v_cvt_pk_bf16_f32 v17, v2, v3
v_cvt_pk_bf16_f32 v18, v4, v5
v_cvt_pk_bf16_f32 v19, v6, v7
buffer_store_dwordx2 v[16:17], v216, s[28:31], s9 offen
buffer_store_dwordx2 v[18:19], v216, s[28:31], s9 offen offset:32
L_rfin3:
s_cmp_lg_u32 s52, 0
s_cbranch_scc1 L_rd3
s_waitcnt vmcnt(0)
v_readfirstlane_b32 s59, v218
s_nop 1
s_and_b32 s60, s59, 0xff
s_cmp_lg_u32 s60, 15
s_cbranch_scc1 L_rd3
s_lshr_b32 s60, s59, 16
s_cmp_eq_u32 s60, 0
s_cbranch_scc1 L_rd3
s_ff1_i32_b32 s61, s60
s_bfe_u32 s62, s59, 0x20008
s_lshl_b32 s55, s61, 2
s_add_u32 s55, s55, s62
s_add_u32 s59, s59, 0x100
s_cmp_eq_u32 s62, 3
s_cbranch_scc0 L_rk3
s_and_b32 s59, s59, 0xffff00ff
s_add_u32 s61, s61, 16
s_bitset0_b32 s59, s61
L_rk3:
v_mov_b32 v218, s59
s_lshr_b32 s56, s55, 4
s_and_b32 s59, s55, 2
s_lshl_b32 s59, s59, 1
s_add_u32 s56, s56, s59
s_add_u32 s56, s56, s64
s_and_b32 s56, s56, 7
s_bfe_u32 s59, s55, 0x20002
s_and_b32 s60, s55, 1
s_lshl_b32 s57, s56, 1
s_add_u32 s57, s57, s60
s_lshl_b32 s9, s57, 6
s_lshl_b32 s57, s57, 2
s_add_u32 s57, s57, s59
s_lshl_b32 s57, s57, 14
s_mul_i32 s60, s59, 14336
s_add_u32 s9, s9, s60
s_cmp_eq_u32 s56, 7
s_cselect_b32 s56, 1, 0
s_cmp_ge_u32 s59, 3
s_cselect_b32 s56, 1, s56
s_cmp_eq_u32 s56, 1
s_cbranch_scc1 L_rfin3
s_branch L_rgo3
L_rd3:
s_endpgm
L_fb3:
s_waitcnt vmcnt(0) lgkmcnt(0)
s_nop 15
s_barrier
v_accvgpr_write_b32 a244, v242
v_accvgpr_write_b32 a245, v243
v_accvgpr_write_b32 a246, v244
v_accvgpr_read_b32 v0, a248
s_mov_b32 s71, 0
s_nop 3
s_branch L_top
.section .rodata,"a"
.p2align 6
.amdhsa_kernel standalone__gqa_block_cached__near_ridge_kernel
  .amdhsa_next_free_vgpr 512
  .amdhsa_next_free_sgpr 102
  .amdhsa_accum_offset 256
  .amdhsa_group_segment_fixed_size 0
  .amdhsa_kernarg_size 64
  .amdhsa_user_sgpr_count 2
  .amdhsa_user_sgpr_kernarg_segment_ptr 1
  .amdhsa_system_sgpr_workgroup_id_x 1
.end_amdhsa_kernel
```
